```python
import torch

def _softmax(x, axis=-1):
    return torch.softmax(x, dim=axis)
def _gelu(x):
    return torch.nn.functional.gelu(x, approximate="tanh")
def _silu(x):
    return torch.nn.functional.silu(x)
def _sigmoid(x):
    return torch.sigmoid(x)
def _layernorm(x, axis=-1, eps=1e-5):
    m = x.mean(dim=axis, keepdim=True)
    v = x.var(dim=axis, keepdim=True, unbiased=False)
    return (x - m) / torch.sqrt(v + eps)
def _scatter_add(tgt, idx, src, axis=0):
    return tgt.clone().index_add_(axis, idx, src)
def _segment_sum(src, seg, n):
    out = torch.zeros((n,) + src.shape[1:], dtype=src.dtype)
    return out.index_add_(0, seg, src)
def _pad(x, pw):
    flat = tuple(v for pair in reversed(pw) for v in pair)
    return torch.nn.functional.pad(x, flat)

kernel_name = 'parallel_sum__compressed_kv_cla__dense_activation_silu__prompt'

def setup_inputs():

    _w = (lambda a: (lambda t: t.to(torch.bfloat16) if t.is_floating_point() else t)(torch.as_tensor(a)))
    def _A_setup():
        B, H, Sq, Sk, D, M = 1, 16, 2048, 2048, 256, 448
        Dc = 4 * D
        return {
            "x": _w((lambda *s: torch.randn(*s, dtype=torch.bfloat16) * 0.05)(B, Sq, M)),
            "c_kv": _w((lambda *s: torch.randn(*s, dtype=torch.bfloat16) * 0.4)(B, Sk, Dc)),
            "w_q": _w((lambda *s: torch.randn(*s, dtype=torch.bfloat16) * 3.2)(M, H, D) * (M ** -0.5)),
            "w_uk": _w((lambda *s: torch.randn(*s, dtype=torch.bfloat16) * 3.2)(Dc, H, D) * (Dc ** -0.5)),
            "w_uv": _w((lambda *s: torch.randn(*s, dtype=torch.bfloat16) * 0.4)(Dc, H, D) * (Dc ** -0.5)),
            "w_o": _w((lambda *s: torch.randn(*s, dtype=torch.bfloat16) * 0.4)(H, D, M) * ((H * D) ** -0.5)),
        }
    _A_in = _A_setup()

    def _B_setup():
        B, S, D, F = 1, 2048, 448, 1792
        return {
            "x": _w((lambda *s: torch.randn(*s, dtype=torch.bfloat16) * 0.05)(B, S, D)),
            "w1": _w((lambda *s: torch.randn(*s, dtype=torch.bfloat16) * 0.8)(D, F) * (D ** -0.5)),
            "w2": _w((lambda *s: torch.randn(*s, dtype=torch.bfloat16) * 0.1)(F, D) * (F ** -0.5)),
        }
    _B_in = _B_setup()

    return {
        "A_x": _A_in["x"],
        "A_c_kv": _A_in["c_kv"],
        "A_w_q": _A_in["w_q"],
        "A_w_uk": _A_in["w_uk"],
        "A_w_uv": _A_in["w_uv"],
        "A_w_o": _A_in["w_o"],
        "B_x": _B_in["x"],
        "B_w1": _B_in["w1"],
        "B_w2": _B_in["w2"],
    }

def reference(A_x, A_c_kv, A_w_q, A_w_uk, A_w_uv, A_w_o, B_x, B_w1, B_w2):
    def _A_ref(x, c_kv, w_q, w_uk, w_uv, w_o):
        B, Sq, M = x.shape[0], x.shape[1], x.shape[2]
        Sk = c_kv.shape[1]
        H, D = w_q.shape[1], w_q.shape[2]
        q = torch.einsum("bqm,mhd->bhqd", x, w_q)
        k = torch.einsum("bkc,chd->bhkd", c_kv, w_uk)
        v = torch.einsum("bkc,chd->bhkd", c_kv, w_uv)
        scores = torch.einsum("bhqd,bhkd->bhqk", q, k) * (D ** -0.5)
        off = Sk - Sq
        qi = torch.arange(Sq)[:, None]
        kj = torch.arange(Sk)[None, :]
        cmask = kj <= (qi + off)
        scores = torch.where(cmask[None, None], scores, -1e9)
        p = _softmax(scores, axis=-1)
        ctx = torch.einsum("bhqk,bhkd->bhqd", p, v)
        return torch.einsum("bhqd,hdm->bqm", ctx, w_o)

    def _B_ref(x, w1, w2):
        h = torch.einsum("bsd,df->bsf", x, w1)
        h = _silu(h)
        out = torch.einsum("bsf,fd->bsd", h, w2)
        return out

    x = A_x
    xn = _layernorm(x, axis=-1)
    return x + _A_ref(xn, A_c_kv, A_w_q, A_w_uk, A_w_uv, A_w_o) + _B_ref(xn, B_w1, B_w2)
```

```asm
; @launch kernel=k1_kernel grid=(256,1,1) block=(256,1,1) lds=163840
.amdgcn_target "amdgcn-amd-amdhsa--gfx950"
.text
.p2align 8
.globl k1_kernel
.type k1_kernel,@function
k1_kernel:
    s_cmp_ge_u32 s2, 256
    s_cbranch_scc1 L_k2_end
    s_load_dwordx4 s[20:23], s[0:1], 0
    s_load_dwordx4 s[24:27], s[0:1], 16
    s_load_dwordx2 s[28:29], s[0:1], 32
    s_load_dwordx2 s[30:31], s[0:1], 56
    s_load_dwordx4 s[32:35], s[0:1], 80
    s_getpc_b64 s[6:7]
    v_lshlrev_b32 v3, 6, v0
    v_min_u32 v3, L_k1_mid-k1_kernel, v3
    global_load_dword v255, v3, s[6:7]
    v_and_b32 v1, 63, v0
    v_lshrrev_b32 v2, 6, v0
    s_and_b32 s3, s2, 7
    v_readfirstlane_b32 s36, v2
    s_lshr_b32 s4, s2, 3
    s_and_b32 s5, s4, 7
    s_lshr_b32 s4, s4, 3
    s_and_b32 s6, s4, 1
    s_lshl_b32 s3, s3, 1
    s_add_u32 s3, s3, s6
    s_lshr_b32 s4, s4, 1
    s_lshr_b32 s37, s36, 1
    s_and_b32 s38, s36, 1
    s_mov_b32 s45, 0
    v_lshrrev_b32 v24, 3, v1
    s_lshl_b32 s54, s38, 10
    s_lshl_b32 s55, s37, 8
    s_add_u32 s54, s54, s55
    v_add_u32 v24, s54, v24
    v_lshlrev_b32 v24, 11, v24
    v_lshrrev_b32 v25, 4, v1
    v_and_b32 v26, 7, v1
    v_xor_b32 v25, v25, v26
    v_lshl_add_u32 v2, v25, 4, v24
    v_xor_b32 v24, 64, v2
    v_add_u32 v3, 15360, v24
    v_add_u32 v4, 30720, v2
    v_add_u32 v5, 46080, v24
    v_add_u32 v6, 1048576, v2
    v_add_u32 v7, 1063936, v24
    v_add_u32 v8, 1079296, v2
    v_add_u32 v9, 1094656, v24
    s_mov_b32 s68, 8192
    v_lshrrev_b32 v24, 5, v1
    v_lshlrev_b32 v25, 2, v24
    v_and_b32 v26, 31, v1
    v_xor_b32 v25, v25, v26
    v_lshlrev_b32 v25, 4, v25
    v_xor_b32 v26, 128, v25
    s_lshl_b32 s54, s36, 3
    v_add_u32 v24, s54, v24
    v_mul_lo_u32 v24, v24, s68
    v_add_u32 v10, v24, v25
    v_add_u32 v26, v24, v26
    s_mul_i32 s56, s68, 2
    s_sub_u32 s56, s56, 1024
    v_add_u32 v11, s56, v26
    s_mul_i32 s56, s68, 4
    s_sub_u32 s56, s56, 2048
    v_add_u32 v12, s56, v10
    s_mul_i32 s56, s68, 6
    s_sub_u32 s56, s56, 3072
    v_add_u32 v13, s56, v26
    s_add_u32 s54, s45, 4
    s_lshl_b32 s67, s38, s54
    v_xor_b32 v10, s67, v10
    v_xor_b32 v11, s67, v11
    v_xor_b32 v12, s67, v12
    v_xor_b32 v13, s67, v13
    s_lshl_b32 s66, s36, 13
    s_add_u32 s41, s66, 65536
    s_add_u32 s53, s41, 98304
    s_lshl_b32 s65, s36, 12
    s_mov_b32 s42, s65
    s_and_b32 s39, s2, 0
    s_lshl_b32 s40, s39, 20
    s_lshl_b32 s39, s39, 8
    s_mov_b32 s52, 2047
    s_mov_b32 s48, 262144
    s_mov_b32 s64, 128
    s_lshl_b32 s6, s5, 16
    s_lshl_b32 s55, s3, 9
    s_sub_u32 s10, 4194304, s6
    s_mov_b32 s11, 0x00020000
    s_sub_u32 s14, 8388608, s55
    s_mov_b32 s15, 0x00020000
    v_lshrrev_b32 v28, 5, v1
    s_lshl_b32 s56, s2, 3
    s_lshl_b32 s7, s36, 1
    s_add_u32 s56, s56, s7
    v_add_u32 v28, s56, v28
    v_mul_u32_u24 v24, 896, v28
    v_and_b32 v25, 31, v1
    v_lshlrev_b32 v26, 4, v25
    v_add_u32 v253, v24, v26
    v_add_u32 v254, 512, v253
    v_cmp_gt_u32 vcc, 24, v25
    v_mov_b32 v27, 0x7ffffff0
    s_nop 0
    v_cndmask_b32 v254, v27, v254, vcc
    s_waitcnt lgkmcnt(0)
    s_add_u32 s8, s22, s6
    s_addc_u32 s9, s23, 0
    s_cmp_eq_u32 s4, 0
    s_cselect_b32 s6, s26, s28
    s_cselect_b32 s7, s27, s29
    s_add_u32 s12, s6, s55
    s_addc_u32 s13, s7, 0
    s_mov_b32 s16, s20
    s_mov_b32 s17, s21
    s_mov_b32 s18, 1835008
    s_mov_b32 s19, 0x00020000
    buffer_load_dwordx4 v[224:227], v253, s[16:19], 0 offen
    buffer_load_dwordx4 v[228:231], v254, s[16:19], 0 offen
    s_mov_b32 m0, s41
    s_nop 0
    buffer_load_dwordx4 v2, s[8:11], s39 offen offset:0 lds
    buffer_load_dwordx4 v3, s[8:11], s39 offen offset:1024 lds
    buffer_load_dwordx4 v4, s[8:11], s39 offen offset:2048 lds
    buffer_load_dwordx4 v5, s[8:11], s39 offen offset:3072 lds
    s_mov_b32 m0, s42
    s_nop 0
    buffer_load_dwordx4 v10, s[12:15], s40 offen offset:0 lds
    buffer_load_dwordx4 v11, s[12:15], s40 offen offset:1024 lds
    buffer_load_dwordx4 v12, s[12:15], s40 offen offset:2048 lds
    buffer_load_dwordx4 v13, s[12:15], s40 offen offset:3072 lds
    s_add_u32 s40, s40, s48
    s_and_b32 s40, s40, 0x7fffff
    s_add_u32 m0, s41, 4096
    s_nop 0
    buffer_load_dwordx4 v6, s[8:11], s39 offen offset:0 lds
    buffer_load_dwordx4 v7, s[8:11], s39 offen offset:1024 lds
    buffer_load_dwordx4 v8, s[8:11], s39 offen offset:2048 lds
    buffer_load_dwordx4 v9, s[8:11], s39 offen offset:3072 lds
    s_add_u32 m0, s42, 16384
    s_nop 0
    buffer_load_dwordx4 v10, s[12:15], s40 offen offset:0 lds
    buffer_load_dwordx4 v11, s[12:15], s40 offen offset:1024 lds
    buffer_load_dwordx4 v12, s[12:15], s40 offen offset:2048 lds
    buffer_load_dwordx4 v13, s[12:15], s40 offen offset:3072 lds
    s_add_u32 s40, s40, s48
    s_and_b32 s40, s40, 0x7fffff
    s_xor_b32 s42, s42, 0x8000
    s_add_u32 s39, s39, s64
    s_add_u32 s41, s41, 32768
    s_and_b32 s39, s39, s52
    s_cmp_ge_u32 s41, s53
    s_cselect_b32 s54, 98304, 0
    s_sub_u32 s41, s41, s54
    v_lshrrev_b32 v24, 5, v28
    v_mul_u32_u24 v24, 28672, v24
    v_bfe_u32 v25, v1, 2, 3
    v_lshl_add_u32 v24, v25, 11, v24
    v_bfe_u32 v25, v28, 4, 1
    v_lshl_add_u32 v24, v25, 10, v24
    v_and_b32 v25, 3, v1
    v_lshl_add_u32 v24, v25, 8, v24
    v_and_b32 v25, 15, v28
    v_lshl_add_u32 v253, v25, 4, v24
    v_add_u32 v254, 16384, v253
    v_cndmask_b32 v254, v27, v254, vcc
    v_and_b32 v24, 15, v1
    v_and_b32 v25, 8, v1
    v_mul_u32_u24 v25, s45, v25
    v_add_u32 v24, v24, v25
    s_lshl_b32 s54, s37, 14
    s_add_u32 s54, s54, 65536
    v_lshlrev_b32 v24, 7, v24
    v_add_u32 v24, s54, v24
    v_bfe_u32 v25, v1, 1, 3
    v_lshrrev_b32 v26, 4, v1
    v_xor_b32 v25, v25, v26
    v_lshl_add_u32 v14, v25, 4, v24
    v_xor_b32 v15, 64, v14
    v_lshrrev_b32 v24, 4, v1
    v_lshlrev_b32 v24, 12, v24
    v_bfe_u32 v25, v1, 2, 2
    v_mul_u32_u24 v25, 576, v25
    v_add_u32 v24, v24, v25
    v_and_b32 v25, 1, v1
    v_lshl_add_u32 v24, v25, 5, v24
    v_bfe_u32 v25, v1, 1, 1
    v_lshl_add_u32 v24, v25, 3, v24
    s_add_u32 s54, s45, 4
    v_bfe_u32 v25, v1, 4, 1
    v_lshl_add_u32 v24, v25, s54, v24
    s_lshl_b32 s55, s38, 8
    v_add_u32 v24, s55, v24
    s_lshl_b32 s55, 1, s54
    v_xor_b32 v25, s55, v24
    v_xor_b32 v16, 0, v24
    v_xor_b32 v17, 0, v25
    v_xor_b32 v18, 64, v24
    v_xor_b32 v19, 64, v25
    v_xor_b32 v20, 128, v24
    v_xor_b32 v21, 128, v25
    v_xor_b32 v27, 192, v24
    v_xor_b32 v31, 192, v25
    s_lshl_b32 s69, s3, 7
    s_and_b32 s45, s2, 7
    s_lshl_b32 s45, s45, 1
    s_bfe_u32 s54, s2, 0x10003
    s_add_u32 s79, s45, s54
    s_bfe_u32 s76, s2, 0x30004
    s_lshl_b32 s76, s76, 2
    s_lshr_b32 s86, s2, 7
    s_and_b32 s87, s2, 127
    s_sub_u32 s45, 64, s76
    s_sub_i32 s71, s45, 44
    s_max_i32 s71, s71, 0
    s_lshl_b32 s72, s45, 15
    s_min_u32 s56, s45, 44
    s_add_u32 s70, s71, s76
    s_add_u32 s70, s70, 4
    s_cmp_eq_u32 s86, 0
    s_cselect_b32 s70, s70, s56
    s_sub_u32 s75, s45, 4
    s_add_u32 s75, s75, s36
    s_add_u32 s76, s76, s36
    s_cmp_eq_u32 s86, 0
    s_cselect_b32 s77, s76, s75
    s_cmp_lg_u32 s71, 0
    s_cselect_b32 s54, 1, 0
    s_and_b32 s78, s54, s86
    s_andn2_b32 s59, s54, s86
    s_cselect_b32 s72, s72, -1
    s_cselect_b32 s73, 1441792, 0
    s_cselect_b32 s71, s71, 1000
    s_cselect_b32 s58, s75, s77
    s_lshr_b32 s54, s73, 15
    s_sub_u32 s75, s58, s54
    s_add_u32 s76, s76, s71
    s_add_u32 s74, s73, 16384
    s_sub_u32 s86, s70, 2
    s_lshr_b32 s84, s87, 3
    s_lshl_b32 s84, s84, 2
    s_and_b32 s85, s87, 7
    s_lshl_b32 s85, s85, 2
    s_add_u32 s85, s85, s36
    s_sub_u32 s54, s70, 5
    s_lshl_b64 s[82:83], 1, s54
    s_cmp_lt_u32 s71, 64
    s_cselect_b32 s6, 0x99, 0
    s_mov_b32 s7, 0
    s_and_b32 s54, s71, 63
    s_lshl_b64 s[6:7], s[6:7], s54
    s_lshr_b64 s[6:7], s[6:7], 5
    s_or_b64 s[82:83], s[82:83], s[6:7]
    s_max_i32 s54, s75, 1
    s_sub_u32 s54, s54, 1
    s_min_u32 s55, s71, s70
    s_sub_u32 s55, s55, 1
    s_sub_i32 s55, s55, s54
    s_max_i32 s55, s55, 0
    s_bfm_b64 s[6:7], s55, s54
    s_or_b64 s[80:81], s[82:83], s[6:7]
    s_max_i32 s54, s76, 1
    s_sub_u32 s54, s54, 1
    s_mov_b32 s55, s70
    s_sub_u32 s55, s55, 1
    s_sub_i32 s55, s55, s54
    s_max_i32 s55, s55, 0
    s_bfm_b64 s[6:7], s55, s54
    s_or_b64 s[80:81], s[80:81], s[6:7]
    s_lshl_b32 s75, s75, 5
    s_lshl_b32 s76, s76, 5
    s_sub_u32 s76, s76, 32
    s_mul_i32 s54, s87, 69632
    s_mul_i32 s55, s36, 17408
    s_add_u32 s54, s54, s55
    s_add_u32 s54, s54, 83886080
    s_add_u32 s88, s34, s54
    s_addc_u32 s89, s35, 0
    s_mov_b32 s90, 17408
    s_mov_b32 s91, 0x00020000
    s_lshl_b32 s54, s36, 8
    v_add_u32 v24, s54, v1
    v_mul_u32_u24 v25, 1171, v24
    v_bfe_u32 v25, v25, 17, 1
    v_lshlrev_b32 v25, 2, v25
    v_xor_b32 v24, v24, v25
    v_lshlrev_b32 v24, 4, v24
    v_subrev_u32 v24, 0, v24
    v_accvgpr_write_b32 a252, v24
    v_add_u32 v24, s54, v1
    v_add_u32 v24, 64, v24
    v_mul_u32_u24 v25, 1171, v24
    v_bfe_u32 v25, v25, 17, 1
    v_lshlrev_b32 v25, 2, v25
    v_xor_b32 v24, v24, v25
    v_lshlrev_b32 v24, 4, v24
    v_subrev_u32 v24, 1024, v24
    v_accvgpr_write_b32 a253, v24
    v_add_u32 v24, s54, v1
    v_add_u32 v24, 128, v24
    v_mul_u32_u24 v25, 1171, v24
    v_bfe_u32 v25, v25, 17, 1
    v_lshlrev_b32 v25, 2, v25
    v_xor_b32 v24, v24, v25
    v_lshlrev_b32 v24, 4, v24
    v_subrev_u32 v24, 2048, v24
    v_accvgpr_write_b32 a254, v24
    v_add_u32 v24, s54, v1
    v_add_u32 v24, 192, v24
    v_mul_u32_u24 v25, 1171, v24
    v_bfe_u32 v25, v25, 17, 1
    v_lshlrev_b32 v25, 2, v25
    v_xor_b32 v24, v24, v25
    v_lshlrev_b32 v24, 4, v24
    v_subrev_u32 v24, 3072, v24
    v_accvgpr_write_b32 a255, v24
    s_mul_i32 s6, s79, 224
    s_add_u32 s20, s30, s6
    s_addc_u32 s21, s31, 0
    s_sub_u32 s22, 1605632, s6
    s_mov_b32 s23, 0x00020000
    s_lshl_b32 s6, s79, 9
    s_add_u32 s28, s24, s6
    s_addc_u32 s29, s25, 0
    s_sub_u32 s30, 3670016, s6
    s_mov_b32 s31, 0x00020000
    s_add_u32 s24, s34, 99614720
    s_addc_u32 s25, s35, 0
    s_mov_b32 s26, 10240
    s_mov_b32 s27, 0x00020000
    s_add_u32 s96, s34, 0
    s_addc_u32 s97, s35, 0
    s_mov_b32 s98, 1835008
    s_mov_b32 s99, 0x00020000
    s_mov_b32 s43, 1
    s_mov_b32 s57, 32768
    s_mov_b32 s60, s32
    s_mov_b32 s61, s33
    s_mov_b32 s62, 256
    s_mov_b32 s63, 0x00020000
    v_mov_b32 v28, 1
    v_mov_b32 v29, 0
    v_mov_b32 v30, 0
    s_bfe_u32 s6, s2, 0x30003
    s_lshl_b32 s6, 8, s6
    s_or_b32 s44, s6, 81920
    s_lshl_b32 s6, s3, 21
    s_lshl_b32 s7, s5, 15
    s_add_u32 s6, s6, s7
    s_lshl_b32 s7, s37, 18
    s_add_u32 s6, s6, s7
    s_lshl_b32 s7, s4, 14
    s_add_u32 s6, s6, s7
    s_lshl_b32 s7, s38, 13
    s_add_u32 s6, s6, s7
    s_add_u32 s3, s6, 2097152
    s_add_u32 s16, s34, s3
    s_addc_u32 s17, s35, 0
    s_mov_b32 s18, 2097152
    s_mov_b32 s49, 524288
    s_mov_b32 s50, 1048576
    s_mov_b32 s51, 1572864
    v_lshlrev_b32 v22, 4, v1
    v_add_u32 v23, 4096, v22
    s_lshl_b32 s5, s2, 7
    s_waitcnt vmcnt(4)
    s_barrier
    s_cmp_eq_u32 s4, 0
    s_cbranch_scc0 L_k1_firstV
    ds_read_b128 a[0:3], v14 offset:0
    ds_read_b64_tr_b16 a[32:33], v16 offset:0
    ds_read_b64_tr_b16 a[34:35], v16 offset:2048
    ds_read_b128 a[4:7], v14 offset:2048
    ds_read_b64_tr_b16 a[36:37], v17 offset:0
    ds_read_b64_tr_b16 a[38:39], v17 offset:2048
    ds_read_b128 a[8:11], v14 offset:4096
    ds_read_b64_tr_b16 a[40:41], v18 offset:0
    ds_read_b64_tr_b16 a[42:43], v18 offset:2048
    ds_read_b128 a[12:15], v14 offset:6144
    ds_read_b64_tr_b16 a[44:45], v19 offset:0
    ds_read_b64_tr_b16 a[46:47], v19 offset:2048
    ds_read_b128 a[16:19], v14 offset:8192
    ds_read_b64_tr_b16 a[48:49], v20 offset:0
    ds_read_b64_tr_b16 a[50:51], v20 offset:2048
    ds_read_b128 a[20:23], v14 offset:10240
    ds_read_b64_tr_b16 a[52:53], v21 offset:0
    ds_read_b64_tr_b16 a[54:55], v21 offset:2048
    ds_read_b128 a[24:27], v14 offset:12288
    ds_read_b64_tr_b16 a[56:57], v27 offset:0
    ds_read_b64_tr_b16 a[58:59], v27 offset:2048
    ds_read_b128 a[28:31], v14 offset:14336
    ds_read_b64_tr_b16 a[60:61], v31 offset:0
    ds_read_b64_tr_b16 a[62:63], v31 offset:2048
L_k1_firstK:
    s_waitcnt lgkmcnt(0)
    v_mfma_f32_16x16x32_bf16 v[32:35], a[32:35], a[0:3], 0
    s_mov_b32 m0, s41
    v_lshlrev_b32 v232, 16, v224
    v_mfma_f32_16x16x32_bf16 v[36:39], a[36:39], a[0:3], 0
    buffer_load_dwordx4 v2, s[8:11], s39 offen offset:0 lds
    v_and_b32 v233, 0xffff0000, v224
    v_mfma_f32_16x16x32_bf16 v[40:43], a[32:35], a[4:7], 0
    v_lshlrev_b32 v234, 16, v225
    v_and_b32 v235, 0xffff0000, v225
    v_mfma_f32_16x16x32_bf16 v[44:47], a[36:39], a[4:7], 0
    buffer_load_dwordx4 v3, s[8:11], s39 offen offset:1024 lds
    v_lshlrev_b32 v236, 16, v226
    v_mfma_f32_16x16x32_bf16 v[48:51], a[40:43], a[0:3], 0
    v_and_b32 v237, 0xffff0000, v226
    v_lshlrev_b32 v238, 16, v227
    v_mfma_f32_16x16x32_bf16 v[52:55], a[44:47], a[0:3], 0
    v_and_b32 v239, 0xffff0000, v227
    v_lshlrev_b32 v240, 16, v228
    v_mfma_f32_16x16x32_bf16 v[56:59], a[40:43], a[4:7], 0
    buffer_load_dwordx4 v4, s[8:11], s39 offen offset:2048 lds
    v_and_b32 v241, 0xffff0000, v228
    v_mfma_f32_16x16x32_bf16 v[60:63], a[44:47], a[4:7], 0
    v_lshlrev_b32 v242, 16, v229
    v_and_b32 v243, 0xffff0000, v229
    v_mfma_f32_16x16x32_bf16 v[64:67], a[48:51], a[0:3], 0
    buffer_load_dwordx4 v5, s[8:11], s39 offen offset:3072 lds
    v_lshlrev_b32 v244, 16, v230
    v_mfma_f32_16x16x32_bf16 v[68:71], a[52:55], a[0:3], 0
    s_mov_b32 m0, s42
    v_and_b32 v245, 0xffff0000, v230
    v_mfma_f32_16x16x32_bf16 v[72:75], a[48:51], a[4:7], 0
    v_lshlrev_b32 v246, 16, v231
    v_and_b32 v247, 0xffff0000, v231
    v_mfma_f32_16x16x32_bf16 v[76:79], a[52:55], a[4:7], 0
    buffer_load_dwordx4 v10, s[12:15], s40 offen offset:0 lds
    v_add_f32 v248, v232, v233
    v_mfma_f32_16x16x32_bf16 v[80:83], a[56:59], a[0:3], 0
    v_add_f32 v248, v248, v234
    v_add_f32 v248, v248, v235
    v_mfma_f32_16x16x32_bf16 v[84:87], a[60:63], a[0:3], 0
    buffer_load_dwordx4 v11, s[12:15], s40 offen offset:1024 lds
    v_add_f32 v248, v248, v236
    v_mfma_f32_16x16x32_bf16 v[88:91], a[56:59], a[4:7], 0
    v_add_f32 v248, v248, v237
    v_add_f32 v248, v248, v238
    v_mfma_f32_16x16x32_bf16 v[92:95], a[60:63], a[4:7], 0
    v_add_f32 v248, v248, v239
    v_add_f32 v248, v248, v240
    v_mfma_f32_16x16x32_bf16 v[96:99], a[32:35], a[8:11], 0
    buffer_load_dwordx4 v12, s[12:15], s40 offen offset:2048 lds
    v_add_f32 v248, v248, v241
    v_mfma_f32_16x16x32_bf16 v[100:103], a[36:39], a[8:11], 0
    v_add_f32 v248, v248, v242
    v_add_f32 v248, v248, v243
    v_mfma_f32_16x16x32_bf16 v[104:107], a[32:35], a[12:15], 0
    buffer_load_dwordx4 v13, s[12:15], s40 offen offset:3072 lds
    v_add_f32 v248, v248, v244
    v_mfma_f32_16x16x32_bf16 v[108:111], a[36:39], a[12:15], 0
    s_add_u32 s40, s40, s48
    s_and_b32 s40, s40, 0x7fffff
    v_mfma_f32_16x16x32_bf16 v[112:115], a[40:43], a[8:11], 0
    s_add_u32 m0, s41, 4096
    v_add_f32 v248, v248, v245
    v_mfma_f32_16x16x32_bf16 v[116:119], a[44:47], a[8:11], 0
    buffer_load_dwordx4 v6, s[8:11], s39 offen offset:0 lds
    v_add_f32 v248, v248, v246
    v_mfma_f32_16x16x32_bf16 v[120:123], a[40:43], a[12:15], 0
    v_add_f32 v248, v248, v247
    s_nop 1
    v_mfma_f32_16x16x32_bf16 v[124:127], a[44:47], a[12:15], 0
    buffer_load_dwordx4 v7, s[8:11], s39 offen offset:1024 lds
    v_add_f32_dpp v248, v248, v248 quad_perm:[1,0,3,2] row_mask:0xf bank_mask:0xf
    v_mfma_f32_16x16x32_bf16 v[128:131], a[48:51], a[8:11], 0
    s_waitcnt vmcnt(10)
    s_barrier
    v_mfma_f32_16x16x32_bf16 v[132:135], a[52:55], a[8:11], 0
    s_nop 1
    v_add_f32_dpp v248, v248, v248 quad_perm:[2,3,0,1] row_mask:0xf bank_mask:0xf
    v_mfma_f32_16x16x32_bf16 v[136:139], a[48:51], a[12:15], 0
    ds_read_b128 a[64:67], v15 offset:0
    buffer_load_dwordx4 v8, s[8:11], s39 offen offset:2048 lds
    v_mfma_f32_16x16x32_bf16 v[140:143], a[52:55], a[12:15], 0
    ds_read_b64_tr_b16 a[96:97], v16 offset:16384
    s_nop 1
    v_mfma_f32_16x16x32_bf16 v[144:147], a[56:59], a[8:11], 0
    buffer_load_dwordx4 v9, s[8:11], s39 offen offset:3072 lds
    v_add_f32_dpp v248, v248, v248 row_half_mirror row_mask:0xf bank_mask:0xf
    v_mfma_f32_16x16x32_bf16 v[148:151], a[60:63], a[8:11], 0
    ds_read_b64_tr_b16 a[98:99], v16 offset:18432
    s_add_u32 m0, s42, 16384
    v_mfma_f32_16x16x32_bf16 v[152:155], a[56:59], a[12:15], 0
    ds_read_b128 a[68:71], v15 offset:2048
    s_nop 1
    v_mfma_f32_16x16x32_bf16 v[156:159], a[60:63], a[12:15], 0
    buffer_load_dwordx4 v10, s[12:15], s40 offen offset:0 lds
    v_add_f32_dpp v248, v248, v248 row_mirror row_mask:0xf bank_mask:0xf
    v_mfma_f32_16x16x32_bf16 v[160:163], a[32:35], a[16:19], 0
    ds_read_b64_tr_b16 a[100:101], v17 offset:16384
    v_mov_b32 v249, v248
    v_mfma_f32_16x16x32_bf16 v[164:167], a[36:39], a[16:19], 0
    ds_read_b64_tr_b16 a[102:103], v17 offset:18432
    s_nop 1
    v_mfma_f32_16x16x32_bf16 v[168:171], a[32:35], a[20:23], 0
    buffer_load_dwordx4 v11, s[12:15], s40 offen offset:1024 lds
    v_permlane16_swap_b32 v248, v249
    v_mfma_f32_16x16x32_bf16 v[172:175], a[36:39], a[20:23], 0
    ds_read_b128 a[72:75], v15 offset:4096
    s_nop 1
    v_mfma_f32_16x16x32_bf16 v[176:179], a[40:43], a[16:19], 0
    ds_read_b64_tr_b16 a[104:105], v18 offset:16384
    buffer_load_dwordx4 v12, s[12:15], s40 offen offset:2048 lds
    v_mfma_f32_16x16x32_bf16 v[180:183], a[44:47], a[16:19], 0
    v_add_f32 v248, v248, v249
    v_mul_f32 v248, 0x3b124925, v248
    v_mfma_f32_16x16x32_bf16 v[184:187], a[40:43], a[20:23], 0
    ds_read_b64_tr_b16 a[106:107], v18 offset:18432
    v_sub_f32 v250, v232, v248
    v_mfma_f32_16x16x32_bf16 v[188:191], a[44:47], a[20:23], 0
    ds_read_b128 a[76:79], v15 offset:6144
    buffer_load_dwordx4 v13, s[12:15], s40 offen offset:3072 lds
    v_mfma_f32_16x16x32_bf16 v[192:195], a[48:51], a[16:19], 0
    s_add_u32 s40, s40, s48
    s_and_b32 s40, s40, 0x7fffff
    v_mfma_f32_16x16x32_bf16 v[196:199], a[52:55], a[16:19], 0
    ds_read_b64_tr_b16 a[108:109], v19 offset:16384
    s_xor_b32 s42, s42, 0x8000
    v_mfma_f32_16x16x32_bf16 v[200:203], a[48:51], a[20:23], 0
    ds_read_b64_tr_b16 a[110:111], v19 offset:18432
    s_add_u32 s39, s39, s64
    v_mfma_f32_16x16x32_bf16 v[204:207], a[52:55], a[20:23], 0
    s_add_u32 s41, s41, 32768
    s_and_b32 s39, s39, s52
    v_mfma_f32_16x16x32_bf16 v[208:211], a[56:59], a[16:19], 0
    ds_read_b128 a[80:83], v15 offset:8192
    s_cmp_ge_u32 s41, s53
    s_cselect_b32 s54, 98304, 0
    s_sub_u32 s41, s41, s54
    v_mfma_f32_16x16x32_bf16 v[212:215], a[60:63], a[16:19], 0
    ds_read_b64_tr_b16 a[112:113], v20 offset:16384
    s_mov_b32 m0, s41
    v_mfma_f32_16x16x32_bf16 v[216:219], a[56:59], a[20:23], 0
    buffer_load_dwordx4 v2, s[8:11], s39 offen offset:0 lds
    v_mul_f32 v251, v250, v250
    v_mfma_f32_16x16x32_bf16 v[220:223], a[60:63], a[20:23], 0
    ds_read_b64_tr_b16 a[114:115], v20 offset:18432
    buffer_load_dwordx4 v3, s[8:11], s39 offen offset:1024 lds
    v_mfma_f32_16x16x32_bf16 a[128:131], a[32:35], a[24:27], 0
    ds_read_b128 a[84:87], v15 offset:10240
    buffer_load_dwordx4 v4, s[8:11], s39 offen offset:2048 lds
    v_mfma_f32_16x16x32_bf16 a[132:135], a[36:39], a[24:27], 0
    buffer_load_dwordx4 v5, s[8:11], s39 offen offset:3072 lds
    v_sub_f32 v250, v233, v248
    v_mfma_f32_16x16x32_bf16 a[136:139], a[32:35], a[28:31], 0
    ds_read_b64_tr_b16 a[116:117], v21 offset:16384
    s_mov_b32 m0, s42
    v_mfma_f32_16x16x32_bf16 a[140:143], a[36:39], a[28:31], 0
    ds_read_b64_tr_b16 a[118:119], v21 offset:18432
    buffer_load_dwordx4 v10, s[12:15], s40 offen offset:0 lds
    v_mfma_f32_16x16x32_bf16 a[144:147], a[40:43], a[24:27], 0
    v_fmac_f32 v251, v250, v250
    v_sub_f32 v250, v234, v248
    v_mfma_f32_16x16x32_bf16 a[148:151], a[44:47], a[24:27], 0
    ds_read_b128 a[88:91], v15 offset:12288
    v_fmac_f32 v251, v250, v250
    v_mfma_f32_16x16x32_bf16 a[152:155], a[40:43], a[28:31], 0
    ds_read_b64_tr_b16 a[120:121], v27 offset:16384
    buffer_load_dwordx4 v11, s[12:15], s40 offen offset:1024 lds
    v_mfma_f32_16x16x32_bf16 a[156:159], a[44:47], a[28:31], 0
    v_sub_f32 v250, v235, v248
    v_fmac_f32 v251, v250, v250
    v_mfma_f32_16x16x32_bf16 a[160:163], a[48:51], a[24:27], 0
    ds_read_b64_tr_b16 a[122:123], v27 offset:18432
    buffer_load_dwordx4 v12, s[12:15], s40 offen offset:2048 lds
    v_mfma_f32_16x16x32_bf16 a[164:167], a[52:55], a[24:27], 0
    ds_read_b128 a[92:95], v15 offset:14336
    v_sub_f32 v250, v236, v248
    v_mfma_f32_16x16x32_bf16 a[168:171], a[48:51], a[28:31], 0
    v_fmac_f32 v251, v250, v250
    v_sub_f32 v250, v237, v248
    v_mfma_f32_16x16x32_bf16 a[172:175], a[52:55], a[28:31], 0
    ds_read_b64_tr_b16 a[124:125], v31 offset:16384
    buffer_load_dwordx4 v13, s[12:15], s40 offen offset:3072 lds
    v_mfma_f32_16x16x32_bf16 a[176:179], a[56:59], a[24:27], 0
    ds_read_b64_tr_b16 a[126:127], v31 offset:18432
    s_add_u32 s40, s40, s48
    s_and_b32 s40, s40, 0x7fffff
    v_mfma_f32_16x16x32_bf16 a[180:183], a[60:63], a[24:27], 0
    v_fmac_f32 v251, v250, v250
    v_sub_f32 v250, v238, v248
    v_mfma_f32_16x16x32_bf16 a[184:187], a[56:59], a[28:31], 0
    s_mov_b32 s47, 1
    s_mov_b32 s46, 32768
    v_mfma_f32_16x16x32_bf16 a[188:191], a[60:63], a[28:31], 0
    v_add_u32 v14, s46, v14
    v_add_u32 v15, s46, v15
    v_xor_b32 v16, 0x8000, v16
    v_xor_b32 v17, 0x8000, v17
    v_xor_b32 v18, 0x8000, v18
    v_xor_b32 v19, 0x8000, v19
    v_xor_b32 v20, 0x8000, v20
    v_xor_b32 v21, 0x8000, v21
    v_xor_b32 v27, 0x8000, v27
    v_xor_b32 v31, 0x8000, v31
    s_waitcnt lgkmcnt(0)
    v_mfma_f32_16x16x32_bf16 v[32:35], a[96:99], a[64:67], v[32:35]
    v_fmac_f32 v251, v250, v250
    v_sub_f32 v250, v239, v248
    v_mfma_f32_16x16x32_bf16 v[36:39], a[100:103], a[64:67], v[36:39]
    s_waitcnt vmcnt(12)
    s_barrier
    v_mfma_f32_16x16x32_bf16 v[40:43], a[96:99], a[68:71], v[40:43]
    s_add_u32 m0, s41, 4096
    v_fmac_f32 v251, v250, v250
    v_mfma_f32_16x16x32_bf16 v[44:47], a[100:103], a[68:71], v[44:47]
    ds_read_b128 a[0:3], v14 offset:0
    buffer_load_dwordx4 v6, s[8:11], s39 offen offset:0 lds
    v_mfma_f32_16x16x32_bf16 v[48:51], a[104:107], a[64:67], v[48:51]
    ds_read_b64_tr_b16 a[32:33], v16 offset:0
    v_sub_f32 v250, v240, v248
    v_mfma_f32_16x16x32_bf16 v[52:55], a[108:111], a[64:67], v[52:55]
    v_mul_f32 v252, v250, v250
    v_sub_f32 v250, v241, v248
    v_mfma_f32_16x16x32_bf16 v[56:59], a[104:107], a[68:71], v[56:59]
    ds_read_b64_tr_b16 a[34:35], v16 offset:2048
    v_fmac_f32 v252, v250, v250
    v_mfma_f32_16x16x32_bf16 v[60:63], a[108:111], a[68:71], v[60:63]
    ds_read_b128 a[4:7], v14 offset:2048
    v_sub_f32 v250, v242, v248
    v_mfma_f32_16x16x32_bf16 v[64:67], a[112:115], a[64:67], v[64:67]
    buffer_load_dwordx4 v7, s[8:11], s39 offen offset:1024 lds
    v_fmac_f32 v252, v250, v250
    v_mfma_f32_16x16x32_bf16 v[68:71], a[116:119], a[64:67], v[68:71]
    ds_read_b64_tr_b16 a[36:37], v17 offset:0
    v_sub_f32 v250, v243, v248
    v_mfma_f32_16x16x32_bf16 v[72:75], a[112:115], a[68:71], v[72:75]
    ds_read_b64_tr_b16 a[38:39], v17 offset:2048
    v_fmac_f32 v252, v250, v250
    v_mfma_f32_16x16x32_bf16 v[76:79], a[116:119], a[68:71], v[76:79]
    v_sub_f32 v250, v244, v248
    v_fmac_f32 v252, v250, v250
    v_mfma_f32_16x16x32_bf16 v[80:83], a[120:123], a[64:67], v[80:83]
    ds_read_b128 a[8:11], v14 offset:4096
    v_sub_f32 v250, v245, v248
    v_mfma_f32_16x16x32_bf16 v[84:87], a[124:127], a[64:67], v[84:87]
    ds_read_b64_tr_b16 a[40:41], v18 offset:0
    buffer_load_dwordx4 v8, s[8:11], s39 offen offset:2048 lds
    v_mfma_f32_16x16x32_bf16 v[88:91], a[120:123], a[68:71], v[88:91]
    v_fmac_f32 v252, v250, v250
    v_sub_f32 v250, v246, v248
    v_mfma_f32_16x16x32_bf16 v[92:95], a[124:127], a[68:71], v[92:95]
    ds_read_b64_tr_b16 a[42:43], v18 offset:2048
    v_fmac_f32 v252, v250, v250
    v_mfma_f32_16x16x32_bf16 v[96:99], a[96:99], a[72:75], v[96:99]
    ds_read_b128 a[12:15], v14 offset:6144
    v_sub_f32 v250, v247, v248
    v_mfma_f32_16x16x32_bf16 v[100:103], a[100:103], a[72:75], v[100:103]
    v_fmac_f32 v252, v250, v250
    v_cndmask_b32 v252, 0, v252, vcc
    v_mfma_f32_16x16x32_bf16 v[104:107], a[96:99], a[76:79], v[104:107]
    ds_read_b64_tr_b16 a[44:45], v19 offset:0
    buffer_load_dwordx4 v9, s[8:11], s39 offen offset:3072 lds
    v_mfma_f32_16x16x32_bf16 v[108:111], a[100:103], a[76:79], v[108:111]
    ds_read_b64_tr_b16 a[46:47], v19 offset:2048
    s_add_u32 s39, s39, s64
    v_mfma_f32_16x16x32_bf16 v[112:115], a[104:107], a[72:75], v[112:115]
    s_add_u32 s41, s41, 32768
    s_and_b32 s39, s39, s52
    v_mfma_f32_16x16x32_bf16 v[116:119], a[108:111], a[72:75], v[116:119]
    ds_read_b128 a[16:19], v14 offset:8192
    s_cmp_ge_u32 s41, s53
    s_cselect_b32 s54, 98304, 0
    s_sub_u32 s41, s41, s54
    v_mfma_f32_16x16x32_bf16 v[120:123], a[104:107], a[76:79], v[120:123]
    ds_read_b64_tr_b16 a[48:49], v20 offset:0
    s_add_u32 m0, s42, 16384
    v_mfma_f32_16x16x32_bf16 v[124:127], a[108:111], a[76:79], v[124:127]
    buffer_load_dwordx4 v10, s[12:15], s40 offen offset:0 lds
    v_add_f32 v251, v251, v252
    v_mfma_f32_16x16x32_bf16 v[128:131], a[112:115], a[72:75], v[128:131]
    ds_read_b64_tr_b16 a[50:51], v20 offset:2048
    s_nop 1
    v_add_f32_dpp v251, v251, v251 quad_perm:[1,0,3,2] row_mask:0xf bank_mask:0xf
    s_nop 1
    v_add_f32_dpp v251, v251, v251 quad_perm:[2,3,0,1] row_mask:0xf bank_mask:0xf
    s_nop 1
    v_add_f32_dpp v251, v251, v251 row_half_mirror row_mask:0xf bank_mask:0xf
    s_nop 1
    v_add_f32_dpp v251, v251, v251 row_mirror row_mask:0xf bank_mask:0xf
    v_mfma_f32_16x16x32_bf16 v[132:135], a[116:119], a[72:75], v[132:135]
    ds_read_b128 a[20:23], v14 offset:10240
    v_mov_b32 v249, v251
    s_nop 1
    v_permlane16_swap_b32 v251, v249
    s_nop 1
    v_add_f32 v251, v251, v249
    v_mul_f32 v251, 0x3b124925, v251
    v_cvt_pk_bf16_f32 v251, v251, v251
    v_and_b32 v251, 0xffff0000, v251
    v_mfma_f32_16x16x32_bf16 v[136:139], a[112:115], a[76:79], v[136:139]
    v_add_f32 v251, 0x3727c5ac, v251
    v_cvt_pk_bf16_f32 v251, v251, v251
    v_and_b32 v251, 0xffff0000, v251
    v_sqrt_f32 v251, v251
    s_nop 0
    v_cvt_pk_bf16_f32 v251, v251, v251
    v_and_b32 v251, 0xffff0000, v251
    v_rcp_f32 v251, v251
    v_mfma_f32_16x16x32_bf16 v[140:143], a[116:119], a[76:79], v[140:143]
    ds_read_b64_tr_b16 a[52:53], v21 offset:0
    v_cvt_pk_bf16_f32 v248, v248, v248
    v_and_b32 v248, 0xffff0000, v248
    v_sub_f32 v232, v232, v248
    v_sub_f32 v233, v233, v248
    v_cvt_pk_bf16_f32 v224, v232, v233
    v_lshlrev_b32 v232, 16, v224
    v_and_b32 v233, 0xffff0000, v224
    v_mul_f32 v232, v232, v251
    v_mfma_f32_16x16x32_bf16 v[144:147], a[120:123], a[72:75], v[144:147]
    ds_read_b64_tr_b16 a[54:55], v21 offset:2048
    buffer_load_dwordx4 v11, s[12:15], s40 offen offset:1024 lds
    v_mul_f32 v233, v233, v251
    v_cvt_pk_bf16_f32 v224, v232, v233
    v_sub_f32 v234, v234, v248
    v_sub_f32 v235, v235, v248
    v_cvt_pk_bf16_f32 v225, v234, v235
    v_lshlrev_b32 v234, 16, v225
    v_and_b32 v235, 0xffff0000, v225
    v_mul_f32 v234, v234, v251
    v_mfma_f32_16x16x32_bf16 v[148:151], a[124:127], a[72:75], v[148:151]
    v_mul_f32 v235, v235, v251
    v_cvt_pk_bf16_f32 v225, v234, v235
    v_sub_f32 v236, v236, v248
    v_sub_f32 v237, v237, v248
    v_cvt_pk_bf16_f32 v226, v236, v237
    v_lshlrev_b32 v236, 16, v226
    v_and_b32 v237, 0xffff0000, v226
    v_mul_f32 v236, v236, v251
    v_mfma_f32_16x16x32_bf16 v[152:155], a[120:123], a[76:79], v[152:155]
    ds_read_b128 a[24:27], v14 offset:12288
    v_mul_f32 v237, v237, v251
    v_cvt_pk_bf16_f32 v226, v236, v237
    v_sub_f32 v238, v238, v248
    v_sub_f32 v239, v239, v248
    v_cvt_pk_bf16_f32 v227, v238, v239
    v_lshlrev_b32 v238, 16, v227
    v_and_b32 v239, 0xffff0000, v227
    v_mfma_f32_16x16x32_bf16 v[156:159], a[124:127], a[76:79], v[156:159]
    ds_read_b64_tr_b16 a[56:57], v27 offset:0
    v_mul_f32 v238, v238, v251
    v_mul_f32 v239, v239, v251
    v_cvt_pk_bf16_f32 v227, v238, v239
    v_sub_f32 v240, v240, v248
    v_sub_f32 v241, v241, v248
    v_cvt_pk_bf16_f32 v228, v240, v241
    v_lshlrev_b32 v240, 16, v228
    v_mfma_f32_16x16x32_bf16 v[160:163], a[96:99], a[80:83], v[160:163]
    v_and_b32 v241, 0xffff0000, v228
    v_mul_f32 v240, v240, v251
    v_mul_f32 v241, v241, v251
    v_cvt_pk_bf16_f32 v228, v240, v241
    v_sub_f32 v242, v242, v248
    v_sub_f32 v243, v243, v248
    v_cvt_pk_bf16_f32 v229, v242, v243
    v_mfma_f32_16x16x32_bf16 v[164:167], a[100:103], a[80:83], v[164:167]
    ds_read_b64_tr_b16 a[58:59], v27 offset:2048
    v_lshlrev_b32 v242, 16, v229
    v_and_b32 v243, 0xffff0000, v229
    v_mul_f32 v242, v242, v251
    v_mul_f32 v243, v243, v251
    v_cvt_pk_bf16_f32 v229, v242, v243
    v_sub_f32 v244, v244, v248
    v_sub_f32 v245, v245, v248
    v_mfma_f32_16x16x32_bf16 v[168:171], a[96:99], a[84:87], v[168:171]
    ds_read_b128 a[28:31], v14 offset:14336
    buffer_load_dwordx4 v12, s[12:15], s40 offen offset:2048 lds
    v_cvt_pk_bf16_f32 v230, v244, v245
    v_lshlrev_b32 v244, 16, v230
    v_and_b32 v245, 0xffff0000, v230
    v_mul_f32 v244, v244, v251
    v_mul_f32 v245, v245, v251
    v_cvt_pk_bf16_f32 v230, v244, v245
    v_sub_f32 v246, v246, v248
    v_mfma_f32_16x16x32_bf16 v[172:175], a[100:103], a[84:87], v[172:175]
    v_sub_f32 v247, v247, v248
    v_cvt_pk_bf16_f32 v231, v246, v247
    v_lshlrev_b32 v246, 16, v231
    v_and_b32 v247, 0xffff0000, v231
    v_mul_f32 v246, v246, v251
    v_mul_f32 v247, v247, v251
    v_cvt_pk_bf16_f32 v231, v246, v247
    v_mfma_f32_16x16x32_bf16 v[176:179], a[104:107], a[80:83], v[176:179]
    ds_read_b64_tr_b16 a[60:61], v31 offset:0
    v_mfma_f32_16x16x32_bf16 v[180:183], a[108:111], a[80:83], v[180:183]
    ds_read_b64_tr_b16 a[62:63], v31 offset:2048
    v_mfma_f32_16x16x32_bf16 v[184:187], a[104:107], a[84:87], v[184:187]
    v_mfma_f32_16x16x32_bf16 v[188:191], a[108:111], a[84:87], v[188:191]
    buffer_load_dwordx4 v13, s[12:15], s40 offen offset:3072 lds
    v_mfma_f32_16x16x32_bf16 v[192:195], a[112:115], a[80:83], v[192:195]
    s_add_u32 s40, s40, s48
    s_and_b32 s40, s40, 0x7fffff
    v_mfma_f32_16x16x32_bf16 v[196:199], a[116:119], a[80:83], v[196:199]
    s_xor_b32 s42, s42, 0x8000
    v_mfma_f32_16x16x32_bf16 v[200:203], a[112:115], a[84:87], v[200:203]
    v_mfma_f32_16x16x32_bf16 v[204:207], a[116:119], a[84:87], v[204:207]
    v_mfma_f32_16x16x32_bf16 v[208:211], a[120:123], a[80:83], v[208:211]
    buffer_store_dwordx4 v[224:227], v253, s[96:99], 0 offen sc0 sc1
    v_mfma_f32_16x16x32_bf16 v[212:215], a[124:127], a[80:83], v[212:215]
    v_mfma_f32_16x16x32_bf16 v[216:219], a[120:123], a[84:87], v[216:219]
    v_mfma_f32_16x16x32_bf16 v[220:223], a[124:127], a[84:87], v[220:223]
    v_mfma_f32_16x16x32_bf16 a[128:131], a[96:99], a[88:91], a[128:131]
    v_mfma_f32_16x16x32_bf16 a[132:135], a[100:103], a[88:91], a[132:135]
    buffer_store_dwordx4 v[228:231], v254, s[96:99], 0 offen sc0 sc1
    v_mfma_f32_16x16x32_bf16 a[136:139], a[96:99], a[92:95], a[136:139]
    v_mfma_f32_16x16x32_bf16 a[140:143], a[100:103], a[92:95], a[140:143]
    v_mfma_f32_16x16x32_bf16 a[144:147], a[104:107], a[88:91], a[144:147]
    v_mfma_f32_16x16x32_bf16 a[148:151], a[108:111], a[88:91], a[148:151]
    v_mfma_f32_16x16x32_bf16 a[152:155], a[104:107], a[92:95], a[152:155]
    buffer_store_dword v29, v29, s[24:27], s5 offen sc0 sc1
    v_mfma_f32_16x16x32_bf16 a[156:159], a[108:111], a[92:95], a[156:159]
    v_mfma_f32_16x16x32_bf16 a[160:163], a[112:115], a[88:91], a[160:163]
    v_mfma_f32_16x16x32_bf16 a[164:167], a[116:119], a[88:91], a[164:167]
    v_mfma_f32_16x16x32_bf16 a[168:171], a[112:115], a[92:95], a[168:171]
    v_mfma_f32_16x16x32_bf16 a[172:175], a[116:119], a[92:95], a[172:175]
    v_mfma_f32_16x16x32_bf16 a[176:179], a[120:123], a[88:91], a[176:179]
    v_mfma_f32_16x16x32_bf16 a[180:183], a[124:127], a[88:91], a[180:183]
    v_mfma_f32_16x16x32_bf16 a[184:187], a[120:123], a[92:95], a[184:187]
    v_mfma_f32_16x16x32_bf16 a[188:191], a[124:127], a[92:95], a[188:191]
L_k1_loopK:
    s_waitcnt lgkmcnt(0)
    v_mfma_f32_16x16x32_bf16 v[32:35], a[32:35], a[0:3], v[32:35]
    v_mfma_f32_16x16x32_bf16 v[36:39], a[36:39], a[0:3], v[36:39]
    s_waitcnt vmcnt(16)
    s_barrier
    v_mfma_f32_16x16x32_bf16 v[40:43], a[32:35], a[4:7], v[40:43]
    s_mov_b32 m0, s41
    v_mfma_f32_16x16x32_bf16 v[44:47], a[36:39], a[4:7], v[44:47]
    ds_read_b128 a[64:67], v15 offset:0
    v_mfma_f32_16x16x32_bf16 v[48:51], a[40:43], a[0:3], v[48:51]
    ds_read_b64_tr_b16 a[96:97], v16 offset:16384
    v_mfma_f32_16x16x32_bf16 v[52:55], a[44:47], a[0:3], v[52:55]
    ds_read_b64_tr_b16 a[98:99], v16 offset:18432
    v_mfma_f32_16x16x32_bf16 v[56:59], a[40:43], a[4:7], v[56:59]
    buffer_load_dwordx4 v2, s[8:11], s39 offen offset:0 lds
    v_mfma_f32_16x16x32_bf16 v[60:63], a[44:47], a[4:7], v[60:63]
    ds_read_b128 a[68:71], v15 offset:2048
    v_mfma_f32_16x16x32_bf16 v[64:67], a[48:51], a[0:3], v[64:67]
    ds_read_b64_tr_b16 a[100:101], v17 offset:16384
    v_mfma_f32_16x16x32_bf16 v[68:71], a[52:55], a[0:3], v[68:71]
    ds_read_b64_tr_b16 a[102:103], v17 offset:18432
    v_mfma_f32_16x16x32_bf16 v[72:75], a[48:51], a[4:7], v[72:75]
    v_mfma_f32_16x16x32_bf16 v[76:79], a[52:55], a[4:7], v[76:79]
    ds_read_b128 a[72:75], v15 offset:4096
    v_mfma_f32_16x16x32_bf16 v[80:83], a[56:59], a[0:3], v[80:83]
    ds_read_b64_tr_b16 a[104:105], v18 offset:16384
    v_mfma_f32_16x16x32_bf16 v[84:87], a[60:63], a[0:3], v[84:87]
    ds_read_b64_tr_b16 a[106:107], v18 offset:18432
    v_mfma_f32_16x16x32_bf16 v[88:91], a[56:59], a[4:7], v[88:91]
    buffer_load_dwordx4 v3, s[8:11], s39 offen offset:1024 lds
    v_mfma_f32_16x16x32_bf16 v[92:95], a[60:63], a[4:7], v[92:95]
    ds_read_b128 a[76:79], v15 offset:6144
    v_mfma_f32_16x16x32_bf16 v[96:99], a[32:35], a[8:11], v[96:99]
    ds_read_b64_tr_b16 a[108:109], v19 offset:16384
    v_mfma_f32_16x16x32_bf16 v[100:103], a[36:39], a[8:11], v[100:103]
    ds_read_b64_tr_b16 a[110:111], v19 offset:18432
    v_mfma_f32_16x16x32_bf16 v[104:107], a[32:35], a[12:15], v[104:107]
    v_mfma_f32_16x16x32_bf16 v[108:111], a[36:39], a[12:15], v[108:111]
    ds_read_b128 a[80:83], v15 offset:8192
    v_mfma_f32_16x16x32_bf16 v[112:115], a[40:43], a[8:11], v[112:115]
    ds_read_b64_tr_b16 a[112:113], v20 offset:16384
    v_mfma_f32_16x16x32_bf16 v[116:119], a[44:47], a[8:11], v[116:119]
    ds_read_b64_tr_b16 a[114:115], v20 offset:18432
    v_mfma_f32_16x16x32_bf16 v[120:123], a[40:43], a[12:15], v[120:123]
    buffer_load_dwordx4 v4, s[8:11], s39 offen offset:2048 lds
    v_mfma_f32_16x16x32_bf16 v[124:127], a[44:47], a[12:15], v[124:127]
    ds_read_b128 a[84:87], v15 offset:10240
    v_mfma_f32_16x16x32_bf16 v[128:131], a[48:51], a[8:11], v[128:131]
    ds_read_b64_tr_b16 a[116:117], v21 offset:16384
    v_mfma_f32_16x16x32_bf16 v[132:135], a[52:55], a[8:11], v[132:135]
    ds_read_b64_tr_b16 a[118:119], v21 offset:18432
    v_mfma_f32_16x16x32_bf16 v[136:139], a[48:51], a[12:15], v[136:139]
    v_mfma_f32_16x16x32_bf16 v[140:143], a[52:55], a[12:15], v[140:143]
    ds_read_b128 a[88:91], v15 offset:12288
    v_mfma_f32_16x16x32_bf16 v[144:147], a[56:59], a[8:11], v[144:147]
    ds_read_b64_tr_b16 a[120:121], v27 offset:16384
    v_mfma_f32_16x16x32_bf16 v[148:151], a[60:63], a[8:11], v[148:151]
    ds_read_b64_tr_b16 a[122:123], v27 offset:18432
    v_mfma_f32_16x16x32_bf16 v[152:155], a[56:59], a[12:15], v[152:155]
    buffer_load_dwordx4 v5, s[8:11], s39 offen offset:3072 lds
    v_mfma_f32_16x16x32_bf16 v[156:159], a[60:63], a[12:15], v[156:159]
    ds_read_b128 a[92:95], v15 offset:14336
    v_mfma_f32_16x16x32_bf16 v[160:163], a[32:35], a[16:19], v[160:163]
    ds_read_b64_tr_b16 a[124:125], v31 offset:16384
    v_mfma_f32_16x16x32_bf16 v[164:167], a[36:39], a[16:19], v[164:167]
    ds_read_b64_tr_b16 a[126:127], v31 offset:18432
    v_mfma_f32_16x16x32_bf16 v[168:171], a[32:35], a[20:23], v[168:171]
    s_mov_b32 m0, s42
    v_mfma_f32_16x16x32_bf16 v[172:175], a[36:39], a[20:23], v[172:175]
    v_mfma_f32_16x16x32_bf16 v[176:179], a[40:43], a[16:19], v[176:179]
    buffer_load_dwordx4 v10, s[12:15], s40 offen offset:0 lds
    v_mfma_f32_16x16x32_bf16 v[180:183], a[44:47], a[16:19], v[180:183]
    v_mfma_f32_16x16x32_bf16 v[184:187], a[40:43], a[20:23], v[184:187]
    s_add_u32 s47, s47, 1
    s_cmp_eq_u32 s47, 3
    v_mfma_f32_16x16x32_bf16 v[188:191], a[44:47], a[20:23], v[188:191]
    s_cselect_b32 s46, 0xffff0000, s57
    s_cselect_b32 s47, 0, s47
    v_mfma_f32_16x16x32_bf16 v[192:195], a[48:51], a[16:19], v[192:195]
    v_mfma_f32_16x16x32_bf16 v[196:199], a[52:55], a[16:19], v[196:199]
    buffer_load_dwordx4 v11, s[12:15], s40 offen offset:1024 lds
    v_mfma_f32_16x16x32_bf16 v[200:203], a[48:51], a[20:23], v[200:203]
    v_mfma_f32_16x16x32_bf16 v[204:207], a[52:55], a[20:23], v[204:207]
    v_add_u32 v14, s46, v14
    v_mfma_f32_16x16x32_bf16 v[208:211], a[56:59], a[16:19], v[208:211]
    v_add_u32 v15, s46, v15
    v_mfma_f32_16x16x32_bf16 v[212:215], a[60:63], a[16:19], v[212:215]
    v_mfma_f32_16x16x32_bf16 v[216:219], a[56:59], a[20:23], v[216:219]
    buffer_load_dwordx4 v12, s[12:15], s40 offen offset:2048 lds
    v_mfma_f32_16x16x32_bf16 v[220:223], a[60:63], a[20:23], v[220:223]
    v_mfma_f32_16x16x32_bf16 a[128:131], a[32:35], a[24:27], a[128:131]
    v_xor_b32 v16, 0x8000, v16
    v_mfma_f32_16x16x32_bf16 a[132:135], a[36:39], a[24:27], a[132:135]
    v_xor_b32 v17, 0x8000, v17
    v_mfma_f32_16x16x32_bf16 a[136:139], a[32:35], a[28:31], a[136:139]
    v_mfma_f32_16x16x32_bf16 a[140:143], a[36:39], a[28:31], a[140:143]
    buffer_load_dwordx4 v13, s[12:15], s40 offen offset:3072 lds
    v_mfma_f32_16x16x32_bf16 a[144:147], a[40:43], a[24:27], a[144:147]
    v_mfma_f32_16x16x32_bf16 a[148:151], a[44:47], a[24:27], a[148:151]
    s_add_u32 s40, s40, s48
    s_and_b32 s40, s40, 0x7fffff
    v_mfma_f32_16x16x32_bf16 a[152:155], a[40:43], a[28:31], a[152:155]
    v_mfma_f32_16x16x32_bf16 a[156:159], a[44:47], a[28:31], a[156:159]
    v_xor_b32 v18, 0x8000, v18
    v_mfma_f32_16x16x32_bf16 a[160:163], a[48:51], a[24:27], a[160:163]
    v_xor_b32 v19, 0x8000, v19
    v_mfma_f32_16x16x32_bf16 a[164:167], a[52:55], a[24:27], a[164:167]
    v_xor_b32 v20, 0x8000, v20
    v_mfma_f32_16x16x32_bf16 a[168:171], a[48:51], a[28:31], a[168:171]
    v_xor_b32 v21, 0x8000, v21
    v_mfma_f32_16x16x32_bf16 a[172:175], a[52:55], a[28:31], a[172:175]
    v_xor_b32 v27, 0x8000, v27
    v_mfma_f32_16x16x32_bf16 a[176:179], a[56:59], a[24:27], a[176:179]
    v_xor_b32 v31, 0x8000, v31
    v_mfma_f32_16x16x32_bf16 a[180:183], a[60:63], a[24:27], a[180:183]
    v_mfma_f32_16x16x32_bf16 a[184:187], a[56:59], a[28:31], a[184:187]
    v_mfma_f32_16x16x32_bf16 a[188:191], a[60:63], a[28:31], a[188:191]
    s_waitcnt lgkmcnt(0)
    v_mfma_f32_16x16x32_bf16 v[32:35], a[96:99], a[64:67], v[32:35]
    v_mfma_f32_16x16x32_bf16 v[36:39], a[100:103], a[64:67], v[36:39]
    s_waitcnt vmcnt(12)
    s_barrier
    v_mfma_f32_16x16x32_bf16 v[40:43], a[96:99], a[68:71], v[40:43]
    s_add_u32 m0, s41, 4096
    v_mfma_f32_16x16x32_bf16 v[44:47], a[100:103], a[68:71], v[44:47]
    ds_read_b128 a[0:3], v14 offset:0
    v_mfma_f32_16x16x32_bf16 v[48:51], a[104:107], a[64:67], v[48:51]
    ds_read_b64_tr_b16 a[32:33], v16 offset:0
    v_mfma_f32_16x16x32_bf16 v[52:55], a[108:111], a[64:67], v[52:55]
    ds_read_b64_tr_b16 a[34:35], v16 offset:2048
    v_mfma_f32_16x16x32_bf16 v[56:59], a[104:107], a[68:71], v[56:59]
    buffer_load_dwordx4 v6, s[8:11], s39 offen offset:0 lds
    v_mfma_f32_16x16x32_bf16 v[60:63], a[108:111], a[68:71], v[60:63]
    ds_read_b128 a[4:7], v14 offset:2048
    v_mfma_f32_16x16x32_bf16 v[64:67], a[112:115], a[64:67], v[64:67]
    ds_read_b64_tr_b16 a[36:37], v17 offset:0
    v_mfma_f32_16x16x32_bf16 v[68:71], a[116:119], a[64:67], v[68:71]
    ds_read_b64_tr_b16 a[38:39], v17 offset:2048
    v_mfma_f32_16x16x32_bf16 v[72:75], a[112:115], a[68:71], v[72:75]
    v_mfma_f32_16x16x32_bf16 v[76:79], a[116:119], a[68:71], v[76:79]
    ds_read_b128 a[8:11], v14 offset:4096
    v_mfma_f32_16x16x32_bf16 v[80:83], a[120:123], a[64:67], v[80:83]
    ds_read_b64_tr_b16 a[40:41], v18 offset:0
    v_mfma_f32_16x16x32_bf16 v[84:87], a[124:127], a[64:67], v[84:87]
    ds_read_b64_tr_b16 a[42:43], v18 offset:2048
    v_mfma_f32_16x16x32_bf16 v[88:91], a[120:123], a[68:71], v[88:91]
    buffer_load_dwordx4 v7, s[8:11], s39 offen offset:1024 lds
    v_mfma_f32_16x16x32_bf16 v[92:95], a[124:127], a[68:71], v[92:95]
    ds_read_b128 a[12:15], v14 offset:6144
    v_mfma_f32_16x16x32_bf16 v[96:99], a[96:99], a[72:75], v[96:99]
    ds_read_b64_tr_b16 a[44:45], v19 offset:0
    v_mfma_f32_16x16x32_bf16 v[100:103], a[100:103], a[72:75], v[100:103]
    ds_read_b64_tr_b16 a[46:47], v19 offset:2048
    v_mfma_f32_16x16x32_bf16 v[104:107], a[96:99], a[76:79], v[104:107]
    v_mfma_f32_16x16x32_bf16 v[108:111], a[100:103], a[76:79], v[108:111]
    ds_read_b128 a[16:19], v14 offset:8192
    v_mfma_f32_16x16x32_bf16 v[112:115], a[104:107], a[72:75], v[112:115]
    ds_read_b64_tr_b16 a[48:49], v20 offset:0
    v_mfma_f32_16x16x32_bf16 v[116:119], a[108:111], a[72:75], v[116:119]
    ds_read_b64_tr_b16 a[50:51], v20 offset:2048
    v_mfma_f32_16x16x32_bf16 v[120:123], a[104:107], a[76:79], v[120:123]
    buffer_load_dwordx4 v8, s[8:11], s39 offen offset:2048 lds
    v_mfma_f32_16x16x32_bf16 v[124:127], a[108:111], a[76:79], v[124:127]
    ds_read_b128 a[20:23], v14 offset:10240
    v_mfma_f32_16x16x32_bf16 v[128:131], a[112:115], a[72:75], v[128:131]
    ds_read_b64_tr_b16 a[52:53], v21 offset:0
    v_mfma_f32_16x16x32_bf16 v[132:135], a[116:119], a[72:75], v[132:135]
    ds_read_b64_tr_b16 a[54:55], v21 offset:2048
    v_mfma_f32_16x16x32_bf16 v[136:139], a[112:115], a[76:79], v[136:139]
    v_mfma_f32_16x16x32_bf16 v[140:143], a[116:119], a[76:79], v[140:143]
    ds_read_b128 a[24:27], v14 offset:12288
    v_mfma_f32_16x16x32_bf16 v[144:147], a[120:123], a[72:75], v[144:147]
    ds_read_b64_tr_b16 a[56:57], v27 offset:0
    v_mfma_f32_16x16x32_bf16 v[148:151], a[124:127], a[72:75], v[148:151]
    ds_read_b64_tr_b16 a[58:59], v27 offset:2048
    v_mfma_f32_16x16x32_bf16 v[152:155], a[120:123], a[76:79], v[152:155]
    buffer_load_dwordx4 v9, s[8:11], s39 offen offset:3072 lds
    v_mfma_f32_16x16x32_bf16 v[156:159], a[124:127], a[76:79], v[156:159]
    ds_read_b128 a[28:31], v14 offset:14336
    v_mfma_f32_16x16x32_bf16 v[160:163], a[96:99], a[80:83], v[160:163]
    ds_read_b64_tr_b16 a[60:61], v31 offset:0
    v_mfma_f32_16x16x32_bf16 v[164:167], a[100:103], a[80:83], v[164:167]
    ds_read_b64_tr_b16 a[62:63], v31 offset:2048
    v_mfma_f32_16x16x32_bf16 v[168:171], a[96:99], a[84:87], v[168:171]
    s_add_u32 m0, s42, 16384
    v_mfma_f32_16x16x32_bf16 v[172:175], a[100:103], a[84:87], v[172:175]
    v_mfma_f32_16x16x32_bf16 v[176:179], a[104:107], a[80:83], v[176:179]
    buffer_load_dwordx4 v10, s[12:15], s40 offen offset:0 lds
    v_mfma_f32_16x16x32_bf16 v[180:183], a[108:111], a[80:83], v[180:183]
    v_mfma_f32_16x16x32_bf16 v[184:187], a[104:107], a[84:87], v[184:187]
    s_add_u32 s39, s39, s64
    s_add_u32 s41, s41, 32768
    v_mfma_f32_16x16x32_bf16 v[188:191], a[108:111], a[84:87], v[188:191]
    s_and_b32 s39, s39, s52
    s_xor_b32 s42, s42, 0x8000
    v_mfma_f32_16x16x32_bf16 v[192:195], a[112:115], a[80:83], v[192:195]
    v_mfma_f32_16x16x32_bf16 v[196:199], a[116:119], a[80:83], v[196:199]
    buffer_load_dwordx4 v11, s[12:15], s40 offen offset:1024 lds
    v_mfma_f32_16x16x32_bf16 v[200:203], a[112:115], a[84:87], v[200:203]
    v_mfma_f32_16x16x32_bf16 v[204:207], a[116:119], a[84:87], v[204:207]
    s_cmp_ge_u32 s41, s53
    s_cselect_b32 s54, 98304, 0
    s_sub_u32 s41, s41, s54
    v_mfma_f32_16x16x32_bf16 v[208:211], a[120:123], a[80:83], v[208:211]
    v_mfma_f32_16x16x32_bf16 v[212:215], a[124:127], a[80:83], v[212:215]
    v_mfma_f32_16x16x32_bf16 v[216:219], a[120:123], a[84:87], v[216:219]
    buffer_load_dwordx4 v12, s[12:15], s40 offen offset:2048 lds
    v_mfma_f32_16x16x32_bf16 v[220:223], a[124:127], a[84:87], v[220:223]
    v_mfma_f32_16x16x32_bf16 a[128:131], a[96:99], a[88:91], a[128:131]
    v_mfma_f32_16x16x32_bf16 a[132:135], a[100:103], a[88:91], a[132:135]
    v_mfma_f32_16x16x32_bf16 a[136:139], a[96:99], a[92:95], a[136:139]
    v_mfma_f32_16x16x32_bf16 a[140:143], a[100:103], a[92:95], a[140:143]
    buffer_load_dwordx4 v13, s[12:15], s40 offen offset:3072 lds
    v_mfma_f32_16x16x32_bf16 a[144:147], a[104:107], a[88:91], a[144:147]
    v_mfma_f32_16x16x32_bf16 a[148:151], a[108:111], a[88:91], a[148:151]
    s_add_u32 s40, s40, s48
    s_and_b32 s40, s40, 0x7fffff
    v_mfma_f32_16x16x32_bf16 a[152:155], a[104:107], a[92:95], a[152:155]
    v_mfma_f32_16x16x32_bf16 a[156:159], a[108:111], a[92:95], a[156:159]
    v_mfma_f32_16x16x32_bf16 a[160:163], a[112:115], a[88:91], a[160:163]
    v_mfma_f32_16x16x32_bf16 a[164:167], a[116:119], a[88:91], a[164:167]
    v_mfma_f32_16x16x32_bf16 a[168:171], a[112:115], a[92:95], a[168:171]
    v_mfma_f32_16x16x32_bf16 a[172:175], a[116:119], a[92:95], a[172:175]
    v_mfma_f32_16x16x32_bf16 a[176:179], a[120:123], a[88:91], a[176:179]
    s_add_u32 s43, s43, 1
    v_mfma_f32_16x16x32_bf16 a[180:183], a[124:127], a[88:91], a[180:183]
    v_mfma_f32_16x16x32_bf16 a[184:187], a[120:123], a[92:95], a[184:187]
    s_bitcmp1_b32 s44, s43
    v_mfma_f32_16x16x32_bf16 a[188:191], a[124:127], a[92:95], a[188:191]
    s_cbranch_scc0 L_k1_loopK
    s_branch L_k1_loopK_evt
L_k1_firstV:
    ds_read_b128 a[0:3], v14 offset:0
    ds_read_b64_tr_b16 a[32:33], v16 offset:0
    ds_read_b64_tr_b16 a[34:35], v16 offset:2048
    ds_read_b128 a[4:7], v14 offset:2048
    ds_read_b64_tr_b16 a[36:37], v17 offset:0
    ds_read_b64_tr_b16 a[38:39], v17 offset:2048
    ds_read_b128 a[8:11], v14 offset:4096
    ds_read_b64_tr_b16 a[40:41], v18 offset:0
    ds_read_b64_tr_b16 a[42:43], v18 offset:2048
    ds_read_b128 a[12:15], v14 offset:6144
    ds_read_b64_tr_b16 a[44:45], v19 offset:0
    ds_read_b64_tr_b16 a[46:47], v19 offset:2048
    ds_read_b128 a[16:19], v14 offset:8192
    ds_read_b64_tr_b16 a[48:49], v20 offset:0
    ds_read_b64_tr_b16 a[50:51], v20 offset:2048
    ds_read_b128 a[20:23], v14 offset:10240
    ds_read_b64_tr_b16 a[52:53], v21 offset:0
    ds_read_b64_tr_b16 a[54:55], v21 offset:2048
    ds_read_b128 a[24:27], v14 offset:12288
    ds_read_b64_tr_b16 a[56:57], v27 offset:0
    ds_read_b64_tr_b16 a[58:59], v27 offset:2048
    ds_read_b128 a[28:31], v14 offset:14336
    ds_read_b64_tr_b16 a[60:61], v31 offset:0
    ds_read_b64_tr_b16 a[62:63], v31 offset:2048
L_k1_firstV2:
    s_waitcnt lgkmcnt(0)
    v_mfma_f32_16x16x32_bf16 v[32:35], a[0:3], a[32:35], 0
    s_mov_b32 m0, s41
    v_lshlrev_b32 v232, 16, v224
    v_mfma_f32_16x16x32_bf16 v[40:43], a[0:3], a[36:39], 0
    buffer_load_dwordx4 v2, s[8:11], s39 offen offset:0 lds
    v_and_b32 v233, 0xffff0000, v224
    v_mfma_f32_16x16x32_bf16 v[36:39], a[4:7], a[32:35], 0
    v_lshlrev_b32 v234, 16, v225
    v_and_b32 v235, 0xffff0000, v225
    v_mfma_f32_16x16x32_bf16 v[44:47], a[4:7], a[36:39], 0
    buffer_load_dwordx4 v3, s[8:11], s39 offen offset:1024 lds
    v_lshlrev_b32 v236, 16, v226
    v_mfma_f32_16x16x32_bf16 v[48:51], a[0:3], a[40:43], 0
    v_and_b32 v237, 0xffff0000, v226
    v_lshlrev_b32 v238, 16, v227
    v_mfma_f32_16x16x32_bf16 v[56:59], a[0:3], a[44:47], 0
    v_and_b32 v239, 0xffff0000, v227
    v_lshlrev_b32 v240, 16, v228
    v_mfma_f32_16x16x32_bf16 v[52:55], a[4:7], a[40:43], 0
    buffer_load_dwordx4 v4, s[8:11], s39 offen offset:2048 lds
    v_and_b32 v241, 0xffff0000, v228
    v_mfma_f32_16x16x32_bf16 v[60:63], a[4:7], a[44:47], 0
    v_lshlrev_b32 v242, 16, v229
    v_and_b32 v243, 0xffff0000, v229
    v_mfma_f32_16x16x32_bf16 v[64:67], a[0:3], a[48:51], 0
    buffer_load_dwordx4 v5, s[8:11], s39 offen offset:3072 lds
    v_lshlrev_b32 v244, 16, v230
    v_mfma_f32_16x16x32_bf16 v[72:75], a[0:3], a[52:55], 0
    s_mov_b32 m0, s42
    v_and_b32 v245, 0xffff0000, v230
    v_mfma_f32_16x16x32_bf16 v[68:71], a[4:7], a[48:51], 0
    v_lshlrev_b32 v246, 16, v231
    v_and_b32 v247, 0xffff0000, v231
    v_mfma_f32_16x16x32_bf16 v[76:79], a[4:7], a[52:55], 0
    buffer_load_dwordx4 v10, s[12:15], s40 offen offset:0 lds
    v_add_f32 v248, v232, v233
    v_mfma_f32_16x16x32_bf16 v[80:83], a[0:3], a[56:59], 0
    v_add_f32 v248, v248, v234
    v_add_f32 v248, v248, v235
    v_mfma_f32_16x16x32_bf16 v[88:91], a[0:3], a[60:63], 0
    buffer_load_dwordx4 v11, s[12:15], s40 offen offset:1024 lds
    v_add_f32 v248, v248, v236
    v_mfma_f32_16x16x32_bf16 v[84:87], a[4:7], a[56:59], 0
    v_add_f32 v248, v248, v237
    v_add_f32 v248, v248, v238
    v_mfma_f32_16x16x32_bf16 v[92:95], a[4:7], a[60:63], 0
    v_add_f32 v248, v248, v239
    v_add_f32 v248, v248, v240
    v_mfma_f32_16x16x32_bf16 v[96:99], a[8:11], a[32:35], 0
    buffer_load_dwordx4 v12, s[12:15], s40 offen offset:2048 lds
    v_add_f32 v248, v248, v241
    v_mfma_f32_16x16x32_bf16 v[104:107], a[8:11], a[36:39], 0
    v_add_f32 v248, v248, v242
    v_add_f32 v248, v248, v243
    v_mfma_f32_16x16x32_bf16 v[100:103], a[12:15], a[32:35], 0
    buffer_load_dwordx4 v13, s[12:15], s40 offen offset:3072 lds
    v_add_f32 v248, v248, v244
    v_mfma_f32_16x16x32_bf16 v[108:111], a[12:15], a[36:39], 0
    s_add_u32 s40, s40, s48
    s_and_b32 s40, s40, 0x7fffff
    v_mfma_f32_16x16x32_bf16 v[112:115], a[8:11], a[40:43], 0
    s_add_u32 m0, s41, 4096
    v_add_f32 v248, v248, v245
    v_mfma_f32_16x16x32_bf16 v[120:123], a[8:11], a[44:47], 0
    buffer_load_dwordx4 v6, s[8:11], s39 offen offset:0 lds
    v_add_f32 v248, v248, v246
    v_mfma_f32_16x16x32_bf16 v[116:119], a[12:15], a[40:43], 0
    v_add_f32 v248, v248, v247
    s_nop 1
    v_mfma_f32_16x16x32_bf16 v[124:127], a[12:15], a[44:47], 0
    buffer_load_dwordx4 v7, s[8:11], s39 offen offset:1024 lds
    v_add_f32_dpp v248, v248, v248 quad_perm:[1,0,3,2] row_mask:0xf bank_mask:0xf
    v_mfma_f32_16x16x32_bf16 v[128:131], a[8:11], a[48:51], 0
    s_waitcnt vmcnt(10)
    s_barrier
    v_mfma_f32_16x16x32_bf16 v[136:139], a[8:11], a[52:55], 0
    s_nop 1
    v_add_f32_dpp v248, v248, v248 quad_perm:[2,3,0,1] row_mask:0xf bank_mask:0xf
    v_mfma_f32_16x16x32_bf16 v[132:135], a[12:15], a[48:51], 0
    ds_read_b128 a[64:67], v15 offset:0
    buffer_load_dwordx4 v8, s[8:11], s39 offen offset:2048 lds
    v_mfma_f32_16x16x32_bf16 v[140:143], a[12:15], a[52:55], 0
    ds_read_b64_tr_b16 a[96:97], v16 offset:16384
    s_nop 1
    v_mfma_f32_16x16x32_bf16 v[144:147], a[8:11], a[56:59], 0
    buffer_load_dwordx4 v9, s[8:11], s39 offen offset:3072 lds
    v_add_f32_dpp v248, v248, v248 row_half_mirror row_mask:0xf bank_mask:0xf
    v_mfma_f32_16x16x32_bf16 v[152:155], a[8:11], a[60:63], 0
    ds_read_b64_tr_b16 a[98:99], v16 offset:18432
    s_add_u32 m0, s42, 16384
    v_mfma_f32_16x16x32_bf16 v[148:151], a[12:15], a[56:59], 0
    ds_read_b128 a[68:71], v15 offset:2048
    s_nop 1
    v_mfma_f32_16x16x32_bf16 v[156:159], a[12:15], a[60:63], 0
    buffer_load_dwordx4 v10, s[12:15], s40 offen offset:0 lds
    v_add_f32_dpp v248, v248, v248 row_mirror row_mask:0xf bank_mask:0xf
    v_mfma_f32_16x16x32_bf16 v[160:163], a[16:19], a[32:35], 0
    ds_read_b64_tr_b16 a[100:101], v17 offset:16384
    v_mov_b32 v249, v248
    v_mfma_f32_16x16x32_bf16 v[168:171], a[16:19], a[36:39], 0
    ds_read_b64_tr_b16 a[102:103], v17 offset:18432
    s_nop 1
    v_mfma_f32_16x16x32_bf16 v[164:167], a[20:23], a[32:35], 0
    buffer_load_dwordx4 v11, s[12:15], s40 offen offset:1024 lds
    v_permlane16_swap_b32 v248, v249
    v_mfma_f32_16x16x32_bf16 v[172:175], a[20:23], a[36:39], 0
    ds_read_b128 a[72:75], v15 offset:4096
    s_nop 1
    v_mfma_f32_16x16x32_bf16 v[176:179], a[16:19], a[40:43], 0
    ds_read_b64_tr_b16 a[104:105], v18 offset:16384
    buffer_load_dwordx4 v12, s[12:15], s40 offen offset:2048 lds
    v_mfma_f32_16x16x32_bf16 v[184:187], a[16:19], a[44:47], 0
    v_add_f32 v248, v248, v249
    v_mul_f32 v248, 0x3b124925, v248
    v_mfma_f32_16x16x32_bf16 v[180:183], a[20:23], a[40:43], 0
    ds_read_b64_tr_b16 a[106:107], v18 offset:18432
    v_sub_f32 v250, v232, v248
    v_mfma_f32_16x16x32_bf16 v[188:191], a[20:23], a[44:47], 0
    ds_read_b128 a[76:79], v15 offset:6144
    buffer_load_dwordx4 v13, s[12:15], s40 offen offset:3072 lds
    v_mfma_f32_16x16x32_bf16 v[192:195], a[16:19], a[48:51], 0
    s_add_u32 s40, s40, s48
    s_and_b32 s40, s40, 0x7fffff
    v_mfma_f32_16x16x32_bf16 v[200:203], a[16:19], a[52:55], 0
    ds_read_b64_tr_b16 a[108:109], v19 offset:16384
    s_xor_b32 s42, s42, 0x8000
    v_mfma_f32_16x16x32_bf16 v[196:199], a[20:23], a[48:51], 0
    ds_read_b64_tr_b16 a[110:111], v19 offset:18432
    s_add_u32 s39, s39, s64
    v_mfma_f32_16x16x32_bf16 v[204:207], a[20:23], a[52:55], 0
    s_add_u32 s41, s41, 32768
    s_and_b32 s39, s39, s52
    v_mfma_f32_16x16x32_bf16 v[208:211], a[16:19], a[56:59], 0
    ds_read_b128 a[80:83], v15 offset:8192
    s_cmp_ge_u32 s41, s53
    s_cselect_b32 s54, 98304, 0
    s_sub_u32 s41, s41, s54
    v_mfma_f32_16x16x32_bf16 v[216:219], a[16:19], a[60:63], 0
    ds_read_b64_tr_b16 a[112:113], v20 offset:16384
    s_mov_b32 m0, s41
    v_mfma_f32_16x16x32_bf16 v[212:215], a[20:23], a[56:59], 0
    buffer_load_dwordx4 v2, s[8:11], s39 offen offset:0 lds
    v_mul_f32 v251, v250, v250
    v_mfma_f32_16x16x32_bf16 v[220:223], a[20:23], a[60:63], 0
    ds_read_b64_tr_b16 a[114:115], v20 offset:18432
    buffer_load_dwordx4 v3, s[8:11], s39 offen offset:1024 lds
    v_mfma_f32_16x16x32_bf16 a[128:131], a[24:27], a[32:35], 0
    ds_read_b128 a[84:87], v15 offset:10240
    buffer_load_dwordx4 v4, s[8:11], s39 offen offset:2048 lds
    v_mfma_f32_16x16x32_bf16 a[136:139], a[24:27], a[36:39], 0
    buffer_load_dwordx4 v5, s[8:11], s39 offen offset:3072 lds
    v_sub_f32 v250, v233, v248
    v_mfma_f32_16x16x32_bf16 a[132:135], a[28:31], a[32:35], 0
    ds_read_b64_tr_b16 a[116:117], v21 offset:16384
    s_mov_b32 m0, s42
    v_mfma_f32_16x16x32_bf16 a[140:143], a[28:31], a[36:39], 0
    ds_read_b64_tr_b16 a[118:119], v21 offset:18432
    buffer_load_dwordx4 v10, s[12:15], s40 offen offset:0 lds
    v_mfma_f32_16x16x32_bf16 a[144:147], a[24:27], a[40:43], 0
    v_fmac_f32 v251, v250, v250
    v_sub_f32 v250, v234, v248
    v_mfma_f32_16x16x32_bf16 a[152:155], a[24:27], a[44:47], 0
    ds_read_b128 a[88:91], v15 offset:12288
    v_fmac_f32 v251, v250, v250
    v_mfma_f32_16x16x32_bf16 a[148:151], a[28:31], a[40:43], 0
    ds_read_b64_tr_b16 a[120:121], v27 offset:16384
    buffer_load_dwordx4 v11, s[12:15], s40 offen offset:1024 lds
    v_mfma_f32_16x16x32_bf16 a[156:159], a[28:31], a[44:47], 0
    v_sub_f32 v250, v235, v248
    v_fmac_f32 v251, v250, v250
    v_mfma_f32_16x16x32_bf16 a[160:163], a[24:27], a[48:51], 0
    ds_read_b64_tr_b16 a[122:123], v27 offset:18432
    buffer_load_dwordx4 v12, s[12:15], s40 offen offset:2048 lds
    v_mfma_f32_16x16x32_bf16 a[168:171], a[24:27], a[52:55], 0
    ds_read_b128 a[92:95], v15 offset:14336
    v_sub_f32 v250, v236, v248
    v_mfma_f32_16x16x32_bf16 a[164:167], a[28:31], a[48:51], 0
    v_fmac_f32 v251, v250, v250
    v_sub_f32 v250, v237, v248
    v_mfma_f32_16x16x32_bf16 a[172:175], a[28:31], a[52:55], 0
    ds_read_b64_tr_b16 a[124:125], v31 offset:16384
    buffer_load_dwordx4 v13, s[12:15], s40 offen offset:3072 lds
    v_mfma_f32_16x16x32_bf16 a[176:179], a[24:27], a[56:59], 0
    ds_read_b64_tr_b16 a[126:127], v31 offset:18432
    s_add_u32 s40, s40, s48
    s_and_b32 s40, s40, 0x7fffff
    v_mfma_f32_16x16x32_bf16 a[184:187], a[24:27], a[60:63], 0
    v_fmac_f32 v251, v250, v250
    v_sub_f32 v250, v238, v248
    v_mfma_f32_16x16x32_bf16 a[180:183], a[28:31], a[56:59], 0
    s_mov_b32 s47, 1
    s_mov_b32 s46, 32768
    v_mfma_f32_16x16x32_bf16 a[188:191], a[28:31], a[60:63], 0
    v_add_u32 v14, s46, v14
    v_add_u32 v15, s46, v15
    v_xor_b32 v16, 0x8000, v16
    v_xor_b32 v17, 0x8000, v17
    v_xor_b32 v18, 0x8000, v18
    v_xor_b32 v19, 0x8000, v19
    v_xor_b32 v20, 0x8000, v20
    v_xor_b32 v21, 0x8000, v21
    v_xor_b32 v27, 0x8000, v27
    v_xor_b32 v31, 0x8000, v31
    s_waitcnt lgkmcnt(0)
    v_mfma_f32_16x16x32_bf16 v[32:35], a[64:67], a[96:99], v[32:35]
    v_fmac_f32 v251, v250, v250
    v_sub_f32 v250, v239, v248
    v_mfma_f32_16x16x32_bf16 v[40:43], a[64:67], a[100:103], v[40:43]
    s_waitcnt vmcnt(12)
    s_barrier
    v_mfma_f32_16x16x32_bf16 v[36:39], a[68:71], a[96:99], v[36:39]
    s_add_u32 m0, s41, 4096
    v_fmac_f32 v251, v250, v250
    v_mfma_f32_16x16x32_bf16 v[44:47], a[68:71], a[100:103], v[44:47]
    ds_read_b128 a[0:3], v14 offset:0
    buffer_load_dwordx4 v6, s[8:11], s39 offen offset:0 lds
    v_mfma_f32_16x16x32_bf16 v[48:51], a[64:67], a[104:107], v[48:51]
    ds_read_b64_tr_b16 a[32:33], v16 offset:0
    v_sub_f32 v250, v240, v248
    v_mfma_f32_16x16x32_bf16 v[56:59], a[64:67], a[108:111], v[56:59]
    v_mul_f32 v252, v250, v250
    v_sub_f32 v250, v241, v248
    v_mfma_f32_16x16x32_bf16 v[52:55], a[68:71], a[104:107], v[52:55]
    ds_read_b64_tr_b16 a[34:35], v16 offset:2048
    v_fmac_f32 v252, v250, v250
    v_mfma_f32_16x16x32_bf16 v[60:63], a[68:71], a[108:111], v[60:63]
    ds_read_b128 a[4:7], v14 offset:2048
    v_sub_f32 v250, v242, v248
    v_mfma_f32_16x16x32_bf16 v[64:67], a[64:67], a[112:115], v[64:67]
    buffer_load_dwordx4 v7, s[8:11], s39 offen offset:1024 lds
    v_fmac_f32 v252, v250, v250
    v_mfma_f32_16x16x32_bf16 v[72:75], a[64:67], a[116:119], v[72:75]
    ds_read_b64_tr_b16 a[36:37], v17 offset:0
    v_sub_f32 v250, v243, v248
    v_mfma_f32_16x16x32_bf16 v[68:71], a[68:71], a[112:115], v[68:71]
    ds_read_b64_tr_b16 a[38:39], v17 offset:2048
    v_fmac_f32 v252, v250, v250
    v_mfma_f32_16x16x32_bf16 v[76:79], a[68:71], a[116:119], v[76:79]
    v_sub_f32 v250, v244, v248
    v_fmac_f32 v252, v250, v250
    v_mfma_f32_16x16x32_bf16 v[80:83], a[64:67], a[120:123], v[80:83]
    ds_read_b128 a[8:11], v14 offset:4096
    v_sub_f32 v250, v245, v248
    v_mfma_f32_16x16x32_bf16 v[88:91], a[64:67], a[124:127], v[88:91]
    ds_read_b64_tr_b16 a[40:41], v18 offset:0
    buffer_load_dwordx4 v8, s[8:11], s39 offen offset:2048 lds
    v_mfma_f32_16x16x32_bf16 v[84:87], a[68:71], a[120:123], v[84:87]
    v_fmac_f32 v252, v250, v250
    v_sub_f32 v250, v246, v248
    v_mfma_f32_16x16x32_bf16 v[92:95], a[68:71], a[124:127], v[92:95]
    ds_read_b64_tr_b16 a[42:43], v18 offset:2048
    v_fmac_f32 v252, v250, v250
    v_mfma_f32_16x16x32_bf16 v[96:99], a[72:75], a[96:99], v[96:99]
    ds_read_b128 a[12:15], v14 offset:6144
    v_sub_f32 v250, v247, v248
    v_mfma_f32_16x16x32_bf16 v[104:107], a[72:75], a[100:103], v[104:107]
    v_fmac_f32 v252, v250, v250
    v_cndmask_b32 v252, 0, v252, vcc
    v_mfma_f32_16x16x32_bf16 v[100:103], a[76:79], a[96:99], v[100:103]
    ds_read_b64_tr_b16 a[44:45], v19 offset:0
    buffer_load_dwordx4 v9, s[8:11], s39 offen offset:3072 lds
    v_mfma_f32_16x16x32_bf16 v[108:111], a[76:79], a[100:103], v[108:111]
    ds_read_b64_tr_b16 a[46:47], v19 offset:2048
    s_add_u32 s39, s39, s64
    v_mfma_f32_16x16x32_bf16 v[112:115], a[72:75], a[104:107], v[112:115]
    s_add_u32 s41, s41, 32768
    s_and_b32 s39, s39, s52
    v_mfma_f32_16x16x32_bf16 v[120:123], a[72:75], a[108:111], v[120:123]
    ds_read_b128 a[16:19], v14 offset:8192
    s_cmp_ge_u32 s41, s53
    s_cselect_b32 s54, 98304, 0
    s_sub_u32 s41, s41, s54
    v_mfma_f32_16x16x32_bf16 v[116:119], a[76:79], a[104:107], v[116:119]
    ds_read_b64_tr_b16 a[48:49], v20 offset:0
    s_add_u32 m0, s42, 16384
    v_mfma_f32_16x16x32_bf16 v[124:127], a[76:79], a[108:111], v[124:127]
    buffer_load_dwordx4 v10, s[12:15], s40 offen offset:0 lds
    v_add_f32 v251, v251, v252
    v_mfma_f32_16x16x32_bf16 v[128:131], a[72:75], a[112:115], v[128:131]
    ds_read_b64_tr_b16 a[50:51], v20 offset:2048
    s_nop 1
    v_add_f32_dpp v251, v251, v251 quad_perm:[1,0,3,2] row_mask:0xf bank_mask:0xf
    s_nop 1
    v_add_f32_dpp v251, v251, v251 quad_perm:[2,3,0,1] row_mask:0xf bank_mask:0xf
    s_nop 1
    v_add_f32_dpp v251, v251, v251 row_half_mirror row_mask:0xf bank_mask:0xf
    s_nop 1
    v_add_f32_dpp v251, v251, v251 row_mirror row_mask:0xf bank_mask:0xf
    v_mfma_f32_16x16x32_bf16 v[136:139], a[72:75], a[116:119], v[136:139]
    ds_read_b128 a[20:23], v14 offset:10240
    v_mov_b32 v249, v251
    s_nop 1
    v_permlane16_swap_b32 v251, v249
    s_nop 1
    v_add_f32 v251, v251, v249
    v_mul_f32 v251, 0x3b124925, v251
    v_cvt_pk_bf16_f32 v251, v251, v251
    v_and_b32 v251, 0xffff0000, v251
    v_mfma_f32_16x16x32_bf16 v[132:135], a[76:79], a[112:115], v[132:135]
    v_add_f32 v251, 0x3727c5ac, v251
    v_cvt_pk_bf16_f32 v251, v251, v251
    v_and_b32 v251, 0xffff0000, v251
    v_sqrt_f32 v251, v251
    s_nop 0
    v_cvt_pk_bf16_f32 v251, v251, v251
    v_and_b32 v251, 0xffff0000, v251
    v_rcp_f32 v251, v251
    v_mfma_f32_16x16x32_bf16 v[140:143], a[76:79], a[116:119], v[140:143]
    ds_read_b64_tr_b16 a[52:53], v21 offset:0
    v_cvt_pk_bf16_f32 v248, v248, v248
    v_and_b32 v248, 0xffff0000, v248
    v_sub_f32 v232, v232, v248
    v_sub_f32 v233, v233, v248
    v_cvt_pk_bf16_f32 v224, v232, v233
    v_lshlrev_b32 v232, 16, v224
    v_and_b32 v233, 0xffff0000, v224
    v_mul_f32 v232, v232, v251
    v_mfma_f32_16x16x32_bf16 v[144:147], a[72:75], a[120:123], v[144:147]
    ds_read_b64_tr_b16 a[54:55], v21 offset:2048
    buffer_load_dwordx4 v11, s[12:15], s40 offen offset:1024 lds
    v_mul_f32 v233, v233, v251
    v_cvt_pk_bf16_f32 v224, v232, v233
    v_sub_f32 v234, v234, v248
    v_sub_f32 v235, v235, v248
    v_cvt_pk_bf16_f32 v225, v234, v235
    v_lshlrev_b32 v234, 16, v225
    v_and_b32 v235, 0xffff0000, v225
    v_mul_f32 v234, v234, v251
    v_mfma_f32_16x16x32_bf16 v[152:155], a[72:75], a[124:127], v[152:155]
    v_mul_f32 v235, v235, v251
    v_cvt_pk_bf16_f32 v225, v234, v235
    v_sub_f32 v236, v236, v248
    v_sub_f32 v237, v237, v248
    v_cvt_pk_bf16_f32 v226, v236, v237
    v_lshlrev_b32 v236, 16, v226
    v_and_b32 v237, 0xffff0000, v226
    v_mul_f32 v236, v236, v251
    v_mfma_f32_16x16x32_bf16 v[148:151], a[76:79], a[120:123], v[148:151]
    ds_read_b128 a[24:27], v14 offset:12288
    v_mul_f32 v237, v237, v251
    v_cvt_pk_bf16_f32 v226, v236, v237
    v_sub_f32 v238, v238, v248
    v_sub_f32 v239, v239, v248
    v_cvt_pk_bf16_f32 v227, v238, v239
    v_lshlrev_b32 v238, 16, v227
    v_and_b32 v239, 0xffff0000, v227
    v_mfma_f32_16x16x32_bf16 v[156:159], a[76:79], a[124:127], v[156:159]
    ds_read_b64_tr_b16 a[56:57], v27 offset:0
    v_mul_f32 v238, v238, v251
    v_mul_f32 v239, v239, v251
    v_cvt_pk_bf16_f32 v227, v238, v239
    v_sub_f32 v240, v240, v248
    v_sub_f32 v241, v241, v248
    v_cvt_pk_bf16_f32 v228, v240, v241
    v_lshlrev_b32 v240, 16, v228
    v_mfma_f32_16x16x32_bf16 v[160:163], a[80:83], a[96:99], v[160:163]
    v_and_b32 v241, 0xffff0000, v228
    v_mul_f32 v240, v240, v251
    v_mul_f32 v241, v241, v251
    v_cvt_pk_bf16_f32 v228, v240, v241
    v_sub_f32 v242, v242, v248
    v_sub_f32 v243, v243, v248
    v_cvt_pk_bf16_f32 v229, v242, v243
    v_mfma_f32_16x16x32_bf16 v[168:171], a[80:83], a[100:103], v[168:171]
    ds_read_b64_tr_b16 a[58:59], v27 offset:2048
    v_lshlrev_b32 v242, 16, v229
    v_and_b32 v243, 0xffff0000, v229
    v_mul_f32 v242, v242, v251
    v_mul_f32 v243, v243, v251
    v_cvt_pk_bf16_f32 v229, v242, v243
    v_sub_f32 v244, v244, v248
    v_sub_f32 v245, v245, v248
    v_mfma_f32_16x16x32_bf16 v[164:167], a[84:87], a[96:99], v[164:167]
    ds_read_b128 a[28:31], v14 offset:14336
    buffer_load_dwordx4 v12, s[12:15], s40 offen offset:2048 lds
    v_cvt_pk_bf16_f32 v230, v244, v245
    v_lshlrev_b32 v244, 16, v230
    v_and_b32 v245, 0xffff0000, v230
    v_mul_f32 v244, v244, v251
    v_mul_f32 v245, v245, v251
    v_cvt_pk_bf16_f32 v230, v244, v245
    v_sub_f32 v246, v246, v248
    v_mfma_f32_16x16x32_bf16 v[172:175], a[84:87], a[100:103], v[172:175]
    v_sub_f32 v247, v247, v248
    v_cvt_pk_bf16_f32 v231, v246, v247
    v_lshlrev_b32 v246, 16, v231
    v_and_b32 v247, 0xffff0000, v231
    v_mul_f32 v246, v246, v251
    v_mul_f32 v247, v247, v251
    v_cvt_pk_bf16_f32 v231, v246, v247
    v_mfma_f32_16x16x32_bf16 v[176:179], a[80:83], a[104:107], v[176:179]
    ds_read_b64_tr_b16 a[60:61], v31 offset:0
    v_mfma_f32_16x16x32_bf16 v[184:187], a[80:83], a[108:111], v[184:187]
    ds_read_b64_tr_b16 a[62:63], v31 offset:2048
    v_mfma_f32_16x16x32_bf16 v[180:183], a[84:87], a[104:107], v[180:183]
    v_mfma_f32_16x16x32_bf16 v[188:191], a[84:87], a[108:111], v[188:191]
    buffer_load_dwordx4 v13, s[12:15], s40 offen offset:3072 lds
    v_mfma_f32_16x16x32_bf16 v[192:195], a[80:83], a[112:115], v[192:195]
    s_add_u32 s40, s40, s48
    s_and_b32 s40, s40, 0x7fffff
    v_mfma_f32_16x16x32_bf16 v[200:203], a[80:83], a[116:119], v[200:203]
    s_xor_b32 s42, s42, 0x8000
    v_mfma_f32_16x16x32_bf16 v[196:199], a[84:87], a[112:115], v[196:199]
    v_mfma_f32_16x16x32_bf16 v[204:207], a[84:87], a[116:119], v[204:207]
    v_mfma_f32_16x16x32_bf16 v[208:211], a[80:83], a[120:123], v[208:211]
    buffer_store_dwordx4 v[224:227], v253, s[96:99], 0 offen sc0 sc1
    v_mfma_f32_16x16x32_bf16 v[216:219], a[80:83], a[124:127], v[216:219]
    v_mfma_f32_16x16x32_bf16 v[212:215], a[84:87], a[120:123], v[212:215]
    v_mfma_f32_16x16x32_bf16 v[220:223], a[84:87], a[124:127], v[220:223]
    v_mfma_f32_16x16x32_bf16 a[128:131], a[88:91], a[96:99], a[128:131]
    v_mfma_f32_16x16x32_bf16 a[136:139], a[88:91], a[100:103], a[136:139]
    buffer_store_dwordx4 v[228:231], v254, s[96:99], 0 offen sc0 sc1
    v_mfma_f32_16x16x32_bf16 a[132:135], a[92:95], a[96:99], a[132:135]
    v_mfma_f32_16x16x32_bf16 a[140:143], a[92:95], a[100:103], a[140:143]
    v_mfma_f32_16x16x32_bf16 a[144:147], a[88:91], a[104:107], a[144:147]
    v_mfma_f32_16x16x32_bf16 a[152:155], a[88:91], a[108:111], a[152:155]
    v_mfma_f32_16x16x32_bf16 a[148:151], a[92:95], a[104:107], a[148:151]
    buffer_store_dword v29, v29, s[24:27], s5 offen sc0 sc1
    v_mfma_f32_16x16x32_bf16 a[156:159], a[92:95], a[108:111], a[156:159]
    v_mfma_f32_16x16x32_bf16 a[160:163], a[88:91], a[112:115], a[160:163]
    v_mfma_f32_16x16x32_bf16 a[168:171], a[88:91], a[116:119], a[168:171]
    v_mfma_f32_16x16x32_bf16 a[164:167], a[92:95], a[112:115], a[164:167]
    v_mfma_f32_16x16x32_bf16 a[172:175], a[92:95], a[116:119], a[172:175]
    v_mfma_f32_16x16x32_bf16 a[176:179], a[88:91], a[120:123], a[176:179]
    v_mfma_f32_16x16x32_bf16 a[184:187], a[88:91], a[124:127], a[184:187]
    v_mfma_f32_16x16x32_bf16 a[180:183], a[92:95], a[120:123], a[180:183]
    v_mfma_f32_16x16x32_bf16 a[188:191], a[92:95], a[124:127], a[188:191]
L_k1_loopV:
    s_waitcnt lgkmcnt(0)
    v_mfma_f32_16x16x32_bf16 v[32:35], a[0:3], a[32:35], v[32:35]
    v_mfma_f32_16x16x32_bf16 v[40:43], a[0:3], a[36:39], v[40:43]
    s_waitcnt vmcnt(16)
    s_barrier
    v_mfma_f32_16x16x32_bf16 v[36:39], a[4:7], a[32:35], v[36:39]
    s_mov_b32 m0, s41
    v_mfma_f32_16x16x32_bf16 v[44:47], a[4:7], a[36:39], v[44:47]
    ds_read_b128 a[64:67], v15 offset:0
    v_mfma_f32_16x16x32_bf16 v[48:51], a[0:3], a[40:43], v[48:51]
    ds_read_b64_tr_b16 a[96:97], v16 offset:16384
    v_mfma_f32_16x16x32_bf16 v[56:59], a[0:3], a[44:47], v[56:59]
    ds_read_b64_tr_b16 a[98:99], v16 offset:18432
    v_mfma_f32_16x16x32_bf16 v[52:55], a[4:7], a[40:43], v[52:55]
    buffer_load_dwordx4 v2, s[8:11], s39 offen offset:0 lds
    v_mfma_f32_16x16x32_bf16 v[60:63], a[4:7], a[44:47], v[60:63]
    ds_read_b128 a[68:71], v15 offset:2048
    v_mfma_f32_16x16x32_bf16 v[64:67], a[0:3], a[48:51], v[64:67]
    ds_read_b64_tr_b16 a[100:101], v17 offset:16384
    v_mfma_f32_16x16x32_bf16 v[72:75], a[0:3], a[52:55], v[72:75]
    ds_read_b64_tr_b16 a[102:103], v17 offset:18432
    v_mfma_f32_16x16x32_bf16 v[68:71], a[4:7], a[48:51], v[68:71]
    v_mfma_f32_16x16x32_bf16 v[76:79], a[4:7], a[52:55], v[76:79]
    ds_read_b128 a[72:75], v15 offset:4096
    v_mfma_f32_16x16x32_bf16 v[80:83], a[0:3], a[56:59], v[80:83]
    ds_read_b64_tr_b16 a[104:105], v18 offset:16384
    v_mfma_f32_16x16x32_bf16 v[88:91], a[0:3], a[60:63], v[88:91]
    ds_read_b64_tr_b16 a[106:107], v18 offset:18432
    v_mfma_f32_16x16x32_bf16 v[84:87], a[4:7], a[56:59], v[84:87]
    buffer_load_dwordx4 v3, s[8:11], s39 offen offset:1024 lds
    v_mfma_f32_16x16x32_bf16 v[92:95], a[4:7], a[60:63], v[92:95]
    ds_read_b128 a[76:79], v15 offset:6144
    v_mfma_f32_16x16x32_bf16 v[96:99], a[8:11], a[32:35], v[96:99]
    ds_read_b64_tr_b16 a[108:109], v19 offset:16384
    v_mfma_f32_16x16x32_bf16 v[104:107], a[8:11], a[36:39], v[104:107]
    ds_read_b64_tr_b16 a[110:111], v19 offset:18432
    v_mfma_f32_16x16x32_bf16 v[100:103], a[12:15], a[32:35], v[100:103]
    v_mfma_f32_16x16x32_bf16 v[108:111], a[12:15], a[36:39], v[108:111]
    ds_read_b128 a[80:83], v15 offset:8192
    v_mfma_f32_16x16x32_bf16 v[112:115], a[8:11], a[40:43], v[112:115]
    ds_read_b64_tr_b16 a[112:113], v20 offset:16384
    v_mfma_f32_16x16x32_bf16 v[120:123], a[8:11], a[44:47], v[120:123]
    ds_read_b64_tr_b16 a[114:115], v20 offset:18432
    v_mfma_f32_16x16x32_bf16 v[116:119], a[12:15], a[40:43], v[116:119]
    buffer_load_dwordx4 v4, s[8:11], s39 offen offset:2048 lds
    v_mfma_f32_16x16x32_bf16 v[124:127], a[12:15], a[44:47], v[124:127]
    ds_read_b128 a[84:87], v15 offset:10240
    v_mfma_f32_16x16x32_bf16 v[128:131], a[8:11], a[48:51], v[128:131]
    ds_read_b64_tr_b16 a[116:117], v21 offset:16384
    v_mfma_f32_16x16x32_bf16 v[136:139], a[8:11], a[52:55], v[136:139]
    ds_read_b64_tr_b16 a[118:119], v21 offset:18432
    v_mfma_f32_16x16x32_bf16 v[132:135], a[12:15], a[48:51], v[132:135]
    v_mfma_f32_16x16x32_bf16 v[140:143], a[12:15], a[52:55], v[140:143]
    ds_read_b128 a[88:91], v15 offset:12288
    v_mfma_f32_16x16x32_bf16 v[144:147], a[8:11], a[56:59], v[144:147]
    ds_read_b64_tr_b16 a[120:121], v27 offset:16384
    v_mfma_f32_16x16x32_bf16 v[152:155], a[8:11], a[60:63], v[152:155]
    ds_read_b64_tr_b16 a[122:123], v27 offset:18432
    v_mfma_f32_16x16x32_bf16 v[148:151], a[12:15], a[56:59], v[148:151]
    buffer_load_dwordx4 v5, s[8:11], s39 offen offset:3072 lds
    v_mfma_f32_16x16x32_bf16 v[156:159], a[12:15], a[60:63], v[156:159]
    ds_read_b128 a[92:95], v15 offset:14336
    v_mfma_f32_16x16x32_bf16 v[160:163], a[16:19], a[32:35], v[160:163]
    ds_read_b64_tr_b16 a[124:125], v31 offset:16384
    v_mfma_f32_16x16x32_bf16 v[168:171], a[16:19], a[36:39], v[168:171]
    ds_read_b64_tr_b16 a[126:127], v31 offset:18432
    v_mfma_f32_16x16x32_bf16 v[164:167], a[20:23], a[32:35], v[164:167]
    s_mov_b32 m0, s42
    v_mfma_f32_16x16x32_bf16 v[172:175], a[20:23], a[36:39], v[172:175]
    v_mfma_f32_16x16x32_bf16 v[176:179], a[16:19], a[40:43], v[176:179]
    buffer_load_dwordx4 v10, s[12:15], s40 offen offset:0 lds
    v_mfma_f32_16x16x32_bf16 v[184:187], a[16:19], a[44:47], v[184:187]
    v_mfma_f32_16x16x32_bf16 v[180:183], a[20:23], a[40:43], v[180:183]
    s_add_u32 s47, s47, 1
    s_cmp_eq_u32 s47, 3
    v_mfma_f32_16x16x32_bf16 v[188:191], a[20:23], a[44:47], v[188:191]
    s_cselect_b32 s46, 0xffff0000, s57
    s_cselect_b32 s47, 0, s47
    v_mfma_f32_16x16x32_bf16 v[192:195], a[16:19], a[48:51], v[192:195]
    v_mfma_f32_16x16x32_bf16 v[200:203], a[16:19], a[52:55], v[200:203]
    buffer_load_dwordx4 v11, s[12:15], s40 offen offset:1024 lds
    v_mfma_f32_16x16x32_bf16 v[196:199], a[20:23], a[48:51], v[196:199]
    v_mfma_f32_16x16x32_bf16 v[204:207], a[20:23], a[52:55], v[204:207]
    v_add_u32 v14, s46, v14
    v_mfma_f32_16x16x32_bf16 v[208:211], a[16:19], a[56:59], v[208:211]
    v_add_u32 v15, s46, v15
    v_mfma_f32_16x16x32_bf16 v[216:219], a[16:19], a[60:63], v[216:219]
    v_mfma_f32_16x16x32_bf16 v[212:215], a[20:23], a[56:59], v[212:215]
    buffer_load_dwordx4 v12, s[12:15], s40 offen offset:2048 lds
    v_mfma_f32_16x16x32_bf16 v[220:223], a[20:23], a[60:63], v[220:223]
    v_mfma_f32_16x16x32_bf16 a[128:131], a[24:27], a[32:35], a[128:131]
    v_xor_b32 v16, 0x8000, v16
    v_mfma_f32_16x16x32_bf16 a[136:139], a[24:27], a[36:39], a[136:139]
    v_xor_b32 v17, 0x8000, v17
    v_mfma_f32_16x16x32_bf16 a[132:135], a[28:31], a[32:35], a[132:135]
    v_mfma_f32_16x16x32_bf16 a[140:143], a[28:31], a[36:39], a[140:143]
    buffer_load_dwordx4 v13, s[12:15], s40 offen offset:3072 lds
    v_mfma_f32_16x16x32_bf16 a[144:147], a[24:27], a[40:43], a[144:147]
    v_mfma_f32_16x16x32_bf16 a[152:155], a[24:27], a[44:47], a[152:155]
    s_add_u32 s40, s40, s48
    s_and_b32 s40, s40, 0x7fffff
    v_mfma_f32_16x16x32_bf16 a[148:151], a[28:31], a[40:43], a[148:151]
    v_mfma_f32_16x16x32_bf16 a[156:159], a[28:31], a[44:47], a[156:159]
    v_xor_b32 v18, 0x8000, v18
    v_mfma_f32_16x16x32_bf16 a[160:163], a[24:27], a[48:51], a[160:163]
    v_xor_b32 v19, 0x8000, v19
    v_mfma_f32_16x16x32_bf16 a[168:171], a[24:27], a[52:55], a[168:171]
    v_xor_b32 v20, 0x8000, v20
    v_mfma_f32_16x16x32_bf16 a[164:167], a[28:31], a[48:51], a[164:167]
    v_xor_b32 v21, 0x8000, v21
    v_mfma_f32_16x16x32_bf16 a[172:175], a[28:31], a[52:55], a[172:175]
    v_xor_b32 v27, 0x8000, v27
    v_mfma_f32_16x16x32_bf16 a[176:179], a[24:27], a[56:59], a[176:179]
    v_xor_b32 v31, 0x8000, v31
    v_mfma_f32_16x16x32_bf16 a[184:187], a[24:27], a[60:63], a[184:187]
    v_mfma_f32_16x16x32_bf16 a[180:183], a[28:31], a[56:59], a[180:183]
    v_mfma_f32_16x16x32_bf16 a[188:191], a[28:31], a[60:63], a[188:191]
    s_waitcnt lgkmcnt(0)
    v_mfma_f32_16x16x32_bf16 v[32:35], a[64:67], a[96:99], v[32:35]
    v_mfma_f32_16x16x32_bf16 v[40:43], a[64:67], a[100:103], v[40:43]
    s_waitcnt vmcnt(12)
    s_barrier
    v_mfma_f32_16x16x32_bf16 v[36:39], a[68:71], a[96:99], v[36:39]
    s_add_u32 m0, s41, 4096
    v_mfma_f32_16x16x32_bf16 v[44:47], a[68:71], a[100:103], v[44:47]
    ds_read_b128 a[0:3], v14 offset:0
    v_mfma_f32_16x16x32_bf16 v[48:51], a[64:67], a[104:107], v[48:51]
    ds_read_b64_tr_b16 a[32:33], v16 offset:0
    v_mfma_f32_16x16x32_bf16 v[56:59], a[64:67], a[108:111], v[56:59]
    ds_read_b64_tr_b16 a[34:35], v16 offset:2048
    v_mfma_f32_16x16x32_bf16 v[52:55], a[68:71], a[104:107], v[52:55]
    buffer_load_dwordx4 v6, s[8:11], s39 offen offset:0 lds
    v_mfma_f32_16x16x32_bf16 v[60:63], a[68:71], a[108:111], v[60:63]
    ds_read_b128 a[4:7], v14 offset:2048
    v_mfma_f32_16x16x32_bf16 v[64:67], a[64:67], a[112:115], v[64:67]
    ds_read_b64_tr_b16 a[36:37], v17 offset:0
    v_mfma_f32_16x16x32_bf16 v[72:75], a[64:67], a[116:119], v[72:75]
    ds_read_b64_tr_b16 a[38:39], v17 offset:2048
    v_mfma_f32_16x16x32_bf16 v[68:71], a[68:71], a[112:115], v[68:71]
    v_mfma_f32_16x16x32_bf16 v[76:79], a[68:71], a[116:119], v[76:79]
    ds_read_b128 a[8:11], v14 offset:4096
    v_mfma_f32_16x16x32_bf16 v[80:83], a[64:67], a[120:123], v[80:83]
    ds_read_b64_tr_b16 a[40:41], v18 offset:0
    v_mfma_f32_16x16x32_bf16 v[88:91], a[64:67], a[124:127], v[88:91]
    ds_read_b64_tr_b16 a[42:43], v18 offset:2048
    v_mfma_f32_16x16x32_bf16 v[84:87], a[68:71], a[120:123], v[84:87]
    buffer_load_dwordx4 v7, s[8:11], s39 offen offset:1024 lds
    v_mfma_f32_16x16x32_bf16 v[92:95], a[68:71], a[124:127], v[92:95]
    ds_read_b128 a[12:15], v14 offset:6144
    v_mfma_f32_16x16x32_bf16 v[96:99], a[72:75], a[96:99], v[96:99]
    ds_read_b64_tr_b16 a[44:45], v19 offset:0
    v_mfma_f32_16x16x32_bf16 v[104:107], a[72:75], a[100:103], v[104:107]
    ds_read_b64_tr_b16 a[46:47], v19 offset:2048
    v_mfma_f32_16x16x32_bf16 v[100:103], a[76:79], a[96:99], v[100:103]
    v_mfma_f32_16x16x32_bf16 v[108:111], a[76:79], a[100:103], v[108:111]
    ds_read_b128 a[16:19], v14 offset:8192
    v_mfma_f32_16x16x32_bf16 v[112:115], a[72:75], a[104:107], v[112:115]
    ds_read_b64_tr_b16 a[48:49], v20 offset:0
    v_mfma_f32_16x16x32_bf16 v[120:123], a[72:75], a[108:111], v[120:123]
    ds_read_b64_tr_b16 a[50:51], v20 offset:2048
    v_mfma_f32_16x16x32_bf16 v[116:119], a[76:79], a[104:107], v[116:119]
    buffer_load_dwordx4 v8, s[8:11], s39 offen offset:2048 lds
    v_mfma_f32_16x16x32_bf16 v[124:127], a[76:79], a[108:111], v[124:127]
    ds_read_b128 a[20:23], v14 offset:10240
    v_mfma_f32_16x16x32_bf16 v[128:131], a[72:75], a[112:115], v[128:131]
    ds_read_b64_tr_b16 a[52:53], v21 offset:0
    v_mfma_f32_16x16x32_bf16 v[136:139], a[72:75], a[116:119], v[136:139]
    ds_read_b64_tr_b16 a[54:55], v21 offset:2048
    v_mfma_f32_16x16x32_bf16 v[132:135], a[76:79], a[112:115], v[132:135]
    v_mfma_f32_16x16x32_bf16 v[140:143], a[76:79], a[116:119], v[140:143]
    ds_read_b128 a[24:27], v14 offset:12288
    v_mfma_f32_16x16x32_bf16 v[144:147], a[72:75], a[120:123], v[144:147]
    ds_read_b64_tr_b16 a[56:57], v27 offset:0
    v_mfma_f32_16x16x32_bf16 v[152:155], a[72:75], a[124:127], v[152:155]
    ds_read_b64_tr_b16 a[58:59], v27 offset:2048
    v_mfma_f32_16x16x32_bf16 v[148:151], a[76:79], a[120:123], v[148:151]
    buffer_load_dwordx4 v9, s[8:11], s39 offen offset:3072 lds
    v_mfma_f32_16x16x32_bf16 v[156:159], a[76:79], a[124:127], v[156:159]
    ds_read_b128 a[28:31], v14 offset:14336
    v_mfma_f32_16x16x32_bf16 v[160:163], a[80:83], a[96:99], v[160:163]
    ds_read_b64_tr_b16 a[60:61], v31 offset:0
    v_mfma_f32_16x16x32_bf16 v[168:171], a[80:83], a[100:103], v[168:171]
    ds_read_b64_tr_b16 a[62:63], v31 offset:2048
    v_mfma_f32_16x16x32_bf16 v[164:167], a[84:87], a[96:99], v[164:167]
    s_add_u32 m0, s42, 16384
    v_mfma_f32_16x16x32_bf16 v[172:175], a[84:87], a[100:103], v[172:175]
    v_mfma_f32_16x16x32_bf16 v[176:179], a[80:83], a[104:107], v[176:179]
    buffer_load_dwordx4 v10, s[12:15], s40 offen offset:0 lds
    v_mfma_f32_16x16x32_bf16 v[184:187], a[80:83], a[108:111], v[184:187]
    v_mfma_f32_16x16x32_bf16 v[180:183], a[84:87], a[104:107], v[180:183]
    s_add_u32 s39, s39, s64
    s_add_u32 s41, s41, 32768
    v_mfma_f32_16x16x32_bf16 v[188:191], a[84:87], a[108:111], v[188:191]
    s_and_b32 s39, s39, s52
    s_xor_b32 s42, s42, 0x8000
    v_mfma_f32_16x16x32_bf16 v[192:195], a[80:83], a[112:115], v[192:195]
    v_mfma_f32_16x16x32_bf16 v[200:203], a[80:83], a[116:119], v[200:203]
    buffer_load_dwordx4 v11, s[12:15], s40 offen offset:1024 lds
    v_mfma_f32_16x16x32_bf16 v[196:199], a[84:87], a[112:115], v[196:199]
    v_mfma_f32_16x16x32_bf16 v[204:207], a[84:87], a[116:119], v[204:207]
    s_cmp_ge_u32 s41, s53
    s_cselect_b32 s54, 98304, 0
    s_sub_u32 s41, s41, s54
    v_mfma_f32_16x16x32_bf16 v[208:211], a[80:83], a[120:123], v[208:211]
    v_mfma_f32_16x16x32_bf16 v[216:219], a[80:83], a[124:127], v[216:219]
    v_mfma_f32_16x16x32_bf16 v[212:215], a[84:87], a[120:123], v[212:215]
    buffer_load_dwordx4 v12, s[12:15], s40 offen offset:2048 lds
    v_mfma_f32_16x16x32_bf16 v[220:223], a[84:87], a[124:127], v[220:223]
    v_mfma_f32_16x16x32_bf16 a[128:131], a[88:91], a[96:99], a[128:131]
    v_mfma_f32_16x16x32_bf16 a[136:139], a[88:91], a[100:103], a[136:139]
    v_mfma_f32_16x16x32_bf16 a[132:135], a[92:95], a[96:99], a[132:135]
    v_mfma_f32_16x16x32_bf16 a[140:143], a[92:95], a[100:103], a[140:143]
    buffer_load_dwordx4 v13, s[12:15], s40 offen offset:3072 lds
    v_mfma_f32_16x16x32_bf16 a[144:147], a[88:91], a[104:107], a[144:147]
    v_mfma_f32_16x16x32_bf16 a[152:155], a[88:91], a[108:111], a[152:155]
    s_add_u32 s40, s40, s48
    s_and_b32 s40, s40, 0x7fffff
    v_mfma_f32_16x16x32_bf16 a[148:151], a[92:95], a[104:107], a[148:151]
    v_mfma_f32_16x16x32_bf16 a[156:159], a[92:95], a[108:111], a[156:159]
    v_mfma_f32_16x16x32_bf16 a[160:163], a[88:91], a[112:115], a[160:163]
    v_mfma_f32_16x16x32_bf16 a[168:171], a[88:91], a[116:119], a[168:171]
    v_mfma_f32_16x16x32_bf16 a[164:167], a[92:95], a[112:115], a[164:167]
    v_mfma_f32_16x16x32_bf16 a[172:175], a[92:95], a[116:119], a[172:175]
    v_mfma_f32_16x16x32_bf16 a[176:179], a[88:91], a[120:123], a[176:179]
    s_add_u32 s43, s43, 1
    v_mfma_f32_16x16x32_bf16 a[184:187], a[88:91], a[124:127], a[184:187]
    v_mfma_f32_16x16x32_bf16 a[180:183], a[92:95], a[120:123], a[180:183]
    s_bitcmp1_b32 s44, s43
    v_mfma_f32_16x16x32_bf16 a[188:191], a[92:95], a[124:127], a[188:191]
    s_cbranch_scc0 L_k1_loopV
    s_branch L_k1_loopV_evt
L_k1_mid:
    s_mov_b32 s55, 0
L_km_ln:
    v_readfirstlane_b32 s54, v30
    s_nop 3
    s_cmp_ge_u32 s54, 256
    s_cbranch_scc1 L_km_lnok
    s_add_u32 s55, s55, 1
    s_cmp_ge_u32 s55, 0x40000
    s_cbranch_scc1 L_km_lnok
    s_sleep 4
    buffer_load_dword v30, v29, s[60:63], 0 offen offset:128 sc1
    s_waitcnt vmcnt(0)
    s_and_b32 s54, s2, 7
    s_lshl_b32 s54, s54, 3
    buffer_load_dwordx2 v[250:251], v29, s[60:63], s54 offen offset:192 sc1
    s_waitcnt vmcnt(0)
    s_branch L_km_ln
L_km_lnok:
    v_readfirstlane_b32 s4, v250
    v_readfirstlane_b32 s5, v251
    s_getreg_b32 s54, hwreg(HW_REG_XCC_ID, 0, 3)
    s_lshl_b32 s54, s54, 3
    s_nop 1
    s_lshr_b64 s[4:5], s[4:5], s54
    s_and_b32 s68, s4, 0xff
    s_mul_i32 s67, s77, 28672
    v_accvgpr_read_b32 v224, a160
    v_accvgpr_read_b32 v225, a161
    v_accvgpr_read_b32 v226, a162
    v_accvgpr_read_b32 v227, a163
    v_accvgpr_read_b32 v228, a164
    v_accvgpr_read_b32 v229, a165
    v_accvgpr_read_b32 v230, a166
    v_accvgpr_read_b32 v231, a167
    v_accvgpr_read_b32 v232, a168
    v_accvgpr_read_b32 v233, a169
    v_accvgpr_read_b32 v234, a170
    v_accvgpr_read_b32 v235, a171
    v_accvgpr_read_b32 v236, a172
    v_accvgpr_read_b32 v237, a173
    v_accvgpr_read_b32 v238, a174
    v_accvgpr_read_b32 v239, a175
    v_accvgpr_read_b32 v240, a176
    v_accvgpr_read_b32 v241, a177
    v_accvgpr_read_b32 v242, a178
    v_accvgpr_read_b32 v243, a179
    v_accvgpr_read_b32 v244, a180
    v_accvgpr_read_b32 v245, a181
    v_accvgpr_read_b32 v246, a182
    v_accvgpr_read_b32 v247, a183
    v_accvgpr_read_b32 v248, a184
    v_accvgpr_read_b32 v249, a185
    v_accvgpr_read_b32 v250, a186
    v_accvgpr_read_b32 v251, a187
    v_accvgpr_read_b32 v252, a188
    v_accvgpr_read_b32 v253, a189
    v_accvgpr_read_b32 v254, a190
    v_accvgpr_read_b32 v255, a191
    s_add_u32 s16, s34, s3
    s_addc_u32 s17, s35, 0
    s_mov_b32 s18, 2097152
    s_mov_b32 s49, 524288
    s_mov_b32 s50, 1048576
    s_mov_b32 s51, 1572864
    buffer_load_dwordx4 a[160:163], v22, s[96:99], s67 offen offset:0 sc1
    s_mul_i32 s55, s36, 57344
    v_subrev_u32 v2, s55, v2
    v_subrev_u32 v3, s55, v3
    v_subrev_u32 v4, s55, v4
    v_subrev_u32 v5, s55, v5
    s_lshl_b32 s54, s38, 8
    v_subrev_u32 v16, s54, v16
    v_subrev_u32 v17, s54, v17
    v_subrev_u32 v18, s54, v18
    v_subrev_u32 v19, s54, v19
    v_subrev_u32 v20, s54, v20
    v_subrev_u32 v21, s54, v21
    v_subrev_u32 v27, s54, v27
    v_subrev_u32 v31, s54, v31
    v_lshrrev_b32 v6, 4, v1
    v_lshlrev_b32 v6, 11, v6
    v_bfe_u32 v26, v1, 2, 2
    buffer_load_dwordx4 a[164:167], v22, s[96:99], s67 offen offset:1024 sc1
    v_mul_u32_u24 v26, 320, v26
    v_add_u32 v6, v6, v26
    v_and_b32 v26, 1, v1
    v_lshl_add_u32 v6, v26, 5, v6
    v_bfe_u32 v26, v1, 1, 1
    v_lshl_add_u32 v6, v26, 3, v6
    v_bfe_u32 v26, v1, 4, 1
    v_lshl_add_u32 v6, v26, 4, v6
    v_add_u32 v6, 98304, v6
    v_xor_b32 v7, 16, v6
    v_xor_b32 v8, 64, v6
    v_xor_b32 v9, 80, v6
    v_xor_b32 v14, 128, v6
    v_xor_b32 v15, 144, v6
    v_xor_b32 v24, 192, v6
    v_xor_b32 v25, 208, v6
    v_cvt_pk_bf16_f32 v32, v32, v33
    buffer_load_dwordx4 a[168:171], v22, s[96:99], s67 offen offset:2048 sc1
    v_cvt_pk_bf16_f32 v33, v34, v35
    v_cvt_pk_bf16_f32 v34, v36, v37
    v_cvt_pk_bf16_f32 v35, v38, v39
    v_cvt_pk_bf16_f32 v36, v40, v41
    v_cvt_pk_bf16_f32 v37, v42, v43
    v_cvt_pk_bf16_f32 v38, v44, v45
    v_cvt_pk_bf16_f32 v39, v46, v47
    v_cvt_pk_bf16_f32 v40, v48, v49
    v_cvt_pk_bf16_f32 v41, v50, v51
    v_cvt_pk_bf16_f32 v42, v52, v53
    v_cvt_pk_bf16_f32 v43, v54, v55
    v_cvt_pk_bf16_f32 v44, v56, v57
    v_cvt_pk_bf16_f32 v45, v58, v59
    v_cvt_pk_bf16_f32 v46, v60, v61
    v_cvt_pk_bf16_f32 v47, v62, v63
    v_cvt_pk_bf16_f32 v48, v64, v65
    v_cvt_pk_bf16_f32 v49, v66, v67
    buffer_load_dwordx4 a[172:175], v22, s[96:99], s67 offen offset:3072 sc1
    v_cvt_pk_bf16_f32 v50, v68, v69
    v_cvt_pk_bf16_f32 v51, v70, v71
    v_cvt_pk_bf16_f32 v52, v72, v73
    v_cvt_pk_bf16_f32 v53, v74, v75
    v_cvt_pk_bf16_f32 v54, v76, v77
    v_cvt_pk_bf16_f32 v55, v78, v79
    v_cvt_pk_bf16_f32 v56, v80, v81
    v_cvt_pk_bf16_f32 v57, v82, v83
    v_cvt_pk_bf16_f32 v58, v84, v85
    v_cvt_pk_bf16_f32 v59, v86, v87
    v_cvt_pk_bf16_f32 v60, v88, v89
    v_cvt_pk_bf16_f32 v61, v90, v91
    v_cvt_pk_bf16_f32 v62, v92, v93
    v_cvt_pk_bf16_f32 v63, v94, v95
    v_cvt_pk_bf16_f32 v64, v96, v97
    v_cvt_pk_bf16_f32 v65, v98, v99
    v_cvt_pk_bf16_f32 v66, v100, v101
    s_add_u32 s67, s67, 4096
    buffer_load_dwordx4 a[176:179], v22, s[96:99], s67 offen offset:0 sc1
    v_cvt_pk_bf16_f32 v67, v102, v103
    v_cvt_pk_bf16_f32 v68, v104, v105
    v_cvt_pk_bf16_f32 v69, v106, v107
    v_cvt_pk_bf16_f32 v70, v108, v109
    v_cvt_pk_bf16_f32 v71, v110, v111
    v_cvt_pk_bf16_f32 v72, v112, v113
    v_cvt_pk_bf16_f32 v73, v114, v115
    v_cvt_pk_bf16_f32 v74, v116, v117
    v_cvt_pk_bf16_f32 v75, v118, v119
    v_cvt_pk_bf16_f32 v76, v120, v121
    v_cvt_pk_bf16_f32 v77, v122, v123
    v_cvt_pk_bf16_f32 v78, v124, v125
    v_cvt_pk_bf16_f32 v79, v126, v127
    v_cvt_pk_bf16_f32 v80, v128, v129
    v_cvt_pk_bf16_f32 v81, v130, v131
    v_cvt_pk_bf16_f32 v82, v132, v133
    v_cvt_pk_bf16_f32 v83, v134, v135
    buffer_load_dwordx4 a[180:183], v22, s[96:99], s67 offen offset:1024 sc1
    v_cvt_pk_bf16_f32 v84, v136, v137
    v_cvt_pk_bf16_f32 v85, v138, v139
    v_cvt_pk_bf16_f32 v86, v140, v141
    v_cvt_pk_bf16_f32 v87, v142, v143
    v_cvt_pk_bf16_f32 v88, v144, v145
    v_cvt_pk_bf16_f32 v89, v146, v147
    v_cvt_pk_bf16_f32 v90, v148, v149
    v_cvt_pk_bf16_f32 v91, v150, v151
    v_cvt_pk_bf16_f32 v92, v152, v153
    v_cvt_pk_bf16_f32 v93, v154, v155
    v_cvt_pk_bf16_f32 v94, v156, v157
    v_cvt_pk_bf16_f32 v95, v158, v159
    v_cvt_pk_bf16_f32 v96, v160, v161
    v_cvt_pk_bf16_f32 v97, v162, v163
    v_cvt_pk_bf16_f32 v98, v164, v165
    v_cvt_pk_bf16_f32 v99, v166, v167
    v_cvt_pk_bf16_f32 v100, v168, v169
    buffer_load_dwordx4 a[184:187], v22, s[96:99], s67 offen offset:2048 sc1
    v_cvt_pk_bf16_f32 v101, v170, v171
    v_cvt_pk_bf16_f32 v102, v172, v173
    v_cvt_pk_bf16_f32 v103, v174, v175
    v_cvt_pk_bf16_f32 v104, v176, v177
    v_cvt_pk_bf16_f32 v105, v178, v179
    v_cvt_pk_bf16_f32 v106, v180, v181
    v_cvt_pk_bf16_f32 v107, v182, v183
    v_cvt_pk_bf16_f32 v108, v184, v185
    v_cvt_pk_bf16_f32 v109, v186, v187
    v_cvt_pk_bf16_f32 v110, v188, v189
    v_cvt_pk_bf16_f32 v111, v190, v191
    v_cvt_pk_bf16_f32 v112, v192, v193
    v_cvt_pk_bf16_f32 v113, v194, v195
    v_cvt_pk_bf16_f32 v114, v196, v197
    v_cvt_pk_bf16_f32 v115, v198, v199
    v_cvt_pk_bf16_f32 v116, v200, v201
    v_cvt_pk_bf16_f32 v117, v202, v203
    buffer_load_dwordx4 a[188:191], v22, s[96:99], s67 offen offset:3072 sc1
    v_cvt_pk_bf16_f32 v118, v204, v205
    v_cvt_pk_bf16_f32 v119, v206, v207
    v_cvt_pk_bf16_f32 v120, v208, v209
    v_cvt_pk_bf16_f32 v121, v210, v211
    v_cvt_pk_bf16_f32 v122, v212, v213
    v_cvt_pk_bf16_f32 v123, v214, v215
    v_cvt_pk_bf16_f32 v124, v216, v217
    v_cvt_pk_bf16_f32 v125, v218, v219
    v_cvt_pk_bf16_f32 v126, v220, v221
    v_cvt_pk_bf16_f32 v127, v222, v223
    v_accvgpr_read_b32 v192, a128
    v_accvgpr_read_b32 v193, a129
    v_accvgpr_read_b32 v194, a130
    v_accvgpr_read_b32 v195, a131
    v_accvgpr_read_b32 v196, a132
    v_accvgpr_read_b32 v197, a133
    v_accvgpr_read_b32 v198, a134
    s_add_u32 m0, s65, 65536
    s_nop 0
    buffer_load_dwordx4 v10, s[12:15], s40 offen offset:0 lds
    v_accvgpr_read_b32 v199, a135
    v_accvgpr_read_b32 v200, a136
    v_accvgpr_read_b32 v201, a137
    v_accvgpr_read_b32 v202, a138
    v_accvgpr_read_b32 v203, a139
    v_accvgpr_read_b32 v204, a140
    v_accvgpr_read_b32 v205, a141
    v_accvgpr_read_b32 v206, a142
    v_accvgpr_read_b32 v207, a143
    v_accvgpr_read_b32 v208, a144
    v_accvgpr_read_b32 v209, a145
    v_accvgpr_read_b32 v210, a146
    v_accvgpr_read_b32 v211, a147
    v_accvgpr_read_b32 v212, a148
    v_accvgpr_read_b32 v213, a149
    v_accvgpr_read_b32 v214, a150
    v_accvgpr_read_b32 v215, a151
    buffer_load_dwordx4 v11, s[12:15], s40 offen offset:1024 lds
    v_accvgpr_read_b32 v216, a152
    v_accvgpr_read_b32 v217, a153
    v_accvgpr_read_b32 v218, a154
    v_accvgpr_read_b32 v219, a155
    v_accvgpr_read_b32 v220, a156
    v_accvgpr_read_b32 v221, a157
    v_accvgpr_read_b32 v222, a158
    v_accvgpr_read_b32 v223, a159
    v_cvt_pk_bf16_f32 v128, v192, v193
    v_cvt_pk_bf16_f32 v129, v194, v195
    v_cvt_pk_bf16_f32 v130, v196, v197
    v_cvt_pk_bf16_f32 v131, v198, v199
    v_cvt_pk_bf16_f32 v132, v200, v201
    v_cvt_pk_bf16_f32 v133, v202, v203
    v_cvt_pk_bf16_f32 v134, v204, v205
    v_cvt_pk_bf16_f32 v135, v206, v207
    v_cvt_pk_bf16_f32 v136, v208, v209
    buffer_load_dwordx4 v12, s[12:15], s40 offen offset:2048 lds
    v_cvt_pk_bf16_f32 v137, v210, v211
    v_cvt_pk_bf16_f32 v138, v212, v213
    v_cvt_pk_bf16_f32 v139, v214, v215
    v_cvt_pk_bf16_f32 v140, v216, v217
    v_cvt_pk_bf16_f32 v141, v218, v219
    v_cvt_pk_bf16_f32 v142, v220, v221
    v_cvt_pk_bf16_f32 v143, v222, v223
    v_cvt_pk_bf16_f32 v144, v224, v225
    v_cvt_pk_bf16_f32 v145, v226, v227
    v_cvt_pk_bf16_f32 v146, v228, v229
    v_cvt_pk_bf16_f32 v147, v230, v231
    v_cvt_pk_bf16_f32 v148, v232, v233
    v_cvt_pk_bf16_f32 v149, v234, v235
    v_cvt_pk_bf16_f32 v150, v236, v237
    v_cvt_pk_bf16_f32 v151, v238, v239
    v_cvt_pk_bf16_f32 v152, v240, v241
    v_cvt_pk_bf16_f32 v153, v242, v243
    buffer_load_dwordx4 v13, s[12:15], s40 offen offset:3072 lds
    v_cvt_pk_bf16_f32 v154, v244, v245
    v_cvt_pk_bf16_f32 v155, v246, v247
    v_cvt_pk_bf16_f32 v156, v248, v249
    v_cvt_pk_bf16_f32 v157, v250, v251
    v_cvt_pk_bf16_f32 v158, v252, v253
    v_cvt_pk_bf16_f32 v159, v254, v255
    s_add_u32 s40, s40, 262144
    s_waitcnt lgkmcnt(0)
    ds_read_b64_tr_b16 a[0:1], v16 offset:0
    ds_read_b64_tr_b16 a[2:3], v16 offset:2048
    ds_read_b64_tr_b16 a[4:5], v18 offset:0
    ds_read_b64_tr_b16 a[6:7], v18 offset:2048
    ds_read_b64_tr_b16 a[8:9], v20 offset:0
    ds_read_b64_tr_b16 a[10:11], v20 offset:2048
    ds_read_b64_tr_b16 a[12:13], v27 offset:0
    ds_read_b64_tr_b16 a[14:15], v27 offset:2048
    ds_read_b64_tr_b16 a[16:17], v16 offset:256
    ds_read_b64_tr_b16 a[18:19], v16 offset:2304
    ds_read_b64_tr_b16 a[20:21], v18 offset:256
    ds_read_b64_tr_b16 a[22:23], v18 offset:2304
    ds_read_b64_tr_b16 a[24:25], v20 offset:256
    ds_read_b64_tr_b16 a[26:27], v20 offset:2304
    s_waitcnt vmcnt(10)
    s_lshl_b32 s3, s79, 7
    s_waitcnt lgkmcnt(6)
    v_mfma_f32_16x16x32_bf16 v[160:163], a[0:3], a[160:163], 0
    ds_read_b64_tr_b16 a[28:29], v27 offset:256
    ds_read_b64_tr_b16 a[30:31], v27 offset:2304
    v_mfma_f32_16x16x32_bf16 v[168:171], a[0:3], a[164:167], 0
    s_add_u32 m0, s65, 81920
    v_mfma_f32_16x16x32_bf16 v[176:179], a[4:7], a[160:163], 0
    ds_read_b64_tr_b16 a[32:33], v6 offset:0
    ds_read_b64_tr_b16 a[34:35], v6 offset:1024
    v_mfma_f32_16x16x32_bf16 v[184:187], a[4:7], a[164:167], 0
    buffer_load_dwordx4 v10, s[12:15], s40 offen offset:0 lds
    v_mfma_f32_16x16x32_bf16 v[192:195], a[8:11], a[160:163], 0
    ds_read_b64_tr_b16 a[36:37], v8 offset:0
    ds_read_b64_tr_b16 a[38:39], v8 offset:1024
    v_mfma_f32_16x16x32_bf16 v[200:203], a[8:11], a[164:167], 0
    buffer_load_dwordx4 v11, s[12:15], s40 offen offset:1024 lds
    v_mfma_f32_16x16x32_bf16 v[208:211], a[12:15], a[160:163], 0
    ds_read_b64_tr_b16 a[40:41], v14 offset:0
    ds_read_b64_tr_b16 a[42:43], v14 offset:1024
    v_mfma_f32_16x16x32_bf16 v[216:219], a[12:15], a[164:167], 0
    buffer_load_dwordx4 v12, s[12:15], s40 offen offset:2048 lds
    s_waitcnt lgkmcnt(6)
    v_mfma_f32_16x16x32_bf16 v[224:227], a[16:19], a[160:163], 0
    ds_read_b64_tr_b16 a[44:45], v24 offset:0
    ds_read_b64_tr_b16 a[46:47], v24 offset:1024
    v_mfma_f32_16x16x32_bf16 v[232:235], a[16:19], a[164:167], 0
    v_mfma_f32_16x16x32_bf16 v[240:243], a[20:23], a[160:163], 0
    ds_read_b64_tr_b16 a[48:49], v17 offset:0
    ds_read_b64_tr_b16 a[50:51], v17 offset:2048
    v_mfma_f32_16x16x32_bf16 v[248:251], a[20:23], a[164:167], 0
    buffer_load_dwordx4 v13, s[12:15], s40 offen offset:3072 lds
    s_add_u32 s40, s40, 262144
    s_add_u32 s67, s67, 4096
    v_mfma_f32_16x16x32_bf16 a[64:67], a[24:27], a[160:163], 0
    ds_read_b64_tr_b16 a[52:53], v19 offset:0
    ds_read_b64_tr_b16 a[54:55], v19 offset:2048
    v_mfma_f32_16x16x32_bf16 a[72:75], a[24:27], a[164:167], 0
    v_mfma_f32_16x16x32_bf16 a[80:83], a[28:31], a[160:163], 0
    ds_read_b64_tr_b16 a[56:57], v21 offset:0
    ds_read_b64_tr_b16 a[58:59], v21 offset:2048
    v_mfma_f32_16x16x32_bf16 a[88:91], a[28:31], a[164:167], 0
    buffer_load_dwordx4 a[192:195], v22, s[96:99], s67 offen offset:0 sc1
    s_waitcnt lgkmcnt(6)
    v_mfma_f32_16x16x32_bf16 a[96:99], a[32:35], a[160:163], 0
    ds_read_b64_tr_b16 a[60:61], v31 offset:0
    ds_read_b64_tr_b16 a[62:63], v31 offset:2048
    v_mfma_f32_16x16x32_bf16 a[104:107], a[32:35], a[164:167], 0
    v_mfma_f32_16x16x32_bf16 a[112:115], a[36:39], a[160:163], 0
    ds_read_b64_tr_b16 a[0:1], v17 offset:256
    ds_read_b64_tr_b16 a[2:3], v17 offset:2304
    v_mfma_f32_16x16x32_bf16 a[120:123], a[36:39], a[164:167], 0
    buffer_load_dwordx4 a[196:199], v22, s[96:99], s67 offen offset:1024 sc1
    v_mfma_f32_16x16x32_bf16 a[128:131], a[40:43], a[160:163], 0
    ds_read_b64_tr_b16 a[4:5], v19 offset:256
    ds_read_b64_tr_b16 a[6:7], v19 offset:2304
    v_mfma_f32_16x16x32_bf16 a[136:139], a[40:43], a[164:167], 0
    v_mfma_f32_16x16x32_bf16 a[144:147], a[44:47], a[160:163], 0
    ds_read_b64_tr_b16 a[8:9], v21 offset:256
    ds_read_b64_tr_b16 a[10:11], v21 offset:2304
    v_mfma_f32_16x16x32_bf16 a[152:155], a[44:47], a[164:167], 0
    buffer_load_dwordx4 a[200:203], v22, s[96:99], s67 offen offset:2048 sc1
    s_waitcnt lgkmcnt(6)
    v_mfma_f32_16x16x32_bf16 v[164:167], a[48:51], a[160:163], 0
    ds_read_b64_tr_b16 a[12:13], v31 offset:256
    ds_read_b64_tr_b16 a[14:15], v31 offset:2304
    v_mfma_f32_16x16x32_bf16 v[172:175], a[48:51], a[164:167], 0
    v_mfma_f32_16x16x32_bf16 v[180:183], a[52:55], a[160:163], 0
    ds_read_b64_tr_b16 a[16:17], v7 offset:0
    ds_read_b64_tr_b16 a[18:19], v7 offset:1024
    v_mfma_f32_16x16x32_bf16 v[188:191], a[52:55], a[164:167], 0
    buffer_load_dwordx4 a[204:207], v22, s[96:99], s67 offen offset:3072 sc1
    s_add_u32 s67, s67, 4096
    v_mfma_f32_16x16x32_bf16 v[196:199], a[56:59], a[160:163], 0
    ds_read_b64_tr_b16 a[20:21], v9 offset:0
    ds_read_b64_tr_b16 a[22:23], v9 offset:1024
    v_mfma_f32_16x16x32_bf16 v[204:207], a[56:59], a[164:167], 0
    v_mfma_f32_16x16x32_bf16 v[212:215], a[60:63], a[160:163], 0
    ds_read_b64_tr_b16 a[24:25], v15 offset:0
    ds_read_b64_tr_b16 a[26:27], v15 offset:1024
    v_mfma_f32_16x16x32_bf16 v[220:223], a[60:63], a[164:167], 0
    buffer_load_dwordx4 a[208:211], v22, s[96:99], s67 offen offset:0 sc1
    s_waitcnt lgkmcnt(6)
    v_mfma_f32_16x16x32_bf16 v[228:231], a[0:3], a[160:163], 0
    ds_read_b64_tr_b16 a[28:29], v25 offset:0
    ds_read_b64_tr_b16 a[30:31], v25 offset:1024
    v_mfma_f32_16x16x32_bf16 v[236:239], a[0:3], a[164:167], 0
    v_mfma_f32_16x16x32_bf16 v[244:247], a[4:7], a[160:163], 0
    buffer_load_dwordx4 a[212:215], v22, s[96:99], s67 offen offset:1024 sc1
    buffer_store_dwordx4 v[32:35], v22, s[16:19], 0 offen offset:0
    s_waitcnt vmcnt(19)
    s_barrier
    ds_read_b64_tr_b16 a[32:33], v16 offset:16384
    ds_read_b64_tr_b16 a[34:35], v16 offset:18432
    v_mfma_f32_16x16x32_bf16 v[252:255], a[4:7], a[164:167], 0
    v_mfma_f32_16x16x32_bf16 a[68:71], a[8:11], a[160:163], 0
    ds_read_b64_tr_b16 a[36:37], v18 offset:16384
    ds_read_b64_tr_b16 a[38:39], v18 offset:18432
    v_mfma_f32_16x16x32_bf16 a[76:79], a[8:11], a[164:167], 0
    v_mfma_f32_16x16x32_bf16 a[84:87], a[12:15], a[160:163], 0
    ds_read_b64_tr_b16 a[40:41], v20 offset:16384
    ds_read_b64_tr_b16 a[42:43], v20 offset:18432
    v_mfma_f32_16x16x32_bf16 a[92:95], a[12:15], a[164:167], 0
    buffer_load_dwordx4 a[216:219], v22, s[96:99], s67 offen offset:2048 sc1
    s_waitcnt lgkmcnt(6)
    v_mfma_f32_16x16x32_bf16 a[100:103], a[16:19], a[160:163], 0
    ds_read_b64_tr_b16 a[44:45], v27 offset:16384
    ds_read_b64_tr_b16 a[46:47], v27 offset:18432
    v_mfma_f32_16x16x32_bf16 a[108:111], a[16:19], a[164:167], 0
    v_mfma_f32_16x16x32_bf16 a[116:119], a[20:23], a[160:163], 0
    ds_read_b64_tr_b16 a[48:49], v16 offset:16640
    ds_read_b64_tr_b16 a[50:51], v16 offset:18688
    v_mfma_f32_16x16x32_bf16 a[124:127], a[20:23], a[164:167], 0
    buffer_load_dwordx4 a[220:223], v22, s[96:99], s67 offen offset:3072 sc1
    v_mfma_f32_16x16x32_bf16 a[132:135], a[24:27], a[160:163], 0
    ds_read_b64_tr_b16 a[52:53], v18 offset:16640
    ds_read_b64_tr_b16 a[54:55], v18 offset:18688
    v_mfma_f32_16x16x32_bf16 a[140:143], a[24:27], a[164:167], 0
    v_mfma_f32_16x16x32_bf16 a[148:151], a[28:31], a[160:163], 0
    ds_read_b64_tr_b16 a[56:57], v20 offset:16640
    ds_read_b64_tr_b16 a[58:59], v20 offset:18688
    v_mfma_f32_16x16x32_bf16 a[156:159], a[28:31], a[164:167], 0
    buffer_store_dwordx4 v[36:39], v22, s[16:19], 0 offen offset:1024
    s_waitcnt lgkmcnt(6)
    v_mfma_f32_16x16x32_bf16 v[160:163], a[32:35], a[168:171], v[160:163]
    ds_read_b64_tr_b16 a[60:61], v27 offset:16640
    ds_read_b64_tr_b16 a[62:63], v27 offset:18688
    v_mfma_f32_16x16x32_bf16 v[168:171], a[32:35], a[172:175], v[168:171]
    v_mfma_f32_16x16x32_bf16 v[176:179], a[36:39], a[168:171], v[176:179]
    ds_read_b64_tr_b16 a[0:1], v6 offset:8192
    ds_read_b64_tr_b16 a[2:3], v6 offset:9216
    v_mfma_f32_16x16x32_bf16 v[184:187], a[36:39], a[172:175], v[184:187]
    buffer_store_dwordx4 v[40:43], v22, s[16:19], 0 offen offset:2048
    v_mfma_f32_16x16x32_bf16 v[192:195], a[40:43], a[168:171], v[192:195]
    ds_read_b64_tr_b16 a[4:5], v8 offset:8192
    ds_read_b64_tr_b16 a[6:7], v8 offset:9216
    v_mfma_f32_16x16x32_bf16 v[200:203], a[40:43], a[172:175], v[200:203]
    v_mfma_f32_16x16x32_bf16 v[208:211], a[44:47], a[168:171], v[208:211]
    ds_read_b64_tr_b16 a[8:9], v14 offset:8192
    ds_read_b64_tr_b16 a[10:11], v14 offset:9216
    v_mfma_f32_16x16x32_bf16 v[216:219], a[44:47], a[172:175], v[216:219]
    buffer_store_dwordx4 v[44:47], v22, s[16:19], 0 offen offset:3072
    s_waitcnt lgkmcnt(6)
    v_mfma_f32_16x16x32_bf16 v[224:227], a[48:51], a[168:171], v[224:227]
    ds_read_b64_tr_b16 a[12:13], v24 offset:8192
    ds_read_b64_tr_b16 a[14:15], v24 offset:9216
    v_mfma_f32_16x16x32_bf16 v[232:235], a[48:51], a[172:175], v[232:235]
    v_mfma_f32_16x16x32_bf16 v[240:243], a[52:55], a[168:171], v[240:243]
    ds_read_b64_tr_b16 a[16:17], v17 offset:16384
    ds_read_b64_tr_b16 a[18:19], v17 offset:18432
    v_mfma_f32_16x16x32_bf16 v[248:251], a[52:55], a[172:175], v[248:251]
    buffer_store_dwordx4 v[48:51], v23, s[16:19], 0 offen offset:0
    v_mfma_f32_16x16x32_bf16 a[64:67], a[56:59], a[168:171], a[64:67]
    ds_read_b64_tr_b16 a[20:21], v19 offset:16384
    ds_read_b64_tr_b16 a[22:23], v19 offset:18432
    v_mfma_f32_16x16x32_bf16 a[72:75], a[56:59], a[172:175], a[72:75]
    v_mfma_f32_16x16x32_bf16 a[80:83], a[60:63], a[168:171], a[80:83]
    ds_read_b64_tr_b16 a[24:25], v21 offset:16384
    ds_read_b64_tr_b16 a[26:27], v21 offset:18432
    v_mfma_f32_16x16x32_bf16 a[88:91], a[60:63], a[172:175], a[88:91]
    buffer_store_dwordx4 v[52:55], v23, s[16:19], 0 offen offset:1024
    s_waitcnt lgkmcnt(6)
    v_mfma_f32_16x16x32_bf16 a[96:99], a[0:3], a[168:171], a[96:99]
    ds_read_b64_tr_b16 a[28:29], v31 offset:16384
    ds_read_b64_tr_b16 a[30:31], v31 offset:18432
    v_mfma_f32_16x16x32_bf16 a[104:107], a[0:3], a[172:175], a[104:107]
    v_mfma_f32_16x16x32_bf16 a[112:115], a[4:7], a[168:171], a[112:115]
    ds_read_b64_tr_b16 a[32:33], v17 offset:16640
    ds_read_b64_tr_b16 a[34:35], v17 offset:18688
    v_mfma_f32_16x16x32_bf16 a[120:123], a[4:7], a[172:175], a[120:123]
    v_mfma_f32_16x16x32_bf16 a[128:131], a[8:11], a[168:171], a[128:131]
    ds_read_b64_tr_b16 a[36:37], v19 offset:16640
    ds_read_b64_tr_b16 a[38:39], v19 offset:18688
    v_mfma_f32_16x16x32_bf16 a[136:139], a[8:11], a[172:175], a[136:139]
    v_mfma_f32_16x16x32_bf16 a[144:147], a[12:15], a[168:171], a[144:147]
    ds_read_b64_tr_b16 a[40:41], v21 offset:16640
    ds_read_b64_tr_b16 a[42:43], v21 offset:18688
    v_mfma_f32_16x16x32_bf16 a[152:155], a[12:15], a[172:175], a[152:155]
    s_waitcnt lgkmcnt(6)
    v_mfma_f32_16x16x32_bf16 v[164:167], a[16:19], a[168:171], v[164:167]
    ds_read_b64_tr_b16 a[44:45], v31 offset:16640
    ds_read_b64_tr_b16 a[46:47], v31 offset:18688
    v_mfma_f32_16x16x32_bf16 v[172:175], a[16:19], a[172:175], v[172:175]
    v_mfma_f32_16x16x32_bf16 v[180:183], a[20:23], a[168:171], v[180:183]
    ds_read_b64_tr_b16 a[48:49], v7 offset:8192
    ds_read_b64_tr_b16 a[50:51], v7 offset:9216
    v_mfma_f32_16x16x32_bf16 v[188:191], a[20:23], a[172:175], v[188:191]
    v_mfma_f32_16x16x32_bf16 v[196:199], a[24:27], a[168:171], v[196:199]
    ds_read_b64_tr_b16 a[52:53], v9 offset:8192
    ds_read_b64_tr_b16 a[54:55], v9 offset:9216
    v_mfma_f32_16x16x32_bf16 v[204:207], a[24:27], a[172:175], v[204:207]
    v_mfma_f32_16x16x32_bf16 v[212:215], a[28:31], a[168:171], v[212:215]
    ds_read_b64_tr_b16 a[56:57], v15 offset:8192
    ds_read_b64_tr_b16 a[58:59], v15 offset:9216
    v_mfma_f32_16x16x32_bf16 v[220:223], a[28:31], a[172:175], v[220:223]
    s_waitcnt lgkmcnt(6)
    v_mfma_f32_16x16x32_bf16 v[228:231], a[32:35], a[168:171], v[228:231]
    ds_read_b64_tr_b16 a[60:61], v25 offset:8192
    ds_read_b64_tr_b16 a[62:63], v25 offset:9216
    v_mfma_f32_16x16x32_bf16 v[236:239], a[32:35], a[172:175], v[236:239]
    v_mfma_f32_16x16x32_bf16 v[244:247], a[36:39], a[168:171], v[244:247]
    s_waitcnt vmcnt(24)
    s_barrier
    ds_read_b64_tr_b16 a[0:1], v16 offset:32768
    ds_read_b64_tr_b16 a[2:3], v16 offset:34816
    v_mfma_f32_16x16x32_bf16 v[252:255], a[36:39], a[172:175], v[252:255]
    v_mfma_f32_16x16x32_bf16 a[68:71], a[40:43], a[168:171], a[68:71]
    ds_read_b64_tr_b16 a[4:5], v18 offset:32768
    ds_read_b64_tr_b16 a[6:7], v18 offset:34816
    v_mfma_f32_16x16x32_bf16 a[76:79], a[40:43], a[172:175], a[76:79]
    s_add_u32 m0, s65, 0
    v_mfma_f32_16x16x32_bf16 a[84:87], a[44:47], a[168:171], a[84:87]
    ds_read_b64_tr_b16 a[8:9], v20 offset:32768
    ds_read_b64_tr_b16 a[10:11], v20 offset:34816
    v_mfma_f32_16x16x32_bf16 a[92:95], a[44:47], a[172:175], a[92:95]
    buffer_load_dwordx4 v10, s[12:15], s40 offen offset:0 lds
    s_waitcnt lgkmcnt(6)
    v_mfma_f32_16x16x32_bf16 a[100:103], a[48:51], a[168:171], a[100:103]
    ds_read_b64_tr_b16 a[12:13], v27 offset:32768
    ds_read_b64_tr_b16 a[14:15], v27 offset:34816
    v_mfma_f32_16x16x32_bf16 a[108:111], a[48:51], a[172:175], a[108:111]
    v_mfma_f32_16x16x32_bf16 a[116:119], a[52:55], a[168:171], a[116:119]
    ds_read_b64_tr_b16 a[16:17], v16 offset:33024
    ds_read_b64_tr_b16 a[18:19], v16 offset:35072
    v_mfma_f32_16x16x32_bf16 a[124:127], a[52:55], a[172:175], a[124:127]
    buffer_load_dwordx4 v11, s[12:15], s40 offen offset:1024 lds
    v_mfma_f32_16x16x32_bf16 a[132:135], a[56:59], a[168:171], a[132:135]
    ds_read_b64_tr_b16 a[20:21], v18 offset:33024
    ds_read_b64_tr_b16 a[22:23], v18 offset:35072
    v_mfma_f32_16x16x32_bf16 a[140:143], a[56:59], a[172:175], a[140:143]
    v_mfma_f32_16x16x32_bf16 a[148:151], a[60:63], a[168:171], a[148:151]
    ds_read_b64_tr_b16 a[24:25], v20 offset:33024
    ds_read_b64_tr_b16 a[26:27], v20 offset:35072
    v_mfma_f32_16x16x32_bf16 a[156:159], a[60:63], a[172:175], a[156:159]
    buffer_load_dwordx4 v12, s[12:15], s40 offen offset:2048 lds
    s_waitcnt lgkmcnt(6)
    v_mfma_f32_16x16x32_bf16 v[160:163], a[0:3], a[176:179], v[160:163]
    ds_read_b64_tr_b16 a[28:29], v27 offset:33024
    ds_read_b64_tr_b16 a[30:31], v27 offset:35072
    v_mfma_f32_16x16x32_bf16 v[168:171], a[0:3], a[180:183], v[168:171]
    v_mfma_f32_16x16x32_bf16 v[176:179], a[4:7], a[176:179], v[176:179]
    ds_read_b64_tr_b16 a[32:33], v6 offset:16384
    ds_read_b64_tr_b16 a[34:35], v6 offset:17408
    v_mfma_f32_16x16x32_bf16 v[184:187], a[4:7], a[180:183], v[184:187]
    buffer_load_dwordx4 v13, s[12:15], s40 offen offset:3072 lds
    s_add_u32 s40, s40, 262144
    s_add_u32 s67, s67, 4096
    v_mfma_f32_16x16x32_bf16 v[192:195], a[8:11], a[176:179], v[192:195]
    ds_read_b64_tr_b16 a[36:37], v8 offset:16384
    ds_read_b64_tr_b16 a[38:39], v8 offset:17408
    v_mfma_f32_16x16x32_bf16 v[200:203], a[8:11], a[180:183], v[200:203]
    v_mfma_f32_16x16x32_bf16 v[208:211], a[12:15], a[176:179], v[208:211]
    ds_read_b64_tr_b16 a[40:41], v14 offset:16384
    ds_read_b64_tr_b16 a[42:43], v14 offset:17408
    v_mfma_f32_16x16x32_bf16 v[216:219], a[12:15], a[180:183], v[216:219]
    buffer_load_dwordx4 a[160:163], v22, s[96:99], s67 offen offset:0 sc1
    s_waitcnt lgkmcnt(6)
    v_mfma_f32_16x16x32_bf16 v[224:227], a[16:19], a[176:179], v[224:227]
    ds_read_b64_tr_b16 a[44:45], v24 offset:16384
    ds_read_b64_tr_b16 a[46:47], v24 offset:17408
    v_mfma_f32_16x16x32_bf16 v[232:235], a[16:19], a[180:183], v[232:235]
    v_mfma_f32_16x16x32_bf16 v[240:243], a[20:23], a[176:179], v[240:243]
    ds_read_b64_tr_b16 a[48:49], v17 offset:32768
    ds_read_b64_tr_b16 a[50:51], v17 offset:34816
    v_mfma_f32_16x16x32_bf16 v[248:251], a[20:23], a[180:183], v[248:251]
    buffer_load_dwordx4 a[164:167], v22, s[96:99], s67 offen offset:1024 sc1
    v_mfma_f32_16x16x32_bf16 a[64:67], a[24:27], a[176:179], a[64:67]
    ds_read_b64_tr_b16 a[52:53], v19 offset:32768
    ds_read_b64_tr_b16 a[54:55], v19 offset:34816
    v_mfma_f32_16x16x32_bf16 a[72:75], a[24:27], a[180:183], a[72:75]
    v_mfma_f32_16x16x32_bf16 a[80:83], a[28:31], a[176:179], a[80:83]
    ds_read_b64_tr_b16 a[56:57], v21 offset:32768
    ds_read_b64_tr_b16 a[58:59], v21 offset:34816
    v_mfma_f32_16x16x32_bf16 a[88:91], a[28:31], a[180:183], a[88:91]
    buffer_store_dwordx4 v[56:59], v23, s[16:19], 0 offen offset:2048
    s_waitcnt lgkmcnt(6)
    v_mfma_f32_16x16x32_bf16 a[96:99], a[32:35], a[176:179], a[96:99]
    ds_read_b64_tr_b16 a[60:61], v31 offset:32768
    ds_read_b64_tr_b16 a[62:63], v31 offset:34816
    v_mfma_f32_16x16x32_bf16 a[104:107], a[32:35], a[180:183], a[104:107]
    v_mfma_f32_16x16x32_bf16 a[112:115], a[36:39], a[176:179], a[112:115]
    ds_read_b64_tr_b16 a[0:1], v17 offset:33024
    ds_read_b64_tr_b16 a[2:3], v17 offset:35072
    v_mfma_f32_16x16x32_bf16 a[120:123], a[36:39], a[180:183], a[120:123]
    buffer_store_dwordx4 v[60:63], v23, s[16:19], 0 offen offset:3072
    v_mfma_f32_16x16x32_bf16 a[128:131], a[40:43], a[176:179], a[128:131]
    ds_read_b64_tr_b16 a[4:5], v19 offset:33024
    ds_read_b64_tr_b16 a[6:7], v19 offset:35072
    v_mfma_f32_16x16x32_bf16 a[136:139], a[40:43], a[180:183], a[136:139]
    v_mfma_f32_16x16x32_bf16 a[144:147], a[44:47], a[176:179], a[144:147]
    ds_read_b64_tr_b16 a[8:9], v21 offset:33024
    ds_read_b64_tr_b16 a[10:11], v21 offset:35072
    v_mfma_f32_16x16x32_bf16 a[152:155], a[44:47], a[180:183], a[152:155]
    buffer_store_dwordx4 v[64:67], v22, s[16:19], s49 offen offset:0
    s_waitcnt lgkmcnt(6)
    v_mfma_f32_16x16x32_bf16 v[164:167], a[48:51], a[176:179], v[164:167]
    ds_read_b64_tr_b16 a[12:13], v31 offset:33024
    ds_read_b64_tr_b16 a[14:15], v31 offset:35072
    v_mfma_f32_16x16x32_bf16 v[172:175], a[48:51], a[180:183], v[172:175]
    v_mfma_f32_16x16x32_bf16 v[180:183], a[52:55], a[176:179], v[180:183]
    ds_read_b64_tr_b16 a[16:17], v7 offset:16384
    ds_read_b64_tr_b16 a[18:19], v7 offset:17408
    v_mfma_f32_16x16x32_bf16 v[188:191], a[52:55], a[180:183], v[188:191]
    v_mfma_f32_16x16x32_bf16 v[196:199], a[56:59], a[176:179], v[196:199]
    ds_read_b64_tr_b16 a[20:21], v9 offset:16384
    ds_read_b64_tr_b16 a[22:23], v9 offset:17408
    v_mfma_f32_16x16x32_bf16 v[204:207], a[56:59], a[180:183], v[204:207]
    v_mfma_f32_16x16x32_bf16 v[212:215], a[60:63], a[176:179], v[212:215]
    ds_read_b64_tr_b16 a[24:25], v15 offset:16384
    ds_read_b64_tr_b16 a[26:27], v15 offset:17408
    v_mfma_f32_16x16x32_bf16 v[220:223], a[60:63], a[180:183], v[220:223]
    s_waitcnt lgkmcnt(6)
    v_mfma_f32_16x16x32_bf16 v[228:231], a[0:3], a[176:179], v[228:231]
    ds_read_b64_tr_b16 a[28:29], v25 offset:16384
    ds_read_b64_tr_b16 a[30:31], v25 offset:17408
    v_mfma_f32_16x16x32_bf16 v[236:239], a[0:3], a[180:183], v[236:239]
    v_mfma_f32_16x16x32_bf16 v[244:247], a[4:7], a[176:179], v[244:247]
    s_waitcnt vmcnt(31)
    s_barrier
    ds_read_b64_tr_b16 a[32:33], v16 offset:49152
    ds_read_b64_tr_b16 a[34:35], v16 offset:51200
    v_mfma_f32_16x16x32_bf16 v[252:255], a[4:7], a[180:183], v[252:255]
    v_mfma_f32_16x16x32_bf16 a[68:71], a[8:11], a[176:179], a[68:71]
    ds_read_b64_tr_b16 a[36:37], v18 offset:49152
    ds_read_b64_tr_b16 a[38:39], v18 offset:51200
    v_mfma_f32_16x16x32_bf16 a[76:79], a[8:11], a[180:183], a[76:79]
    s_add_u32 m0, s65, 16384
    v_mfma_f32_16x16x32_bf16 a[84:87], a[12:15], a[176:179], a[84:87]
    ds_read_b64_tr_b16 a[40:41], v20 offset:49152
    ds_read_b64_tr_b16 a[42:43], v20 offset:51200
    v_mfma_f32_16x16x32_bf16 a[92:95], a[12:15], a[180:183], a[92:95]
    buffer_load_dwordx4 v10, s[12:15], s40 offen offset:0 lds
    s_waitcnt lgkmcnt(6)
    v_mfma_f32_16x16x32_bf16 a[100:103], a[16:19], a[176:179], a[100:103]
    ds_read_b64_tr_b16 a[44:45], v27 offset:49152
    ds_read_b64_tr_b16 a[46:47], v27 offset:51200
    v_mfma_f32_16x16x32_bf16 a[108:111], a[16:19], a[180:183], a[108:111]
    buffer_load_dwordx4 v11, s[12:15], s40 offen offset:1024 lds
    v_mfma_f32_16x16x32_bf16 a[116:119], a[20:23], a[176:179], a[116:119]
    ds_read_b64_tr_b16 a[48:49], v16 offset:49408
    ds_read_b64_tr_b16 a[50:51], v16 offset:51456
    v_mfma_f32_16x16x32_bf16 a[124:127], a[20:23], a[180:183], a[124:127]
    buffer_load_dwordx4 v12, s[12:15], s40 offen offset:2048 lds
    v_mfma_f32_16x16x32_bf16 a[132:135], a[24:27], a[176:179], a[132:135]
    ds_read_b64_tr_b16 a[52:53], v18 offset:49408
    ds_read_b64_tr_b16 a[54:55], v18 offset:51456
    v_mfma_f32_16x16x32_bf16 a[140:143], a[24:27], a[180:183], a[140:143]
    buffer_load_dwordx4 v13, s[12:15], s40 offen offset:3072 lds
    s_add_u32 s40, s40, 262144
    v_mfma_f32_16x16x32_bf16 a[148:151], a[28:31], a[176:179], a[148:151]
    ds_read_b64_tr_b16 a[56:57], v20 offset:49408
    ds_read_b64_tr_b16 a[58:59], v20 offset:51456
    v_mfma_f32_16x16x32_bf16 a[156:159], a[28:31], a[180:183], a[156:159]
    buffer_load_dwordx4 a[168:171], v22, s[96:99], s67 offen offset:2048 sc1
    s_waitcnt lgkmcnt(6)
    v_mfma_f32_16x16x32_bf16 v[160:163], a[32:35], a[184:187], v[160:163]
    ds_read_b64_tr_b16 a[60:61], v27 offset:49408
    ds_read_b64_tr_b16 a[62:63], v27 offset:51456
    v_mfma_f32_16x16x32_bf16 v[168:171], a[32:35], a[188:191], v[168:171]
    v_mfma_f32_16x16x32_bf16 v[176:179], a[36:39], a[184:187], v[176:179]
    ds_read_b64_tr_b16 a[0:1], v6 offset:24576
    ds_read_b64_tr_b16 a[2:3], v6 offset:25600
    v_mfma_f32_16x16x32_bf16 v[184:187], a[36:39], a[188:191], v[184:187]
    buffer_load_dwordx4 a[172:175], v22, s[96:99], s67 offen offset:3072 sc1
    v_mfma_f32_16x16x32_bf16 v[192:195], a[40:43], a[184:187], v[192:195]
    ds_read_b64_tr_b16 a[4:5], v8 offset:24576
    ds_read_b64_tr_b16 a[6:7], v8 offset:25600
    v_mfma_f32_16x16x32_bf16 v[200:203], a[40:43], a[188:191], v[200:203]
    v_mfma_f32_16x16x32_bf16 v[208:211], a[44:47], a[184:187], v[208:211]
    ds_read_b64_tr_b16 a[8:9], v14 offset:24576
    ds_read_b64_tr_b16 a[10:11], v14 offset:25600
    v_mfma_f32_16x16x32_bf16 v[216:219], a[44:47], a[188:191], v[216:219]
    buffer_store_dwordx4 v[68:71], v22, s[16:19], s49 offen offset:1024
    s_waitcnt lgkmcnt(6)
    v_mfma_f32_16x16x32_bf16 v[224:227], a[48:51], a[184:187], v[224:227]
    ds_read_b64_tr_b16 a[12:13], v24 offset:24576
    ds_read_b64_tr_b16 a[14:15], v24 offset:25600
    v_mfma_f32_16x16x32_bf16 v[232:235], a[48:51], a[188:191], v[232:235]
    v_mfma_f32_16x16x32_bf16 v[240:243], a[52:55], a[184:187], v[240:243]
    ds_read_b64_tr_b16 a[16:17], v17 offset:49152
    ds_read_b64_tr_b16 a[18:19], v17 offset:51200
    v_mfma_f32_16x16x32_bf16 v[248:251], a[52:55], a[188:191], v[248:251]
    buffer_store_dwordx4 v[72:75], v22, s[16:19], s49 offen offset:2048
    v_mfma_f32_16x16x32_bf16 a[64:67], a[56:59], a[184:187], a[64:67]
    ds_read_b64_tr_b16 a[20:21], v19 offset:49152
    ds_read_b64_tr_b16 a[22:23], v19 offset:51200
    v_mfma_f32_16x16x32_bf16 a[72:75], a[56:59], a[188:191], a[72:75]
    v_mfma_f32_16x16x32_bf16 a[80:83], a[60:63], a[184:187], a[80:83]
    ds_read_b64_tr_b16 a[24:25], v21 offset:49152
    ds_read_b64_tr_b16 a[26:27], v21 offset:51200
    v_mfma_f32_16x16x32_bf16 a[88:91], a[60:63], a[188:191], a[88:91]
    buffer_store_dwordx4 v[76:79], v22, s[16:19], s49 offen offset:3072
    s_add_u32 m0, s65, 98304
    s_waitcnt lgkmcnt(6)
    v_mfma_f32_16x16x32_bf16 a[96:99], a[0:3], a[184:187], a[96:99]
    ds_read_b64_tr_b16 a[28:29], v31 offset:49152
    ds_read_b64_tr_b16 a[30:31], v31 offset:51200
    v_mfma_f32_16x16x32_bf16 a[104:107], a[0:3], a[188:191], a[104:107]
    v_mfma_f32_16x16x32_bf16 a[112:115], a[4:7], a[184:187], a[112:115]
    ds_read_b64_tr_b16 a[32:33], v17 offset:49408
    ds_read_b64_tr_b16 a[34:35], v17 offset:51456
    v_mfma_f32_16x16x32_bf16 a[120:123], a[4:7], a[188:191], a[120:123]
    buffer_load_dwordx4 v2, s[8:11], s39 offen offset:0 lds
    v_mfma_f32_16x16x32_bf16 a[128:131], a[8:11], a[184:187], a[128:131]
    ds_read_b64_tr_b16 a[36:37], v19 offset:49408
    ds_read_b64_tr_b16 a[38:39], v19 offset:51456
    v_mfma_f32_16x16x32_bf16 a[136:139], a[8:11], a[188:191], a[136:139]
    v_mfma_f32_16x16x32_bf16 a[144:147], a[12:15], a[184:187], a[144:147]
    ds_read_b64_tr_b16 a[40:41], v21 offset:49408
    ds_read_b64_tr_b16 a[42:43], v21 offset:51456
    v_mfma_f32_16x16x32_bf16 a[152:155], a[12:15], a[188:191], a[152:155]
    buffer_load_dwordx4 v3, s[8:11], s39 offen offset:1024 lds
    s_waitcnt lgkmcnt(6)
    v_mfma_f32_16x16x32_bf16 v[164:167], a[16:19], a[184:187], v[164:167]
    ds_read_b64_tr_b16 a[44:45], v31 offset:49408
    ds_read_b64_tr_b16 a[46:47], v31 offset:51456
    v_mfma_f32_16x16x32_bf16 v[172:175], a[16:19], a[188:191], v[172:175]
    v_mfma_f32_16x16x32_bf16 v[180:183], a[20:23], a[184:187], v[180:183]
    ds_read_b64_tr_b16 a[48:49], v7 offset:24576
    ds_read_b64_tr_b16 a[50:51], v7 offset:25600
    v_mfma_f32_16x16x32_bf16 v[188:191], a[20:23], a[188:191], v[188:191]
    buffer_load_dwordx4 v4, s[8:11], s39 offen offset:2048 lds
    v_mfma_f32_16x16x32_bf16 v[196:199], a[24:27], a[184:187], v[196:199]
    ds_read_b64_tr_b16 a[52:53], v9 offset:24576
    ds_read_b64_tr_b16 a[54:55], v9 offset:25600
    v_mfma_f32_16x16x32_bf16 v[204:207], a[24:27], a[188:191], v[204:207]
    v_mfma_f32_16x16x32_bf16 v[212:215], a[28:31], a[184:187], v[212:215]
    ds_read_b64_tr_b16 a[56:57], v15 offset:24576
    ds_read_b64_tr_b16 a[58:59], v15 offset:25600
    v_mfma_f32_16x16x32_bf16 v[220:223], a[28:31], a[188:191], v[220:223]
    buffer_load_dwordx4 v5, s[8:11], s39 offen offset:3072 lds
    s_add_u32 s39, s39, 229376
    s_waitcnt lgkmcnt(6)
    v_mfma_f32_16x16x32_bf16 v[228:231], a[32:35], a[184:187], v[228:231]
    ds_read_b64_tr_b16 a[60:61], v25 offset:24576
    ds_read_b64_tr_b16 a[62:63], v25 offset:25600
    v_mfma_f32_16x16x32_bf16 v[236:239], a[32:35], a[188:191], v[236:239]
    v_mfma_f32_16x16x32_bf16 v[244:247], a[36:39], a[184:187], v[244:247]
    s_waitcnt vmcnt(34)
    s_barrier
    v_xor_b32 v16, 0x10000, v16
    v_xor_b32 v17, 0x10000, v17
    v_xor_b32 v18, 0x10000, v18
    v_xor_b32 v19, 0x10000, v19
    v_xor_b32 v20, 0x10000, v20
    v_xor_b32 v21, 0x10000, v21
    v_xor_b32 v27, 0x10000, v27
    v_xor_b32 v31, 0x10000, v31
    ds_read_b64_tr_b16 a[0:1], v16 offset:0
    ds_read_b64_tr_b16 a[2:3], v16 offset:2048
    v_mfma_f32_16x16x32_bf16 v[252:255], a[36:39], a[188:191], v[252:255]
    v_mfma_f32_16x16x32_bf16 a[68:71], a[40:43], a[184:187], a[68:71]
    ds_read_b64_tr_b16 a[4:5], v18 offset:0
    ds_read_b64_tr_b16 a[6:7], v18 offset:2048
    v_mfma_f32_16x16x32_bf16 a[76:79], a[40:43], a[188:191], a[76:79]
    s_add_u32 m0, s65, 32768
    v_mfma_f32_16x16x32_bf16 a[84:87], a[44:47], a[184:187], a[84:87]
    ds_read_b64_tr_b16 a[8:9], v20 offset:0
    ds_read_b64_tr_b16 a[10:11], v20 offset:2048
    v_mfma_f32_16x16x32_bf16 a[92:95], a[44:47], a[188:191], a[92:95]
    buffer_load_dwordx4 v10, s[12:15], s40 offen offset:0 lds
    s_waitcnt lgkmcnt(6)
    v_mfma_f32_16x16x32_bf16 a[100:103], a[48:51], a[184:187], a[100:103]
    ds_read_b64_tr_b16 a[12:13], v27 offset:0
    ds_read_b64_tr_b16 a[14:15], v27 offset:2048
    v_mfma_f32_16x16x32_bf16 a[108:111], a[48:51], a[188:191], a[108:111]
    v_mfma_f32_16x16x32_bf16 a[116:119], a[52:55], a[184:187], a[116:119]
    ds_read_b64_tr_b16 a[16:17], v16 offset:256
    ds_read_b64_tr_b16 a[18:19], v16 offset:2304
    v_mfma_f32_16x16x32_bf16 a[124:127], a[52:55], a[188:191], a[124:127]
    buffer_load_dwordx4 v11, s[12:15], s40 offen offset:1024 lds
    v_mfma_f32_16x16x32_bf16 a[132:135], a[56:59], a[184:187], a[132:135]
    ds_read_b64_tr_b16 a[20:21], v18 offset:256
    ds_read_b64_tr_b16 a[22:23], v18 offset:2304
    v_mfma_f32_16x16x32_bf16 a[140:143], a[56:59], a[188:191], a[140:143]
    v_mfma_f32_16x16x32_bf16 a[148:151], a[60:63], a[184:187], a[148:151]
    ds_read_b64_tr_b16 a[24:25], v20 offset:256
    ds_read_b64_tr_b16 a[26:27], v20 offset:2304
    v_mfma_f32_16x16x32_bf16 a[156:159], a[60:63], a[188:191], a[156:159]
    buffer_load_dwordx4 v12, s[12:15], s40 offen offset:2048 lds
    s_waitcnt lgkmcnt(6)
    v_mfma_f32_16x16x32_bf16 v[160:163], a[0:3], a[192:195], v[160:163]
    ds_read_b64_tr_b16 a[28:29], v27 offset:256
    ds_read_b64_tr_b16 a[30:31], v27 offset:2304
    v_mfma_f32_16x16x32_bf16 v[168:171], a[0:3], a[196:199], v[168:171]
    v_mfma_f32_16x16x32_bf16 v[176:179], a[4:7], a[192:195], v[176:179]
    ds_read_b64_tr_b16 a[32:33], v6 offset:32768
    ds_read_b64_tr_b16 a[34:35], v6 offset:33792
    v_mfma_f32_16x16x32_bf16 v[184:187], a[4:7], a[196:199], v[184:187]
    buffer_load_dwordx4 v13, s[12:15], s40 offen offset:3072 lds
    s_add_u32 s40, s40, 262144
    s_add_u32 s67, s67, 4096
    v_mfma_f32_16x16x32_bf16 v[192:195], a[8:11], a[192:195], v[192:195]
    ds_read_b64_tr_b16 a[36:37], v8 offset:32768
    ds_read_b64_tr_b16 a[38:39], v8 offset:33792
    v_mfma_f32_16x16x32_bf16 v[200:203], a[8:11], a[196:199], v[200:203]
    v_mfma_f32_16x16x32_bf16 v[208:211], a[12:15], a[192:195], v[208:211]
    ds_read_b64_tr_b16 a[40:41], v14 offset:32768
    ds_read_b64_tr_b16 a[42:43], v14 offset:33792
    v_mfma_f32_16x16x32_bf16 v[216:219], a[12:15], a[196:199], v[216:219]
    buffer_load_dwordx4 a[176:179], v22, s[96:99], s67 offen offset:0 sc1
    s_waitcnt lgkmcnt(6)
    v_mfma_f32_16x16x32_bf16 v[224:227], a[16:19], a[192:195], v[224:227]
    ds_read_b64_tr_b16 a[44:45], v24 offset:32768
    ds_read_b64_tr_b16 a[46:47], v24 offset:33792
    v_mfma_f32_16x16x32_bf16 v[232:235], a[16:19], a[196:199], v[232:235]
    v_mfma_f32_16x16x32_bf16 v[240:243], a[20:23], a[192:195], v[240:243]
    ds_read_b64_tr_b16 a[48:49], v17 offset:0
    ds_read_b64_tr_b16 a[50:51], v17 offset:2048
    v_mfma_f32_16x16x32_bf16 v[248:251], a[20:23], a[196:199], v[248:251]
    buffer_load_dwordx4 a[180:183], v22, s[96:99], s67 offen offset:1024 sc1
    v_mfma_f32_16x16x32_bf16 a[64:67], a[24:27], a[192:195], a[64:67]
    ds_read_b64_tr_b16 a[52:53], v19 offset:0
    ds_read_b64_tr_b16 a[54:55], v19 offset:2048
    v_mfma_f32_16x16x32_bf16 a[72:75], a[24:27], a[196:199], a[72:75]
    v_mfma_f32_16x16x32_bf16 a[80:83], a[28:31], a[192:195], a[80:83]
    ds_read_b64_tr_b16 a[56:57], v21 offset:0
    ds_read_b64_tr_b16 a[58:59], v21 offset:2048
    v_mfma_f32_16x16x32_bf16 a[88:91], a[28:31], a[196:199], a[88:91]
    buffer_store_dwordx4 v[80:83], v23, s[16:19], s49 offen offset:0
    s_waitcnt lgkmcnt(6)
    v_mfma_f32_16x16x32_bf16 a[96:99], a[32:35], a[192:195], a[96:99]
    ds_read_b64_tr_b16 a[60:61], v31 offset:0
    ds_read_b64_tr_b16 a[62:63], v31 offset:2048
    v_mfma_f32_16x16x32_bf16 a[104:107], a[32:35], a[196:199], a[104:107]
    v_mfma_f32_16x16x32_bf16 a[112:115], a[36:39], a[192:195], a[112:115]
    ds_read_b64_tr_b16 a[0:1], v17 offset:256
    ds_read_b64_tr_b16 a[2:3], v17 offset:2304
    v_mfma_f32_16x16x32_bf16 a[120:123], a[36:39], a[196:199], a[120:123]
    buffer_store_dwordx4 v[84:87], v23, s[16:19], s49 offen offset:1024
    v_mfma_f32_16x16x32_bf16 a[128:131], a[40:43], a[192:195], a[128:131]
    ds_read_b64_tr_b16 a[4:5], v19 offset:256
    ds_read_b64_tr_b16 a[6:7], v19 offset:2304
    v_mfma_f32_16x16x32_bf16 a[136:139], a[40:43], a[196:199], a[136:139]
    v_mfma_f32_16x16x32_bf16 a[144:147], a[44:47], a[192:195], a[144:147]
    ds_read_b64_tr_b16 a[8:9], v21 offset:256
    ds_read_b64_tr_b16 a[10:11], v21 offset:2304
    v_mfma_f32_16x16x32_bf16 a[152:155], a[44:47], a[196:199], a[152:155]
    buffer_store_dwordx4 v[88:91], v23, s[16:19], s49 offen offset:2048
    s_waitcnt lgkmcnt(6)
    v_mfma_f32_16x16x32_bf16 v[164:167], a[48:51], a[192:195], v[164:167]
    ds_read_b64_tr_b16 a[12:13], v31 offset:256
    ds_read_b64_tr_b16 a[14:15], v31 offset:2304
    v_mfma_f32_16x16x32_bf16 v[172:175], a[48:51], a[196:199], v[172:175]
    v_mfma_f32_16x16x32_bf16 v[180:183], a[52:55], a[192:195], v[180:183]
    ds_read_b64_tr_b16 a[16:17], v7 offset:32768
    ds_read_b64_tr_b16 a[18:19], v7 offset:33792
    v_mfma_f32_16x16x32_bf16 v[188:191], a[52:55], a[196:199], v[188:191]
    v_mfma_f32_16x16x32_bf16 v[196:199], a[56:59], a[192:195], v[196:199]
    ds_read_b64_tr_b16 a[20:21], v9 offset:32768
    ds_read_b64_tr_b16 a[22:23], v9 offset:33792
    v_mfma_f32_16x16x32_bf16 v[204:207], a[56:59], a[196:199], v[204:207]
    v_mfma_f32_16x16x32_bf16 v[212:215], a[60:63], a[192:195], v[212:215]
    ds_read_b64_tr_b16 a[24:25], v15 offset:32768
    ds_read_b64_tr_b16 a[26:27], v15 offset:33792
    v_mfma_f32_16x16x32_bf16 v[220:223], a[60:63], a[196:199], v[220:223]
    s_waitcnt lgkmcnt(6)
    v_mfma_f32_16x16x32_bf16 v[228:231], a[0:3], a[192:195], v[228:231]
    ds_read_b64_tr_b16 a[28:29], v25 offset:32768
    ds_read_b64_tr_b16 a[30:31], v25 offset:33792
    v_mfma_f32_16x16x32_bf16 v[236:239], a[0:3], a[196:199], v[236:239]
    v_mfma_f32_16x16x32_bf16 v[244:247], a[4:7], a[192:195], v[244:247]
    s_waitcnt vmcnt(41)
    s_barrier
    ds_read_b64_tr_b16 a[32:33], v16 offset:16384
    ds_read_b64_tr_b16 a[34:35], v16 offset:18432
    v_mfma_f32_16x16x32_bf16 v[252:255], a[4:7], a[196:199], v[252:255]
    v_mfma_f32_16x16x32_bf16 a[68:71], a[8:11], a[192:195], a[68:71]
    ds_read_b64_tr_b16 a[36:37], v18 offset:16384
    ds_read_b64_tr_b16 a[38:39], v18 offset:18432
    v_mfma_f32_16x16x32_bf16 a[76:79], a[8:11], a[196:199], a[76:79]
    s_add_u32 m0, s65, 49152
    v_mfma_f32_16x16x32_bf16 a[84:87], a[12:15], a[192:195], a[84:87]
    ds_read_b64_tr_b16 a[40:41], v20 offset:16384
    ds_read_b64_tr_b16 a[42:43], v20 offset:18432
    v_mfma_f32_16x16x32_bf16 a[92:95], a[12:15], a[196:199], a[92:95]
    buffer_load_dwordx4 v10, s[12:15], s40 offen offset:0 lds
    s_waitcnt lgkmcnt(6)
    v_mfma_f32_16x16x32_bf16 a[100:103], a[16:19], a[192:195], a[100:103]
    ds_read_b64_tr_b16 a[44:45], v27 offset:16384
    ds_read_b64_tr_b16 a[46:47], v27 offset:18432
    v_mfma_f32_16x16x32_bf16 a[108:111], a[16:19], a[196:199], a[108:111]
    buffer_load_dwordx4 v11, s[12:15], s40 offen offset:1024 lds
    v_mfma_f32_16x16x32_bf16 a[116:119], a[20:23], a[192:195], a[116:119]
    ds_read_b64_tr_b16 a[48:49], v16 offset:16640
    ds_read_b64_tr_b16 a[50:51], v16 offset:18688
    v_mfma_f32_16x16x32_bf16 a[124:127], a[20:23], a[196:199], a[124:127]
    buffer_load_dwordx4 v12, s[12:15], s40 offen offset:2048 lds
    v_mfma_f32_16x16x32_bf16 a[132:135], a[24:27], a[192:195], a[132:135]
    ds_read_b64_tr_b16 a[52:53], v18 offset:16640
    ds_read_b64_tr_b16 a[54:55], v18 offset:18688
    v_mfma_f32_16x16x32_bf16 a[140:143], a[24:27], a[196:199], a[140:143]
    buffer_load_dwordx4 v13, s[12:15], s40 offen offset:3072 lds
    s_add_u32 s40, s40, 262144
    v_mfma_f32_16x16x32_bf16 a[148:151], a[28:31], a[192:195], a[148:151]
    ds_read_b64_tr_b16 a[56:57], v20 offset:16640
    ds_read_b64_tr_b16 a[58:59], v20 offset:18688
    v_mfma_f32_16x16x32_bf16 a[156:159], a[28:31], a[196:199], a[156:159]
    buffer_load_dwordx4 a[184:187], v22, s[96:99], s67 offen offset:2048 sc1
    s_waitcnt lgkmcnt(6)
    v_mfma_f32_16x16x32_bf16 v[160:163], a[32:35], a[200:203], v[160:163]
    ds_read_b64_tr_b16 a[60:61], v27 offset:16640
    ds_read_b64_tr_b16 a[62:63], v27 offset:18688
    v_mfma_f32_16x16x32_bf16 v[168:171], a[32:35], a[204:207], v[168:171]
    v_mfma_f32_16x16x32_bf16 v[176:179], a[36:39], a[200:203], v[176:179]
    ds_read_b64_tr_b16 a[0:1], v6 offset:40960
    ds_read_b64_tr_b16 a[2:3], v6 offset:41984
    v_mfma_f32_16x16x32_bf16 v[184:187], a[36:39], a[204:207], v[184:187]
    buffer_load_dwordx4 a[188:191], v22, s[96:99], s67 offen offset:3072 sc1
    v_mfma_f32_16x16x32_bf16 v[192:195], a[40:43], a[200:203], v[192:195]
    ds_read_b64_tr_b16 a[4:5], v8 offset:40960
    ds_read_b64_tr_b16 a[6:7], v8 offset:41984
    v_mfma_f32_16x16x32_bf16 v[200:203], a[40:43], a[204:207], v[200:203]
    v_mfma_f32_16x16x32_bf16 v[208:211], a[44:47], a[200:203], v[208:211]
    ds_read_b64_tr_b16 a[8:9], v14 offset:40960
    ds_read_b64_tr_b16 a[10:11], v14 offset:41984
    v_mfma_f32_16x16x32_bf16 v[216:219], a[44:47], a[204:207], v[216:219]
    buffer_store_dwordx4 v[92:95], v23, s[16:19], s49 offen offset:3072
    s_waitcnt lgkmcnt(6)
    v_mfma_f32_16x16x32_bf16 v[224:227], a[48:51], a[200:203], v[224:227]
    ds_read_b64_tr_b16 a[12:13], v24 offset:40960
    ds_read_b64_tr_b16 a[14:15], v24 offset:41984
    v_mfma_f32_16x16x32_bf16 v[232:235], a[48:51], a[204:207], v[232:235]
    v_mfma_f32_16x16x32_bf16 v[240:243], a[52:55], a[200:203], v[240:243]
    ds_read_b64_tr_b16 a[16:17], v17 offset:16384
    ds_read_b64_tr_b16 a[18:19], v17 offset:18432
    v_mfma_f32_16x16x32_bf16 v[248:251], a[52:55], a[204:207], v[248:251]
    buffer_store_dwordx4 v[96:99], v22, s[16:19], s50 offen offset:0
    v_mfma_f32_16x16x32_bf16 a[64:67], a[56:59], a[200:203], a[64:67]
    ds_read_b64_tr_b16 a[20:21], v19 offset:16384
    ds_read_b64_tr_b16 a[22:23], v19 offset:18432
    v_mfma_f32_16x16x32_bf16 a[72:75], a[56:59], a[204:207], a[72:75]
    v_mfma_f32_16x16x32_bf16 a[80:83], a[60:63], a[200:203], a[80:83]
    ds_read_b64_tr_b16 a[24:25], v21 offset:16384
    ds_read_b64_tr_b16 a[26:27], v21 offset:18432
    v_mfma_f32_16x16x32_bf16 a[88:91], a[60:63], a[204:207], a[88:91]
    buffer_store_dwordx4 v[100:103], v22, s[16:19], s50 offen offset:1024
    s_add_u32 m0, s65, 114688
    s_waitcnt lgkmcnt(6)
    v_mfma_f32_16x16x32_bf16 a[96:99], a[0:3], a[200:203], a[96:99]
    ds_read_b64_tr_b16 a[28:29], v31 offset:16384
    ds_read_b64_tr_b16 a[30:31], v31 offset:18432
    v_mfma_f32_16x16x32_bf16 a[104:107], a[0:3], a[204:207], a[104:107]
    v_mfma_f32_16x16x32_bf16 a[112:115], a[4:7], a[200:203], a[112:115]
    ds_read_b64_tr_b16 a[32:33], v17 offset:16640
    ds_read_b64_tr_b16 a[34:35], v17 offset:18688
    v_mfma_f32_16x16x32_bf16 a[120:123], a[4:7], a[204:207], a[120:123]
    buffer_load_dwordx4 v2, s[8:11], s39 offen offset:0 lds
    v_mfma_f32_16x16x32_bf16 a[128:131], a[8:11], a[200:203], a[128:131]
    ds_read_b64_tr_b16 a[36:37], v19 offset:16640
    ds_read_b64_tr_b16 a[38:39], v19 offset:18688
    v_mfma_f32_16x16x32_bf16 a[136:139], a[8:11], a[204:207], a[136:139]
    v_mfma_f32_16x16x32_bf16 a[144:147], a[12:15], a[200:203], a[144:147]
    ds_read_b64_tr_b16 a[40:41], v21 offset:16640
    ds_read_b64_tr_b16 a[42:43], v21 offset:18688
    v_mfma_f32_16x16x32_bf16 a[152:155], a[12:15], a[204:207], a[152:155]
    buffer_load_dwordx4 v3, s[8:11], s39 offen offset:1024 lds
    s_waitcnt lgkmcnt(6)
    v_mfma_f32_16x16x32_bf16 v[164:167], a[16:19], a[200:203], v[164:167]
    ds_read_b64_tr_b16 a[44:45], v31 offset:16640
    ds_read_b64_tr_b16 a[46:47], v31 offset:18688
    v_mfma_f32_16x16x32_bf16 v[172:175], a[16:19], a[204:207], v[172:175]
    v_mfma_f32_16x16x32_bf16 v[180:183], a[20:23], a[200:203], v[180:183]
    ds_read_b64_tr_b16 a[48:49], v7 offset:40960
    ds_read_b64_tr_b16 a[50:51], v7 offset:41984
    v_mfma_f32_16x16x32_bf16 v[188:191], a[20:23], a[204:207], v[188:191]
    buffer_load_dwordx4 v4, s[8:11], s39 offen offset:2048 lds
    v_mfma_f32_16x16x32_bf16 v[196:199], a[24:27], a[200:203], v[196:199]
    ds_read_b64_tr_b16 a[52:53], v9 offset:40960
    ds_read_b64_tr_b16 a[54:55], v9 offset:41984
    v_mfma_f32_16x16x32_bf16 v[204:207], a[24:27], a[204:207], v[204:207]
    v_mfma_f32_16x16x32_bf16 v[212:215], a[28:31], a[200:203], v[212:215]
    ds_read_b64_tr_b16 a[56:57], v15 offset:40960
    ds_read_b64_tr_b16 a[58:59], v15 offset:41984
    v_mfma_f32_16x16x32_bf16 v[220:223], a[28:31], a[204:207], v[220:223]
    buffer_load_dwordx4 v5, s[8:11], s39 offen offset:3072 lds
    s_add_u32 s39, s39, 229376
    s_waitcnt lgkmcnt(6)
    v_mfma_f32_16x16x32_bf16 v[228:231], a[32:35], a[200:203], v[228:231]
    ds_read_b64_tr_b16 a[60:61], v25 offset:40960
    ds_read_b64_tr_b16 a[62:63], v25 offset:41984
    v_mfma_f32_16x16x32_bf16 v[236:239], a[32:35], a[204:207], v[236:239]
    v_mfma_f32_16x16x32_bf16 v[244:247], a[36:39], a[200:203], v[244:247]
    s_waitcnt vmcnt(40)
    s_barrier
    v_xor_b32 v16, 0x10000, v16
    v_xor_b32 v17, 0x10000, v17
    v_xor_b32 v18, 0x10000, v18
    v_xor_b32 v19, 0x10000, v19
    v_xor_b32 v20, 0x10000, v20
    v_xor_b32 v21, 0x10000, v21
    v_xor_b32 v27, 0x10000, v27
    v_xor_b32 v31, 0x10000, v31
    ds_read_b64_tr_b16 a[0:1], v16 offset:0
    ds_read_b64_tr_b16 a[2:3], v16 offset:2048
    v_mfma_f32_16x16x32_bf16 v[252:255], a[36:39], a[204:207], v[252:255]
    v_mfma_f32_16x16x32_bf16 a[68:71], a[40:43], a[200:203], a[68:71]
    ds_read_b64_tr_b16 a[4:5], v18 offset:0
    ds_read_b64_tr_b16 a[6:7], v18 offset:2048
    v_mfma_f32_16x16x32_bf16 a[76:79], a[40:43], a[204:207], a[76:79]
    s_add_u32 m0, s65, 65536
    v_mfma_f32_16x16x32_bf16 a[84:87], a[44:47], a[200:203], a[84:87]
    ds_read_b64_tr_b16 a[8:9], v20 offset:0
    ds_read_b64_tr_b16 a[10:11], v20 offset:2048
    v_mfma_f32_16x16x32_bf16 a[92:95], a[44:47], a[204:207], a[92:95]
    buffer_load_dwordx4 v10, s[12:15], s40 offen offset:0 lds
    s_waitcnt lgkmcnt(6)
    v_mfma_f32_16x16x32_bf16 a[100:103], a[48:51], a[200:203], a[100:103]
    ds_read_b64_tr_b16 a[12:13], v27 offset:0
    ds_read_b64_tr_b16 a[14:15], v27 offset:2048
    v_mfma_f32_16x16x32_bf16 a[108:111], a[48:51], a[204:207], a[108:111]
    v_mfma_f32_16x16x32_bf16 a[116:119], a[52:55], a[200:203], a[116:119]
    ds_read_b64_tr_b16 a[16:17], v16 offset:256
    ds_read_b64_tr_b16 a[18:19], v16 offset:2304
    v_mfma_f32_16x16x32_bf16 a[124:127], a[52:55], a[204:207], a[124:127]
    buffer_load_dwordx4 v11, s[12:15], s40 offen offset:1024 lds
    v_mfma_f32_16x16x32_bf16 a[132:135], a[56:59], a[200:203], a[132:135]
    ds_read_b64_tr_b16 a[20:21], v18 offset:256
    ds_read_b64_tr_b16 a[22:23], v18 offset:2304
    v_mfma_f32_16x16x32_bf16 a[140:143], a[56:59], a[204:207], a[140:143]
    v_mfma_f32_16x16x32_bf16 a[148:151], a[60:63], a[200:203], a[148:151]
    ds_read_b64_tr_b16 a[24:25], v20 offset:256
    ds_read_b64_tr_b16 a[26:27], v20 offset:2304
    v_mfma_f32_16x16x32_bf16 a[156:159], a[60:63], a[204:207], a[156:159]
    buffer_load_dwordx4 v12, s[12:15], s40 offen offset:2048 lds
    s_waitcnt lgkmcnt(6)
    v_mfma_f32_16x16x32_bf16 v[160:163], a[0:3], a[208:211], v[160:163]
    ds_read_b64_tr_b16 a[28:29], v27 offset:256
    ds_read_b64_tr_b16 a[30:31], v27 offset:2304
    v_mfma_f32_16x16x32_bf16 v[168:171], a[0:3], a[212:215], v[168:171]
    v_mfma_f32_16x16x32_bf16 v[176:179], a[4:7], a[208:211], v[176:179]
    ds_read_b64_tr_b16 a[32:33], v6 offset:49152
    ds_read_b64_tr_b16 a[34:35], v6 offset:50176
    v_mfma_f32_16x16x32_bf16 v[184:187], a[4:7], a[212:215], v[184:187]
    buffer_load_dwordx4 v13, s[12:15], s40 offen offset:3072 lds
    s_add_u32 s40, s40, 262144
    s_add_u32 s67, s67, 4096
    v_mfma_f32_16x16x32_bf16 v[192:195], a[8:11], a[208:211], v[192:195]
    ds_read_b64_tr_b16 a[36:37], v8 offset:49152
    ds_read_b64_tr_b16 a[38:39], v8 offset:50176
    v_mfma_f32_16x16x32_bf16 v[200:203], a[8:11], a[212:215], v[200:203]
    v_mfma_f32_16x16x32_bf16 v[208:211], a[12:15], a[208:211], v[208:211]
    ds_read_b64_tr_b16 a[40:41], v14 offset:49152
    ds_read_b64_tr_b16 a[42:43], v14 offset:50176
    v_mfma_f32_16x16x32_bf16 v[216:219], a[12:15], a[212:215], v[216:219]
    buffer_load_dwordx4 a[192:195], v22, s[96:99], s67 offen offset:0 sc1
    s_waitcnt lgkmcnt(6)
    v_mfma_f32_16x16x32_bf16 v[224:227], a[16:19], a[208:211], v[224:227]
    ds_read_b64_tr_b16 a[44:45], v24 offset:49152
    ds_read_b64_tr_b16 a[46:47], v24 offset:50176
    v_mfma_f32_16x16x32_bf16 v[232:235], a[16:19], a[212:215], v[232:235]
    v_mfma_f32_16x16x32_bf16 v[240:243], a[20:23], a[208:211], v[240:243]
    ds_read_b64_tr_b16 a[48:49], v17 offset:0
    ds_read_b64_tr_b16 a[50:51], v17 offset:2048
    v_mfma_f32_16x16x32_bf16 v[248:251], a[20:23], a[212:215], v[248:251]
    buffer_load_dwordx4 a[196:199], v22, s[96:99], s67 offen offset:1024 sc1
    v_mfma_f32_16x16x32_bf16 a[64:67], a[24:27], a[208:211], a[64:67]
    ds_read_b64_tr_b16 a[52:53], v19 offset:0
    ds_read_b64_tr_b16 a[54:55], v19 offset:2048
    v_mfma_f32_16x16x32_bf16 a[72:75], a[24:27], a[212:215], a[72:75]
    v_mfma_f32_16x16x32_bf16 a[80:83], a[28:31], a[208:211], a[80:83]
    ds_read_b64_tr_b16 a[56:57], v21 offset:0
    ds_read_b64_tr_b16 a[58:59], v21 offset:2048
    v_mfma_f32_16x16x32_bf16 a[88:91], a[28:31], a[212:215], a[88:91]
    buffer_store_dwordx4 v[104:107], v22, s[16:19], s50 offen offset:2048
    s_waitcnt lgkmcnt(6)
    v_mfma_f32_16x16x32_bf16 a[96:99], a[32:35], a[208:211], a[96:99]
    ds_read_b64_tr_b16 a[60:61], v31 offset:0
    ds_read_b64_tr_b16 a[62:63], v31 offset:2048
    v_mfma_f32_16x16x32_bf16 a[104:107], a[32:35], a[212:215], a[104:107]
    v_mfma_f32_16x16x32_bf16 a[112:115], a[36:39], a[208:211], a[112:115]
    ds_read_b64_tr_b16 a[0:1], v17 offset:256
    ds_read_b64_tr_b16 a[2:3], v17 offset:2304
    v_mfma_f32_16x16x32_bf16 a[120:123], a[36:39], a[212:215], a[120:123]
    buffer_store_dwordx4 v[108:111], v22, s[16:19], s50 offen offset:3072
    v_mfma_f32_16x16x32_bf16 a[128:131], a[40:43], a[208:211], a[128:131]
    ds_read_b64_tr_b16 a[4:5], v19 offset:256
    ds_read_b64_tr_b16 a[6:7], v19 offset:2304
    v_mfma_f32_16x16x32_bf16 a[136:139], a[40:43], a[212:215], a[136:139]
    v_mfma_f32_16x16x32_bf16 a[144:147], a[44:47], a[208:211], a[144:147]
    ds_read_b64_tr_b16 a[8:9], v21 offset:256
    ds_read_b64_tr_b16 a[10:11], v21 offset:2304
    v_mfma_f32_16x16x32_bf16 a[152:155], a[44:47], a[212:215], a[152:155]
    buffer_store_dwordx4 v[112:115], v23, s[16:19], s50 offen offset:0
    s_waitcnt lgkmcnt(6)
    v_mfma_f32_16x16x32_bf16 v[164:167], a[48:51], a[208:211], v[164:167]
    ds_read_b64_tr_b16 a[12:13], v31 offset:256
    ds_read_b64_tr_b16 a[14:15], v31 offset:2304
    v_mfma_f32_16x16x32_bf16 v[172:175], a[48:51], a[212:215], v[172:175]
    v_mfma_f32_16x16x32_bf16 v[180:183], a[52:55], a[208:211], v[180:183]
    ds_read_b64_tr_b16 a[16:17], v7 offset:49152
    ds_read_b64_tr_b16 a[18:19], v7 offset:50176
    v_mfma_f32_16x16x32_bf16 v[188:191], a[52:55], a[212:215], v[188:191]
    v_mfma_f32_16x16x32_bf16 v[196:199], a[56:59], a[208:211], v[196:199]
    ds_read_b64_tr_b16 a[20:21], v9 offset:49152
    ds_read_b64_tr_b16 a[22:23], v9 offset:50176
    v_mfma_f32_16x16x32_bf16 v[204:207], a[56:59], a[212:215], v[204:207]
    v_mfma_f32_16x16x32_bf16 v[212:215], a[60:63], a[208:211], v[212:215]
    ds_read_b64_tr_b16 a[24:25], v15 offset:49152
    ds_read_b64_tr_b16 a[26:27], v15 offset:50176
    v_mfma_f32_16x16x32_bf16 v[220:223], a[60:63], a[212:215], v[220:223]
    s_waitcnt lgkmcnt(6)
    v_mfma_f32_16x16x32_bf16 v[228:231], a[0:3], a[208:211], v[228:231]
    ds_read_b64_tr_b16 a[28:29], v25 offset:49152
    ds_read_b64_tr_b16 a[30:31], v25 offset:50176
    v_mfma_f32_16x16x32_bf16 v[236:239], a[0:3], a[212:215], v[236:239]
    v_mfma_f32_16x16x32_bf16 v[244:247], a[4:7], a[208:211], v[244:247]
    s_waitcnt vmcnt(40)
    s_barrier
    ds_read_b64_tr_b16 a[32:33], v16 offset:16384
    ds_read_b64_tr_b16 a[34:35], v16 offset:18432
    v_mfma_f32_16x16x32_bf16 v[252:255], a[4:7], a[212:215], v[252:255]
    v_mfma_f32_16x16x32_bf16 a[68:71], a[8:11], a[208:211], a[68:71]
    ds_read_b64_tr_b16 a[36:37], v18 offset:16384
    ds_read_b64_tr_b16 a[38:39], v18 offset:18432
    v_mfma_f32_16x16x32_bf16 a[76:79], a[8:11], a[212:215], a[76:79]
    s_add_u32 m0, s65, 81920
    v_mfma_f32_16x16x32_bf16 a[84:87], a[12:15], a[208:211], a[84:87]
    ds_read_b64_tr_b16 a[40:41], v20 offset:16384
    ds_read_b64_tr_b16 a[42:43], v20 offset:18432
    v_mfma_f32_16x16x32_bf16 a[92:95], a[12:15], a[212:215], a[92:95]
    buffer_load_dwordx4 v10, s[12:15], s40 offen offset:0 lds
    s_waitcnt lgkmcnt(6)
    v_mfma_f32_16x16x32_bf16 a[100:103], a[16:19], a[208:211], a[100:103]
    ds_read_b64_tr_b16 a[44:45], v27 offset:16384
    ds_read_b64_tr_b16 a[46:47], v27 offset:18432
    v_mfma_f32_16x16x32_bf16 a[108:111], a[16:19], a[212:215], a[108:111]
    buffer_load_dwordx4 v11, s[12:15], s40 offen offset:1024 lds
    v_mfma_f32_16x16x32_bf16 a[116:119], a[20:23], a[208:211], a[116:119]
    ds_read_b64_tr_b16 a[48:49], v16 offset:16640
    ds_read_b64_tr_b16 a[50:51], v16 offset:18688
    v_mfma_f32_16x16x32_bf16 a[124:127], a[20:23], a[212:215], a[124:127]
    buffer_load_dwordx4 v12, s[12:15], s40 offen offset:2048 lds
    v_mfma_f32_16x16x32_bf16 a[132:135], a[24:27], a[208:211], a[132:135]
    ds_read_b64_tr_b16 a[52:53], v18 offset:16640
    ds_read_b64_tr_b16 a[54:55], v18 offset:18688
    v_mfma_f32_16x16x32_bf16 a[140:143], a[24:27], a[212:215], a[140:143]
    v_mfma_f32_16x16x32_bf16 a[148:151], a[28:31], a[208:211], a[148:151]
    ds_read_b64_tr_b16 a[56:57], v20 offset:16640
    ds_read_b64_tr_b16 a[58:59], v20 offset:18688
    v_mfma_f32_16x16x32_bf16 a[156:159], a[28:31], a[212:215], a[156:159]
    buffer_load_dwordx4 v13, s[12:15], s40 offen offset:3072 lds
    s_add_u32 s40, s40, 262144
    s_waitcnt lgkmcnt(6)
    v_mfma_f32_16x16x32_bf16 v[160:163], a[32:35], a[216:219], v[160:163]
    ds_read_b64_tr_b16 a[60:61], v27 offset:16640
    ds_read_b64_tr_b16 a[62:63], v27 offset:18688
    v_mfma_f32_16x16x32_bf16 v[168:171], a[32:35], a[220:223], v[168:171]
    v_mfma_f32_16x16x32_bf16 v[176:179], a[36:39], a[216:219], v[176:179]
    ds_read_b64_tr_b16 a[0:1], v6 offset:57344
    ds_read_b64_tr_b16 a[2:3], v6 offset:58368
    v_mfma_f32_16x16x32_bf16 v[184:187], a[36:39], a[220:223], v[184:187]
    buffer_load_dwordx4 a[200:203], v22, s[96:99], s67 offen offset:2048 sc1
    v_mfma_f32_16x16x32_bf16 v[192:195], a[40:43], a[216:219], v[192:195]
    ds_read_b64_tr_b16 a[4:5], v8 offset:57344
    ds_read_b64_tr_b16 a[6:7], v8 offset:58368
    v_mfma_f32_16x16x32_bf16 v[200:203], a[40:43], a[220:223], v[200:203]
    v_mfma_f32_16x16x32_bf16 v[208:211], a[44:47], a[216:219], v[208:211]
    ds_read_b64_tr_b16 a[8:9], v14 offset:57344
    ds_read_b64_tr_b16 a[10:11], v14 offset:58368
    v_mfma_f32_16x16x32_bf16 v[216:219], a[44:47], a[220:223], v[216:219]
    buffer_load_dwordx4 a[204:207], v22, s[96:99], s67 offen offset:3072 sc1
    s_waitcnt lgkmcnt(6)
    v_mfma_f32_16x16x32_bf16 v[224:227], a[48:51], a[216:219], v[224:227]
    ds_read_b64_tr_b16 a[12:13], v24 offset:57344
    ds_read_b64_tr_b16 a[14:15], v24 offset:58368
    v_mfma_f32_16x16x32_bf16 v[232:235], a[48:51], a[220:223], v[232:235]
    v_mfma_f32_16x16x32_bf16 v[240:243], a[52:55], a[216:219], v[240:243]
    ds_read_b64_tr_b16 a[16:17], v17 offset:16384
    ds_read_b64_tr_b16 a[18:19], v17 offset:18432
    v_mfma_f32_16x16x32_bf16 v[248:251], a[52:55], a[220:223], v[248:251]
    buffer_store_dwordx4 v[116:119], v23, s[16:19], s50 offen offset:1024
    v_mfma_f32_16x16x32_bf16 a[64:67], a[56:59], a[216:219], a[64:67]
    ds_read_b64_tr_b16 a[20:21], v19 offset:16384
    ds_read_b64_tr_b16 a[22:23], v19 offset:18432
    v_mfma_f32_16x16x32_bf16 a[72:75], a[56:59], a[220:223], a[72:75]
    v_mfma_f32_16x16x32_bf16 a[80:83], a[60:63], a[216:219], a[80:83]
    ds_read_b64_tr_b16 a[24:25], v21 offset:16384
    ds_read_b64_tr_b16 a[26:27], v21 offset:18432
    v_mfma_f32_16x16x32_bf16 a[88:91], a[60:63], a[220:223], a[88:91]
    buffer_store_dwordx4 v[120:123], v23, s[16:19], s50 offen offset:2048
    s_add_u32 m0, s65, 131072
    s_waitcnt lgkmcnt(6)
    v_mfma_f32_16x16x32_bf16 a[96:99], a[0:3], a[216:219], a[96:99]
    ds_read_b64_tr_b16 a[28:29], v31 offset:16384
    ds_read_b64_tr_b16 a[30:31], v31 offset:18432
    v_mfma_f32_16x16x32_bf16 a[104:107], a[0:3], a[220:223], a[104:107]
    v_mfma_f32_16x16x32_bf16 a[112:115], a[4:7], a[216:219], a[112:115]
    ds_read_b64_tr_b16 a[32:33], v17 offset:16640
    ds_read_b64_tr_b16 a[34:35], v17 offset:18688
    v_mfma_f32_16x16x32_bf16 a[120:123], a[4:7], a[220:223], a[120:123]
    buffer_load_dwordx4 v2, s[8:11], s39 offen offset:0 lds
    v_mfma_f32_16x16x32_bf16 a[128:131], a[8:11], a[216:219], a[128:131]
    ds_read_b64_tr_b16 a[36:37], v19 offset:16640
    ds_read_b64_tr_b16 a[38:39], v19 offset:18688
    v_mfma_f32_16x16x32_bf16 a[136:139], a[8:11], a[220:223], a[136:139]
    v_mfma_f32_16x16x32_bf16 a[144:147], a[12:15], a[216:219], a[144:147]
    ds_read_b64_tr_b16 a[40:41], v21 offset:16640
    ds_read_b64_tr_b16 a[42:43], v21 offset:18688
    v_mfma_f32_16x16x32_bf16 a[152:155], a[12:15], a[220:223], a[152:155]
    buffer_load_dwordx4 v3, s[8:11], s39 offen offset:1024 lds
    s_waitcnt lgkmcnt(6)
    v_mfma_f32_16x16x32_bf16 v[164:167], a[16:19], a[216:219], v[164:167]
    ds_read_b64_tr_b16 a[44:45], v31 offset:16640
    ds_read_b64_tr_b16 a[46:47], v31 offset:18688
    v_mfma_f32_16x16x32_bf16 v[172:175], a[16:19], a[220:223], v[172:175]
    v_mfma_f32_16x16x32_bf16 v[180:183], a[20:23], a[216:219], v[180:183]
    ds_read_b64_tr_b16 a[48:49], v7 offset:57344
    ds_read_b64_tr_b16 a[50:51], v7 offset:58368
    v_mfma_f32_16x16x32_bf16 v[188:191], a[20:23], a[220:223], v[188:191]
    buffer_load_dwordx4 v4, s[8:11], s39 offen offset:2048 lds
    v_mfma_f32_16x16x32_bf16 v[196:199], a[24:27], a[216:219], v[196:199]
    ds_read_b64_tr_b16 a[52:53], v9 offset:57344
    ds_read_b64_tr_b16 a[54:55], v9 offset:58368
    v_mfma_f32_16x16x32_bf16 v[204:207], a[24:27], a[220:223], v[204:207]
    v_mfma_f32_16x16x32_bf16 v[212:215], a[28:31], a[216:219], v[212:215]
    ds_read_b64_tr_b16 a[56:57], v15 offset:57344
    ds_read_b64_tr_b16 a[58:59], v15 offset:58368
    v_mfma_f32_16x16x32_bf16 v[220:223], a[28:31], a[220:223], v[220:223]
    buffer_load_dwordx4 v5, s[8:11], s39 offen offset:3072 lds
    s_add_u32 s39, s39, 229376
    s_mov_b32 s4, 0x3db8aa3b
    s_mov_b32 s5, 0x3db8aa3b
    s_cmp_eq_u32 s59, 0
    s_cbranch_scc1 L_km_single
    s_waitcnt lgkmcnt(6)
    v_mfma_f32_16x16x32_bf16 v[228:231], a[32:35], a[216:219], v[228:231]
    ds_read_b64_tr_b16 a[60:61], v25 offset:57344
    ds_read_b64_tr_b16 a[62:63], v25 offset:58368
    v_mfma_f32_16x16x32_bf16 v[236:239], a[32:35], a[220:223], v[236:239]
    v_mfma_f32_16x16x32_bf16 v[244:247], a[36:39], a[216:219], v[244:247]
    s_waitcnt vmcnt(39)
    s_barrier
    ds_read_b64_tr_b16 a[0:1], v16 offset:32768
    ds_read_b64_tr_b16 a[2:3], v16 offset:34816
    v_mfma_f32_16x16x32_bf16 v[252:255], a[36:39], a[220:223], v[252:255]
    v_mfma_f32_16x16x32_bf16 a[68:71], a[40:43], a[216:219], a[68:71]
    ds_read_b64_tr_b16 a[4:5], v18 offset:32768
    ds_read_b64_tr_b16 a[6:7], v18 offset:34816
    v_mfma_f32_16x16x32_bf16 a[76:79], a[40:43], a[220:223], a[76:79]
    s_add_u32 m0, s65, 0
    v_mfma_f32_16x16x32_bf16 a[84:87], a[44:47], a[216:219], a[84:87]
    ds_read_b64_tr_b16 a[8:9], v20 offset:32768
    ds_read_b64_tr_b16 a[10:11], v20 offset:34816
    v_mfma_f32_16x16x32_bf16 a[92:95], a[44:47], a[220:223], a[92:95]
    buffer_load_dwordx4 v10, s[12:15], s40 offen offset:0 lds
    s_waitcnt lgkmcnt(6)
    v_mfma_f32_16x16x32_bf16 a[100:103], a[48:51], a[216:219], a[100:103]
    ds_read_b64_tr_b16 a[12:13], v27 offset:32768
    ds_read_b64_tr_b16 a[14:15], v27 offset:34816
    v_mfma_f32_16x16x32_bf16 a[108:111], a[48:51], a[220:223], a[108:111]
    v_mfma_f32_16x16x32_bf16 a[116:119], a[52:55], a[216:219], a[116:119]
    ds_read_b64_tr_b16 a[16:17], v16 offset:33024
    ds_read_b64_tr_b16 a[18:19], v16 offset:35072
    v_mfma_f32_16x16x32_bf16 a[124:127], a[52:55], a[220:223], a[124:127]
    buffer_load_dwordx4 v11, s[12:15], s40 offen offset:1024 lds
    v_mfma_f32_16x16x32_bf16 a[132:135], a[56:59], a[216:219], a[132:135]
    ds_read_b64_tr_b16 a[20:21], v18 offset:33024
    ds_read_b64_tr_b16 a[22:23], v18 offset:35072
    v_mfma_f32_16x16x32_bf16 a[140:143], a[56:59], a[220:223], a[140:143]
    v_mfma_f32_16x16x32_bf16 a[148:151], a[60:63], a[216:219], a[148:151]
    ds_read_b64_tr_b16 a[24:25], v20 offset:33024
    ds_read_b64_tr_b16 a[26:27], v20 offset:35072
    v_mfma_f32_16x16x32_bf16 a[156:159], a[60:63], a[220:223], a[156:159]
    buffer_load_dwordx4 v12, s[12:15], s40 offen offset:2048 lds
    s_waitcnt lgkmcnt(6)
    v_mfma_f32_16x16x32_bf16 v[160:163], a[0:3], a[160:163], v[160:163]
    ds_read_b64_tr_b16 a[28:29], v27 offset:33024
    ds_read_b64_tr_b16 a[30:31], v27 offset:35072
    v_mfma_f32_16x16x32_bf16 v[168:171], a[0:3], a[164:167], v[168:171]
    v_mfma_f32_16x16x32_bf16 v[176:179], a[4:7], a[160:163], v[176:179]
    ds_read_b64_tr_b16 a[32:33], v6 offset:0
    ds_read_b64_tr_b16 a[34:35], v6 offset:1024
    v_mfma_f32_16x16x32_bf16 v[184:187], a[4:7], a[164:167], v[184:187]
    buffer_load_dwordx4 v13, s[12:15], s40 offen offset:3072 lds
    s_add_u32 s40, s40, 262144
    s_mul_i32 s67, s58, 28672
    v_mfma_f32_16x16x32_bf16 v[192:195], a[8:11], a[160:163], v[192:195]
    ds_read_b64_tr_b16 a[36:37], v8 offset:0
    ds_read_b64_tr_b16 a[38:39], v8 offset:1024
    v_mfma_f32_16x16x32_bf16 v[200:203], a[8:11], a[164:167], v[200:203]
    v_mfma_f32_16x16x32_bf16 v[208:211], a[12:15], a[160:163], v[208:211]
    ds_read_b64_tr_b16 a[40:41], v14 offset:0
    ds_read_b64_tr_b16 a[42:43], v14 offset:1024
    v_mfma_f32_16x16x32_bf16 v[216:219], a[12:15], a[164:167], v[216:219]
    buffer_load_dwordx4 a[208:211], v22, s[96:99], s67 offen offset:0 sc1
    s_waitcnt lgkmcnt(6)
    v_mfma_f32_16x16x32_bf16 v[224:227], a[16:19], a[160:163], v[224:227]
    ds_read_b64_tr_b16 a[44:45], v24 offset:0
    ds_read_b64_tr_b16 a[46:47], v24 offset:1024
    v_mfma_f32_16x16x32_bf16 v[232:235], a[16:19], a[164:167], v[232:235]
    v_mfma_f32_16x16x32_bf16 v[240:243], a[20:23], a[160:163], v[240:243]
    ds_read_b64_tr_b16 a[48:49], v17 offset:32768
    ds_read_b64_tr_b16 a[50:51], v17 offset:34816
    v_mfma_f32_16x16x32_bf16 v[248:251], a[20:23], a[164:167], v[248:251]
    buffer_load_dwordx4 a[212:215], v22, s[96:99], s67 offen offset:1024 sc1
    v_mfma_f32_16x16x32_bf16 a[64:67], a[24:27], a[160:163], a[64:67]
    ds_read_b64_tr_b16 a[52:53], v19 offset:32768
    ds_read_b64_tr_b16 a[54:55], v19 offset:34816
    v_mfma_f32_16x16x32_bf16 a[72:75], a[24:27], a[164:167], a[72:75]
    v_mfma_f32_16x16x32_bf16 a[80:83], a[28:31], a[160:163], a[80:83]
    ds_read_b64_tr_b16 a[56:57], v21 offset:32768
    ds_read_b64_tr_b16 a[58:59], v21 offset:34816
    v_mfma_f32_16x16x32_bf16 a[88:91], a[28:31], a[164:167], a[88:91]
    buffer_store_dwordx4 v[124:127], v23, s[16:19], s50 offen offset:3072
    s_waitcnt lgkmcnt(6)
    v_mfma_f32_16x16x32_bf16 a[96:99], a[32:35], a[160:163], a[96:99]
    ds_read_b64_tr_b16 a[60:61], v31 offset:32768
    ds_read_b64_tr_b16 a[62:63], v31 offset:34816
    v_mfma_f32_16x16x32_bf16 a[104:107], a[32:35], a[164:167], a[104:107]
    v_mfma_f32_16x16x32_bf16 a[112:115], a[36:39], a[160:163], a[112:115]
    ds_read_b64_tr_b16 a[0:1], v17 offset:33024
    ds_read_b64_tr_b16 a[2:3], v17 offset:35072
    v_mfma_f32_16x16x32_bf16 a[120:123], a[36:39], a[164:167], a[120:123]
    buffer_store_dwordx4 v[128:131], v22, s[16:19], s51 offen offset:0
    v_mfma_f32_16x16x32_bf16 a[128:131], a[40:43], a[160:163], a[128:131]
    ds_read_b64_tr_b16 a[4:5], v19 offset:33024
    ds_read_b64_tr_b16 a[6:7], v19 offset:35072
    v_mfma_f32_16x16x32_bf16 a[136:139], a[40:43], a[164:167], a[136:139]
    v_mfma_f32_16x16x32_bf16 a[144:147], a[44:47], a[160:163], a[144:147]
    ds_read_b64_tr_b16 a[8:9], v21 offset:33024
    ds_read_b64_tr_b16 a[10:11], v21 offset:35072
    v_mfma_f32_16x16x32_bf16 a[152:155], a[44:47], a[164:167], a[152:155]
    buffer_store_dwordx4 v[132:135], v22, s[16:19], s51 offen offset:1024
    s_waitcnt lgkmcnt(6)
    v_mfma_f32_16x16x32_bf16 v[164:167], a[48:51], a[160:163], v[164:167]
    ds_read_b64_tr_b16 a[12:13], v31 offset:33024
    ds_read_b64_tr_b16 a[14:15], v31 offset:35072
    v_mfma_f32_16x16x32_bf16 v[172:175], a[48:51], a[164:167], v[172:175]
    v_mfma_f32_16x16x32_bf16 v[180:183], a[52:55], a[160:163], v[180:183]
    ds_read_b64_tr_b16 a[16:17], v7 offset:0
    ds_read_b64_tr_b16 a[18:19], v7 offset:1024
    v_mfma_f32_16x16x32_bf16 v[188:191], a[52:55], a[164:167], v[188:191]
    v_mfma_f32_16x16x32_bf16 v[196:199], a[56:59], a[160:163], v[196:199]
    ds_read_b64_tr_b16 a[20:21], v9 offset:0
    ds_read_b64_tr_b16 a[22:23], v9 offset:1024
    v_mfma_f32_16x16x32_bf16 v[204:207], a[56:59], a[164:167], v[204:207]
    v_mfma_f32_16x16x32_bf16 v[212:215], a[60:63], a[160:163], v[212:215]
    ds_read_b64_tr_b16 a[24:25], v15 offset:0
    ds_read_b64_tr_b16 a[26:27], v15 offset:1024
    v_mfma_f32_16x16x32_bf16 v[220:223], a[60:63], a[164:167], v[220:223]
    s_waitcnt lgkmcnt(6)
    v_mfma_f32_16x16x32_bf16 v[228:231], a[0:3], a[160:163], v[228:231]
    ds_read_b64_tr_b16 a[28:29], v25 offset:0
    ds_read_b64_tr_b16 a[30:31], v25 offset:1024
    v_mfma_f32_16x16x32_bf16 v[236:239], a[0:3], a[164:167], v[236:239]
    v_mfma_f32_16x16x32_bf16 v[244:247], a[4:7], a[160:163], v[244:247]
    s_waitcnt vmcnt(39)
    s_barrier
    ds_read_b64_tr_b16 a[32:33], v16 offset:49152
    ds_read_b64_tr_b16 a[34:35], v16 offset:51200
    v_mfma_f32_16x16x32_bf16 v[252:255], a[4:7], a[164:167], v[252:255]
    v_mfma_f32_16x16x32_bf16 a[68:71], a[8:11], a[160:163], a[68:71]
    ds_read_b64_tr_b16 a[36:37], v18 offset:49152
    ds_read_b64_tr_b16 a[38:39], v18 offset:51200
    v_mfma_f32_16x16x32_bf16 a[76:79], a[8:11], a[164:167], a[76:79]
    s_add_u32 m0, s65, 16384
    v_mfma_f32_16x16x32_bf16 a[84:87], a[12:15], a[160:163], a[84:87]
    ds_read_b64_tr_b16 a[40:41], v20 offset:49152
    ds_read_b64_tr_b16 a[42:43], v20 offset:51200
    v_mfma_f32_16x16x32_bf16 a[92:95], a[12:15], a[164:167], a[92:95]
    buffer_load_dwordx4 v10, s[12:15], s40 offen offset:0 lds
    s_waitcnt lgkmcnt(6)
    v_mfma_f32_16x16x32_bf16 a[100:103], a[16:19], a[160:163], a[100:103]
    ds_read_b64_tr_b16 a[44:45], v27 offset:49152
    ds_read_b64_tr_b16 a[46:47], v27 offset:51200
    v_mfma_f32_16x16x32_bf16 a[108:111], a[16:19], a[164:167], a[108:111]
    v_mfma_f32_16x16x32_bf16 a[116:119], a[20:23], a[160:163], a[116:119]
    ds_read_b64_tr_b16 a[48:49], v16 offset:49408
    ds_read_b64_tr_b16 a[50:51], v16 offset:51456
    v_mfma_f32_16x16x32_bf16 a[124:127], a[20:23], a[164:167], a[124:127]
    buffer_load_dwordx4 v11, s[12:15], s40 offen offset:1024 lds
    v_mfma_f32_16x16x32_bf16 a[132:135], a[24:27], a[160:163], a[132:135]
    ds_read_b64_tr_b16 a[52:53], v18 offset:49408
    ds_read_b64_tr_b16 a[54:55], v18 offset:51456
    v_mfma_f32_16x16x32_bf16 a[140:143], a[24:27], a[164:167], a[140:143]
    v_mfma_f32_16x16x32_bf16 a[148:151], a[28:31], a[160:163], a[148:151]
    ds_read_b64_tr_b16 a[56:57], v20 offset:49408
    ds_read_b64_tr_b16 a[58:59], v20 offset:51456
    v_mfma_f32_16x16x32_bf16 a[156:159], a[28:31], a[164:167], a[156:159]
    buffer_load_dwordx4 v12, s[12:15], s40 offen offset:2048 lds
    s_waitcnt lgkmcnt(6)
    v_mfma_f32_16x16x32_bf16 v[160:163], a[32:35], a[168:171], v[160:163]
    ds_read_b64_tr_b16 a[60:61], v27 offset:49408
    ds_read_b64_tr_b16 a[62:63], v27 offset:51456
    v_mfma_f32_16x16x32_bf16 v[168:171], a[32:35], a[172:175], v[168:171]
    v_mfma_f32_16x16x32_bf16 v[176:179], a[36:39], a[168:171], v[176:179]
    ds_read_b64_tr_b16 a[0:1], v6 offset:8192
    ds_read_b64_tr_b16 a[2:3], v6 offset:9216
    v_mfma_f32_16x16x32_bf16 v[184:187], a[36:39], a[172:175], v[184:187]
    buffer_load_dwordx4 v13, s[12:15], s40 offen offset:3072 lds
    s_add_u32 s40, s40, 262144
    v_mfma_f32_16x16x32_bf16 v[192:195], a[40:43], a[168:171], v[192:195]
    ds_read_b64_tr_b16 a[4:5], v8 offset:8192
    ds_read_b64_tr_b16 a[6:7], v8 offset:9216
    v_mfma_f32_16x16x32_bf16 v[200:203], a[40:43], a[172:175], v[200:203]
    v_mfma_f32_16x16x32_bf16 v[208:211], a[44:47], a[168:171], v[208:211]
    ds_read_b64_tr_b16 a[8:9], v14 offset:8192
    ds_read_b64_tr_b16 a[10:11], v14 offset:9216
    v_mfma_f32_16x16x32_bf16 v[216:219], a[44:47], a[172:175], v[216:219]
    buffer_load_dwordx4 a[216:219], v22, s[96:99], s67 offen offset:2048 sc1
    s_waitcnt lgkmcnt(6)
    v_mfma_f32_16x16x32_bf16 v[224:227], a[48:51], a[168:171], v[224:227]
    ds_read_b64_tr_b16 a[12:13], v24 offset:8192
    ds_read_b64_tr_b16 a[14:15], v24 offset:9216
    v_mfma_f32_16x16x32_bf16 v[232:235], a[48:51], a[172:175], v[232:235]
    v_mfma_f32_16x16x32_bf16 v[240:243], a[52:55], a[168:171], v[240:243]
    ds_read_b64_tr_b16 a[16:17], v17 offset:49152
    ds_read_b64_tr_b16 a[18:19], v17 offset:51200
    v_mfma_f32_16x16x32_bf16 v[248:251], a[52:55], a[172:175], v[248:251]
    buffer_load_dwordx4 a[220:223], v22, s[96:99], s67 offen offset:3072 sc1
    v_mfma_f32_16x16x32_bf16 a[64:67], a[56:59], a[168:171], a[64:67]
    ds_read_b64_tr_b16 a[20:21], v19 offset:49152
    ds_read_b64_tr_b16 a[22:23], v19 offset:51200
    v_mfma_f32_16x16x32_bf16 a[72:75], a[56:59], a[172:175], a[72:75]
    v_mfma_f32_16x16x32_bf16 a[80:83], a[60:63], a[168:171], a[80:83]
    ds_read_b64_tr_b16 a[24:25], v21 offset:49152
    ds_read_b64_tr_b16 a[26:27], v21 offset:51200
    v_mfma_f32_16x16x32_bf16 a[88:91], a[60:63], a[172:175], a[88:91]
    buffer_store_dwordx4 v[136:139], v22, s[16:19], s51 offen offset:2048
    s_waitcnt lgkmcnt(6)
    v_mfma_f32_16x16x32_bf16 a[96:99], a[0:3], a[168:171], a[96:99]
    ds_read_b64_tr_b16 a[28:29], v31 offset:49152
    ds_read_b64_tr_b16 a[30:31], v31 offset:51200
    v_mfma_f32_16x16x32_bf16 a[104:107], a[0:3], a[172:175], a[104:107]
    v_mfma_f32_16x16x32_bf16 a[112:115], a[4:7], a[168:171], a[112:115]
    ds_read_b64_tr_b16 a[32:33], v17 offset:49408
    ds_read_b64_tr_b16 a[34:35], v17 offset:51456
    v_mfma_f32_16x16x32_bf16 a[120:123], a[4:7], a[172:175], a[120:123]
    buffer_store_dwordx4 v[140:143], v22, s[16:19], s51 offen offset:3072
    v_mfma_f32_16x16x32_bf16 a[128:131], a[8:11], a[168:171], a[128:131]
    ds_read_b64_tr_b16 a[36:37], v19 offset:49408
    ds_read_b64_tr_b16 a[38:39], v19 offset:51456
    v_mfma_f32_16x16x32_bf16 a[136:139], a[8:11], a[172:175], a[136:139]
    v_mfma_f32_16x16x32_bf16 a[144:147], a[12:15], a[168:171], a[144:147]
    ds_read_b64_tr_b16 a[40:41], v21 offset:49408
    ds_read_b64_tr_b16 a[42:43], v21 offset:51456
    v_mfma_f32_16x16x32_bf16 a[152:155], a[12:15], a[172:175], a[152:155]
    buffer_store_dwordx4 v[144:147], v23, s[16:19], s51 offen offset:0
    s_waitcnt lgkmcnt(6)
    v_mfma_f32_16x16x32_bf16 v[164:167], a[16:19], a[168:171], v[164:167]
    ds_read_b64_tr_b16 a[44:45], v31 offset:49408
    ds_read_b64_tr_b16 a[46:47], v31 offset:51456
    v_mfma_f32_16x16x32_bf16 v[172:175], a[16:19], a[172:175], v[172:175]
    v_mfma_f32_16x16x32_bf16 v[180:183], a[20:23], a[168:171], v[180:183]
    ds_read_b64_tr_b16 a[48:49], v7 offset:8192
    ds_read_b64_tr_b16 a[50:51], v7 offset:9216
    v_mfma_f32_16x16x32_bf16 v[188:191], a[20:23], a[172:175], v[188:191]
    v_mfma_f32_16x16x32_bf16 v[196:199], a[24:27], a[168:171], v[196:199]
    ds_read_b64_tr_b16 a[52:53], v9 offset:8192
    ds_read_b64_tr_b16 a[54:55], v9 offset:9216
    v_mfma_f32_16x16x32_bf16 v[204:207], a[24:27], a[172:175], v[204:207]
    v_mfma_f32_16x16x32_bf16 v[212:215], a[28:31], a[168:171], v[212:215]
    ds_read_b64_tr_b16 a[56:57], v15 offset:8192
    ds_read_b64_tr_b16 a[58:59], v15 offset:9216
    v_mfma_f32_16x16x32_bf16 v[220:223], a[28:31], a[172:175], v[220:223]
    s_waitcnt lgkmcnt(6)
    v_mfma_f32_16x16x32_bf16 v[228:231], a[32:35], a[168:171], v[228:231]
    ds_read_b64_tr_b16 a[60:61], v25 offset:8192
    ds_read_b64_tr_b16 a[62:63], v25 offset:9216
    v_mfma_f32_16x16x32_bf16 v[236:239], a[32:35], a[172:175], v[236:239]
    v_mfma_f32_16x16x32_bf16 v[244:247], a[36:39], a[168:171], v[244:247]
    s_waitcnt vmcnt(35)
    s_barrier
    v_xor_b32 v16, 0x10000, v16
    v_xor_b32 v17, 0x10000, v17
    v_xor_b32 v18, 0x10000, v18
    v_xor_b32 v19, 0x10000, v19
    v_xor_b32 v20, 0x10000, v20
    v_xor_b32 v21, 0x10000, v21
    v_xor_b32 v27, 0x10000, v27
    v_xor_b32 v31, 0x10000, v31
    ds_read_b64_tr_b16 a[0:1], v16 offset:0
    ds_read_b64_tr_b16 a[2:3], v16 offset:2048
    v_mfma_f32_16x16x32_bf16 v[252:255], a[36:39], a[172:175], v[252:255]
    v_mfma_f32_16x16x32_bf16 a[68:71], a[40:43], a[168:171], a[68:71]
    ds_read_b64_tr_b16 a[4:5], v18 offset:0
    ds_read_b64_tr_b16 a[6:7], v18 offset:2048
    v_mfma_f32_16x16x32_bf16 a[76:79], a[40:43], a[172:175], a[76:79]
    s_mov_b32 s40, 0
    s_add_u32 m0, s65, 32768
    v_mfma_f32_16x16x32_bf16 a[84:87], a[44:47], a[168:171], a[84:87]
    ds_read_b64_tr_b16 a[8:9], v20 offset:0
    ds_read_b64_tr_b16 a[10:11], v20 offset:2048
    v_mfma_f32_16x16x32_bf16 a[92:95], a[44:47], a[172:175], a[92:95]
    buffer_load_dwordx4 v10, s[12:15], s40 offen offset:0 lds
    s_waitcnt lgkmcnt(6)
    v_mfma_f32_16x16x32_bf16 a[100:103], a[48:51], a[168:171], a[100:103]
    ds_read_b64_tr_b16 a[12:13], v27 offset:0
    ds_read_b64_tr_b16 a[14:15], v27 offset:2048
    v_mfma_f32_16x16x32_bf16 a[108:111], a[48:51], a[172:175], a[108:111]
    v_mfma_f32_16x16x32_bf16 a[116:119], a[52:55], a[168:171], a[116:119]
    ds_read_b64_tr_b16 a[16:17], v16 offset:256
    ds_read_b64_tr_b16 a[18:19], v16 offset:2304
    v_mfma_f32_16x16x32_bf16 a[124:127], a[52:55], a[172:175], a[124:127]
    buffer_load_dwordx4 v11, s[12:15], s40 offen offset:1024 lds
    v_mfma_f32_16x16x32_bf16 a[132:135], a[56:59], a[168:171], a[132:135]
    ds_read_b64_tr_b16 a[20:21], v18 offset:256
    ds_read_b64_tr_b16 a[22:23], v18 offset:2304
    v_mfma_f32_16x16x32_bf16 a[140:143], a[56:59], a[172:175], a[140:143]
    v_mfma_f32_16x16x32_bf16 a[148:151], a[60:63], a[168:171], a[148:151]
    ds_read_b64_tr_b16 a[24:25], v20 offset:256
    ds_read_b64_tr_b16 a[26:27], v20 offset:2304
    v_mfma_f32_16x16x32_bf16 a[156:159], a[60:63], a[172:175], a[156:159]
    buffer_load_dwordx4 v12, s[12:15], s40 offen offset:2048 lds
    s_waitcnt lgkmcnt(6)
    v_mfma_f32_16x16x32_bf16 v[160:163], a[0:3], a[176:179], v[160:163]
    ds_read_b64_tr_b16 a[28:29], v27 offset:256
    ds_read_b64_tr_b16 a[30:31], v27 offset:2304
    v_mfma_f32_16x16x32_bf16 v[168:171], a[0:3], a[180:183], v[168:171]
    v_mfma_f32_16x16x32_bf16 v[176:179], a[4:7], a[176:179], v[176:179]
    ds_read_b64_tr_b16 a[32:33], v6 offset:16384
    ds_read_b64_tr_b16 a[34:35], v6 offset:17408
    v_mfma_f32_16x16x32_bf16 v[184:187], a[4:7], a[180:183], v[184:187]
    buffer_load_dwordx4 v13, s[12:15], s40 offen offset:3072 lds
    s_add_u32 s40, s40, 262144
    s_add_u32 s67, s67, 4096
    v_mfma_f32_16x16x32_bf16 v[192:195], a[8:11], a[176:179], v[192:195]
    ds_read_b64_tr_b16 a[36:37], v8 offset:16384
    ds_read_b64_tr_b16 a[38:39], v8 offset:17408
    v_mfma_f32_16x16x32_bf16 v[200:203], a[8:11], a[180:183], v[200:203]
    v_mfma_f32_16x16x32_bf16 v[208:211], a[12:15], a[176:179], v[208:211]
    ds_read_b64_tr_b16 a[40:41], v14 offset:16384
    ds_read_b64_tr_b16 a[42:43], v14 offset:17408
    v_mfma_f32_16x16x32_bf16 v[216:219], a[12:15], a[180:183], v[216:219]
    buffer_load_dwordx4 a[160:163], v22, s[96:99], s67 offen offset:0 sc1
    s_waitcnt lgkmcnt(6)
    v_mfma_f32_16x16x32_bf16 v[224:227], a[16:19], a[176:179], v[224:227]
    ds_read_b64_tr_b16 a[44:45], v24 offset:16384
    ds_read_b64_tr_b16 a[46:47], v24 offset:17408
    v_mfma_f32_16x16x32_bf16 v[232:235], a[16:19], a[180:183], v[232:235]
    v_mfma_f32_16x16x32_bf16 v[240:243], a[20:23], a[176:179], v[240:243]
    ds_read_b64_tr_b16 a[48:49], v17 offset:0
    ds_read_b64_tr_b16 a[50:51], v17 offset:2048
    v_mfma_f32_16x16x32_bf16 v[248:251], a[20:23], a[180:183], v[248:251]
    buffer_load_dwordx4 a[164:167], v22, s[96:99], s67 offen offset:1024 sc1
    v_mfma_f32_16x16x32_bf16 a[64:67], a[24:27], a[176:179], a[64:67]
    ds_read_b64_tr_b16 a[52:53], v19 offset:0
    ds_read_b64_tr_b16 a[54:55], v19 offset:2048
    v_mfma_f32_16x16x32_bf16 a[72:75], a[24:27], a[180:183], a[72:75]
    v_mfma_f32_16x16x32_bf16 a[80:83], a[28:31], a[176:179], a[80:83]
    ds_read_b64_tr_b16 a[56:57], v21 offset:0
    ds_read_b64_tr_b16 a[58:59], v21 offset:2048
    v_mfma_f32_16x16x32_bf16 a[88:91], a[28:31], a[180:183], a[88:91]
    buffer_store_dwordx4 v[148:151], v23, s[16:19], s51 offen offset:1024
    s_waitcnt lgkmcnt(6)
    v_mfma_f32_16x16x32_bf16 a[96:99], a[32:35], a[176:179], a[96:99]
    ds_read_b64_tr_b16 a[60:61], v31 offset:0
    ds_read_b64_tr_b16 a[62:63], v31 offset:2048
    v_mfma_f32_16x16x32_bf16 a[104:107], a[32:35], a[180:183], a[104:107]
    v_mfma_f32_16x16x32_bf16 a[112:115], a[36:39], a[176:179], a[112:115]
    ds_read_b64_tr_b16 a[0:1], v17 offset:256
    ds_read_b64_tr_b16 a[2:3], v17 offset:2304
    v_mfma_f32_16x16x32_bf16 a[120:123], a[36:39], a[180:183], a[120:123]
    buffer_store_dwordx4 v[152:155], v23, s[16:19], s51 offen offset:2048
    v_mfma_f32_16x16x32_bf16 a[128:131], a[40:43], a[176:179], a[128:131]
    ds_read_b64_tr_b16 a[4:5], v19 offset:256
    ds_read_b64_tr_b16 a[6:7], v19 offset:2304
    v_mfma_f32_16x16x32_bf16 a[136:139], a[40:43], a[180:183], a[136:139]
    v_mfma_f32_16x16x32_bf16 a[144:147], a[44:47], a[176:179], a[144:147]
    ds_read_b64_tr_b16 a[8:9], v21 offset:256
    ds_read_b64_tr_b16 a[10:11], v21 offset:2304
    v_mfma_f32_16x16x32_bf16 a[152:155], a[44:47], a[180:183], a[152:155]
    buffer_store_dwordx4 v[156:159], v23, s[16:19], s51 offen offset:3072
    s_waitcnt lgkmcnt(6)
    v_mfma_f32_16x16x32_bf16 v[164:167], a[48:51], a[176:179], v[164:167]
    ds_read_b64_tr_b16 a[12:13], v31 offset:256
    ds_read_b64_tr_b16 a[14:15], v31 offset:2304
    v_mfma_f32_16x16x32_bf16 v[172:175], a[48:51], a[180:183], v[172:175]
    v_mfma_f32_16x16x32_bf16 v[180:183], a[52:55], a[176:179], v[180:183]
    ds_read_b64_tr_b16 a[16:17], v7 offset:16384
    ds_read_b64_tr_b16 a[18:19], v7 offset:17408
    v_mfma_f32_16x16x32_bf16 v[188:191], a[52:55], a[180:183], v[188:191]
    v_mfma_f32_16x16x32_bf16 v[196:199], a[56:59], a[176:179], v[196:199]
    ds_read_b64_tr_b16 a[20:21], v9 offset:16384
    ds_read_b64_tr_b16 a[22:23], v9 offset:17408
    v_mfma_f32_16x16x32_bf16 v[204:207], a[56:59], a[180:183], v[204:207]
    v_mfma_f32_16x16x32_bf16 v[212:215], a[60:63], a[176:179], v[212:215]
    ds_read_b64_tr_b16 a[24:25], v15 offset:16384
    ds_read_b64_tr_b16 a[26:27], v15 offset:17408
    v_mfma_f32_16x16x32_bf16 v[220:223], a[60:63], a[180:183], v[220:223]
    s_waitcnt lgkmcnt(6)
    v_mfma_f32_16x16x32_bf16 v[228:231], a[0:3], a[176:179], v[228:231]
    ds_read_b64_tr_b16 a[28:29], v25 offset:16384
    ds_read_b64_tr_b16 a[30:31], v25 offset:17408
    v_mfma_f32_16x16x32_bf16 v[236:239], a[0:3], a[180:183], v[236:239]
    v_mfma_f32_16x16x32_bf16 v[244:247], a[4:7], a[176:179], v[244:247]
    s_waitcnt vmcnt(35)
    s_barrier
    ds_read_b64_tr_b16 a[32:33], v16 offset:16384
    ds_read_b64_tr_b16 a[34:35], v16 offset:18432
    v_mfma_f32_16x16x32_bf16 v[252:255], a[4:7], a[180:183], v[252:255]
    v_mfma_f32_16x16x32_bf16 a[68:71], a[8:11], a[176:179], a[68:71]
    ds_read_b64_tr_b16 a[36:37], v18 offset:16384
    ds_read_b64_tr_b16 a[38:39], v18 offset:18432
    v_mfma_f32_16x16x32_bf16 a[76:79], a[8:11], a[180:183], a[76:79]
    s_add_u32 m0, s65, 49152
    v_mfma_f32_16x16x32_bf16 a[84:87], a[12:15], a[176:179], a[84:87]
    ds_read_b64_tr_b16 a[40:41], v20 offset:16384
    ds_read_b64_tr_b16 a[42:43], v20 offset:18432
    v_mfma_f32_16x16x32_bf16 a[92:95], a[12:15], a[180:183], a[92:95]
    buffer_load_dwordx4 v10, s[12:15], s40 offen offset:0 lds
    s_waitcnt lgkmcnt(6)
    v_mfma_f32_16x16x32_bf16 a[100:103], a[16:19], a[176:179], a[100:103]
    ds_read_b64_tr_b16 a[44:45], v27 offset:16384
    ds_read_b64_tr_b16 a[46:47], v27 offset:18432
    v_mfma_f32_16x16x32_bf16 a[108:111], a[16:19], a[180:183], a[108:111]
    v_mfma_f32_16x16x32_bf16 a[116:119], a[20:23], a[176:179], a[116:119]
    ds_read_b64_tr_b16 a[48:49], v16 offset:16640
    ds_read_b64_tr_b16 a[50:51], v16 offset:18688
    v_mfma_f32_16x16x32_bf16 a[124:127], a[20:23], a[180:183], a[124:127]
    buffer_load_dwordx4 v11, s[12:15], s40 offen offset:1024 lds
    v_mfma_f32_16x16x32_bf16 a[132:135], a[24:27], a[176:179], a[132:135]
    ds_read_b64_tr_b16 a[52:53], v18 offset:16640
    ds_read_b64_tr_b16 a[54:55], v18 offset:18688
    v_mfma_f32_16x16x32_bf16 a[140:143], a[24:27], a[180:183], a[140:143]
    v_mfma_f32_16x16x32_bf16 a[148:151], a[28:31], a[176:179], a[148:151]
    ds_read_b64_tr_b16 a[56:57], v20 offset:16640
    ds_read_b64_tr_b16 a[58:59], v20 offset:18688
    v_mfma_f32_16x16x32_bf16 a[156:159], a[28:31], a[180:183], a[156:159]
    buffer_load_dwordx4 v12, s[12:15], s40 offen offset:2048 lds
    s_waitcnt lgkmcnt(6)
    v_mfma_f32_16x16x32_bf16 v[160:163], a[32:35], a[184:187], v[160:163]
    ds_read_b64_tr_b16 a[60:61], v27 offset:16640
    ds_read_b64_tr_b16 a[62:63], v27 offset:18688
    v_mfma_f32_16x16x32_bf16 v[168:171], a[32:35], a[188:191], v[168:171]
    v_mfma_f32_16x16x32_bf16 v[176:179], a[36:39], a[184:187], v[176:179]
    ds_read_b64_tr_b16 a[0:1], v6 offset:24576
    ds_read_b64_tr_b16 a[2:3], v6 offset:25600
    v_mfma_f32_16x16x32_bf16 v[184:187], a[36:39], a[188:191], v[184:187]
    buffer_load_dwordx4 v13, s[12:15], s40 offen offset:3072 lds
    s_add_u32 s40, s40, 262144
    v_mfma_f32_16x16x32_bf16 v[192:195], a[40:43], a[184:187], v[192:195]
    ds_read_b64_tr_b16 a[4:5], v8 offset:24576
    ds_read_b64_tr_b16 a[6:7], v8 offset:25600
    v_mfma_f32_16x16x32_bf16 v[200:203], a[40:43], a[188:191], v[200:203]
    v_mfma_f32_16x16x32_bf16 v[208:211], a[44:47], a[184:187], v[208:211]
    ds_read_b64_tr_b16 a[8:9], v14 offset:24576
    ds_read_b64_tr_b16 a[10:11], v14 offset:25600
    v_mfma_f32_16x16x32_bf16 v[216:219], a[44:47], a[188:191], v[216:219]
    buffer_load_dwordx4 a[168:171], v22, s[96:99], s67 offen offset:2048 sc1
    s_waitcnt lgkmcnt(6)
    v_mfma_f32_16x16x32_bf16 v[224:227], a[48:51], a[184:187], v[224:227]
    ds_read_b64_tr_b16 a[12:13], v24 offset:24576
    ds_read_b64_tr_b16 a[14:15], v24 offset:25600
    v_mfma_f32_16x16x32_bf16 v[232:235], a[48:51], a[188:191], v[232:235]
    v_mfma_f32_16x16x32_bf16 v[240:243], a[52:55], a[184:187], v[240:243]
    ds_read_b64_tr_b16 a[16:17], v17 offset:16384
    ds_read_b64_tr_b16 a[18:19], v17 offset:18432
    v_mfma_f32_16x16x32_bf16 v[248:251], a[52:55], a[188:191], v[248:251]
    buffer_load_dwordx4 a[172:175], v22, s[96:99], s67 offen offset:3072 sc1
    v_mfma_f32_16x16x32_bf16 a[64:67], a[56:59], a[184:187], a[64:67]
    ds_read_b64_tr_b16 a[20:21], v19 offset:16384
    ds_read_b64_tr_b16 a[22:23], v19 offset:18432
    v_mfma_f32_16x16x32_bf16 a[72:75], a[56:59], a[188:191], a[72:75]
    v_mfma_f32_16x16x32_bf16 a[80:83], a[60:63], a[184:187], a[80:83]
    ds_read_b64_tr_b16 a[24:25], v21 offset:16384
    ds_read_b64_tr_b16 a[26:27], v21 offset:18432
    v_mfma_f32_16x16x32_bf16 a[88:91], a[60:63], a[188:191], a[88:91]
    s_waitcnt lgkmcnt(6)
    v_mfma_f32_16x16x32_bf16 a[96:99], a[0:3], a[184:187], a[96:99]
    ds_read_b64_tr_b16 a[28:29], v31 offset:16384
    ds_read_b64_tr_b16 a[30:31], v31 offset:18432
    v_mfma_f32_16x16x32_bf16 a[104:107], a[0:3], a[188:191], a[104:107]
    v_mfma_f32_16x16x32_bf16 a[112:115], a[4:7], a[184:187], a[112:115]
    ds_read_b64_tr_b16 a[32:33], v17 offset:16640
    ds_read_b64_tr_b16 a[34:35], v17 offset:18688
    v_mfma_f32_16x16x32_bf16 a[120:123], a[4:7], a[188:191], a[120:123]
    v_mfma_f32_16x16x32_bf16 a[128:131], a[8:11], a[184:187], a[128:131]
    ds_read_b64_tr_b16 a[36:37], v19 offset:16640
    ds_read_b64_tr_b16 a[38:39], v19 offset:18688
    v_mfma_f32_16x16x32_bf16 a[136:139], a[8:11], a[188:191], a[136:139]
    v_mfma_f32_16x16x32_bf16 a[144:147], a[12:15], a[184:187], a[144:147]
    ds_read_b64_tr_b16 a[40:41], v21 offset:16640
    ds_read_b64_tr_b16 a[42:43], v21 offset:18688
    v_mfma_f32_16x16x32_bf16 a[152:155], a[12:15], a[188:191], a[152:155]
    s_waitcnt lgkmcnt(6)
    v_mfma_f32_16x16x32_bf16 v[164:167], a[16:19], a[184:187], v[164:167]
    ds_read_b64_tr_b16 a[44:45], v31 offset:16640
    ds_read_b64_tr_b16 a[46:47], v31 offset:18688
    v_mfma_f32_16x16x32_bf16 v[172:175], a[16:19], a[188:191], v[172:175]
    v_mfma_f32_16x16x32_bf16 v[180:183], a[20:23], a[184:187], v[180:183]
    ds_read_b64_tr_b16 a[48:49], v7 offset:24576
    ds_read_b64_tr_b16 a[50:51], v7 offset:25600
    v_mfma_f32_16x16x32_bf16 v[188:191], a[20:23], a[188:191], v[188:191]
    v_mfma_f32_16x16x32_bf16 v[196:199], a[24:27], a[184:187], v[196:199]
    ds_read_b64_tr_b16 a[52:53], v9 offset:24576
    ds_read_b64_tr_b16 a[54:55], v9 offset:25600
    v_mfma_f32_16x16x32_bf16 v[204:207], a[24:27], a[188:191], v[204:207]
    v_mfma_f32_16x16x32_bf16 v[212:215], a[28:31], a[184:187], v[212:215]
    ds_read_b64_tr_b16 a[56:57], v15 offset:24576
    ds_read_b64_tr_b16 a[58:59], v15 offset:25600
    v_mfma_f32_16x16x32_bf16 v[220:223], a[28:31], a[188:191], v[220:223]
    s_waitcnt lgkmcnt(6)
    v_mfma_f32_16x16x32_bf16 v[228:231], a[32:35], a[184:187], v[228:231]
    ds_read_b64_tr_b16 a[60:61], v25 offset:24576
    ds_read_b64_tr_b16 a[62:63], v25 offset:25600
    v_mfma_f32_16x16x32_bf16 v[236:239], a[32:35], a[188:191], v[236:239]
    v_mfma_f32_16x16x32_bf16 v[244:247], a[36:39], a[184:187], v[244:247]
    s_waitcnt vmcnt(6)
    s_barrier
    v_xor_b32 v16, 0x10000, v16
    v_xor_b32 v17, 0x10000, v17
    v_xor_b32 v18, 0x10000, v18
    v_xor_b32 v19, 0x10000, v19
    v_xor_b32 v20, 0x10000, v20
    v_xor_b32 v21, 0x10000, v21
    v_xor_b32 v27, 0x10000, v27
    v_xor_b32 v31, 0x10000, v31
    s_cmp_lg_u32 s36, 0
    s_cbranch_scc1 L_km_nosigD
    s_cmp_eq_u32 s68, 32
    s_cbranch_scc1 L_km_sigD
    buffer_wbl2 sc1
    s_waitcnt vmcnt(0)
L_km_sigD:
    s_mov_b64 exec, 1
    buffer_atomic_add v28, v29, s[24:27], s69 offen sc1
    s_mov_b64 exec, -1
L_km_nosigD:
    ds_read_b64_tr_b16 a[0:1], v16 offset:0
    ds_read_b64_tr_b16 a[2:3], v16 offset:2048
    v_mfma_f32_16x16x32_bf16 v[252:255], a[36:39], a[188:191], v[252:255]
    v_mfma_f32_16x16x32_bf16 a[68:71], a[40:43], a[184:187], a[68:71]
    ds_read_b64_tr_b16 a[4:5], v18 offset:0
    ds_read_b64_tr_b16 a[6:7], v18 offset:2048
    v_mfma_f32_16x16x32_bf16 a[76:79], a[40:43], a[188:191], a[76:79]
    s_add_u32 m0, s65, 65536
    v_mfma_f32_16x16x32_bf16 a[84:87], a[44:47], a[184:187], a[84:87]
    ds_read_b64_tr_b16 a[8:9], v20 offset:0
    ds_read_b64_tr_b16 a[10:11], v20 offset:2048
    v_mfma_f32_16x16x32_bf16 a[92:95], a[44:47], a[188:191], a[92:95]
    buffer_load_dwordx4 v10, s[12:15], s40 offen offset:0 lds
    s_waitcnt lgkmcnt(6)
    v_mfma_f32_16x16x32_bf16 a[100:103], a[48:51], a[184:187], a[100:103]
    ds_read_b64_tr_b16 a[12:13], v27 offset:0
    ds_read_b64_tr_b16 a[14:15], v27 offset:2048
    v_mfma_f32_16x16x32_bf16 a[108:111], a[48:51], a[188:191], a[108:111]
    v_mfma_f32_16x16x32_bf16 a[116:119], a[52:55], a[184:187], a[116:119]
    ds_read_b64_tr_b16 a[16:17], v16 offset:256
    ds_read_b64_tr_b16 a[18:19], v16 offset:2304
    v_mfma_f32_16x16x32_bf16 a[124:127], a[52:55], a[188:191], a[124:127]
    buffer_load_dwordx4 v11, s[12:15], s40 offen offset:1024 lds
    v_mfma_f32_16x16x32_bf16 a[132:135], a[56:59], a[184:187], a[132:135]
    ds_read_b64_tr_b16 a[20:21], v18 offset:256
    ds_read_b64_tr_b16 a[22:23], v18 offset:2304
    v_mfma_f32_16x16x32_bf16 a[140:143], a[56:59], a[188:191], a[140:143]
    v_mfma_f32_16x16x32_bf16 a[148:151], a[60:63], a[184:187], a[148:151]
    ds_read_b64_tr_b16 a[24:25], v20 offset:256
    ds_read_b64_tr_b16 a[26:27], v20 offset:2304
    v_mfma_f32_16x16x32_bf16 a[156:159], a[60:63], a[188:191], a[156:159]
    buffer_load_dwordx4 v12, s[12:15], s40 offen offset:2048 lds
    s_waitcnt lgkmcnt(6)
    v_mfma_f32_16x16x32_bf16 v[160:163], a[0:3], a[192:195], v[160:163]
    ds_read_b64_tr_b16 a[28:29], v27 offset:256
    ds_read_b64_tr_b16 a[30:31], v27 offset:2304
    v_mfma_f32_16x16x32_bf16 v[168:171], a[0:3], a[196:199], v[168:171]
    v_mfma_f32_16x16x32_bf16 v[176:179], a[4:7], a[192:195], v[176:179]
    ds_read_b64_tr_b16 a[32:33], v6 offset:32768
    ds_read_b64_tr_b16 a[34:35], v6 offset:33792
    v_mfma_f32_16x16x32_bf16 v[184:187], a[4:7], a[196:199], v[184:187]
    buffer_load_dwordx4 v13, s[12:15], s40 offen offset:3072 lds
    s_add_u32 s40, s40, 262144
    s_add_u32 s67, s67, 4096
    v_mfma_f32_16x16x32_bf16 v[192:195], a[8:11], a[192:195], v[192:195]
    ds_read_b64_tr_b16 a[36:37], v8 offset:32768
    ds_read_b64_tr_b16 a[38:39], v8 offset:33792
    v_mfma_f32_16x16x32_bf16 v[200:203], a[8:11], a[196:199], v[200:203]
    v_mfma_f32_16x16x32_bf16 v[208:211], a[12:15], a[192:195], v[208:211]
    ds_read_b64_tr_b16 a[40:41], v14 offset:32768
    ds_read_b64_tr_b16 a[42:43], v14 offset:33792
    v_mfma_f32_16x16x32_bf16 v[216:219], a[12:15], a[196:199], v[216:219]
    buffer_load_dwordx4 a[176:179], v22, s[96:99], s67 offen offset:0 sc1
    s_waitcnt lgkmcnt(6)
    v_mfma_f32_16x16x32_bf16 v[224:227], a[16:19], a[192:195], v[224:227]
    ds_read_b64_tr_b16 a[44:45], v24 offset:32768
    ds_read_b64_tr_b16 a[46:47], v24 offset:33792
    v_mfma_f32_16x16x32_bf16 v[232:235], a[16:19], a[196:199], v[232:235]
    v_mfma_f32_16x16x32_bf16 v[240:243], a[20:23], a[192:195], v[240:243]
    ds_read_b64_tr_b16 a[48:49], v17 offset:0
    ds_read_b64_tr_b16 a[50:51], v17 offset:2048
    v_mfma_f32_16x16x32_bf16 v[248:251], a[20:23], a[196:199], v[248:251]
    buffer_load_dwordx4 a[180:183], v22, s[96:99], s67 offen offset:1024 sc1
    v_mfma_f32_16x16x32_bf16 a[64:67], a[24:27], a[192:195], a[64:67]
    ds_read_b64_tr_b16 a[52:53], v19 offset:0
    ds_read_b64_tr_b16 a[54:55], v19 offset:2048
    v_mfma_f32_16x16x32_bf16 a[72:75], a[24:27], a[196:199], a[72:75]
    v_mfma_f32_16x16x32_bf16 a[80:83], a[28:31], a[192:195], a[80:83]
    ds_read_b64_tr_b16 a[56:57], v21 offset:0
    ds_read_b64_tr_b16 a[58:59], v21 offset:2048
    v_mfma_f32_16x16x32_bf16 a[88:91], a[28:31], a[196:199], a[88:91]
    s_waitcnt lgkmcnt(6)
    v_mfma_f32_16x16x32_bf16 a[96:99], a[32:35], a[192:195], a[96:99]
    ds_read_b64_tr_b16 a[60:61], v31 offset:0
    ds_read_b64_tr_b16 a[62:63], v31 offset:2048
    v_mfma_f32_16x16x32_bf16 a[104:107], a[32:35], a[196:199], a[104:107]
    v_mfma_f32_16x16x32_bf16 a[112:115], a[36:39], a[192:195], a[112:115]
    ds_read_b64_tr_b16 a[0:1], v17 offset:256
    ds_read_b64_tr_b16 a[2:3], v17 offset:2304
    v_mfma_f32_16x16x32_bf16 a[120:123], a[36:39], a[196:199], a[120:123]
    v_mfma_f32_16x16x32_bf16 a[128:131], a[40:43], a[192:195], a[128:131]
    ds_read_b64_tr_b16 a[4:5], v19 offset:256
    ds_read_b64_tr_b16 a[6:7], v19 offset:2304
    v_mfma_f32_16x16x32_bf16 a[136:139], a[40:43], a[196:199], a[136:139]
    v_mfma_f32_16x16x32_bf16 a[144:147], a[44:47], a[192:195], a[144:147]
    ds_read_b64_tr_b16 a[8:9], v21 offset:256
    ds_read_b64_tr_b16 a[10:11], v21 offset:2304
    v_mfma_f32_16x16x32_bf16 a[152:155], a[44:47], a[196:199], a[152:155]
    s_waitcnt lgkmcnt(6)
    v_mfma_f32_16x16x32_bf16 v[164:167], a[48:51], a[192:195], v[164:167]
    ds_read_b64_tr_b16 a[12:13], v31 offset:256
    ds_read_b64_tr_b16 a[14:15], v31 offset:2304
    v_mfma_f32_16x16x32_bf16 v[172:175], a[48:51], a[196:199], v[172:175]
    v_mfma_f32_16x16x32_bf16 v[180:183], a[52:55], a[192:195], v[180:183]
    ds_read_b64_tr_b16 a[16:17], v7 offset:32768
    ds_read_b64_tr_b16 a[18:19], v7 offset:33792
    v_mfma_f32_16x16x32_bf16 v[188:191], a[52:55], a[196:199], v[188:191]
    v_mfma_f32_16x16x32_bf16 v[196:199], a[56:59], a[192:195], v[196:199]
    ds_read_b64_tr_b16 a[20:21], v9 offset:32768
    ds_read_b64_tr_b16 a[22:23], v9 offset:33792
    v_mfma_f32_16x16x32_bf16 v[204:207], a[56:59], a[196:199], v[204:207]
    v_mfma_f32_16x16x32_bf16 v[212:215], a[60:63], a[192:195], v[212:215]
    ds_read_b64_tr_b16 a[24:25], v15 offset:32768
    ds_read_b64_tr_b16 a[26:27], v15 offset:33792
    v_mfma_f32_16x16x32_bf16 v[220:223], a[60:63], a[196:199], v[220:223]
    s_waitcnt lgkmcnt(6)
    v_mfma_f32_16x16x32_bf16 v[228:231], a[0:3], a[192:195], v[228:231]
    ds_read_b64_tr_b16 a[28:29], v25 offset:32768
    ds_read_b64_tr_b16 a[30:31], v25 offset:33792
    v_mfma_f32_16x16x32_bf16 v[236:239], a[0:3], a[196:199], v[236:239]
    v_mfma_f32_16x16x32_bf16 v[244:247], a[4:7], a[192:195], v[244:247]
    s_waitcnt vmcnt(26)
    s_barrier
    ds_read_b64_tr_b16 a[32:33], v16 offset:16384
    ds_read_b64_tr_b16 a[34:35], v16 offset:18432
    v_mfma_f32_16x16x32_bf16 v[252:255], a[4:7], a[196:199], v[252:255]
    v_mfma_f32_16x16x32_bf16 a[68:71], a[8:11], a[192:195], a[68:71]
    ds_read_b64_tr_b16 a[36:37], v18 offset:16384
    ds_read_b64_tr_b16 a[38:39], v18 offset:18432
    v_mfma_f32_16x16x32_bf16 a[76:79], a[8:11], a[196:199], a[76:79]
    s_add_u32 m0, s65, 81920
    v_mfma_f32_16x16x32_bf16 a[84:87], a[12:15], a[192:195], a[84:87]
    ds_read_b64_tr_b16 a[40:41], v20 offset:16384
    ds_read_b64_tr_b16 a[42:43], v20 offset:18432
    v_mfma_f32_16x16x32_bf16 a[92:95], a[12:15], a[196:199], a[92:95]
    buffer_load_dwordx4 v10, s[12:15], s40 offen offset:0 lds
    s_waitcnt lgkmcnt(6)
    v_mfma_f32_16x16x32_bf16 a[100:103], a[16:19], a[192:195], a[100:103]
    ds_read_b64_tr_b16 a[44:45], v27 offset:16384
    ds_read_b64_tr_b16 a[46:47], v27 offset:18432
    v_mfma_f32_16x16x32_bf16 a[108:111], a[16:19], a[196:199], a[108:111]
    v_mfma_f32_16x16x32_bf16 a[116:119], a[20:23], a[192:195], a[116:119]
    ds_read_b64_tr_b16 a[48:49], v16 offset:16640
    ds_read_b64_tr_b16 a[50:51], v16 offset:18688
    v_mfma_f32_16x16x32_bf16 a[124:127], a[20:23], a[196:199], a[124:127]
    buffer_load_dwordx4 v11, s[12:15], s40 offen offset:1024 lds
    v_mfma_f32_16x16x32_bf16 a[132:135], a[24:27], a[192:195], a[132:135]
    ds_read_b64_tr_b16 a[52:53], v18 offset:16640
    ds_read_b64_tr_b16 a[54:55], v18 offset:18688
    v_mfma_f32_16x16x32_bf16 a[140:143], a[24:27], a[196:199], a[140:143]
    v_mfma_f32_16x16x32_bf16 a[148:151], a[28:31], a[192:195], a[148:151]
    ds_read_b64_tr_b16 a[56:57], v20 offset:16640
    ds_read_b64_tr_b16 a[58:59], v20 offset:18688
    v_mfma_f32_16x16x32_bf16 a[156:159], a[28:31], a[196:199], a[156:159]
    buffer_load_dwordx4 v12, s[12:15], s40 offen offset:2048 lds
    s_waitcnt lgkmcnt(6)
    v_mfma_f32_16x16x32_bf16 v[160:163], a[32:35], a[200:203], v[160:163]
    ds_read_b64_tr_b16 a[60:61], v27 offset:16640
    ds_read_b64_tr_b16 a[62:63], v27 offset:18688
    v_mfma_f32_16x16x32_bf16 v[168:171], a[32:35], a[204:207], v[168:171]
    v_mfma_f32_16x16x32_bf16 v[176:179], a[36:39], a[200:203], v[176:179]
    ds_read_b64_tr_b16 a[0:1], v6 offset:40960
    ds_read_b64_tr_b16 a[2:3], v6 offset:41984
    v_mfma_f32_16x16x32_bf16 v[184:187], a[36:39], a[204:207], v[184:187]
    buffer_load_dwordx4 v13, s[12:15], s40 offen offset:3072 lds
    s_add_u32 s40, s40, 262144
    v_mfma_f32_16x16x32_bf16 v[192:195], a[40:43], a[200:203], v[192:195]
    ds_read_b64_tr_b16 a[4:5], v8 offset:40960
    ds_read_b64_tr_b16 a[6:7], v8 offset:41984
    v_mfma_f32_16x16x32_bf16 v[200:203], a[40:43], a[204:207], v[200:203]
    v_mfma_f32_16x16x32_bf16 v[208:211], a[44:47], a[200:203], v[208:211]
    ds_read_b64_tr_b16 a[8:9], v14 offset:40960
    ds_read_b64_tr_b16 a[10:11], v14 offset:41984
    v_mfma_f32_16x16x32_bf16 v[216:219], a[44:47], a[204:207], v[216:219]
    buffer_load_dwordx4 a[184:187], v22, s[96:99], s67 offen offset:2048 sc1
    s_waitcnt lgkmcnt(6)
    v_mfma_f32_16x16x32_bf16 v[224:227], a[48:51], a[200:203], v[224:227]
    ds_read_b64_tr_b16 a[12:13], v24 offset:40960
    ds_read_b64_tr_b16 a[14:15], v24 offset:41984
    v_mfma_f32_16x16x32_bf16 v[232:235], a[48:51], a[204:207], v[232:235]
    v_mfma_f32_16x16x32_bf16 v[240:243], a[52:55], a[200:203], v[240:243]
    ds_read_b64_tr_b16 a[16:17], v17 offset:16384
    ds_read_b64_tr_b16 a[18:19], v17 offset:18432
    v_mfma_f32_16x16x32_bf16 v[248:251], a[52:55], a[204:207], v[248:251]
    buffer_load_dwordx4 a[188:191], v22, s[96:99], s67 offen offset:3072 sc1
    v_mfma_f32_16x16x32_bf16 a[64:67], a[56:59], a[200:203], a[64:67]
    ds_read_b64_tr_b16 a[20:21], v19 offset:16384
    ds_read_b64_tr_b16 a[22:23], v19 offset:18432
    v_mfma_f32_16x16x32_bf16 a[72:75], a[56:59], a[204:207], a[72:75]
    v_mfma_f32_16x16x32_bf16 a[80:83], a[60:63], a[200:203], a[80:83]
    ds_read_b64_tr_b16 a[24:25], v21 offset:16384
    ds_read_b64_tr_b16 a[26:27], v21 offset:18432
    v_mfma_f32_16x16x32_bf16 a[88:91], a[60:63], a[204:207], a[88:91]
    s_waitcnt lgkmcnt(6)
    v_mfma_f32_16x16x32_bf16 a[96:99], a[0:3], a[200:203], a[96:99]
    ds_read_b64_tr_b16 a[28:29], v31 offset:16384
    ds_read_b64_tr_b16 a[30:31], v31 offset:18432
    v_mfma_f32_16x16x32_bf16 a[104:107], a[0:3], a[204:207], a[104:107]
    v_mfma_f32_16x16x32_bf16 a[112:115], a[4:7], a[200:203], a[112:115]
    ds_read_b64_tr_b16 a[32:33], v17 offset:16640
    ds_read_b64_tr_b16 a[34:35], v17 offset:18688
    v_mfma_f32_16x16x32_bf16 a[120:123], a[4:7], a[204:207], a[120:123]
    v_mfma_f32_16x16x32_bf16 a[128:131], a[8:11], a[200:203], a[128:131]
    ds_read_b64_tr_b16 a[36:37], v19 offset:16640
    ds_read_b64_tr_b16 a[38:39], v19 offset:18688
    v_mfma_f32_16x16x32_bf16 a[136:139], a[8:11], a[204:207], a[136:139]
    v_mfma_f32_16x16x32_bf16 a[144:147], a[12:15], a[200:203], a[144:147]
    ds_read_b64_tr_b16 a[40:41], v21 offset:16640
    ds_read_b64_tr_b16 a[42:43], v21 offset:18688
    v_mfma_f32_16x16x32_bf16 a[152:155], a[12:15], a[204:207], a[152:155]
    s_waitcnt lgkmcnt(6)
    v_mfma_f32_16x16x32_bf16 v[164:167], a[16:19], a[200:203], v[164:167]
    ds_read_b64_tr_b16 a[44:45], v31 offset:16640
    ds_read_b64_tr_b16 a[46:47], v31 offset:18688
    v_mfma_f32_16x16x32_bf16 v[172:175], a[16:19], a[204:207], v[172:175]
    v_mfma_f32_16x16x32_bf16 v[180:183], a[20:23], a[200:203], v[180:183]
    ds_read_b64_tr_b16 a[48:49], v7 offset:40960
    ds_read_b64_tr_b16 a[50:51], v7 offset:41984
    v_mfma_f32_16x16x32_bf16 v[188:191], a[20:23], a[204:207], v[188:191]
    v_mfma_f32_16x16x32_bf16 v[196:199], a[24:27], a[200:203], v[196:199]
    ds_read_b64_tr_b16 a[52:53], v9 offset:40960
    ds_read_b64_tr_b16 a[54:55], v9 offset:41984
    v_mfma_f32_16x16x32_bf16 v[204:207], a[24:27], a[204:207], v[204:207]
    v_mfma_f32_16x16x32_bf16 v[212:215], a[28:31], a[200:203], v[212:215]
    ds_read_b64_tr_b16 a[56:57], v15 offset:40960
    ds_read_b64_tr_b16 a[58:59], v15 offset:41984
    v_mfma_f32_16x16x32_bf16 v[220:223], a[28:31], a[204:207], v[220:223]
    s_waitcnt lgkmcnt(6)
    v_mfma_f32_16x16x32_bf16 v[228:231], a[32:35], a[200:203], v[228:231]
    ds_read_b64_tr_b16 a[60:61], v25 offset:40960
    ds_read_b64_tr_b16 a[62:63], v25 offset:41984
    v_mfma_f32_16x16x32_bf16 v[236:239], a[32:35], a[204:207], v[236:239]
    v_mfma_f32_16x16x32_bf16 v[244:247], a[36:39], a[200:203], v[244:247]
    s_waitcnt vmcnt(23)
    s_barrier
    ds_read_b64_tr_b16 a[0:1], v16 offset:32768
    ds_read_b64_tr_b16 a[2:3], v16 offset:34816
    v_mfma_f32_16x16x32_bf16 v[252:255], a[36:39], a[204:207], v[252:255]
    v_mfma_f32_16x16x32_bf16 a[68:71], a[40:43], a[200:203], a[68:71]
    ds_read_b64_tr_b16 a[4:5], v18 offset:32768
    ds_read_b64_tr_b16 a[6:7], v18 offset:34816
    v_mfma_f32_16x16x32_bf16 a[76:79], a[40:43], a[204:207], a[76:79]
    s_add_u32 m0, s65, 0
    v_mfma_f32_16x16x32_bf16 a[84:87], a[44:47], a[200:203], a[84:87]
    ds_read_b64_tr_b16 a[8:9], v20 offset:32768
    ds_read_b64_tr_b16 a[10:11], v20 offset:34816
    v_mfma_f32_16x16x32_bf16 a[92:95], a[44:47], a[204:207], a[92:95]
    buffer_load_dwordx4 v10, s[12:15], s40 offen offset:0 lds
    s_waitcnt lgkmcnt(6)
    v_mfma_f32_16x16x32_bf16 a[100:103], a[48:51], a[200:203], a[100:103]
    ds_read_b64_tr_b16 a[12:13], v27 offset:32768
    ds_read_b64_tr_b16 a[14:15], v27 offset:34816
    v_mfma_f32_16x16x32_bf16 a[108:111], a[48:51], a[204:207], a[108:111]
    v_mfma_f32_16x16x32_bf16 a[116:119], a[52:55], a[200:203], a[116:119]
    ds_read_b64_tr_b16 a[16:17], v16 offset:33024
    ds_read_b64_tr_b16 a[18:19], v16 offset:35072
    v_mfma_f32_16x16x32_bf16 a[124:127], a[52:55], a[204:207], a[124:127]
    buffer_load_dwordx4 v11, s[12:15], s40 offen offset:1024 lds
    v_mfma_f32_16x16x32_bf16 a[132:135], a[56:59], a[200:203], a[132:135]
    ds_read_b64_tr_b16 a[20:21], v18 offset:33024
    ds_read_b64_tr_b16 a[22:23], v18 offset:35072
    v_mfma_f32_16x16x32_bf16 a[140:143], a[56:59], a[204:207], a[140:143]
    v_mfma_f32_16x16x32_bf16 a[148:151], a[60:63], a[200:203], a[148:151]
    ds_read_b64_tr_b16 a[24:25], v20 offset:33024
    ds_read_b64_tr_b16 a[26:27], v20 offset:35072
    v_mfma_f32_16x16x32_bf16 a[156:159], a[60:63], a[204:207], a[156:159]
    buffer_load_dwordx4 v12, s[12:15], s40 offen offset:2048 lds
    s_waitcnt lgkmcnt(6)
    v_mfma_f32_16x16x32_bf16 v[32:35], a[0:3], a[208:211], 0
    ds_read_b64_tr_b16 a[28:29], v27 offset:33024
    ds_read_b64_tr_b16 a[30:31], v27 offset:35072
    v_mfma_f32_16x16x32_bf16 v[40:43], a[0:3], a[212:215], 0
    v_mfma_f32_16x16x32_bf16 v[48:51], a[4:7], a[208:211], 0
    ds_read_b64_tr_b16 a[32:33], v17 offset:32768
    ds_read_b64_tr_b16 a[34:35], v17 offset:34816
    v_mfma_f32_16x16x32_bf16 v[56:59], a[4:7], a[212:215], 0
    buffer_load_dwordx4 v13, s[12:15], s40 offen offset:3072 lds
    s_add_u32 s40, s40, 262144
    s_add_u32 s67, s67, 4096
    v_mfma_f32_16x16x32_bf16 v[64:67], a[8:11], a[208:211], 0
    ds_read_b64_tr_b16 a[36:37], v19 offset:32768
    ds_read_b64_tr_b16 a[38:39], v19 offset:34816
    v_mfma_f32_16x16x32_bf16 v[72:75], a[8:11], a[212:215], 0
    v_mfma_f32_16x16x32_bf16 v[80:83], a[12:15], a[208:211], 0
    ds_read_b64_tr_b16 a[40:41], v21 offset:32768
    ds_read_b64_tr_b16 a[42:43], v21 offset:34816
    v_mfma_f32_16x16x32_bf16 v[88:91], a[12:15], a[212:215], 0
    buffer_load_dwordx4 a[192:195], v22, s[96:99], s67 offen offset:0 sc1
    s_waitcnt lgkmcnt(6)
    v_mfma_f32_16x16x32_bf16 v[96:99], a[16:19], a[208:211], 0
    ds_read_b64_tr_b16 a[44:45], v31 offset:32768
    ds_read_b64_tr_b16 a[46:47], v31 offset:34816
    v_mfma_f32_16x16x32_bf16 v[104:107], a[16:19], a[212:215], 0
    v_accvgpr_read_b32 v2, a96
    v_accvgpr_read_b32 v3, a97
    v_mfma_f32_16x16x32_bf16 v[112:115], a[20:23], a[208:211], 0
    ds_read_b64_tr_b16 a[48:49], v17 offset:33024
    ds_read_b64_tr_b16 a[50:51], v17 offset:35072
    v_mfma_f32_16x16x32_bf16 v[120:123], a[20:23], a[212:215], 0
    buffer_load_dwordx4 a[196:199], v22, s[96:99], s67 offen offset:1024 sc1
    v_accvgpr_read_b32 v4, a98
    v_mfma_f32_16x16x32_bf16 v[128:131], a[24:27], a[208:211], 0
    ds_read_b64_tr_b16 a[52:53], v19 offset:33024
    ds_read_b64_tr_b16 a[54:55], v19 offset:35072
    v_mfma_f32_16x16x32_bf16 v[136:139], a[24:27], a[212:215], 0
    v_accvgpr_read_b32 v5, a99
    v_accvgpr_read_b32 v6, a100
    v_mfma_f32_16x16x32_bf16 v[144:147], a[28:31], a[208:211], 0
    ds_read_b64_tr_b16 a[56:57], v21 offset:33024
    ds_read_b64_tr_b16 a[58:59], v21 offset:35072
    v_mfma_f32_16x16x32_bf16 v[152:155], a[28:31], a[212:215], 0
    v_accvgpr_read_b32 v7, a101
    s_waitcnt lgkmcnt(6)
    v_mfma_f32_16x16x32_bf16 v[36:39], a[32:35], a[208:211], 0
    ds_read_b64_tr_b16 a[60:61], v31 offset:33024
    ds_read_b64_tr_b16 a[62:63], v31 offset:35072
    v_mfma_f32_16x16x32_bf16 v[44:47], a[32:35], a[212:215], 0
    v_accvgpr_read_b32 v8, a102
    v_accvgpr_read_b32 v9, a103
    v_mfma_f32_16x16x32_bf16 v[52:55], a[36:39], a[208:211], 0
    s_waitcnt vmcnt(20)
    s_barrier
    ds_read_b64_tr_b16 a[0:1], v16 offset:49152
    ds_read_b64_tr_b16 a[2:3], v16 offset:51200
    v_mfma_f32_16x16x32_bf16 v[60:63], a[36:39], a[212:215], 0
    v_mfma_f32_16x16x32_bf16 v[68:71], a[40:43], a[208:211], 0
    ds_read_b64_tr_b16 a[4:5], v18 offset:49152
    ds_read_b64_tr_b16 a[6:7], v18 offset:51200
    v_mfma_f32_16x16x32_bf16 v[76:79], a[40:43], a[212:215], 0
    s_add_u32 m0, s65, 16384
    v_cvt_pk_bf16_f32 v14, v2, v3
    v_mfma_f32_16x16x32_bf16 v[84:87], a[44:47], a[208:211], 0
    ds_read_b64_tr_b16 a[8:9], v20 offset:49152
    ds_read_b64_tr_b16 a[10:11], v20 offset:51200
    v_mfma_f32_16x16x32_bf16 v[92:95], a[44:47], a[212:215], 0
    buffer_load_dwordx4 v10, s[12:15], s40 offen offset:0 lds
    s_waitcnt lgkmcnt(6)
    v_mfma_f32_16x16x32_bf16 v[100:103], a[48:51], a[208:211], 0
    ds_read_b64_tr_b16 a[12:13], v27 offset:49152
    ds_read_b64_tr_b16 a[14:15], v27 offset:51200
    v_mfma_f32_16x16x32_bf16 v[108:111], a[48:51], a[212:215], 0
    v_cvt_pk_bf16_f32 v15, v4, v5
    v_cvt_pk_bf16_f32 v24, v6, v7
    v_mfma_f32_16x16x32_bf16 v[116:119], a[52:55], a[208:211], 0
    ds_read_b64_tr_b16 a[16:17], v16 offset:49408
    ds_read_b64_tr_b16 a[18:19], v16 offset:51456
    v_mfma_f32_16x16x32_bf16 v[124:127], a[52:55], a[212:215], 0
    buffer_load_dwordx4 v11, s[12:15], s40 offen offset:1024 lds
    v_cvt_pk_bf16_f32 v25, v8, v9
    v_mfma_f32_16x16x32_bf16 v[132:135], a[56:59], a[208:211], 0
    ds_read_b64_tr_b16 a[20:21], v18 offset:49408
    ds_read_b64_tr_b16 a[22:23], v18 offset:51456
    v_mfma_f32_16x16x32_bf16 v[140:143], a[56:59], a[212:215], 0
    v_accvgpr_read_b32 v2, a104
    v_accvgpr_read_b32 v3, a105
    v_mfma_f32_16x16x32_bf16 v[148:151], a[60:63], a[208:211], 0
    ds_read_b64_tr_b16 a[24:25], v20 offset:49408
    ds_read_b64_tr_b16 a[26:27], v20 offset:51456
    v_mfma_f32_16x16x32_bf16 v[156:159], a[60:63], a[212:215], 0
    buffer_load_dwordx4 v12, s[12:15], s40 offen offset:2048 lds
    s_waitcnt lgkmcnt(6)
    v_mfma_f32_16x16x32_bf16 v[32:35], a[0:3], a[216:219], v[32:35]
    ds_read_b64_tr_b16 a[28:29], v27 offset:49408
    ds_read_b64_tr_b16 a[30:31], v27 offset:51456
    v_mfma_f32_16x16x32_bf16 v[40:43], a[0:3], a[220:223], v[40:43]
    v_accvgpr_read_b32 v4, a106
    v_accvgpr_read_b32 v5, a107
    v_mfma_f32_16x16x32_bf16 v[48:51], a[4:7], a[216:219], v[48:51]
    ds_read_b64_tr_b16 a[32:33], v17 offset:49152
    ds_read_b64_tr_b16 a[34:35], v17 offset:51200
    v_mfma_f32_16x16x32_bf16 v[56:59], a[4:7], a[220:223], v[56:59]
    buffer_load_dwordx4 v13, s[12:15], s40 offen offset:3072 lds
    s_add_u32 s40, s40, 262144
    v_mfma_f32_16x16x32_bf16 v[64:67], a[8:11], a[216:219], v[64:67]
    ds_read_b64_tr_b16 a[36:37], v19 offset:49152
    ds_read_b64_tr_b16 a[38:39], v19 offset:51200
    v_mfma_f32_16x16x32_bf16 v[72:75], a[8:11], a[220:223], v[72:75]
    v_accvgpr_read_b32 v6, a108
    v_accvgpr_read_b32 v7, a109
    v_mfma_f32_16x16x32_bf16 v[80:83], a[12:15], a[216:219], v[80:83]
    ds_read_b64_tr_b16 a[40:41], v21 offset:49152
    ds_read_b64_tr_b16 a[42:43], v21 offset:51200
    v_mfma_f32_16x16x32_bf16 v[88:91], a[12:15], a[220:223], v[88:91]
    buffer_load_dwordx4 a[200:203], v22, s[96:99], s67 offen offset:2048 sc1
    s_waitcnt lgkmcnt(6)
    v_mfma_f32_16x16x32_bf16 v[96:99], a[16:19], a[216:219], v[96:99]
    ds_read_b64_tr_b16 a[44:45], v31 offset:49152
    ds_read_b64_tr_b16 a[46:47], v31 offset:51200
    v_mfma_f32_16x16x32_bf16 v[104:107], a[16:19], a[220:223], v[104:107]
    v_accvgpr_read_b32 v8, a110
    v_accvgpr_read_b32 v9, a111
    v_mfma_f32_16x16x32_bf16 v[112:115], a[20:23], a[216:219], v[112:115]
    ds_read_b64_tr_b16 a[48:49], v17 offset:49408
    ds_read_b64_tr_b16 a[50:51], v17 offset:51456
    v_mfma_f32_16x16x32_bf16 v[120:123], a[20:23], a[220:223], v[120:123]
    buffer_load_dwordx4 a[204:207], v22, s[96:99], s67 offen offset:3072 sc1
    v_cvt_pk_bf16_f32 v2, v2, v3
    v_mfma_f32_16x16x32_bf16 v[128:131], a[24:27], a[216:219], v[128:131]
    ds_read_b64_tr_b16 a[52:53], v19 offset:49408
    ds_read_b64_tr_b16 a[54:55], v19 offset:51456
    v_mfma_f32_16x16x32_bf16 v[136:139], a[24:27], a[220:223], v[136:139]
    v_cvt_pk_bf16_f32 v4, v4, v5
    v_cvt_pk_bf16_f32 v6, v6, v7
    v_mfma_f32_16x16x32_bf16 v[144:147], a[28:31], a[216:219], v[144:147]
    ds_read_b64_tr_b16 a[56:57], v21 offset:49408
    ds_read_b64_tr_b16 a[58:59], v21 offset:51456
    v_mfma_f32_16x16x32_bf16 v[152:155], a[28:31], a[220:223], v[152:155]
    v_cvt_pk_bf16_f32 v8, v8, v9
    s_waitcnt lgkmcnt(6)
    v_mfma_f32_16x16x32_bf16 v[36:39], a[32:35], a[216:219], v[36:39]
    ds_read_b64_tr_b16 a[60:61], v31 offset:49408
    ds_read_b64_tr_b16 a[62:63], v31 offset:51456
    v_mfma_f32_16x16x32_bf16 v[44:47], a[32:35], a[220:223], v[44:47]
    s_nop 1
    v_permlane16_swap_b32 v14, v2
    v_mfma_f32_16x16x32_bf16 v[52:55], a[36:39], a[216:219], v[52:55]
    s_waitcnt vmcnt(20)
    s_barrier
    v_xor_b32 v16, 0x10000, v16
    v_xor_b32 v17, 0x10000, v17
    v_xor_b32 v18, 0x10000, v18
    v_xor_b32 v19, 0x10000, v19
    v_xor_b32 v20, 0x10000, v20
    v_xor_b32 v21, 0x10000, v21
    v_xor_b32 v27, 0x10000, v27
    v_xor_b32 v31, 0x10000, v31
    ds_read_b64_tr_b16 a[0:1], v16 offset:0
    ds_read_b64_tr_b16 a[2:3], v16 offset:2048
    v_mfma_f32_16x16x32_bf16 v[60:63], a[36:39], a[220:223], v[60:63]
    v_mfma_f32_16x16x32_bf16 v[68:71], a[40:43], a[216:219], v[68:71]
    ds_read_b64_tr_b16 a[4:5], v18 offset:0
    ds_read_b64_tr_b16 a[6:7], v18 offset:2048
    v_mfma_f32_16x16x32_bf16 v[76:79], a[40:43], a[220:223], v[76:79]
    s_add_u32 m0, s65, 32768
    v_permlane16_swap_b32 v15, v4
    v_mfma_f32_16x16x32_bf16 v[84:87], a[44:47], a[216:219], v[84:87]
    ds_read_b64_tr_b16 a[8:9], v20 offset:0
    ds_read_b64_tr_b16 a[10:11], v20 offset:2048
    v_mfma_f32_16x16x32_bf16 v[92:95], a[44:47], a[220:223], v[92:95]
    buffer_load_dwordx4 v10, s[12:15], s40 offen offset:0 lds
    s_waitcnt lgkmcnt(6)
    v_mfma_f32_16x16x32_bf16 v[100:103], a[48:51], a[216:219], v[100:103]
    ds_read_b64_tr_b16 a[12:13], v27 offset:0
    ds_read_b64_tr_b16 a[14:15], v27 offset:2048
    v_mfma_f32_16x16x32_bf16 v[108:111], a[48:51], a[220:223], v[108:111]
    v_permlane16_swap_b32 v24, v6
    v_permlane16_swap_b32 v25, v8
    v_mfma_f32_16x16x32_bf16 v[116:119], a[52:55], a[216:219], v[116:119]
    ds_read_b64_tr_b16 a[16:17], v16 offset:256
    ds_read_b64_tr_b16 a[18:19], v16 offset:2304
    v_mfma_f32_16x16x32_bf16 v[124:127], a[52:55], a[220:223], v[124:127]
    buffer_load_dwordx4 v11, s[12:15], s40 offen offset:1024 lds
    s_nop 0
    v_mfma_f32_16x16x32_bf16 v[132:135], a[56:59], a[216:219], v[132:135]
    ds_read_b64_tr_b16 a[20:21], v18 offset:256
    ds_read_b64_tr_b16 a[22:23], v18 offset:2304
    v_mfma_f32_16x16x32_bf16 v[140:143], a[56:59], a[220:223], v[140:143]
    v_accvgpr_write_b32 a224, v14
    v_accvgpr_write_b32 a225, v15
    v_mfma_f32_16x16x32_bf16 v[148:151], a[60:63], a[216:219], v[148:151]
    ds_read_b64_tr_b16 a[24:25], v20 offset:256
    ds_read_b64_tr_b16 a[26:27], v20 offset:2304
    v_mfma_f32_16x16x32_bf16 v[156:159], a[60:63], a[220:223], v[156:159]
    buffer_load_dwordx4 v12, s[12:15], s40 offen offset:2048 lds
    s_waitcnt lgkmcnt(6)
    v_mfma_f32_16x16x32_bf16 v[32:35], a[0:3], a[160:163], v[32:35]
    ds_read_b64_tr_b16 a[28:29], v27 offset:256
    ds_read_b64_tr_b16 a[30:31], v27 offset:2304
    v_mfma_f32_16x16x32_bf16 v[40:43], a[0:3], a[164:167], v[40:43]
    v_accvgpr_write_b32 a226, v24
    v_accvgpr_write_b32 a227, v25
    v_mfma_f32_16x16x32_bf16 v[48:51], a[4:7], a[160:163], v[48:51]
    ds_read_b64_tr_b16 a[32:33], v17 offset:0
    ds_read_b64_tr_b16 a[34:35], v17 offset:2048
    v_mfma_f32_16x16x32_bf16 v[56:59], a[4:7], a[164:167], v[56:59]
    buffer_load_dwordx4 v13, s[12:15], s40 offen offset:3072 lds
    s_add_u32 s40, s40, 262144
    s_add_u32 s67, s67, 4096
    v_mfma_f32_16x16x32_bf16 v[64:67], a[8:11], a[160:163], v[64:67]
    ds_read_b64_tr_b16 a[36:37], v19 offset:0
    ds_read_b64_tr_b16 a[38:39], v19 offset:2048
    v_mfma_f32_16x16x32_bf16 v[72:75], a[8:11], a[164:167], v[72:75]
    v_accvgpr_write_b32 a228, v2
    v_accvgpr_write_b32 a229, v4
    v_mfma_f32_16x16x32_bf16 v[80:83], a[12:15], a[160:163], v[80:83]
    ds_read_b64_tr_b16 a[40:41], v21 offset:0
    ds_read_b64_tr_b16 a[42:43], v21 offset:2048
    v_mfma_f32_16x16x32_bf16 v[88:91], a[12:15], a[164:167], v[88:91]
    buffer_load_dwordx4 a[208:211], v22, s[96:99], s67 offen offset:0 sc1
    s_waitcnt lgkmcnt(6)
    v_mfma_f32_16x16x32_bf16 v[96:99], a[16:19], a[160:163], v[96:99]
    ds_read_b64_tr_b16 a[44:45], v31 offset:0
    ds_read_b64_tr_b16 a[46:47], v31 offset:2048
    v_mfma_f32_16x16x32_bf16 v[104:107], a[16:19], a[164:167], v[104:107]
    v_accvgpr_write_b32 a230, v6
    v_accvgpr_write_b32 a231, v8
    v_mfma_f32_16x16x32_bf16 v[112:115], a[20:23], a[160:163], v[112:115]
    ds_read_b64_tr_b16 a[48:49], v17 offset:256
    ds_read_b64_tr_b16 a[50:51], v17 offset:2304
    v_mfma_f32_16x16x32_bf16 v[120:123], a[20:23], a[164:167], v[120:123]
    buffer_load_dwordx4 a[212:215], v22, s[96:99], s67 offen offset:1024 sc1
    v_accvgpr_read_b32 v2, a112
    v_mfma_f32_16x16x32_bf16 v[128:131], a[24:27], a[160:163], v[128:131]
    ds_read_b64_tr_b16 a[52:53], v19 offset:256
    ds_read_b64_tr_b16 a[54:55], v19 offset:2304
    v_mfma_f32_16x16x32_bf16 v[136:139], a[24:27], a[164:167], v[136:139]
    v_accvgpr_read_b32 v3, a113
    v_accvgpr_read_b32 v4, a114
    v_mfma_f32_16x16x32_bf16 v[144:147], a[28:31], a[160:163], v[144:147]
    ds_read_b64_tr_b16 a[56:57], v21 offset:256
    ds_read_b64_tr_b16 a[58:59], v21 offset:2304
    v_mfma_f32_16x16x32_bf16 v[152:155], a[28:31], a[164:167], v[152:155]
    v_accvgpr_read_b32 v5, a115
    s_waitcnt lgkmcnt(6)
    v_mfma_f32_16x16x32_bf16 v[36:39], a[32:35], a[160:163], v[36:39]
    ds_read_b64_tr_b16 a[60:61], v31 offset:256
    ds_read_b64_tr_b16 a[62:63], v31 offset:2304
    v_mfma_f32_16x16x32_bf16 v[44:47], a[32:35], a[164:167], v[44:47]
    v_accvgpr_read_b32 v6, a116
    v_accvgpr_read_b32 v7, a117
    v_mfma_f32_16x16x32_bf16 v[52:55], a[36:39], a[160:163], v[52:55]
    s_waitcnt vmcnt(20)
    s_barrier
    ds_read_b64_tr_b16 a[0:1], v16 offset:16384
    ds_read_b64_tr_b16 a[2:3], v16 offset:18432
    v_mfma_f32_16x16x32_bf16 v[60:63], a[36:39], a[164:167], v[60:63]
    v_mfma_f32_16x16x32_bf16 v[68:71], a[40:43], a[160:163], v[68:71]
    ds_read_b64_tr_b16 a[4:5], v18 offset:16384
    ds_read_b64_tr_b16 a[6:7], v18 offset:18432
    v_mfma_f32_16x16x32_bf16 v[76:79], a[40:43], a[164:167], v[76:79]
    s_add_u32 m0, s65, 49152
    v_accvgpr_read_b32 v8, a118
    v_mfma_f32_16x16x32_bf16 v[84:87], a[44:47], a[160:163], v[84:87]
    ds_read_b64_tr_b16 a[8:9], v20 offset:16384
    ds_read_b64_tr_b16 a[10:11], v20 offset:18432
    v_mfma_f32_16x16x32_bf16 v[92:95], a[44:47], a[164:167], v[92:95]
    buffer_load_dwordx4 v10, s[12:15], s40 offen offset:0 lds
    s_waitcnt lgkmcnt(6)
    v_mfma_f32_16x16x32_bf16 v[100:103], a[48:51], a[160:163], v[100:103]
    ds_read_b64_tr_b16 a[12:13], v27 offset:16384
    ds_read_b64_tr_b16 a[14:15], v27 offset:18432
    v_mfma_f32_16x16x32_bf16 v[108:111], a[48:51], a[164:167], v[108:111]
    v_accvgpr_read_b32 v9, a119
    v_cvt_pk_bf16_f32 v14, v2, v3
    v_mfma_f32_16x16x32_bf16 v[116:119], a[52:55], a[160:163], v[116:119]
    ds_read_b64_tr_b16 a[16:17], v16 offset:16640
    ds_read_b64_tr_b16 a[18:19], v16 offset:18688
    v_mfma_f32_16x16x32_bf16 v[124:127], a[52:55], a[164:167], v[124:127]
    buffer_load_dwordx4 v11, s[12:15], s40 offen offset:1024 lds
    v_cvt_pk_bf16_f32 v15, v4, v5
    v_mfma_f32_16x16x32_bf16 v[132:135], a[56:59], a[160:163], v[132:135]
    ds_read_b64_tr_b16 a[20:21], v18 offset:16640
    ds_read_b64_tr_b16 a[22:23], v18 offset:18688
    v_mfma_f32_16x16x32_bf16 v[140:143], a[56:59], a[164:167], v[140:143]
    v_cvt_pk_bf16_f32 v24, v6, v7
    v_cvt_pk_bf16_f32 v25, v8, v9
    v_mfma_f32_16x16x32_bf16 v[148:151], a[60:63], a[160:163], v[148:151]
    ds_read_b64_tr_b16 a[24:25], v20 offset:16640
    ds_read_b64_tr_b16 a[26:27], v20 offset:18688
    v_mfma_f32_16x16x32_bf16 v[156:159], a[60:63], a[164:167], v[156:159]
    buffer_load_dwordx4 v12, s[12:15], s40 offen offset:2048 lds
    s_waitcnt lgkmcnt(6)
    v_mfma_f32_16x16x32_bf16 v[32:35], a[0:3], a[168:171], v[32:35]
    ds_read_b64_tr_b16 a[28:29], v27 offset:16640
    ds_read_b64_tr_b16 a[30:31], v27 offset:18688
    v_mfma_f32_16x16x32_bf16 v[40:43], a[0:3], a[172:175], v[40:43]
    v_accvgpr_read_b32 v2, a120
    v_accvgpr_read_b32 v3, a121
    v_mfma_f32_16x16x32_bf16 v[48:51], a[4:7], a[168:171], v[48:51]
    ds_read_b64_tr_b16 a[32:33], v17 offset:16384
    ds_read_b64_tr_b16 a[34:35], v17 offset:18432
    v_mfma_f32_16x16x32_bf16 v[56:59], a[4:7], a[172:175], v[56:59]
    buffer_load_dwordx4 v13, s[12:15], s40 offen offset:3072 lds
    s_add_u32 s40, s40, 262144
    v_mfma_f32_16x16x32_bf16 v[64:67], a[8:11], a[168:171], v[64:67]
    ds_read_b64_tr_b16 a[36:37], v19 offset:16384
    ds_read_b64_tr_b16 a[38:39], v19 offset:18432
    v_mfma_f32_16x16x32_bf16 v[72:75], a[8:11], a[172:175], v[72:75]
    v_accvgpr_read_b32 v4, a122
    v_accvgpr_read_b32 v5, a123
    v_mfma_f32_16x16x32_bf16 v[80:83], a[12:15], a[168:171], v[80:83]
    ds_read_b64_tr_b16 a[40:41], v21 offset:16384
    ds_read_b64_tr_b16 a[42:43], v21 offset:18432
    v_mfma_f32_16x16x32_bf16 v[88:91], a[12:15], a[172:175], v[88:91]
    buffer_load_dwordx4 a[216:219], v22, s[96:99], s67 offen offset:2048 sc1
    s_waitcnt lgkmcnt(6)
    v_mfma_f32_16x16x32_bf16 v[96:99], a[16:19], a[168:171], v[96:99]
    ds_read_b64_tr_b16 a[44:45], v31 offset:16384
    ds_read_b64_tr_b16 a[46:47], v31 offset:18432
    v_mfma_f32_16x16x32_bf16 v[104:107], a[16:19], a[172:175], v[104:107]
    v_accvgpr_read_b32 v6, a124
    v_accvgpr_read_b32 v7, a125
    v_mfma_f32_16x16x32_bf16 v[112:115], a[20:23], a[168:171], v[112:115]
    ds_read_b64_tr_b16 a[48:49], v17 offset:16640
    ds_read_b64_tr_b16 a[50:51], v17 offset:18688
    v_mfma_f32_16x16x32_bf16 v[120:123], a[20:23], a[172:175], v[120:123]
    buffer_load_dwordx4 a[220:223], v22, s[96:99], s67 offen offset:3072 sc1
    v_accvgpr_read_b32 v8, a126
    v_mfma_f32_16x16x32_bf16 v[128:131], a[24:27], a[168:171], v[128:131]
    ds_read_b64_tr_b16 a[52:53], v19 offset:16640
    ds_read_b64_tr_b16 a[54:55], v19 offset:18688
    v_mfma_f32_16x16x32_bf16 v[136:139], a[24:27], a[172:175], v[136:139]
    v_accvgpr_read_b32 v9, a127
    v_cvt_pk_bf16_f32 v2, v2, v3
    v_mfma_f32_16x16x32_bf16 v[144:147], a[28:31], a[168:171], v[144:147]
    ds_read_b64_tr_b16 a[56:57], v21 offset:16640
    ds_read_b64_tr_b16 a[58:59], v21 offset:18688
    v_mfma_f32_16x16x32_bf16 v[152:155], a[28:31], a[172:175], v[152:155]
    v_cvt_pk_bf16_f32 v4, v4, v5
    s_waitcnt lgkmcnt(6)
    v_mfma_f32_16x16x32_bf16 v[36:39], a[32:35], a[168:171], v[36:39]
    ds_read_b64_tr_b16 a[60:61], v31 offset:16640
    ds_read_b64_tr_b16 a[62:63], v31 offset:18688
    v_mfma_f32_16x16x32_bf16 v[44:47], a[32:35], a[172:175], v[44:47]
    v_cvt_pk_bf16_f32 v6, v6, v7
    v_cvt_pk_bf16_f32 v8, v8, v9
    v_mfma_f32_16x16x32_bf16 v[52:55], a[36:39], a[168:171], v[52:55]
    s_waitcnt vmcnt(20)
    s_barrier
    v_xor_b32 v16, 0x10000, v16
    v_xor_b32 v17, 0x10000, v17
    v_xor_b32 v18, 0x10000, v18
    v_xor_b32 v19, 0x10000, v19
    v_xor_b32 v20, 0x10000, v20
    v_xor_b32 v21, 0x10000, v21
    v_xor_b32 v27, 0x10000, v27
    v_xor_b32 v31, 0x10000, v31
    ds_read_b64_tr_b16 a[0:1], v16 offset:0
    ds_read_b64_tr_b16 a[2:3], v16 offset:2048
    v_mfma_f32_16x16x32_bf16 v[60:63], a[36:39], a[172:175], v[60:63]
    v_mfma_f32_16x16x32_bf16 v[68:71], a[40:43], a[168:171], v[68:71]
    ds_read_b64_tr_b16 a[4:5], v18 offset:0
    ds_read_b64_tr_b16 a[6:7], v18 offset:2048
    v_mfma_f32_16x16x32_bf16 v[76:79], a[40:43], a[172:175], v[76:79]
    s_add_u32 m0, s65, 65536
    s_nop 1
    v_mfma_f32_16x16x32_bf16 v[84:87], a[44:47], a[168:171], v[84:87]
    ds_read_b64_tr_b16 a[8:9], v20 offset:0
    ds_read_b64_tr_b16 a[10:11], v20 offset:2048
    v_mfma_f32_16x16x32_bf16 v[92:95], a[44:47], a[172:175], v[92:95]
    buffer_load_dwordx4 v10, s[12:15], s40 offen offset:0 lds
    s_waitcnt lgkmcnt(6)
    v_mfma_f32_16x16x32_bf16 v[100:103], a[48:51], a[168:171], v[100:103]
    ds_read_b64_tr_b16 a[12:13], v27 offset:0
    ds_read_b64_tr_b16 a[14:15], v27 offset:2048
    v_mfma_f32_16x16x32_bf16 v[108:111], a[48:51], a[172:175], v[108:111]
    v_permlane16_swap_b32 v14, v2
    v_permlane16_swap_b32 v15, v4
    v_mfma_f32_16x16x32_bf16 v[116:119], a[52:55], a[168:171], v[116:119]
    ds_read_b64_tr_b16 a[16:17], v16 offset:256
    ds_read_b64_tr_b16 a[18:19], v16 offset:2304
    v_mfma_f32_16x16x32_bf16 v[124:127], a[52:55], a[172:175], v[124:127]
    buffer_load_dwordx4 v11, s[12:15], s40 offen offset:1024 lds
    v_permlane16_swap_b32 v24, v6
    v_mfma_f32_16x16x32_bf16 v[132:135], a[56:59], a[168:171], v[132:135]
    ds_read_b64_tr_b16 a[20:21], v18 offset:256
    ds_read_b64_tr_b16 a[22:23], v18 offset:2304
    v_mfma_f32_16x16x32_bf16 v[140:143], a[56:59], a[172:175], v[140:143]
    v_permlane16_swap_b32 v25, v8
    s_nop 0
    v_mfma_f32_16x16x32_bf16 v[148:151], a[60:63], a[168:171], v[148:151]
    ds_read_b64_tr_b16 a[24:25], v20 offset:256
    ds_read_b64_tr_b16 a[26:27], v20 offset:2304
    v_mfma_f32_16x16x32_bf16 v[156:159], a[60:63], a[172:175], v[156:159]
    buffer_load_dwordx4 v12, s[12:15], s40 offen offset:2048 lds
    s_waitcnt lgkmcnt(6)
    v_mfma_f32_16x16x32_bf16 v[32:35], a[0:3], a[176:179], v[32:35]
    ds_read_b64_tr_b16 a[28:29], v27 offset:256
    ds_read_b64_tr_b16 a[30:31], v27 offset:2304
    v_mfma_f32_16x16x32_bf16 v[40:43], a[0:3], a[180:183], v[40:43]
    v_accvgpr_write_b32 a232, v14
    v_accvgpr_write_b32 a233, v15
    v_mfma_f32_16x16x32_bf16 v[48:51], a[4:7], a[176:179], v[48:51]
    ds_read_b64_tr_b16 a[32:33], v17 offset:0
    ds_read_b64_tr_b16 a[34:35], v17 offset:2048
    v_mfma_f32_16x16x32_bf16 v[56:59], a[4:7], a[180:183], v[56:59]
    buffer_load_dwordx4 v13, s[12:15], s40 offen offset:3072 lds
    s_add_u32 s40, s40, 262144
    s_add_u32 s67, s67, 4096
    v_mfma_f32_16x16x32_bf16 v[64:67], a[8:11], a[176:179], v[64:67]
    ds_read_b64_tr_b16 a[36:37], v19 offset:0
    ds_read_b64_tr_b16 a[38:39], v19 offset:2048
    v_mfma_f32_16x16x32_bf16 v[72:75], a[8:11], a[180:183], v[72:75]
    v_accvgpr_write_b32 a234, v24
    v_accvgpr_write_b32 a235, v25
    v_mfma_f32_16x16x32_bf16 v[80:83], a[12:15], a[176:179], v[80:83]
    ds_read_b64_tr_b16 a[40:41], v21 offset:0
    ds_read_b64_tr_b16 a[42:43], v21 offset:2048
    v_mfma_f32_16x16x32_bf16 v[88:91], a[12:15], a[180:183], v[88:91]
    buffer_load_dwordx4 a[160:163], v22, s[96:99], s67 offen offset:0 sc1
    s_waitcnt lgkmcnt(6)
    v_mfma_f32_16x16x32_bf16 v[96:99], a[16:19], a[176:179], v[96:99]
    ds_read_b64_tr_b16 a[44:45], v31 offset:0
    ds_read_b64_tr_b16 a[46:47], v31 offset:2048
    v_mfma_f32_16x16x32_bf16 v[104:107], a[16:19], a[180:183], v[104:107]
    v_accvgpr_write_b32 a236, v2
    v_accvgpr_write_b32 a237, v4
    v_mfma_f32_16x16x32_bf16 v[112:115], a[20:23], a[176:179], v[112:115]
    ds_read_b64_tr_b16 a[48:49], v17 offset:256
    ds_read_b64_tr_b16 a[50:51], v17 offset:2304
    v_mfma_f32_16x16x32_bf16 v[120:123], a[20:23], a[180:183], v[120:123]
    buffer_load_dwordx4 a[164:167], v22, s[96:99], s67 offen offset:1024 sc1
    v_accvgpr_write_b32 a238, v6
    v_mfma_f32_16x16x32_bf16 v[128:131], a[24:27], a[176:179], v[128:131]
    ds_read_b64_tr_b16 a[52:53], v19 offset:256
    ds_read_b64_tr_b16 a[54:55], v19 offset:2304
    v_mfma_f32_16x16x32_bf16 v[136:139], a[24:27], a[180:183], v[136:139]
    v_accvgpr_write_b32 a239, v8
    v_accvgpr_read_b32 v2, a128
    v_mfma_f32_16x16x32_bf16 v[144:147], a[28:31], a[176:179], v[144:147]
    ds_read_b64_tr_b16 a[56:57], v21 offset:256
    ds_read_b64_tr_b16 a[58:59], v21 offset:2304
    v_mfma_f32_16x16x32_bf16 v[152:155], a[28:31], a[180:183], v[152:155]
    v_accvgpr_read_b32 v3, a129
    s_waitcnt lgkmcnt(6)
    v_mfma_f32_16x16x32_bf16 v[36:39], a[32:35], a[176:179], v[36:39]
    ds_read_b64_tr_b16 a[60:61], v31 offset:256
    ds_read_b64_tr_b16 a[62:63], v31 offset:2304
    v_mfma_f32_16x16x32_bf16 v[44:47], a[32:35], a[180:183], v[44:47]
    v_accvgpr_read_b32 v4, a130
    v_accvgpr_read_b32 v5, a131
    v_mfma_f32_16x16x32_bf16 v[52:55], a[36:39], a[176:179], v[52:55]
    s_waitcnt vmcnt(20)
    s_barrier
    ds_read_b64_tr_b16 a[0:1], v16 offset:16384
    ds_read_b64_tr_b16 a[2:3], v16 offset:18432
    v_mfma_f32_16x16x32_bf16 v[60:63], a[36:39], a[180:183], v[60:63]
    v_mfma_f32_16x16x32_bf16 v[68:71], a[40:43], a[176:179], v[68:71]
    ds_read_b64_tr_b16 a[4:5], v18 offset:16384
    ds_read_b64_tr_b16 a[6:7], v18 offset:18432
    v_mfma_f32_16x16x32_bf16 v[76:79], a[40:43], a[180:183], v[76:79]
    s_add_u32 m0, s65, 81920
    v_accvgpr_read_b32 v6, a132
    v_mfma_f32_16x16x32_bf16 v[84:87], a[44:47], a[176:179], v[84:87]
    ds_read_b64_tr_b16 a[8:9], v20 offset:16384
    ds_read_b64_tr_b16 a[10:11], v20 offset:18432
    v_mfma_f32_16x16x32_bf16 v[92:95], a[44:47], a[180:183], v[92:95]
    buffer_load_dwordx4 v10, s[12:15], s40 offen offset:0 lds
    s_waitcnt lgkmcnt(6)
    v_mfma_f32_16x16x32_bf16 v[100:103], a[48:51], a[176:179], v[100:103]
    ds_read_b64_tr_b16 a[12:13], v27 offset:16384
    ds_read_b64_tr_b16 a[14:15], v27 offset:18432
    v_mfma_f32_16x16x32_bf16 v[108:111], a[48:51], a[180:183], v[108:111]
    v_accvgpr_read_b32 v7, a133
    v_accvgpr_read_b32 v8, a134
    v_mfma_f32_16x16x32_bf16 v[116:119], a[52:55], a[176:179], v[116:119]
    ds_read_b64_tr_b16 a[16:17], v16 offset:16640
    ds_read_b64_tr_b16 a[18:19], v16 offset:18688
    v_mfma_f32_16x16x32_bf16 v[124:127], a[52:55], a[180:183], v[124:127]
    buffer_load_dwordx4 v11, s[12:15], s40 offen offset:1024 lds
    v_accvgpr_read_b32 v9, a135
    v_mfma_f32_16x16x32_bf16 v[132:135], a[56:59], a[176:179], v[132:135]
    ds_read_b64_tr_b16 a[20:21], v18 offset:16640
    ds_read_b64_tr_b16 a[22:23], v18 offset:18688
    v_mfma_f32_16x16x32_bf16 v[140:143], a[56:59], a[180:183], v[140:143]
    v_cvt_pk_bf16_f32 v14, v2, v3
    v_cvt_pk_bf16_f32 v15, v4, v5
    v_mfma_f32_16x16x32_bf16 v[148:151], a[60:63], a[176:179], v[148:151]
    ds_read_b64_tr_b16 a[24:25], v20 offset:16640
    ds_read_b64_tr_b16 a[26:27], v20 offset:18688
    v_mfma_f32_16x16x32_bf16 v[156:159], a[60:63], a[180:183], v[156:159]
    buffer_load_dwordx4 v12, s[12:15], s40 offen offset:2048 lds
    s_waitcnt lgkmcnt(6)
    v_mfma_f32_16x16x32_bf16 v[32:35], a[0:3], a[184:187], v[32:35]
    ds_read_b64_tr_b16 a[28:29], v27 offset:16640
    ds_read_b64_tr_b16 a[30:31], v27 offset:18688
    v_mfma_f32_16x16x32_bf16 v[40:43], a[0:3], a[188:191], v[40:43]
    v_cvt_pk_bf16_f32 v24, v6, v7
    v_cvt_pk_bf16_f32 v25, v8, v9
    v_mfma_f32_16x16x32_bf16 v[48:51], a[4:7], a[184:187], v[48:51]
    ds_read_b64_tr_b16 a[32:33], v17 offset:16384
    ds_read_b64_tr_b16 a[34:35], v17 offset:18432
    v_mfma_f32_16x16x32_bf16 v[56:59], a[4:7], a[188:191], v[56:59]
    buffer_load_dwordx4 v13, s[12:15], s40 offen offset:3072 lds
    s_add_u32 s40, s40, 262144
    v_mfma_f32_16x16x32_bf16 v[64:67], a[8:11], a[184:187], v[64:67]
    ds_read_b64_tr_b16 a[36:37], v19 offset:16384
    ds_read_b64_tr_b16 a[38:39], v19 offset:18432
    v_mfma_f32_16x16x32_bf16 v[72:75], a[8:11], a[188:191], v[72:75]
    v_accvgpr_read_b32 v2, a136
    v_accvgpr_read_b32 v3, a137
    v_mfma_f32_16x16x32_bf16 v[80:83], a[12:15], a[184:187], v[80:83]
    ds_read_b64_tr_b16 a[40:41], v21 offset:16384
    ds_read_b64_tr_b16 a[42:43], v21 offset:18432
    v_mfma_f32_16x16x32_bf16 v[88:91], a[12:15], a[188:191], v[88:91]
    buffer_load_dwordx4 a[168:171], v22, s[96:99], s67 offen offset:2048 sc1
    s_waitcnt lgkmcnt(6)
    v_mfma_f32_16x16x32_bf16 v[96:99], a[16:19], a[184:187], v[96:99]
    ds_read_b64_tr_b16 a[44:45], v31 offset:16384
    ds_read_b64_tr_b16 a[46:47], v31 offset:18432
    v_mfma_f32_16x16x32_bf16 v[104:107], a[16:19], a[188:191], v[104:107]
    v_accvgpr_read_b32 v4, a138
    v_accvgpr_read_b32 v5, a139
    v_mfma_f32_16x16x32_bf16 v[112:115], a[20:23], a[184:187], v[112:115]
    ds_read_b64_tr_b16 a[48:49], v17 offset:16640
    ds_read_b64_tr_b16 a[50:51], v17 offset:18688
    v_mfma_f32_16x16x32_bf16 v[120:123], a[20:23], a[188:191], v[120:123]
    buffer_load_dwordx4 a[172:175], v22, s[96:99], s67 offen offset:3072 sc1
    v_accvgpr_read_b32 v6, a140
    v_mfma_f32_16x16x32_bf16 v[128:131], a[24:27], a[184:187], v[128:131]
    ds_read_b64_tr_b16 a[52:53], v19 offset:16640
    ds_read_b64_tr_b16 a[54:55], v19 offset:18688
    v_mfma_f32_16x16x32_bf16 v[136:139], a[24:27], a[188:191], v[136:139]
    v_accvgpr_read_b32 v7, a141
    v_accvgpr_read_b32 v8, a142
    v_mfma_f32_16x16x32_bf16 v[144:147], a[28:31], a[184:187], v[144:147]
    ds_read_b64_tr_b16 a[56:57], v21 offset:16640
    ds_read_b64_tr_b16 a[58:59], v21 offset:18688
    v_mfma_f32_16x16x32_bf16 v[152:155], a[28:31], a[188:191], v[152:155]
    v_accvgpr_read_b32 v9, a143
    s_waitcnt lgkmcnt(6)
    v_mfma_f32_16x16x32_bf16 v[36:39], a[32:35], a[184:187], v[36:39]
    ds_read_b64_tr_b16 a[60:61], v31 offset:16640
    ds_read_b64_tr_b16 a[62:63], v31 offset:18688
    v_mfma_f32_16x16x32_bf16 v[44:47], a[32:35], a[188:191], v[44:47]
    v_cvt_pk_bf16_f32 v2, v2, v3
    v_cvt_pk_bf16_f32 v4, v4, v5
    v_mfma_f32_16x16x32_bf16 v[52:55], a[36:39], a[184:187], v[52:55]
    s_waitcnt vmcnt(20)
    s_barrier
    ds_read_b64_tr_b16 a[0:1], v16 offset:32768
    ds_read_b64_tr_b16 a[2:3], v16 offset:34816
    v_mfma_f32_16x16x32_bf16 v[60:63], a[36:39], a[188:191], v[60:63]
    v_mfma_f32_16x16x32_bf16 v[68:71], a[40:43], a[184:187], v[68:71]
    ds_read_b64_tr_b16 a[4:5], v18 offset:32768
    ds_read_b64_tr_b16 a[6:7], v18 offset:34816
    v_mfma_f32_16x16x32_bf16 v[76:79], a[40:43], a[188:191], v[76:79]
    s_add_u32 m0, s65, 0
    v_cvt_pk_bf16_f32 v6, v6, v7
    v_mfma_f32_16x16x32_bf16 v[84:87], a[44:47], a[184:187], v[84:87]
    ds_read_b64_tr_b16 a[8:9], v20 offset:32768
    ds_read_b64_tr_b16 a[10:11], v20 offset:34816
    v_mfma_f32_16x16x32_bf16 v[92:95], a[44:47], a[188:191], v[92:95]
    buffer_load_dwordx4 v10, s[12:15], s40 offen offset:0 lds
    s_waitcnt lgkmcnt(6)
    v_mfma_f32_16x16x32_bf16 v[100:103], a[48:51], a[184:187], v[100:103]
    ds_read_b64_tr_b16 a[12:13], v27 offset:32768
    ds_read_b64_tr_b16 a[14:15], v27 offset:34816
    v_mfma_f32_16x16x32_bf16 v[108:111], a[48:51], a[188:191], v[108:111]
    v_cvt_pk_bf16_f32 v8, v8, v9
    s_nop 1
    v_mfma_f32_16x16x32_bf16 v[116:119], a[52:55], a[184:187], v[116:119]
    ds_read_b64_tr_b16 a[16:17], v16 offset:33024
    ds_read_b64_tr_b16 a[18:19], v16 offset:35072
    v_mfma_f32_16x16x32_bf16 v[124:127], a[52:55], a[188:191], v[124:127]
    buffer_load_dwordx4 v11, s[12:15], s40 offen offset:1024 lds
    v_permlane16_swap_b32 v14, v2
    v_mfma_f32_16x16x32_bf16 v[132:135], a[56:59], a[184:187], v[132:135]
    ds_read_b64_tr_b16 a[20:21], v18 offset:33024
    ds_read_b64_tr_b16 a[22:23], v18 offset:35072
    v_mfma_f32_16x16x32_bf16 v[140:143], a[56:59], a[188:191], v[140:143]
    v_permlane16_swap_b32 v15, v4
    v_permlane16_swap_b32 v24, v6
    v_mfma_f32_16x16x32_bf16 v[148:151], a[60:63], a[184:187], v[148:151]
    ds_read_b64_tr_b16 a[24:25], v20 offset:33024
    ds_read_b64_tr_b16 a[26:27], v20 offset:35072
    v_mfma_f32_16x16x32_bf16 v[156:159], a[60:63], a[188:191], v[156:159]
    buffer_load_dwordx4 v12, s[12:15], s40 offen offset:2048 lds
    s_waitcnt lgkmcnt(6)
    v_mfma_f32_16x16x32_bf16 v[32:35], a[0:3], a[192:195], v[32:35]
    ds_read_b64_tr_b16 a[28:29], v27 offset:33024
    ds_read_b64_tr_b16 a[30:31], v27 offset:35072
    v_mfma_f32_16x16x32_bf16 v[40:43], a[0:3], a[196:199], v[40:43]
    v_permlane16_swap_b32 v25, v8
    s_nop 0
    v_mfma_f32_16x16x32_bf16 v[48:51], a[4:7], a[192:195], v[48:51]
    ds_read_b64_tr_b16 a[32:33], v17 offset:32768
    ds_read_b64_tr_b16 a[34:35], v17 offset:34816
    v_mfma_f32_16x16x32_bf16 v[56:59], a[4:7], a[196:199], v[56:59]
    buffer_load_dwordx4 v13, s[12:15], s40 offen offset:3072 lds
    s_add_u32 s40, s40, 262144
    s_add_u32 s67, s67, 4096
    v_mfma_f32_16x16x32_bf16 v[64:67], a[8:11], a[192:195], v[64:67]
    ds_read_b64_tr_b16 a[36:37], v19 offset:32768
    ds_read_b64_tr_b16 a[38:39], v19 offset:34816
    v_mfma_f32_16x16x32_bf16 v[72:75], a[8:11], a[196:199], v[72:75]
    v_accvgpr_write_b32 a240, v14
    v_accvgpr_write_b32 a241, v15
    v_mfma_f32_16x16x32_bf16 v[80:83], a[12:15], a[192:195], v[80:83]
    ds_read_b64_tr_b16 a[40:41], v21 offset:32768
    ds_read_b64_tr_b16 a[42:43], v21 offset:34816
    v_mfma_f32_16x16x32_bf16 v[88:91], a[12:15], a[196:199], v[88:91]
    buffer_load_dwordx4 a[176:179], v22, s[96:99], s67 offen offset:0 sc1
    s_waitcnt lgkmcnt(6)
    v_mfma_f32_16x16x32_bf16 v[96:99], a[16:19], a[192:195], v[96:99]
    ds_read_b64_tr_b16 a[44:45], v31 offset:32768
    ds_read_b64_tr_b16 a[46:47], v31 offset:34816
    v_mfma_f32_16x16x32_bf16 v[104:107], a[16:19], a[196:199], v[104:107]
    v_accvgpr_write_b32 a242, v24
    v_accvgpr_write_b32 a243, v25
    v_mfma_f32_16x16x32_bf16 v[112:115], a[20:23], a[192:195], v[112:115]
    ds_read_b64_tr_b16 a[48:49], v17 offset:33024
    ds_read_b64_tr_b16 a[50:51], v17 offset:35072
    v_mfma_f32_16x16x32_bf16 v[120:123], a[20:23], a[196:199], v[120:123]
    buffer_load_dwordx4 a[180:183], v22, s[96:99], s67 offen offset:1024 sc1
    v_accvgpr_write_b32 a244, v2
    v_mfma_f32_16x16x32_bf16 v[128:131], a[24:27], a[192:195], v[128:131]
    ds_read_b64_tr_b16 a[52:53], v19 offset:33024
    ds_read_b64_tr_b16 a[54:55], v19 offset:35072
    v_mfma_f32_16x16x32_bf16 v[136:139], a[24:27], a[196:199], v[136:139]
    v_accvgpr_write_b32 a245, v4
    v_accvgpr_write_b32 a246, v6
    v_mfma_f32_16x16x32_bf16 v[144:147], a[28:31], a[192:195], v[144:147]
    ds_read_b64_tr_b16 a[56:57], v21 offset:33024
    ds_read_b64_tr_b16 a[58:59], v21 offset:35072
    v_mfma_f32_16x16x32_bf16 v[152:155], a[28:31], a[196:199], v[152:155]
    v_accvgpr_write_b32 a247, v8
    s_waitcnt lgkmcnt(6)
    v_mfma_f32_16x16x32_bf16 v[36:39], a[32:35], a[192:195], v[36:39]
    ds_read_b64_tr_b16 a[60:61], v31 offset:33024
    ds_read_b64_tr_b16 a[62:63], v31 offset:35072
    v_mfma_f32_16x16x32_bf16 v[44:47], a[32:35], a[196:199], v[44:47]
    v_accvgpr_read_b32 v2, a144
    v_accvgpr_read_b32 v3, a145
    v_mfma_f32_16x16x32_bf16 v[52:55], a[36:39], a[192:195], v[52:55]
    s_waitcnt vmcnt(20)
    s_barrier
    ds_read_b64_tr_b16 a[0:1], v16 offset:49152
    ds_read_b64_tr_b16 a[2:3], v16 offset:51200
    v_mfma_f32_16x16x32_bf16 v[60:63], a[36:39], a[196:199], v[60:63]
    v_mfma_f32_16x16x32_bf16 v[68:71], a[40:43], a[192:195], v[68:71]
    ds_read_b64_tr_b16 a[4:5], v18 offset:49152
    ds_read_b64_tr_b16 a[6:7], v18 offset:51200
    v_mfma_f32_16x16x32_bf16 v[76:79], a[40:43], a[196:199], v[76:79]
    s_add_u32 m0, s65, 16384
    v_accvgpr_read_b32 v4, a146
    v_mfma_f32_16x16x32_bf16 v[84:87], a[44:47], a[192:195], v[84:87]
    ds_read_b64_tr_b16 a[8:9], v20 offset:49152
    ds_read_b64_tr_b16 a[10:11], v20 offset:51200
    v_mfma_f32_16x16x32_bf16 v[92:95], a[44:47], a[196:199], v[92:95]
    buffer_load_dwordx4 v10, s[12:15], s40 offen offset:0 lds
    s_waitcnt lgkmcnt(6)
    v_mfma_f32_16x16x32_bf16 v[100:103], a[48:51], a[192:195], v[100:103]
    ds_read_b64_tr_b16 a[12:13], v27 offset:49152
    ds_read_b64_tr_b16 a[14:15], v27 offset:51200
    v_mfma_f32_16x16x32_bf16 v[108:111], a[48:51], a[196:199], v[108:111]
    v_accvgpr_read_b32 v5, a147
    v_accvgpr_read_b32 v6, a148
    v_mfma_f32_16x16x32_bf16 v[116:119], a[52:55], a[192:195], v[116:119]
    ds_read_b64_tr_b16 a[16:17], v16 offset:49408
    ds_read_b64_tr_b16 a[18:19], v16 offset:51456
    v_mfma_f32_16x16x32_bf16 v[124:127], a[52:55], a[196:199], v[124:127]
    buffer_load_dwordx4 v11, s[12:15], s40 offen offset:1024 lds
    v_accvgpr_read_b32 v7, a149
    v_mfma_f32_16x16x32_bf16 v[132:135], a[56:59], a[192:195], v[132:135]
    ds_read_b64_tr_b16 a[20:21], v18 offset:49408
    ds_read_b64_tr_b16 a[22:23], v18 offset:51456
    v_mfma_f32_16x16x32_bf16 v[140:143], a[56:59], a[196:199], v[140:143]
    v_accvgpr_read_b32 v8, a150
    v_accvgpr_read_b32 v9, a151
    v_mfma_f32_16x16x32_bf16 v[148:151], a[60:63], a[192:195], v[148:151]
    ds_read_b64_tr_b16 a[24:25], v20 offset:49408
    ds_read_b64_tr_b16 a[26:27], v20 offset:51456
    v_mfma_f32_16x16x32_bf16 v[156:159], a[60:63], a[196:199], v[156:159]
    buffer_load_dwordx4 v12, s[12:15], s40 offen offset:2048 lds
    s_waitcnt lgkmcnt(6)
    v_mfma_f32_16x16x32_bf16 v[32:35], a[0:3], a[200:203], v[32:35]
    ds_read_b64_tr_b16 a[28:29], v27 offset:49408
    ds_read_b64_tr_b16 a[30:31], v27 offset:51456
    v_mfma_f32_16x16x32_bf16 v[40:43], a[0:3], a[204:207], v[40:43]
    v_cvt_pk_bf16_f32 v14, v2, v3
    v_cvt_pk_bf16_f32 v15, v4, v5
    v_mfma_f32_16x16x32_bf16 v[48:51], a[4:7], a[200:203], v[48:51]
    ds_read_b64_tr_b16 a[32:33], v17 offset:49152
    ds_read_b64_tr_b16 a[34:35], v17 offset:51200
    v_mfma_f32_16x16x32_bf16 v[56:59], a[4:7], a[204:207], v[56:59]
    buffer_load_dwordx4 v13, s[12:15], s40 offen offset:3072 lds
    s_add_u32 s40, s40, 262144
    v_mfma_f32_16x16x32_bf16 v[64:67], a[8:11], a[200:203], v[64:67]
    ds_read_b64_tr_b16 a[36:37], v19 offset:49152
    ds_read_b64_tr_b16 a[38:39], v19 offset:51200
    v_mfma_f32_16x16x32_bf16 v[72:75], a[8:11], a[204:207], v[72:75]
    v_cvt_pk_bf16_f32 v24, v6, v7
    v_cvt_pk_bf16_f32 v25, v8, v9
    v_mfma_f32_16x16x32_bf16 v[80:83], a[12:15], a[200:203], v[80:83]
    ds_read_b64_tr_b16 a[40:41], v21 offset:49152
    ds_read_b64_tr_b16 a[42:43], v21 offset:51200
    v_mfma_f32_16x16x32_bf16 v[88:91], a[12:15], a[204:207], v[88:91]
    buffer_load_dwordx4 a[184:187], v22, s[96:99], s67 offen offset:2048 sc1
    s_waitcnt lgkmcnt(6)
    v_mfma_f32_16x16x32_bf16 v[96:99], a[16:19], a[200:203], v[96:99]
    ds_read_b64_tr_b16 a[44:45], v31 offset:49152
    ds_read_b64_tr_b16 a[46:47], v31 offset:51200
    v_mfma_f32_16x16x32_bf16 v[104:107], a[16:19], a[204:207], v[104:107]
    v_accvgpr_read_b32 v2, a152
    v_accvgpr_read_b32 v3, a153
    v_mfma_f32_16x16x32_bf16 v[112:115], a[20:23], a[200:203], v[112:115]
    ds_read_b64_tr_b16 a[48:49], v17 offset:49408
    ds_read_b64_tr_b16 a[50:51], v17 offset:51456
    v_mfma_f32_16x16x32_bf16 v[120:123], a[20:23], a[204:207], v[120:123]
    buffer_load_dwordx4 a[188:191], v22, s[96:99], s67 offen offset:3072 sc1
    v_accvgpr_read_b32 v4, a154
    v_mfma_f32_16x16x32_bf16 v[128:131], a[24:27], a[200:203], v[128:131]
    ds_read_b64_tr_b16 a[52:53], v19 offset:49408
    ds_read_b64_tr_b16 a[54:55], v19 offset:51456
    v_mfma_f32_16x16x32_bf16 v[136:139], a[24:27], a[204:207], v[136:139]
    v_accvgpr_read_b32 v5, a155
    v_accvgpr_read_b32 v6, a156
    v_mfma_f32_16x16x32_bf16 v[144:147], a[28:31], a[200:203], v[144:147]
    ds_read_b64_tr_b16 a[56:57], v21 offset:49408
    ds_read_b64_tr_b16 a[58:59], v21 offset:51456
    v_mfma_f32_16x16x32_bf16 v[152:155], a[28:31], a[204:207], v[152:155]
    v_accvgpr_read_b32 v7, a157
    s_waitcnt lgkmcnt(6)
    v_mfma_f32_16x16x32_bf16 v[36:39], a[32:35], a[200:203], v[36:39]
    ds_read_b64_tr_b16 a[60:61], v31 offset:49408
    ds_read_b64_tr_b16 a[62:63], v31 offset:51456
    v_mfma_f32_16x16x32_bf16 v[44:47], a[32:35], a[204:207], v[44:47]
    v_accvgpr_read_b32 v8, a158
    v_accvgpr_read_b32 v9, a159
    v_mfma_f32_16x16x32_bf16 v[52:55], a[36:39], a[200:203], v[52:55]
    s_waitcnt vmcnt(20)
    s_barrier
    v_xor_b32 v16, 0x10000, v16
    v_xor_b32 v17, 0x10000, v17
    v_xor_b32 v18, 0x10000, v18
    v_xor_b32 v19, 0x10000, v19
    v_xor_b32 v20, 0x10000, v20
    v_xor_b32 v21, 0x10000, v21
    v_xor_b32 v27, 0x10000, v27
    v_xor_b32 v31, 0x10000, v31
    ds_read_b64_tr_b16 a[0:1], v16 offset:0
    ds_read_b64_tr_b16 a[2:3], v16 offset:2048
    v_mfma_f32_16x16x32_bf16 v[60:63], a[36:39], a[204:207], v[60:63]
    v_mfma_f32_16x16x32_bf16 v[68:71], a[40:43], a[200:203], v[68:71]
    ds_read_b64_tr_b16 a[4:5], v18 offset:0
    ds_read_b64_tr_b16 a[6:7], v18 offset:2048
    v_mfma_f32_16x16x32_bf16 v[76:79], a[40:43], a[204:207], v[76:79]
    s_add_u32 m0, s65, 32768
    v_cvt_pk_bf16_f32 v2, v2, v3
    v_mfma_f32_16x16x32_bf16 v[84:87], a[44:47], a[200:203], v[84:87]
    ds_read_b64_tr_b16 a[8:9], v20 offset:0
    ds_read_b64_tr_b16 a[10:11], v20 offset:2048
    v_mfma_f32_16x16x32_bf16 v[92:95], a[44:47], a[204:207], v[92:95]
    buffer_load_dwordx4 v10, s[12:15], s40 offen offset:0 lds
    s_waitcnt lgkmcnt(6)
    v_mfma_f32_16x16x32_bf16 v[100:103], a[48:51], a[200:203], v[100:103]
    ds_read_b64_tr_b16 a[12:13], v27 offset:0
    ds_read_b64_tr_b16 a[14:15], v27 offset:2048
    v_mfma_f32_16x16x32_bf16 v[108:111], a[48:51], a[204:207], v[108:111]
    v_cvt_pk_bf16_f32 v4, v4, v5
    v_cvt_pk_bf16_f32 v6, v6, v7
    v_mfma_f32_16x16x32_bf16 v[116:119], a[52:55], a[200:203], v[116:119]
    ds_read_b64_tr_b16 a[16:17], v16 offset:256
    ds_read_b64_tr_b16 a[18:19], v16 offset:2304
    v_mfma_f32_16x16x32_bf16 v[124:127], a[52:55], a[204:207], v[124:127]
    buffer_load_dwordx4 v11, s[12:15], s40 offen offset:1024 lds
    v_cvt_pk_bf16_f32 v8, v8, v9
    v_mfma_f32_16x16x32_bf16 v[132:135], a[56:59], a[200:203], v[132:135]
    ds_read_b64_tr_b16 a[20:21], v18 offset:256
    ds_read_b64_tr_b16 a[22:23], v18 offset:2304
    v_mfma_f32_16x16x32_bf16 v[140:143], a[56:59], a[204:207], v[140:143]
    s_nop 1
    v_permlane16_swap_b32 v14, v2
    v_mfma_f32_16x16x32_bf16 v[148:151], a[60:63], a[200:203], v[148:151]
    ds_read_b64_tr_b16 a[24:25], v20 offset:256
    ds_read_b64_tr_b16 a[26:27], v20 offset:2304
    v_mfma_f32_16x16x32_bf16 v[156:159], a[60:63], a[204:207], v[156:159]
    buffer_load_dwordx4 v12, s[12:15], s40 offen offset:2048 lds
    s_waitcnt lgkmcnt(6)
    v_mfma_f32_16x16x32_bf16 v[32:35], a[0:3], a[208:211], v[32:35]
    ds_read_b64_tr_b16 a[28:29], v27 offset:256
    ds_read_b64_tr_b16 a[30:31], v27 offset:2304
    v_mfma_f32_16x16x32_bf16 v[40:43], a[0:3], a[212:215], v[40:43]
    v_permlane16_swap_b32 v15, v4
    v_permlane16_swap_b32 v24, v6
    v_mfma_f32_16x16x32_bf16 v[48:51], a[4:7], a[208:211], v[48:51]
    ds_read_b64_tr_b16 a[32:33], v17 offset:0
    ds_read_b64_tr_b16 a[34:35], v17 offset:2048
    v_mfma_f32_16x16x32_bf16 v[56:59], a[4:7], a[212:215], v[56:59]
    buffer_load_dwordx4 v13, s[12:15], s40 offen offset:3072 lds
    s_add_u32 s40, s40, 262144
    v_mfma_f32_16x16x32_bf16 v[64:67], a[8:11], a[208:211], v[64:67]
    ds_read_b64_tr_b16 a[36:37], v19 offset:0
    ds_read_b64_tr_b16 a[38:39], v19 offset:2048
    v_mfma_f32_16x16x32_bf16 v[72:75], a[8:11], a[212:215], v[72:75]
    v_permlane16_swap_b32 v25, v8
    s_nop 0
    v_mfma_f32_16x16x32_bf16 v[80:83], a[12:15], a[208:211], v[80:83]
    ds_read_b64_tr_b16 a[40:41], v21 offset:0
    ds_read_b64_tr_b16 a[42:43], v21 offset:2048
    v_mfma_f32_16x16x32_bf16 v[88:91], a[12:15], a[212:215], v[88:91]
    v_accvgpr_write_b32 a248, v14
    s_waitcnt lgkmcnt(6)
    v_mfma_f32_16x16x32_bf16 v[96:99], a[16:19], a[208:211], v[96:99]
    ds_read_b64_tr_b16 a[44:45], v31 offset:0
    ds_read_b64_tr_b16 a[46:47], v31 offset:2048
    v_mfma_f32_16x16x32_bf16 v[104:107], a[16:19], a[212:215], v[104:107]
    v_accvgpr_write_b32 a249, v15
    v_accvgpr_write_b32 a250, v24
    v_mfma_f32_16x16x32_bf16 v[112:115], a[20:23], a[208:211], v[112:115]
    ds_read_b64_tr_b16 a[48:49], v17 offset:256
    ds_read_b64_tr_b16 a[50:51], v17 offset:2304
    v_mfma_f32_16x16x32_bf16 v[120:123], a[20:23], a[212:215], v[120:123]
    v_accvgpr_write_b32 a251, v25
    v_accvgpr_read_b32 v2, a64
    v_mfma_f32_16x16x32_bf16 v[128:131], a[24:27], a[208:211], v[128:131]
    ds_read_b64_tr_b16 a[52:53], v19 offset:256
    ds_read_b64_tr_b16 a[54:55], v19 offset:2304
    v_mfma_f32_16x16x32_bf16 v[136:139], a[24:27], a[212:215], v[136:139]
    v_accvgpr_read_b32 v3, a65
    v_accvgpr_read_b32 v4, a66
    v_mfma_f32_16x16x32_bf16 v[144:147], a[28:31], a[208:211], v[144:147]
    ds_read_b64_tr_b16 a[56:57], v21 offset:256
    ds_read_b64_tr_b16 a[58:59], v21 offset:2304
    v_mfma_f32_16x16x32_bf16 v[152:155], a[28:31], a[212:215], v[152:155]
    v_accvgpr_read_b32 v5, a67
    s_waitcnt lgkmcnt(6)
    v_mfma_f32_16x16x32_bf16 v[36:39], a[32:35], a[208:211], v[36:39]
    ds_read_b64_tr_b16 a[60:61], v31 offset:256
    ds_read_b64_tr_b16 a[62:63], v31 offset:2304
    v_mfma_f32_16x16x32_bf16 v[44:47], a[32:35], a[212:215], v[44:47]
    v_accvgpr_read_b32 v6, a68
    v_accvgpr_read_b32 v7, a69
    v_mfma_f32_16x16x32_bf16 v[52:55], a[36:39], a[208:211], v[52:55]
    s_waitcnt vmcnt(18)
    s_barrier
    ds_read_b64_tr_b16 a[0:1], v16 offset:16384
    ds_read_b64_tr_b16 a[2:3], v16 offset:18432
    v_mfma_f32_16x16x32_bf16 v[60:63], a[36:39], a[212:215], v[60:63]
    v_mfma_f32_16x16x32_bf16 v[68:71], a[40:43], a[208:211], v[68:71]
    ds_read_b64_tr_b16 a[4:5], v18 offset:16384
    ds_read_b64_tr_b16 a[6:7], v18 offset:18432
    v_mfma_f32_16x16x32_bf16 v[76:79], a[40:43], a[212:215], v[76:79]
    s_add_u32 m0, s65, 49152
    v_accvgpr_read_b32 v8, a70
    v_mfma_f32_16x16x32_bf16 v[84:87], a[44:47], a[208:211], v[84:87]
    ds_read_b64_tr_b16 a[8:9], v20 offset:16384
    ds_read_b64_tr_b16 a[10:11], v20 offset:18432
    v_mfma_f32_16x16x32_bf16 v[92:95], a[44:47], a[212:215], v[92:95]
    buffer_load_dwordx4 v10, s[12:15], s40 offen offset:0 lds
    s_waitcnt lgkmcnt(6)
    v_mfma_f32_16x16x32_bf16 v[100:103], a[48:51], a[208:211], v[100:103]
    ds_read_b64_tr_b16 a[12:13], v27 offset:16384
    ds_read_b64_tr_b16 a[14:15], v27 offset:18432
    v_mfma_f32_16x16x32_bf16 v[108:111], a[48:51], a[212:215], v[108:111]
    v_accvgpr_read_b32 v9, a71
    v_mul_f32 v2, s4, v2
    v_mfma_f32_16x16x32_bf16 v[116:119], a[52:55], a[208:211], v[116:119]
    ds_read_b64_tr_b16 a[16:17], v16 offset:16640
    ds_read_b64_tr_b16 a[18:19], v16 offset:18688
    v_mfma_f32_16x16x32_bf16 v[124:127], a[52:55], a[212:215], v[124:127]
    buffer_load_dwordx4 v11, s[12:15], s40 offen offset:1024 lds
    v_mul_f32 v3, s4, v3
    v_mfma_f32_16x16x32_bf16 v[132:135], a[56:59], a[208:211], v[132:135]
    ds_read_b64_tr_b16 a[20:21], v18 offset:16640
    ds_read_b64_tr_b16 a[22:23], v18 offset:18688
    v_mfma_f32_16x16x32_bf16 v[140:143], a[56:59], a[212:215], v[140:143]
    v_mul_f32 v4, s4, v4
    v_mul_f32 v5, s4, v5
    v_mfma_f32_16x16x32_bf16 v[148:151], a[60:63], a[208:211], v[148:151]
    ds_read_b64_tr_b16 a[24:25], v20 offset:16640
    ds_read_b64_tr_b16 a[26:27], v20 offset:18688
    v_mfma_f32_16x16x32_bf16 v[156:159], a[60:63], a[212:215], v[156:159]
    buffer_load_dwordx4 v12, s[12:15], s40 offen offset:2048 lds
    s_waitcnt lgkmcnt(6)
    v_mfma_f32_16x16x32_bf16 v[32:35], a[0:3], a[216:219], v[32:35]
    ds_read_b64_tr_b16 a[28:29], v27 offset:16640
    ds_read_b64_tr_b16 a[30:31], v27 offset:18688
    v_mfma_f32_16x16x32_bf16 v[40:43], a[0:3], a[220:223], v[40:43]
    v_mul_f32 v6, s4, v6
    v_mul_f32 v7, s4, v7
    v_mfma_f32_16x16x32_bf16 v[48:51], a[4:7], a[216:219], v[48:51]
    ds_read_b64_tr_b16 a[32:33], v17 offset:16384
    ds_read_b64_tr_b16 a[34:35], v17 offset:18432
    v_mfma_f32_16x16x32_bf16 v[56:59], a[4:7], a[220:223], v[56:59]
    buffer_load_dwordx4 v13, s[12:15], s40 offen offset:3072 lds
    s_add_u32 s40, s40, 262144
    v_mfma_f32_16x16x32_bf16 v[64:67], a[8:11], a[216:219], v[64:67]
    ds_read_b64_tr_b16 a[36:37], v19 offset:16384
    ds_read_b64_tr_b16 a[38:39], v19 offset:18432
    v_mfma_f32_16x16x32_bf16 v[72:75], a[8:11], a[220:223], v[72:75]
    v_mul_f32 v8, s4, v8
    v_mul_f32 v9, s4, v9
    v_mfma_f32_16x16x32_bf16 v[80:83], a[12:15], a[216:219], v[80:83]
    ds_read_b64_tr_b16 a[40:41], v21 offset:16384
    ds_read_b64_tr_b16 a[42:43], v21 offset:18432
    v_mfma_f32_16x16x32_bf16 v[88:91], a[12:15], a[220:223], v[88:91]
    v_cvt_pk_bf16_f32 v2, v2, v3
    s_waitcnt lgkmcnt(6)
    v_mfma_f32_16x16x32_bf16 v[96:99], a[16:19], a[216:219], v[96:99]
    ds_read_b64_tr_b16 a[44:45], v31 offset:16384
    ds_read_b64_tr_b16 a[46:47], v31 offset:18432
    v_mfma_f32_16x16x32_bf16 v[104:107], a[16:19], a[220:223], v[104:107]
    v_cvt_pk_bf16_f32 v4, v4, v5
    v_cvt_pk_bf16_f32 v6, v6, v7
    v_mfma_f32_16x16x32_bf16 v[112:115], a[20:23], a[216:219], v[112:115]
    ds_read_b64_tr_b16 a[48:49], v17 offset:16640
    ds_read_b64_tr_b16 a[50:51], v17 offset:18688
    v_mfma_f32_16x16x32_bf16 v[120:123], a[20:23], a[220:223], v[120:123]
    v_cvt_pk_bf16_f32 v8, v8, v9
    v_accvgpr_write_b32 a112, v2
    v_mfma_f32_16x16x32_bf16 v[128:131], a[24:27], a[216:219], v[128:131]
    ds_read_b64_tr_b16 a[52:53], v19 offset:16640
    ds_read_b64_tr_b16 a[54:55], v19 offset:18688
    v_mfma_f32_16x16x32_bf16 v[136:139], a[24:27], a[220:223], v[136:139]
    v_accvgpr_write_b32 a113, v4
    v_accvgpr_write_b32 a114, v6
    v_mfma_f32_16x16x32_bf16 v[144:147], a[28:31], a[216:219], v[144:147]
    ds_read_b64_tr_b16 a[56:57], v21 offset:16640
    ds_read_b64_tr_b16 a[58:59], v21 offset:18688
    v_mfma_f32_16x16x32_bf16 v[152:155], a[28:31], a[220:223], v[152:155]
    v_accvgpr_write_b32 a115, v8
    s_waitcnt lgkmcnt(6)
    v_mfma_f32_16x16x32_bf16 v[36:39], a[32:35], a[216:219], v[36:39]
    ds_read_b64_tr_b16 a[60:61], v31 offset:16640
    ds_read_b64_tr_b16 a[62:63], v31 offset:18688
    v_mfma_f32_16x16x32_bf16 v[44:47], a[32:35], a[220:223], v[44:47]
    v_accvgpr_read_b32 v2, a72
    v_accvgpr_read_b32 v3, a73
    v_mfma_f32_16x16x32_bf16 v[52:55], a[36:39], a[216:219], v[52:55]
    s_waitcnt vmcnt(16)
    s_barrier
    v_xor_b32 v16, 0x10000, v16
    v_xor_b32 v17, 0x10000, v17
    v_xor_b32 v18, 0x10000, v18
    v_xor_b32 v19, 0x10000, v19
    v_xor_b32 v20, 0x10000, v20
    v_xor_b32 v21, 0x10000, v21
    v_xor_b32 v27, 0x10000, v27
    v_xor_b32 v31, 0x10000, v31
    ds_read_b64_tr_b16 a[0:1], v16 offset:0
    ds_read_b64_tr_b16 a[2:3], v16 offset:2048
    v_mfma_f32_16x16x32_bf16 v[60:63], a[36:39], a[220:223], v[60:63]
    v_mfma_f32_16x16x32_bf16 v[68:71], a[40:43], a[216:219], v[68:71]
    ds_read_b64_tr_b16 a[4:5], v18 offset:0
    ds_read_b64_tr_b16 a[6:7], v18 offset:2048
    v_mfma_f32_16x16x32_bf16 v[76:79], a[40:43], a[220:223], v[76:79]
    v_accvgpr_read_b32 v4, a74
    v_accvgpr_read_b32 v5, a75
    v_mfma_f32_16x16x32_bf16 v[84:87], a[44:47], a[216:219], v[84:87]
    ds_read_b64_tr_b16 a[8:9], v20 offset:0
    ds_read_b64_tr_b16 a[10:11], v20 offset:2048
    v_mfma_f32_16x16x32_bf16 v[92:95], a[44:47], a[220:223], v[92:95]
    v_accvgpr_read_b32 v6, a76
    s_waitcnt lgkmcnt(6)
    v_mfma_f32_16x16x32_bf16 v[100:103], a[48:51], a[216:219], v[100:103]
    ds_read_b64_tr_b16 a[12:13], v27 offset:0
    ds_read_b64_tr_b16 a[14:15], v27 offset:2048
    v_mfma_f32_16x16x32_bf16 v[108:111], a[48:51], a[220:223], v[108:111]
    v_accvgpr_read_b32 v7, a77
    v_accvgpr_read_b32 v8, a78
    v_mfma_f32_16x16x32_bf16 v[116:119], a[52:55], a[216:219], v[116:119]
    ds_read_b64_tr_b16 a[16:17], v16 offset:256
    ds_read_b64_tr_b16 a[18:19], v16 offset:2304
    v_mfma_f32_16x16x32_bf16 v[124:127], a[52:55], a[220:223], v[124:127]
    v_accvgpr_read_b32 v9, a79
    v_mul_f32 v2, s4, v2
    v_mfma_f32_16x16x32_bf16 v[132:135], a[56:59], a[216:219], v[132:135]
    ds_read_b64_tr_b16 a[20:21], v18 offset:256
    ds_read_b64_tr_b16 a[22:23], v18 offset:2304
    v_mfma_f32_16x16x32_bf16 v[140:143], a[56:59], a[220:223], v[140:143]
    v_mul_f32 v3, s4, v3
    v_mul_f32 v4, s4, v4
    v_mfma_f32_16x16x32_bf16 v[148:151], a[60:63], a[216:219], v[148:151]
    ds_read_b64_tr_b16 a[24:25], v20 offset:256
    ds_read_b64_tr_b16 a[26:27], v20 offset:2304
    v_mfma_f32_16x16x32_bf16 v[156:159], a[60:63], a[220:223], v[156:159]
    v_mul_f32 v5, s4, v5
    s_waitcnt lgkmcnt(6)
    v_mfma_f32_16x16x32_bf16 v[32:35], a[0:3], a[160:163], v[32:35]
    ds_read_b64_tr_b16 a[28:29], v27 offset:256
    ds_read_b64_tr_b16 a[30:31], v27 offset:2304
    v_mfma_f32_16x16x32_bf16 v[40:43], a[0:3], a[164:167], v[40:43]
    v_mul_f32 v6, s4, v6
    v_mul_f32 v7, s4, v7
    v_mfma_f32_16x16x32_bf16 v[48:51], a[4:7], a[160:163], v[48:51]
    ds_read_b64_tr_b16 a[32:33], v17 offset:0
    ds_read_b64_tr_b16 a[34:35], v17 offset:2048
    v_mfma_f32_16x16x32_bf16 v[56:59], a[4:7], a[164:167], v[56:59]
    v_mul_f32 v8, s4, v8
    v_mul_f32 v9, s4, v9
    v_mfma_f32_16x16x32_bf16 v[64:67], a[8:11], a[160:163], v[64:67]
    ds_read_b64_tr_b16 a[36:37], v19 offset:0
    ds_read_b64_tr_b16 a[38:39], v19 offset:2048
    v_mfma_f32_16x16x32_bf16 v[72:75], a[8:11], a[164:167], v[72:75]
    v_cvt_pk_bf16_f32 v2, v2, v3
    v_cvt_pk_bf16_f32 v4, v4, v5
    v_mfma_f32_16x16x32_bf16 v[80:83], a[12:15], a[160:163], v[80:83]
    ds_read_b64_tr_b16 a[40:41], v21 offset:0
    ds_read_b64_tr_b16 a[42:43], v21 offset:2048
    v_mfma_f32_16x16x32_bf16 v[88:91], a[12:15], a[164:167], v[88:91]
    v_cvt_pk_bf16_f32 v6, v6, v7
    s_waitcnt lgkmcnt(6)
    v_mfma_f32_16x16x32_bf16 v[96:99], a[16:19], a[160:163], v[96:99]
    ds_read_b64_tr_b16 a[44:45], v31 offset:0
    ds_read_b64_tr_b16 a[46:47], v31 offset:2048
    v_mfma_f32_16x16x32_bf16 v[104:107], a[16:19], a[164:167], v[104:107]
    v_cvt_pk_bf16_f32 v8, v8, v9
    v_accvgpr_write_b32 a116, v2
    v_mfma_f32_16x16x32_bf16 v[112:115], a[20:23], a[160:163], v[112:115]
    ds_read_b64_tr_b16 a[48:49], v17 offset:256
    ds_read_b64_tr_b16 a[50:51], v17 offset:2304
    v_mfma_f32_16x16x32_bf16 v[120:123], a[20:23], a[164:167], v[120:123]
    v_accvgpr_write_b32 a117, v4
    v_accvgpr_write_b32 a118, v6
    v_mfma_f32_16x16x32_bf16 v[128:131], a[24:27], a[160:163], v[128:131]
    ds_read_b64_tr_b16 a[52:53], v19 offset:256
    ds_read_b64_tr_b16 a[54:55], v19 offset:2304
    v_mfma_f32_16x16x32_bf16 v[136:139], a[24:27], a[164:167], v[136:139]
    v_accvgpr_write_b32 a119, v8
    v_accvgpr_read_b32 v2, a80
    v_mfma_f32_16x16x32_bf16 v[144:147], a[28:31], a[160:163], v[144:147]
    ds_read_b64_tr_b16 a[56:57], v21 offset:256
    ds_read_b64_tr_b16 a[58:59], v21 offset:2304
    v_mfma_f32_16x16x32_bf16 v[152:155], a[28:31], a[164:167], v[152:155]
    v_accvgpr_read_b32 v3, a81
    s_waitcnt lgkmcnt(6)
    v_mfma_f32_16x16x32_bf16 v[36:39], a[32:35], a[160:163], v[36:39]
    ds_read_b64_tr_b16 a[60:61], v31 offset:256
    ds_read_b64_tr_b16 a[62:63], v31 offset:2304
    v_mfma_f32_16x16x32_bf16 v[44:47], a[32:35], a[164:167], v[44:47]
    v_accvgpr_read_b32 v4, a82
    v_accvgpr_read_b32 v5, a83
    v_mfma_f32_16x16x32_bf16 v[52:55], a[36:39], a[160:163], v[52:55]
    s_waitcnt vmcnt(10)
    s_barrier
    ds_read_b64_tr_b16 a[0:1], v16 offset:16384
    ds_read_b64_tr_b16 a[2:3], v16 offset:18432
    v_mfma_f32_16x16x32_bf16 v[60:63], a[36:39], a[164:167], v[60:63]
    v_mfma_f32_16x16x32_bf16 v[68:71], a[40:43], a[160:163], v[68:71]
    ds_read_b64_tr_b16 a[4:5], v18 offset:16384
    ds_read_b64_tr_b16 a[6:7], v18 offset:18432
    v_mfma_f32_16x16x32_bf16 v[76:79], a[40:43], a[164:167], v[76:79]
    v_accvgpr_read_b32 v6, a84
    v_accvgpr_read_b32 v7, a85
    v_mfma_f32_16x16x32_bf16 v[84:87], a[44:47], a[160:163], v[84:87]
    ds_read_b64_tr_b16 a[8:9], v20 offset:16384
    ds_read_b64_tr_b16 a[10:11], v20 offset:18432
    v_mfma_f32_16x16x32_bf16 v[92:95], a[44:47], a[164:167], v[92:95]
    v_accvgpr_read_b32 v8, a86
    s_waitcnt lgkmcnt(6)
    v_mfma_f32_16x16x32_bf16 v[100:103], a[48:51], a[160:163], v[100:103]
    ds_read_b64_tr_b16 a[12:13], v27 offset:16384
    ds_read_b64_tr_b16 a[14:15], v27 offset:18432
    v_mfma_f32_16x16x32_bf16 v[108:111], a[48:51], a[164:167], v[108:111]
    v_accvgpr_read_b32 v9, a87
    v_mul_f32 v2, s4, v2
    v_mfma_f32_16x16x32_bf16 v[116:119], a[52:55], a[160:163], v[116:119]
    ds_read_b64_tr_b16 a[16:17], v16 offset:16640
    ds_read_b64_tr_b16 a[18:19], v16 offset:18688
    v_mfma_f32_16x16x32_bf16 v[124:127], a[52:55], a[164:167], v[124:127]
    v_mul_f32 v3, s4, v3
    v_mul_f32 v4, s4, v4
    v_mfma_f32_16x16x32_bf16 v[132:135], a[56:59], a[160:163], v[132:135]
    ds_read_b64_tr_b16 a[20:21], v18 offset:16640
    ds_read_b64_tr_b16 a[22:23], v18 offset:18688
    v_mfma_f32_16x16x32_bf16 v[140:143], a[56:59], a[164:167], v[140:143]
    v_mul_f32 v5, s4, v5
    v_mul_f32 v6, s4, v6
    v_mfma_f32_16x16x32_bf16 v[148:151], a[60:63], a[160:163], v[148:151]
    ds_read_b64_tr_b16 a[24:25], v20 offset:16640
    ds_read_b64_tr_b16 a[26:27], v20 offset:18688
    v_mfma_f32_16x16x32_bf16 v[156:159], a[60:63], a[164:167], v[156:159]
    v_mul_f32 v7, s4, v7
    s_waitcnt lgkmcnt(6)
    v_mfma_f32_16x16x32_bf16 v[32:35], a[0:3], a[168:171], v[32:35]
    ds_read_b64_tr_b16 a[28:29], v27 offset:16640
    ds_read_b64_tr_b16 a[30:31], v27 offset:18688
    v_mfma_f32_16x16x32_bf16 v[40:43], a[0:3], a[172:175], v[40:43]
    v_mul_f32 v8, s4, v8
    v_mul_f32 v9, s4, v9
    v_mfma_f32_16x16x32_bf16 v[48:51], a[4:7], a[168:171], v[48:51]
    ds_read_b64_tr_b16 a[32:33], v17 offset:16384
    ds_read_b64_tr_b16 a[34:35], v17 offset:18432
    v_mfma_f32_16x16x32_bf16 v[56:59], a[4:7], a[172:175], v[56:59]
    v_cvt_pk_bf16_f32 v2, v2, v3
    v_cvt_pk_bf16_f32 v4, v4, v5
    v_mfma_f32_16x16x32_bf16 v[64:67], a[8:11], a[168:171], v[64:67]
    ds_read_b64_tr_b16 a[36:37], v19 offset:16384
    ds_read_b64_tr_b16 a[38:39], v19 offset:18432
    v_mfma_f32_16x16x32_bf16 v[72:75], a[8:11], a[172:175], v[72:75]
    v_cvt_pk_bf16_f32 v6, v6, v7
    v_cvt_pk_bf16_f32 v8, v8, v9
    v_mfma_f32_16x16x32_bf16 v[80:83], a[12:15], a[168:171], v[80:83]
    ds_read_b64_tr_b16 a[40:41], v21 offset:16384
    ds_read_b64_tr_b16 a[42:43], v21 offset:18432
    v_mfma_f32_16x16x32_bf16 v[88:91], a[12:15], a[172:175], v[88:91]
    v_accvgpr_write_b32 a120, v2
    s_waitcnt lgkmcnt(6)
    v_mfma_f32_16x16x32_bf16 v[96:99], a[16:19], a[168:171], v[96:99]
    ds_read_b64_tr_b16 a[44:45], v31 offset:16384
    ds_read_b64_tr_b16 a[46:47], v31 offset:18432
    v_mfma_f32_16x16x32_bf16 v[104:107], a[16:19], a[172:175], v[104:107]
    v_accvgpr_write_b32 a121, v4
    v_accvgpr_write_b32 a122, v6
    v_mfma_f32_16x16x32_bf16 v[112:115], a[20:23], a[168:171], v[112:115]
    ds_read_b64_tr_b16 a[48:49], v17 offset:16640
    ds_read_b64_tr_b16 a[50:51], v17 offset:18688
    v_mfma_f32_16x16x32_bf16 v[120:123], a[20:23], a[172:175], v[120:123]
    v_accvgpr_write_b32 a123, v8
    v_accvgpr_read_b32 v2, a88
    v_mfma_f32_16x16x32_bf16 v[128:131], a[24:27], a[168:171], v[128:131]
    ds_read_b64_tr_b16 a[52:53], v19 offset:16640
    ds_read_b64_tr_b16 a[54:55], v19 offset:18688
    v_mfma_f32_16x16x32_bf16 v[136:139], a[24:27], a[172:175], v[136:139]
    v_accvgpr_read_b32 v3, a89
    v_accvgpr_read_b32 v4, a90
    v_mfma_f32_16x16x32_bf16 v[144:147], a[28:31], a[168:171], v[144:147]
    ds_read_b64_tr_b16 a[56:57], v21 offset:16640
    ds_read_b64_tr_b16 a[58:59], v21 offset:18688
    v_mfma_f32_16x16x32_bf16 v[152:155], a[28:31], a[172:175], v[152:155]
    v_accvgpr_read_b32 v5, a91
    s_waitcnt lgkmcnt(6)
    v_mfma_f32_16x16x32_bf16 v[36:39], a[32:35], a[168:171], v[36:39]
    ds_read_b64_tr_b16 a[60:61], v31 offset:16640
    ds_read_b64_tr_b16 a[62:63], v31 offset:18688
    v_mfma_f32_16x16x32_bf16 v[44:47], a[32:35], a[172:175], v[44:47]
    v_accvgpr_read_b32 v6, a92
    v_accvgpr_read_b32 v7, a93
    v_mfma_f32_16x16x32_bf16 v[52:55], a[36:39], a[168:171], v[52:55]
    s_waitcnt vmcnt(4)
    s_barrier
    ds_read_b64_tr_b16 a[0:1], v16 offset:32768
    ds_read_b64_tr_b16 a[2:3], v16 offset:34816
    v_mfma_f32_16x16x32_bf16 v[60:63], a[36:39], a[172:175], v[60:63]
    v_mfma_f32_16x16x32_bf16 v[68:71], a[40:43], a[168:171], v[68:71]
    ds_read_b64_tr_b16 a[4:5], v18 offset:32768
    ds_read_b64_tr_b16 a[6:7], v18 offset:34816
    v_mfma_f32_16x16x32_bf16 v[76:79], a[40:43], a[172:175], v[76:79]
    v_accvgpr_read_b32 v8, a94
    v_accvgpr_read_b32 v9, a95
    v_mfma_f32_16x16x32_bf16 v[84:87], a[44:47], a[168:171], v[84:87]
    ds_read_b64_tr_b16 a[8:9], v20 offset:32768
    ds_read_b64_tr_b16 a[10:11], v20 offset:34816
    v_mfma_f32_16x16x32_bf16 v[92:95], a[44:47], a[172:175], v[92:95]
    v_mul_f32 v2, s4, v2
    s_waitcnt lgkmcnt(6)
    v_mfma_f32_16x16x32_bf16 v[100:103], a[48:51], a[168:171], v[100:103]
    ds_read_b64_tr_b16 a[12:13], v27 offset:32768
    ds_read_b64_tr_b16 a[14:15], v27 offset:34816
    v_mfma_f32_16x16x32_bf16 v[108:111], a[48:51], a[172:175], v[108:111]
    v_mul_f32 v3, s4, v3
    v_mul_f32 v4, s4, v4
    v_mfma_f32_16x16x32_bf16 v[116:119], a[52:55], a[168:171], v[116:119]
    ds_read_b64_tr_b16 a[16:17], v16 offset:33024
    ds_read_b64_tr_b16 a[18:19], v16 offset:35072
    v_mfma_f32_16x16x32_bf16 v[124:127], a[52:55], a[172:175], v[124:127]
    v_mul_f32 v5, s4, v5
    v_mul_f32 v6, s4, v6
    v_mfma_f32_16x16x32_bf16 v[132:135], a[56:59], a[168:171], v[132:135]
    ds_read_b64_tr_b16 a[20:21], v18 offset:33024
    ds_read_b64_tr_b16 a[22:23], v18 offset:35072
    v_mfma_f32_16x16x32_bf16 v[140:143], a[56:59], a[172:175], v[140:143]
    v_mul_f32 v7, s4, v7
    v_mul_f32 v8, s4, v8
    v_mfma_f32_16x16x32_bf16 v[148:151], a[60:63], a[168:171], v[148:151]
    ds_read_b64_tr_b16 a[24:25], v20 offset:33024
    ds_read_b64_tr_b16 a[26:27], v20 offset:35072
    v_mfma_f32_16x16x32_bf16 v[156:159], a[60:63], a[172:175], v[156:159]
    v_mul_f32 v9, s4, v9
    s_waitcnt lgkmcnt(6)
    v_mfma_f32_16x16x32_bf16 v[32:35], a[0:3], a[176:179], v[32:35]
    ds_read_b64_tr_b16 a[28:29], v27 offset:33024
    ds_read_b64_tr_b16 a[30:31], v27 offset:35072
    v_mfma_f32_16x16x32_bf16 v[40:43], a[0:3], a[180:183], v[40:43]
    v_cvt_pk_bf16_f32 v2, v2, v3
    v_cvt_pk_bf16_f32 v4, v4, v5
    v_mfma_f32_16x16x32_bf16 v[48:51], a[4:7], a[176:179], v[48:51]
    ds_read_b64_tr_b16 a[32:33], v17 offset:32768
    ds_read_b64_tr_b16 a[34:35], v17 offset:34816
    v_mfma_f32_16x16x32_bf16 v[56:59], a[4:7], a[180:183], v[56:59]
    v_cvt_pk_bf16_f32 v6, v6, v7
    v_cvt_pk_bf16_f32 v8, v8, v9
    v_mfma_f32_16x16x32_bf16 v[64:67], a[8:11], a[176:179], v[64:67]
    ds_read_b64_tr_b16 a[36:37], v19 offset:32768
    ds_read_b64_tr_b16 a[38:39], v19 offset:34816
    v_mfma_f32_16x16x32_bf16 v[72:75], a[8:11], a[180:183], v[72:75]
    v_accvgpr_write_b32 a124, v2
    v_accvgpr_write_b32 a125, v4
    v_mfma_f32_16x16x32_bf16 v[80:83], a[12:15], a[176:179], v[80:83]
    ds_read_b64_tr_b16 a[40:41], v21 offset:32768
    ds_read_b64_tr_b16 a[42:43], v21 offset:34816
    v_mfma_f32_16x16x32_bf16 v[88:91], a[12:15], a[180:183], v[88:91]
    v_accvgpr_write_b32 a126, v6
    s_waitcnt lgkmcnt(6)
    v_mfma_f32_16x16x32_bf16 v[96:99], a[16:19], a[176:179], v[96:99]
    ds_read_b64_tr_b16 a[44:45], v31 offset:32768
    ds_read_b64_tr_b16 a[46:47], v31 offset:34816
    v_mfma_f32_16x16x32_bf16 v[104:107], a[16:19], a[180:183], v[104:107]
    v_accvgpr_write_b32 a127, v8
    v_mul_f32 v160, s4, v160
    v_mfma_f32_16x16x32_bf16 v[112:115], a[20:23], a[176:179], v[112:115]
    ds_read_b64_tr_b16 a[48:49], v17 offset:33024
    ds_read_b64_tr_b16 a[50:51], v17 offset:35072
    v_mfma_f32_16x16x32_bf16 v[120:123], a[20:23], a[180:183], v[120:123]
    v_mul_f32 v161, s4, v161
    v_mul_f32 v162, s4, v162
    v_mfma_f32_16x16x32_bf16 v[128:131], a[24:27], a[176:179], v[128:131]
    ds_read_b64_tr_b16 a[52:53], v19 offset:33024
    ds_read_b64_tr_b16 a[54:55], v19 offset:35072
    v_mfma_f32_16x16x32_bf16 v[136:139], a[24:27], a[180:183], v[136:139]
    v_mul_f32 v163, s4, v163
    v_mul_f32 v164, s4, v164
    v_mfma_f32_16x16x32_bf16 v[144:147], a[28:31], a[176:179], v[144:147]
    ds_read_b64_tr_b16 a[56:57], v21 offset:33024
    ds_read_b64_tr_b16 a[58:59], v21 offset:35072
    v_mfma_f32_16x16x32_bf16 v[152:155], a[28:31], a[180:183], v[152:155]
    v_mul_f32 v165, s4, v165
    s_waitcnt lgkmcnt(6)
    v_mfma_f32_16x16x32_bf16 v[36:39], a[32:35], a[176:179], v[36:39]
    ds_read_b64_tr_b16 a[60:61], v31 offset:33024
    ds_read_b64_tr_b16 a[62:63], v31 offset:35072
    v_mfma_f32_16x16x32_bf16 v[44:47], a[32:35], a[180:183], v[44:47]
    v_mul_f32 v166, s4, v166
    v_mul_f32 v167, s4, v167
    v_mfma_f32_16x16x32_bf16 v[52:55], a[36:39], a[176:179], v[52:55]
    s_waitcnt vmcnt(0)
    s_barrier
    ds_read_b64_tr_b16 a[0:1], v16 offset:49152
    ds_read_b64_tr_b16 a[2:3], v16 offset:51200
    v_mfma_f32_16x16x32_bf16 v[60:63], a[36:39], a[180:183], v[60:63]
    v_mfma_f32_16x16x32_bf16 v[68:71], a[40:43], a[176:179], v[68:71]
    ds_read_b64_tr_b16 a[4:5], v18 offset:49152
    ds_read_b64_tr_b16 a[6:7], v18 offset:51200
    v_mfma_f32_16x16x32_bf16 v[76:79], a[40:43], a[180:183], v[76:79]
    v_mul_f32 v168, s4, v168
    v_mul_f32 v169, s4, v169
    v_mfma_f32_16x16x32_bf16 v[84:87], a[44:47], a[176:179], v[84:87]
    ds_read_b64_tr_b16 a[8:9], v20 offset:49152
    ds_read_b64_tr_b16 a[10:11], v20 offset:51200
    v_mfma_f32_16x16x32_bf16 v[92:95], a[44:47], a[180:183], v[92:95]
    v_mul_f32 v170, s4, v170
    s_waitcnt lgkmcnt(6)
    v_mfma_f32_16x16x32_bf16 v[100:103], a[48:51], a[176:179], v[100:103]
    ds_read_b64_tr_b16 a[12:13], v27 offset:49152
    ds_read_b64_tr_b16 a[14:15], v27 offset:51200
    v_mfma_f32_16x16x32_bf16 v[108:111], a[48:51], a[180:183], v[108:111]
    v_mul_f32 v171, s4, v171
    v_mul_f32 v172, s4, v172
    v_mfma_f32_16x16x32_bf16 v[116:119], a[52:55], a[176:179], v[116:119]
    ds_read_b64_tr_b16 a[16:17], v16 offset:49408
    ds_read_b64_tr_b16 a[18:19], v16 offset:51456
    v_mfma_f32_16x16x32_bf16 v[124:127], a[52:55], a[180:183], v[124:127]
    v_mul_f32 v173, s4, v173
    v_mul_f32 v174, s4, v174
    v_mfma_f32_16x16x32_bf16 v[132:135], a[56:59], a[176:179], v[132:135]
    ds_read_b64_tr_b16 a[20:21], v18 offset:49408
    ds_read_b64_tr_b16 a[22:23], v18 offset:51456
    v_mfma_f32_16x16x32_bf16 v[140:143], a[56:59], a[180:183], v[140:143]
    v_mul_f32 v175, s4, v175
    v_cvt_pk_bf16_f32 v160, v160, v161
    v_mfma_f32_16x16x32_bf16 v[148:151], a[60:63], a[176:179], v[148:151]
    ds_read_b64_tr_b16 a[24:25], v20 offset:49408
    ds_read_b64_tr_b16 a[26:27], v20 offset:51456
    v_mfma_f32_16x16x32_bf16 v[156:159], a[60:63], a[180:183], v[156:159]
    v_cvt_pk_bf16_f32 v162, v162, v163
    s_waitcnt lgkmcnt(6)
    v_mfma_f32_16x16x32_bf16 v[32:35], a[0:3], a[184:187], v[32:35]
    ds_read_b64_tr_b16 a[28:29], v27 offset:49408
    ds_read_b64_tr_b16 a[30:31], v27 offset:51456
    v_mfma_f32_16x16x32_bf16 v[40:43], a[0:3], a[188:191], v[40:43]
    v_cvt_pk_bf16_f32 v164, v164, v165
    v_cvt_pk_bf16_f32 v166, v166, v167
    v_mfma_f32_16x16x32_bf16 v[48:51], a[4:7], a[184:187], v[48:51]
    ds_read_b64_tr_b16 a[32:33], v17 offset:49152
    ds_read_b64_tr_b16 a[34:35], v17 offset:51200
    v_mfma_f32_16x16x32_bf16 v[56:59], a[4:7], a[188:191], v[56:59]
    v_cvt_pk_bf16_f32 v168, v168, v169
    v_cvt_pk_bf16_f32 v170, v170, v171
    v_mfma_f32_16x16x32_bf16 v[64:67], a[8:11], a[184:187], v[64:67]
    ds_read_b64_tr_b16 a[36:37], v19 offset:49152
    ds_read_b64_tr_b16 a[38:39], v19 offset:51200
    v_mfma_f32_16x16x32_bf16 v[72:75], a[8:11], a[188:191], v[72:75]
    v_cvt_pk_bf16_f32 v172, v172, v173
    v_cvt_pk_bf16_f32 v174, v174, v175
    v_mfma_f32_16x16x32_bf16 v[80:83], a[12:15], a[184:187], v[80:83]
    ds_read_b64_tr_b16 a[40:41], v21 offset:49152
    ds_read_b64_tr_b16 a[42:43], v21 offset:51200
    v_mfma_f32_16x16x32_bf16 v[88:91], a[12:15], a[188:191], v[88:91]
    v_accvgpr_write_b32 a64, v160
    s_waitcnt lgkmcnt(6)
    v_mfma_f32_16x16x32_bf16 v[96:99], a[16:19], a[184:187], v[96:99]
    ds_read_b64_tr_b16 a[44:45], v31 offset:49152
    ds_read_b64_tr_b16 a[46:47], v31 offset:51200
    v_mfma_f32_16x16x32_bf16 v[104:107], a[16:19], a[188:191], v[104:107]
    buffer_load_dword v30, v29, s[24:27], s3 offen sc1
    v_accvgpr_write_b32 a65, v162
    v_mfma_f32_16x16x32_bf16 v[112:115], a[20:23], a[184:187], v[112:115]
    ds_read_b64_tr_b16 a[48:49], v17 offset:49408
    ds_read_b64_tr_b16 a[50:51], v17 offset:51456
    v_mfma_f32_16x16x32_bf16 v[120:123], a[20:23], a[188:191], v[120:123]
    v_accvgpr_write_b32 a66, v164
    v_accvgpr_write_b32 a67, v166
    v_mfma_f32_16x16x32_bf16 v[128:131], a[24:27], a[184:187], v[128:131]
    ds_read_b64_tr_b16 a[52:53], v19 offset:49408
    ds_read_b64_tr_b16 a[54:55], v19 offset:51456
    v_mfma_f32_16x16x32_bf16 v[136:139], a[24:27], a[188:191], v[136:139]
    v_accvgpr_write_b32 a68, v168
    v_accvgpr_write_b32 a69, v170
    v_mfma_f32_16x16x32_bf16 v[144:147], a[28:31], a[184:187], v[144:147]
    ds_read_b64_tr_b16 a[56:57], v21 offset:49408
    ds_read_b64_tr_b16 a[58:59], v21 offset:51456
    v_mfma_f32_16x16x32_bf16 v[152:155], a[28:31], a[188:191], v[152:155]
    v_accvgpr_write_b32 a70, v172
    s_waitcnt lgkmcnt(6)
    v_mfma_f32_16x16x32_bf16 v[36:39], a[32:35], a[184:187], v[36:39]
    ds_read_b64_tr_b16 a[60:61], v31 offset:49408
    ds_read_b64_tr_b16 a[62:63], v31 offset:51456
    v_mfma_f32_16x16x32_bf16 v[44:47], a[32:35], a[188:191], v[44:47]
    v_accvgpr_write_b32 a71, v174
    v_mul_f32 v176, s4, v176
    v_mfma_f32_16x16x32_bf16 v[52:55], a[36:39], a[184:187], v[52:55]
    v_mfma_f32_16x16x32_bf16 v[60:63], a[36:39], a[188:191], v[60:63]
    v_mul_f32 v177, s4, v177
    v_mul_f32 v178, s4, v178
    v_mul_f32 v179, s4, v179
    v_mul_f32 v180, s4, v180
    v_mfma_f32_16x16x32_bf16 v[68:71], a[40:43], a[184:187], v[68:71]
    v_mfma_f32_16x16x32_bf16 v[76:79], a[40:43], a[188:191], v[76:79]
    v_mul_f32 v181, s4, v181
    v_mul_f32 v182, s4, v182
    v_mul_f32 v183, s4, v183
    v_mul_f32 v184, s4, v184
    v_mfma_f32_16x16x32_bf16 v[84:87], a[44:47], a[184:187], v[84:87]
    v_mfma_f32_16x16x32_bf16 v[92:95], a[44:47], a[188:191], v[92:95]
    v_mul_f32 v185, s4, v185
    v_mul_f32 v186, s4, v186
    v_mul_f32 v187, s4, v187
    s_waitcnt lgkmcnt(0)
    v_mfma_f32_16x16x32_bf16 v[100:103], a[48:51], a[184:187], v[100:103]
    v_mfma_f32_16x16x32_bf16 v[108:111], a[48:51], a[188:191], v[108:111]
    v_mul_f32 v188, s4, v188
    v_mul_f32 v189, s4, v189
    v_mul_f32 v190, s4, v190
    v_mul_f32 v191, s4, v191
    v_mfma_f32_16x16x32_bf16 v[116:119], a[52:55], a[184:187], v[116:119]
    v_mfma_f32_16x16x32_bf16 v[124:127], a[52:55], a[188:191], v[124:127]
    v_cvt_pk_bf16_f32 v176, v176, v177
    v_cvt_pk_bf16_f32 v178, v178, v179
    v_cvt_pk_bf16_f32 v180, v180, v181
    v_cvt_pk_bf16_f32 v182, v182, v183
    v_mfma_f32_16x16x32_bf16 v[132:135], a[56:59], a[184:187], v[132:135]
    v_mfma_f32_16x16x32_bf16 v[140:143], a[56:59], a[188:191], v[140:143]
    v_cvt_pk_bf16_f32 v184, v184, v185
    v_cvt_pk_bf16_f32 v186, v186, v187
    v_cvt_pk_bf16_f32 v188, v188, v189
    v_cvt_pk_bf16_f32 v190, v190, v191
    v_mfma_f32_16x16x32_bf16 v[148:151], a[60:63], a[184:187], v[148:151]
    v_mfma_f32_16x16x32_bf16 v[156:159], a[60:63], a[188:191], v[156:159]
    v_accvgpr_write_b32 a72, v176
    v_accvgpr_write_b32 a73, v178
    v_accvgpr_write_b32 a74, v180
    v_accvgpr_write_b32 a75, v182
    v_accvgpr_write_b32 a76, v184
    v_accvgpr_write_b32 a77, v186
    v_accvgpr_write_b32 a78, v188
    v_accvgpr_write_b32 a79, v190
    v_mul_f32 v192, s4, v192
    v_mul_f32 v193, s4, v193
    v_mul_f32 v194, s4, v194
    v_mul_f32 v195, s4, v195
    v_mul_f32 v196, s4, v196
    v_mul_f32 v197, s4, v197
    v_mul_f32 v198, s4, v198
    v_mul_f32 v199, s4, v199
    v_mul_f32 v200, s4, v200
    v_mul_f32 v201, s4, v201
    v_mul_f32 v202, s4, v202
    v_mul_f32 v203, s4, v203
    v_mul_f32 v204, s4, v204
    v_mul_f32 v205, s4, v205
    v_mul_f32 v206, s4, v206
    v_mul_f32 v207, s4, v207
    v_cvt_pk_bf16_f32 v192, v192, v193
    v_cvt_pk_bf16_f32 v194, v194, v195
    v_cvt_pk_bf16_f32 v196, v196, v197
    v_cvt_pk_bf16_f32 v198, v198, v199
    v_cvt_pk_bf16_f32 v200, v200, v201
    v_cvt_pk_bf16_f32 v202, v202, v203
    v_cvt_pk_bf16_f32 v204, v204, v205
    v_cvt_pk_bf16_f32 v206, v206, v207
    v_accvgpr_write_b32 a80, v192
    v_accvgpr_write_b32 a81, v194
    v_accvgpr_write_b32 a82, v196
    v_accvgpr_write_b32 a83, v198
    v_accvgpr_write_b32 a84, v200
    v_accvgpr_write_b32 a85, v202
    v_accvgpr_write_b32 a86, v204
    v_accvgpr_write_b32 a87, v206
    v_mul_f32 v208, s4, v208
    v_mul_f32 v209, s4, v209
    v_mul_f32 v210, s4, v210
    v_mul_f32 v211, s4, v211
    v_mul_f32 v212, s4, v212
    v_mul_f32 v213, s4, v213
    v_mul_f32 v214, s4, v214
    v_mul_f32 v215, s4, v215
    v_mul_f32 v216, s4, v216
    v_mul_f32 v217, s4, v217
    v_mul_f32 v218, s4, v218
    v_mul_f32 v219, s4, v219
    v_mul_f32 v220, s4, v220
    v_mul_f32 v221, s4, v221
    v_mul_f32 v222, s4, v222
    v_mul_f32 v223, s4, v223
    v_cvt_pk_bf16_f32 v208, v208, v209
    v_cvt_pk_bf16_f32 v210, v210, v211
    v_cvt_pk_bf16_f32 v212, v212, v213
    v_cvt_pk_bf16_f32 v214, v214, v215
    v_cvt_pk_bf16_f32 v216, v216, v217
    v_cvt_pk_bf16_f32 v218, v218, v219
    v_cvt_pk_bf16_f32 v220, v220, v221
    v_cvt_pk_bf16_f32 v222, v222, v223
    v_accvgpr_write_b32 a88, v208
    v_accvgpr_write_b32 a89, v210
    v_accvgpr_write_b32 a90, v212
    v_accvgpr_write_b32 a91, v214
    v_accvgpr_write_b32 a92, v216
    v_accvgpr_write_b32 a93, v218
    v_accvgpr_write_b32 a94, v220
    v_accvgpr_write_b32 a95, v222
    v_mul_f32 v224, s4, v224
    v_mul_f32 v225, s4, v225
    v_mul_f32 v226, s4, v226
    v_mul_f32 v227, s4, v227
    v_mul_f32 v228, s4, v228
    v_mul_f32 v229, s4, v229
    v_mul_f32 v230, s4, v230
    v_mul_f32 v231, s4, v231
    v_mul_f32 v232, s4, v232
    v_mul_f32 v233, s4, v233
    v_mul_f32 v234, s4, v234
    v_mul_f32 v235, s4, v235
    v_mul_f32 v236, s4, v236
    v_mul_f32 v237, s4, v237
    v_mul_f32 v238, s4, v238
    v_mul_f32 v239, s4, v239
    v_cvt_pk_bf16_f32 v224, v224, v225
    v_cvt_pk_bf16_f32 v226, v226, v227
    v_cvt_pk_bf16_f32 v228, v228, v229
    v_cvt_pk_bf16_f32 v230, v230, v231
    v_cvt_pk_bf16_f32 v232, v232, v233
    v_cvt_pk_bf16_f32 v234, v234, v235
    v_cvt_pk_bf16_f32 v236, v236, v237
    v_cvt_pk_bf16_f32 v238, v238, v239
    v_accvgpr_write_b32 a96, v224
    v_accvgpr_write_b32 a97, v226
    v_accvgpr_write_b32 a98, v228
    v_accvgpr_write_b32 a99, v230
    v_accvgpr_write_b32 a100, v232
    v_accvgpr_write_b32 a101, v234
    v_accvgpr_write_b32 a102, v236
    v_accvgpr_write_b32 a103, v238
    v_mul_f32 v240, s4, v240
    v_mul_f32 v241, s4, v241
    v_mul_f32 v242, s4, v242
    v_mul_f32 v243, s4, v243
    v_mul_f32 v244, s4, v244
    v_mul_f32 v245, s4, v245
    v_mul_f32 v246, s4, v246
    v_mul_f32 v247, s4, v247
    v_mul_f32 v248, s4, v248
    v_mul_f32 v249, s4, v249
    v_mul_f32 v250, s4, v250
    v_mul_f32 v251, s4, v251
    v_mul_f32 v252, s4, v252
    v_mul_f32 v253, s4, v253
    v_mul_f32 v254, s4, v254
    v_mul_f32 v255, s4, v255
    v_cvt_pk_bf16_f32 v240, v240, v241
    v_cvt_pk_bf16_f32 v242, v242, v243
    v_cvt_pk_bf16_f32 v244, v244, v245
    v_cvt_pk_bf16_f32 v246, v246, v247
    v_cvt_pk_bf16_f32 v248, v248, v249
    v_cvt_pk_bf16_f32 v250, v250, v251
    v_cvt_pk_bf16_f32 v252, v252, v253
    v_cvt_pk_bf16_f32 v254, v254, v255
    v_accvgpr_write_b32 a104, v240
    v_accvgpr_write_b32 a105, v242
    v_accvgpr_write_b32 a106, v244
    v_accvgpr_write_b32 a107, v246
    v_accvgpr_write_b32 a108, v248
    v_accvgpr_write_b32 a109, v250
    v_accvgpr_write_b32 a110, v252
    v_accvgpr_write_b32 a111, v254
    s_load_dwordx2 s[30:31], s[0:1], 40
    s_load_dwordx2 s[100:101], s[0:1], 64
    s_mov_b32 s42, 32768
    s_mov_b32 s43, 16384
    s_lshl_b32 s44, s36, 12
    s_add_u32 s45, s44, 65536
    s_mov_b32 s55, s45
    s_lshl_b32 s7, s79, 21
    s_add_u32 s7, s7, 2097152
    s_add_u32 s8, s34, s7
    s_addc_u32 s9, s35, 0
    s_mov_b32 s10, 2097152
    v_lshlrev_b32 v2, 4, v1
    v_add_u32 v3, s44, v2
    v_add_u32 v4, s44, v2
    v_add_u32 v5, s44, v2
    v_add_u32 v6, s44, v2
    s_mov_b32 s6, 0
L_k2_kvpD:
    s_waitcnt vmcnt(0)
    v_readfirstlane_b32 s7, v30
    s_nop 3
    s_cmp_ge_u32 s7, 16
    s_cbranch_scc1 L_k2_kvokD
    buffer_load_dword v30, v29, s[24:27], s3 offen sc1
    s_add_u32 s6, s6, 1
    s_cmp_lt_u32 s6, 0x80000
    s_cbranch_scc1 L_k2_kvpD
L_k2_kvokD:
    s_barrier
    s_mov_b32 m0, s44
    s_nop 0
    buffer_load_dwordx4 v3, s[8:11], s73 offen offset:0 sc1 lds
    v_pk_mul_f32 v[32:33], v[32:33], s[4:5]
    v_pk_mul_f32 v[34:35], v[34:35], s[4:5]
    v_pk_mul_f32 v[36:37], v[36:37], s[4:5]
    v_pk_mul_f32 v[38:39], v[38:39], s[4:5]
    v_pk_mul_f32 v[40:41], v[40:41], s[4:5]
    v_pk_mul_f32 v[42:43], v[42:43], s[4:5]
    v_pk_mul_f32 v[44:45], v[44:45], s[4:5]
    v_pk_mul_f32 v[46:47], v[46:47], s[4:5]
    v_cvt_pk_bf16_f32 v32, v32, v33
    v_cvt_pk_bf16_f32 v34, v34, v35
    v_cvt_pk_bf16_f32 v36, v36, v37
    buffer_load_dwordx4 v4, s[8:11], s73 offen offset:1024 sc1 lds
    v_cvt_pk_bf16_f32 v38, v38, v39
    v_cvt_pk_bf16_f32 v40, v40, v41
    v_cvt_pk_bf16_f32 v42, v42, v43
    v_cvt_pk_bf16_f32 v44, v44, v45
    v_cvt_pk_bf16_f32 v46, v46, v47
    v_accvgpr_write_b32 a0, v32
    v_accvgpr_write_b32 a1, v34
    v_accvgpr_write_b32 a2, v36
    v_accvgpr_write_b32 a3, v38
    v_accvgpr_write_b32 a4, v40
    v_accvgpr_write_b32 a5, v42
    buffer_load_dwordx4 v5, s[8:11], s73 offen offset:2048 sc1 lds
    v_accvgpr_write_b32 a6, v44
    v_accvgpr_write_b32 a7, v46
    v_pk_mul_f32 v[48:49], v[48:49], s[4:5]
    v_pk_mul_f32 v[50:51], v[50:51], s[4:5]
    v_pk_mul_f32 v[52:53], v[52:53], s[4:5]
    v_pk_mul_f32 v[54:55], v[54:55], s[4:5]
    v_pk_mul_f32 v[56:57], v[56:57], s[4:5]
    v_pk_mul_f32 v[58:59], v[58:59], s[4:5]
    v_pk_mul_f32 v[60:61], v[60:61], s[4:5]
    v_pk_mul_f32 v[62:63], v[62:63], s[4:5]
    v_cvt_pk_bf16_f32 v48, v48, v49
    buffer_load_dwordx4 v6, s[8:11], s73 offen offset:3072 sc1 lds
    v_cvt_pk_bf16_f32 v50, v50, v51
    v_cvt_pk_bf16_f32 v52, v52, v53
    v_cvt_pk_bf16_f32 v54, v54, v55
    v_cvt_pk_bf16_f32 v56, v56, v57
    v_cvt_pk_bf16_f32 v58, v58, v59
    v_cvt_pk_bf16_f32 v60, v60, v61
    v_cvt_pk_bf16_f32 v62, v62, v63
    v_accvgpr_write_b32 a8, v48
    v_accvgpr_write_b32 a9, v50
    v_accvgpr_write_b32 a10, v52
    v_accvgpr_write_b32 a11, v54
    s_mov_b32 m0, s45
    s_nop 0
    buffer_load_dwordx4 v3, s[8:11], s74 offen offset:0 sc1 lds
    v_accvgpr_write_b32 a12, v56
    v_accvgpr_write_b32 a13, v58
    v_accvgpr_write_b32 a14, v60
    v_accvgpr_write_b32 a15, v62
    v_pk_mul_f32 v[64:65], v[64:65], s[4:5]
    v_pk_mul_f32 v[66:67], v[66:67], s[4:5]
    v_pk_mul_f32 v[68:69], v[68:69], s[4:5]
    v_pk_mul_f32 v[70:71], v[70:71], s[4:5]
    v_pk_mul_f32 v[72:73], v[72:73], s[4:5]
    v_pk_mul_f32 v[74:75], v[74:75], s[4:5]
    v_pk_mul_f32 v[76:77], v[76:77], s[4:5]
    buffer_load_dwordx4 v4, s[8:11], s74 offen offset:1024 sc1 lds
    v_pk_mul_f32 v[78:79], v[78:79], s[4:5]
    v_cvt_pk_bf16_f32 v64, v64, v65
    v_cvt_pk_bf16_f32 v66, v66, v67
    v_cvt_pk_bf16_f32 v68, v68, v69
    v_cvt_pk_bf16_f32 v70, v70, v71
    v_cvt_pk_bf16_f32 v72, v72, v73
    v_cvt_pk_bf16_f32 v74, v74, v75
    v_cvt_pk_bf16_f32 v76, v76, v77
    v_cvt_pk_bf16_f32 v78, v78, v79
    v_accvgpr_write_b32 a16, v64
    v_accvgpr_write_b32 a17, v66
    buffer_load_dwordx4 v5, s[8:11], s74 offen offset:2048 sc1 lds
    v_accvgpr_write_b32 a18, v68
    v_accvgpr_write_b32 a19, v70
    v_accvgpr_write_b32 a20, v72
    v_accvgpr_write_b32 a21, v74
    v_accvgpr_write_b32 a22, v76
    v_accvgpr_write_b32 a23, v78
    v_pk_mul_f32 v[80:81], v[80:81], s[4:5]
    v_pk_mul_f32 v[82:83], v[82:83], s[4:5]
    v_pk_mul_f32 v[84:85], v[84:85], s[4:5]
    v_pk_mul_f32 v[86:87], v[86:87], s[4:5]
    v_pk_mul_f32 v[88:89], v[88:89], s[4:5]
    buffer_load_dwordx4 v6, s[8:11], s74 offen offset:3072 sc1 lds
    v_pk_mul_f32 v[90:91], v[90:91], s[4:5]
    v_pk_mul_f32 v[92:93], v[92:93], s[4:5]
    v_pk_mul_f32 v[94:95], v[94:95], s[4:5]
    v_cvt_pk_bf16_f32 v80, v80, v81
    v_cvt_pk_bf16_f32 v82, v82, v83
    v_cvt_pk_bf16_f32 v84, v84, v85
    v_cvt_pk_bf16_f32 v86, v86, v87
    v_cvt_pk_bf16_f32 v88, v88, v89
    v_cvt_pk_bf16_f32 v90, v90, v91
    v_cvt_pk_bf16_f32 v92, v92, v93
    v_cvt_pk_bf16_f32 v94, v94, v95
    s_add_u32 s73, s73, s42
    s_cmp_eq_u32 s73, s72
    s_cselect_b32 s73, 0, s73
    s_add_u32 s74, s73, s43
    s_add_u32 m0, s44, 16384
    s_nop 0
    buffer_load_dwordx4 v3, s[8:11], s73 offen offset:0 sc1 lds
    v_accvgpr_write_b32 a24, v80
    v_accvgpr_write_b32 a25, v82
    v_accvgpr_write_b32 a26, v84
    v_accvgpr_write_b32 a27, v86
    v_accvgpr_write_b32 a28, v88
    v_accvgpr_write_b32 a29, v90
    v_accvgpr_write_b32 a30, v92
    v_accvgpr_write_b32 a31, v94
    v_pk_mul_f32 v[96:97], v[96:97], s[4:5]
    v_pk_mul_f32 v[98:99], v[98:99], s[4:5]
    v_pk_mul_f32 v[100:101], v[100:101], s[4:5]
    buffer_load_dwordx4 v4, s[8:11], s73 offen offset:1024 sc1 lds
    v_pk_mul_f32 v[102:103], v[102:103], s[4:5]
    v_pk_mul_f32 v[104:105], v[104:105], s[4:5]
    v_pk_mul_f32 v[106:107], v[106:107], s[4:5]
    v_pk_mul_f32 v[108:109], v[108:109], s[4:5]
    v_pk_mul_f32 v[110:111], v[110:111], s[4:5]
    v_cvt_pk_bf16_f32 v96, v96, v97
    v_cvt_pk_bf16_f32 v98, v98, v99
    v_cvt_pk_bf16_f32 v100, v100, v101
    v_cvt_pk_bf16_f32 v102, v102, v103
    v_cvt_pk_bf16_f32 v104, v104, v105
    v_cvt_pk_bf16_f32 v106, v106, v107
    buffer_load_dwordx4 v5, s[8:11], s73 offen offset:2048 sc1 lds
    v_cvt_pk_bf16_f32 v108, v108, v109
    v_cvt_pk_bf16_f32 v110, v110, v111
    v_accvgpr_write_b32 a32, v96
    v_accvgpr_write_b32 a33, v98
    v_accvgpr_write_b32 a34, v100
    v_accvgpr_write_b32 a35, v102
    v_accvgpr_write_b32 a36, v104
    v_accvgpr_write_b32 a37, v106
    v_accvgpr_write_b32 a38, v108
    v_accvgpr_write_b32 a39, v110
    v_pk_mul_f32 v[112:113], v[112:113], s[4:5]
    buffer_load_dwordx4 v6, s[8:11], s73 offen offset:3072 sc1 lds
    v_pk_mul_f32 v[114:115], v[114:115], s[4:5]
    v_pk_mul_f32 v[116:117], v[116:117], s[4:5]
    v_pk_mul_f32 v[118:119], v[118:119], s[4:5]
    v_pk_mul_f32 v[120:121], v[120:121], s[4:5]
    v_pk_mul_f32 v[122:123], v[122:123], s[4:5]
    v_pk_mul_f32 v[124:125], v[124:125], s[4:5]
    v_pk_mul_f32 v[126:127], v[126:127], s[4:5]
    v_cvt_pk_bf16_f32 v112, v112, v113
    v_cvt_pk_bf16_f32 v114, v114, v115
    v_cvt_pk_bf16_f32 v116, v116, v117
    v_cvt_pk_bf16_f32 v118, v118, v119
    s_add_u32 m0, s45, 16384
    s_nop 0
    buffer_load_dwordx4 v3, s[8:11], s74 offen offset:0 sc1 lds
    v_cvt_pk_bf16_f32 v120, v120, v121
    v_cvt_pk_bf16_f32 v122, v122, v123
    v_cvt_pk_bf16_f32 v124, v124, v125
    v_cvt_pk_bf16_f32 v126, v126, v127
    v_accvgpr_write_b32 a40, v112
    v_accvgpr_write_b32 a41, v114
    v_accvgpr_write_b32 a42, v116
    v_accvgpr_write_b32 a43, v118
    v_accvgpr_write_b32 a44, v120
    v_accvgpr_write_b32 a45, v122
    v_accvgpr_write_b32 a46, v124
    buffer_load_dwordx4 v4, s[8:11], s74 offen offset:1024 sc1 lds
    v_accvgpr_write_b32 a47, v126
    v_pk_mul_f32 v[128:129], v[128:129], s[4:5]
    v_pk_mul_f32 v[130:131], v[130:131], s[4:5]
    v_pk_mul_f32 v[132:133], v[132:133], s[4:5]
    v_pk_mul_f32 v[134:135], v[134:135], s[4:5]
    v_pk_mul_f32 v[136:137], v[136:137], s[4:5]
    v_pk_mul_f32 v[138:139], v[138:139], s[4:5]
    v_pk_mul_f32 v[140:141], v[140:141], s[4:5]
    v_pk_mul_f32 v[142:143], v[142:143], s[4:5]
    v_cvt_pk_bf16_f32 v128, v128, v129
    v_cvt_pk_bf16_f32 v130, v130, v131
    buffer_load_dwordx4 v5, s[8:11], s74 offen offset:2048 sc1 lds
    v_cvt_pk_bf16_f32 v132, v132, v133
    v_cvt_pk_bf16_f32 v134, v134, v135
    v_cvt_pk_bf16_f32 v136, v136, v137
    v_cvt_pk_bf16_f32 v138, v138, v139
    v_cvt_pk_bf16_f32 v140, v140, v141
    v_cvt_pk_bf16_f32 v142, v142, v143
    v_accvgpr_write_b32 a48, v128
    v_accvgpr_write_b32 a49, v130
    v_accvgpr_write_b32 a50, v132
    v_accvgpr_write_b32 a51, v134
    v_accvgpr_write_b32 a52, v136
    buffer_load_dwordx4 v6, s[8:11], s74 offen offset:3072 sc1 lds
    v_accvgpr_write_b32 a53, v138
    v_accvgpr_write_b32 a54, v140
    v_accvgpr_write_b32 a55, v142
    v_pk_mul_f32 v[144:145], v[144:145], s[4:5]
    v_pk_mul_f32 v[146:147], v[146:147], s[4:5]
    v_pk_mul_f32 v[148:149], v[148:149], s[4:5]
    v_pk_mul_f32 v[150:151], v[150:151], s[4:5]
    v_pk_mul_f32 v[152:153], v[152:153], s[4:5]
    v_pk_mul_f32 v[154:155], v[154:155], s[4:5]
    v_pk_mul_f32 v[156:157], v[156:157], s[4:5]
    v_pk_mul_f32 v[158:159], v[158:159], s[4:5]
    s_add_u32 s73, s73, s42
    s_cmp_eq_u32 s73, s72
    s_cselect_b32 s73, 0, s73
    s_add_u32 s74, s73, s43
    s_xor_b32 s44, s44, 0x8000
    s_add_u32 s45, s45, 0x8000
    s_cmp_ge_u32 s45, 163840
    s_cselect_b32 s45, s55, s45
    s_mov_b32 m0, s44
    s_nop 0
    buffer_load_dwordx4 v3, s[8:11], s73 offen offset:0 sc1 lds
    v_cvt_pk_bf16_f32 v144, v144, v145
    v_cvt_pk_bf16_f32 v146, v146, v147
    v_cvt_pk_bf16_f32 v148, v148, v149
    v_cvt_pk_bf16_f32 v150, v150, v151
    v_cvt_pk_bf16_f32 v152, v152, v153
    v_cvt_pk_bf16_f32 v154, v154, v155
    v_cvt_pk_bf16_f32 v156, v156, v157
    v_cvt_pk_bf16_f32 v158, v158, v159
    v_accvgpr_write_b32 a56, v144
    v_accvgpr_write_b32 a57, v146
    v_accvgpr_write_b32 a58, v148
    buffer_load_dwordx4 v4, s[8:11], s73 offen offset:1024 sc1 lds
    v_accvgpr_write_b32 a59, v150
    v_accvgpr_write_b32 a60, v152
    v_accvgpr_write_b32 a61, v154
    v_accvgpr_write_b32 a62, v156
    v_accvgpr_write_b32 a63, v158
    s_mov_b32 s46, 65536
    v_mov_b32 v7, v2
    v_add_u32 v8, 65536, v2
    s_mov_b32 s47, 0x41c00000
    s_mov_b32 s37, 0
    s_mov_b32 s50, 0
    buffer_load_dwordx4 v5, s[8:11], s73 offen offset:2048 sc1 lds
    s_mov_b32 s51, 0
    v_mov_b64 v[24:25], 0
    v_mov_b64 v[26:27], 0
    v_mov_b64 v[28:29], 0
    v_mov_b64 v[30:31], 0
    buffer_load_dwordx4 v6, s[8:11], s73 offen offset:3072 sc1 lds
    s_branch L_k2_go
L_km_single:
    s_waitcnt lgkmcnt(6)
    v_mfma_f32_16x16x32_bf16 v[228:231], a[32:35], a[216:219], v[228:231]
    ds_read_b64_tr_b16 a[60:61], v25 offset:57344
    ds_read_b64_tr_b16 a[62:63], v25 offset:58368
    v_mfma_f32_16x16x32_bf16 v[236:239], a[32:35], a[220:223], v[236:239]
    v_mfma_f32_16x16x32_bf16 v[244:247], a[36:39], a[216:219], v[244:247]
    s_waitcnt vmcnt(39)
    s_barrier
    ds_read_b64_tr_b16 a[0:1], v16 offset:32768
    ds_read_b64_tr_b16 a[2:3], v16 offset:34816
    v_mfma_f32_16x16x32_bf16 v[252:255], a[36:39], a[220:223], v[252:255]
    v_mfma_f32_16x16x32_bf16 a[68:71], a[40:43], a[216:219], a[68:71]
    ds_read_b64_tr_b16 a[4:5], v18 offset:32768
    ds_read_b64_tr_b16 a[6:7], v18 offset:34816
    v_mfma_f32_16x16x32_bf16 a[76:79], a[40:43], a[220:223], a[76:79]
    s_add_u32 m0, s65, 0
    v_mfma_f32_16x16x32_bf16 a[84:87], a[44:47], a[216:219], a[84:87]
    ds_read_b64_tr_b16 a[8:9], v20 offset:32768
    ds_read_b64_tr_b16 a[10:11], v20 offset:34816
    v_mfma_f32_16x16x32_bf16 a[92:95], a[44:47], a[220:223], a[92:95]
    buffer_load_dwordx4 v10, s[12:15], s40 offen offset:0 lds
    s_waitcnt lgkmcnt(6)
    v_mfma_f32_16x16x32_bf16 a[100:103], a[48:51], a[216:219], a[100:103]
    ds_read_b64_tr_b16 a[12:13], v27 offset:32768
    ds_read_b64_tr_b16 a[14:15], v27 offset:34816
    v_mfma_f32_16x16x32_bf16 a[108:111], a[48:51], a[220:223], a[108:111]
    v_mfma_f32_16x16x32_bf16 a[116:119], a[52:55], a[216:219], a[116:119]
    ds_read_b64_tr_b16 a[16:17], v16 offset:33024
    ds_read_b64_tr_b16 a[18:19], v16 offset:35072
    v_mfma_f32_16x16x32_bf16 a[124:127], a[52:55], a[220:223], a[124:127]
    buffer_load_dwordx4 v11, s[12:15], s40 offen offset:1024 lds
    v_mfma_f32_16x16x32_bf16 a[132:135], a[56:59], a[216:219], a[132:135]
    ds_read_b64_tr_b16 a[20:21], v18 offset:33024
    ds_read_b64_tr_b16 a[22:23], v18 offset:35072
    v_mfma_f32_16x16x32_bf16 a[140:143], a[56:59], a[220:223], a[140:143]
    v_mfma_f32_16x16x32_bf16 a[148:151], a[60:63], a[216:219], a[148:151]
    ds_read_b64_tr_b16 a[24:25], v20 offset:33024
    ds_read_b64_tr_b16 a[26:27], v20 offset:35072
    v_mfma_f32_16x16x32_bf16 a[156:159], a[60:63], a[220:223], a[156:159]
    buffer_load_dwordx4 v12, s[12:15], s40 offen offset:2048 lds
    s_waitcnt lgkmcnt(6)
    v_mfma_f32_16x16x32_bf16 v[160:163], a[0:3], a[160:163], v[160:163]
    ds_read_b64_tr_b16 a[28:29], v27 offset:33024
    ds_read_b64_tr_b16 a[30:31], v27 offset:35072
    v_mfma_f32_16x16x32_bf16 v[168:171], a[0:3], a[164:167], v[168:171]
    v_mfma_f32_16x16x32_bf16 v[176:179], a[4:7], a[160:163], v[176:179]
    ds_read_b64_tr_b16 a[32:33], v6 offset:0
    ds_read_b64_tr_b16 a[34:35], v6 offset:1024
    v_mfma_f32_16x16x32_bf16 v[184:187], a[4:7], a[164:167], v[184:187]
    buffer_load_dwordx4 v13, s[12:15], s40 offen offset:3072 lds
    s_add_u32 s40, s40, 262144
    v_mfma_f32_16x16x32_bf16 v[192:195], a[8:11], a[160:163], v[192:195]
    ds_read_b64_tr_b16 a[36:37], v8 offset:0
    ds_read_b64_tr_b16 a[38:39], v8 offset:1024
    v_mfma_f32_16x16x32_bf16 v[200:203], a[8:11], a[164:167], v[200:203]
    v_mfma_f32_16x16x32_bf16 v[208:211], a[12:15], a[160:163], v[208:211]
    ds_read_b64_tr_b16 a[40:41], v14 offset:0
    ds_read_b64_tr_b16 a[42:43], v14 offset:1024
    v_mfma_f32_16x16x32_bf16 v[216:219], a[12:15], a[164:167], v[216:219]
    buffer_store_dwordx4 v[124:127], v23, s[16:19], s50 offen offset:3072
    s_waitcnt lgkmcnt(6)
    v_mfma_f32_16x16x32_bf16 v[224:227], a[16:19], a[160:163], v[224:227]
    ds_read_b64_tr_b16 a[44:45], v24 offset:0
    ds_read_b64_tr_b16 a[46:47], v24 offset:1024
    v_mfma_f32_16x16x32_bf16 v[232:235], a[16:19], a[164:167], v[232:235]
    v_mfma_f32_16x16x32_bf16 v[240:243], a[20:23], a[160:163], v[240:243]
    ds_read_b64_tr_b16 a[48:49], v17 offset:32768
    ds_read_b64_tr_b16 a[50:51], v17 offset:34816
    v_mfma_f32_16x16x32_bf16 v[248:251], a[20:23], a[164:167], v[248:251]
    buffer_store_dwordx4 v[128:131], v22, s[16:19], s51 offen offset:0
    v_mfma_f32_16x16x32_bf16 a[64:67], a[24:27], a[160:163], a[64:67]
    ds_read_b64_tr_b16 a[52:53], v19 offset:32768
    ds_read_b64_tr_b16 a[54:55], v19 offset:34816
    v_mfma_f32_16x16x32_bf16 a[72:75], a[24:27], a[164:167], a[72:75]
    v_mfma_f32_16x16x32_bf16 a[80:83], a[28:31], a[160:163], a[80:83]
    ds_read_b64_tr_b16 a[56:57], v21 offset:32768
    ds_read_b64_tr_b16 a[58:59], v21 offset:34816
    v_mfma_f32_16x16x32_bf16 a[88:91], a[28:31], a[164:167], a[88:91]
    buffer_store_dwordx4 v[132:135], v22, s[16:19], s51 offen offset:1024
    s_waitcnt lgkmcnt(6)
    v_mfma_f32_16x16x32_bf16 a[96:99], a[32:35], a[160:163], a[96:99]
    ds_read_b64_tr_b16 a[60:61], v31 offset:32768
    ds_read_b64_tr_b16 a[62:63], v31 offset:34816
    v_mfma_f32_16x16x32_bf16 a[104:107], a[32:35], a[164:167], a[104:107]
    v_mfma_f32_16x16x32_bf16 a[112:115], a[36:39], a[160:163], a[112:115]
    ds_read_b64_tr_b16 a[0:1], v17 offset:33024
    ds_read_b64_tr_b16 a[2:3], v17 offset:35072
    v_mfma_f32_16x16x32_bf16 a[120:123], a[36:39], a[164:167], a[120:123]
    v_mfma_f32_16x16x32_bf16 a[128:131], a[40:43], a[160:163], a[128:131]
    ds_read_b64_tr_b16 a[4:5], v19 offset:33024
    ds_read_b64_tr_b16 a[6:7], v19 offset:35072
    v_mfma_f32_16x16x32_bf16 a[136:139], a[40:43], a[164:167], a[136:139]
    v_mfma_f32_16x16x32_bf16 a[144:147], a[44:47], a[160:163], a[144:147]
    ds_read_b64_tr_b16 a[8:9], v21 offset:33024
    ds_read_b64_tr_b16 a[10:11], v21 offset:35072
    v_mfma_f32_16x16x32_bf16 a[152:155], a[44:47], a[164:167], a[152:155]
    s_waitcnt lgkmcnt(6)
    v_mfma_f32_16x16x32_bf16 v[164:167], a[48:51], a[160:163], v[164:167]
    ds_read_b64_tr_b16 a[12:13], v31 offset:33024
    ds_read_b64_tr_b16 a[14:15], v31 offset:35072
    v_mfma_f32_16x16x32_bf16 v[172:175], a[48:51], a[164:167], v[172:175]
    v_mfma_f32_16x16x32_bf16 v[180:183], a[52:55], a[160:163], v[180:183]
    ds_read_b64_tr_b16 a[16:17], v7 offset:0
    ds_read_b64_tr_b16 a[18:19], v7 offset:1024
    v_mfma_f32_16x16x32_bf16 v[188:191], a[52:55], a[164:167], v[188:191]
    v_mfma_f32_16x16x32_bf16 v[196:199], a[56:59], a[160:163], v[196:199]
    ds_read_b64_tr_b16 a[20:21], v9 offset:0
    ds_read_b64_tr_b16 a[22:23], v9 offset:1024
    v_mfma_f32_16x16x32_bf16 v[204:207], a[56:59], a[164:167], v[204:207]
    v_mfma_f32_16x16x32_bf16 v[212:215], a[60:63], a[160:163], v[212:215]
    ds_read_b64_tr_b16 a[24:25], v15 offset:0
    ds_read_b64_tr_b16 a[26:27], v15 offset:1024
    v_mfma_f32_16x16x32_bf16 v[220:223], a[60:63], a[164:167], v[220:223]
    s_waitcnt lgkmcnt(6)
    v_mfma_f32_16x16x32_bf16 v[228:231], a[0:3], a[160:163], v[228:231]
    ds_read_b64_tr_b16 a[28:29], v25 offset:0
    ds_read_b64_tr_b16 a[30:31], v25 offset:1024
    v_mfma_f32_16x16x32_bf16 v[236:239], a[0:3], a[164:167], v[236:239]
    v_mfma_f32_16x16x32_bf16 v[244:247], a[4:7], a[160:163], v[244:247]
    s_waitcnt vmcnt(37)
    s_barrier
    ds_read_b64_tr_b16 a[32:33], v16 offset:49152
    ds_read_b64_tr_b16 a[34:35], v16 offset:51200
    v_mfma_f32_16x16x32_bf16 v[252:255], a[4:7], a[164:167], v[252:255]
    v_mfma_f32_16x16x32_bf16 a[68:71], a[8:11], a[160:163], a[68:71]
    ds_read_b64_tr_b16 a[36:37], v18 offset:49152
    ds_read_b64_tr_b16 a[38:39], v18 offset:51200
    v_mfma_f32_16x16x32_bf16 a[76:79], a[8:11], a[164:167], a[76:79]
    s_add_u32 m0, s65, 16384
    v_mfma_f32_16x16x32_bf16 a[84:87], a[12:15], a[160:163], a[84:87]
    ds_read_b64_tr_b16 a[40:41], v20 offset:49152
    ds_read_b64_tr_b16 a[42:43], v20 offset:51200
    v_mfma_f32_16x16x32_bf16 a[92:95], a[12:15], a[164:167], a[92:95]
    buffer_load_dwordx4 v10, s[12:15], s40 offen offset:0 lds
    s_waitcnt lgkmcnt(6)
    v_mfma_f32_16x16x32_bf16 a[100:103], a[16:19], a[160:163], a[100:103]
    ds_read_b64_tr_b16 a[44:45], v27 offset:49152
    ds_read_b64_tr_b16 a[46:47], v27 offset:51200
    v_mfma_f32_16x16x32_bf16 a[108:111], a[16:19], a[164:167], a[108:111]
    v_mfma_f32_16x16x32_bf16 a[116:119], a[20:23], a[160:163], a[116:119]
    ds_read_b64_tr_b16 a[48:49], v16 offset:49408
    ds_read_b64_tr_b16 a[50:51], v16 offset:51456
    v_mfma_f32_16x16x32_bf16 a[124:127], a[20:23], a[164:167], a[124:127]
    buffer_load_dwordx4 v11, s[12:15], s40 offen offset:1024 lds
    v_mfma_f32_16x16x32_bf16 a[132:135], a[24:27], a[160:163], a[132:135]
    ds_read_b64_tr_b16 a[52:53], v18 offset:49408
    ds_read_b64_tr_b16 a[54:55], v18 offset:51456
    v_mfma_f32_16x16x32_bf16 a[140:143], a[24:27], a[164:167], a[140:143]
    v_mfma_f32_16x16x32_bf16 a[148:151], a[28:31], a[160:163], a[148:151]
    ds_read_b64_tr_b16 a[56:57], v20 offset:49408
    ds_read_b64_tr_b16 a[58:59], v20 offset:51456
    v_mfma_f32_16x16x32_bf16 a[156:159], a[28:31], a[164:167], a[156:159]
    buffer_load_dwordx4 v12, s[12:15], s40 offen offset:2048 lds
    s_waitcnt lgkmcnt(6)
    v_mfma_f32_16x16x32_bf16 v[160:163], a[32:35], a[168:171], v[160:163]
    ds_read_b64_tr_b16 a[60:61], v27 offset:49408
    ds_read_b64_tr_b16 a[62:63], v27 offset:51456
    v_mfma_f32_16x16x32_bf16 v[168:171], a[32:35], a[172:175], v[168:171]
    v_mfma_f32_16x16x32_bf16 v[176:179], a[36:39], a[168:171], v[176:179]
    ds_read_b64_tr_b16 a[0:1], v6 offset:8192
    ds_read_b64_tr_b16 a[2:3], v6 offset:9216
    v_mfma_f32_16x16x32_bf16 v[184:187], a[36:39], a[172:175], v[184:187]
    buffer_load_dwordx4 v13, s[12:15], s40 offen offset:3072 lds
    s_add_u32 s40, s40, 262144
    v_mfma_f32_16x16x32_bf16 v[192:195], a[40:43], a[168:171], v[192:195]
    ds_read_b64_tr_b16 a[4:5], v8 offset:8192
    ds_read_b64_tr_b16 a[6:7], v8 offset:9216
    v_mfma_f32_16x16x32_bf16 v[200:203], a[40:43], a[172:175], v[200:203]
    v_mfma_f32_16x16x32_bf16 v[208:211], a[44:47], a[168:171], v[208:211]
    ds_read_b64_tr_b16 a[8:9], v14 offset:8192
    ds_read_b64_tr_b16 a[10:11], v14 offset:9216
    v_mfma_f32_16x16x32_bf16 v[216:219], a[44:47], a[172:175], v[216:219]
    buffer_store_dwordx4 v[136:139], v22, s[16:19], s51 offen offset:2048
    s_waitcnt lgkmcnt(6)
    v_mfma_f32_16x16x32_bf16 v[224:227], a[48:51], a[168:171], v[224:227]
    ds_read_b64_tr_b16 a[12:13], v24 offset:8192
    ds_read_b64_tr_b16 a[14:15], v24 offset:9216
    v_mfma_f32_16x16x32_bf16 v[232:235], a[48:51], a[172:175], v[232:235]
    v_mfma_f32_16x16x32_bf16 v[240:243], a[52:55], a[168:171], v[240:243]
    ds_read_b64_tr_b16 a[16:17], v17 offset:49152
    ds_read_b64_tr_b16 a[18:19], v17 offset:51200
    v_mfma_f32_16x16x32_bf16 v[248:251], a[52:55], a[172:175], v[248:251]
    buffer_store_dwordx4 v[140:143], v22, s[16:19], s51 offen offset:3072
    v_mfma_f32_16x16x32_bf16 a[64:67], a[56:59], a[168:171], a[64:67]
    ds_read_b64_tr_b16 a[20:21], v19 offset:49152
    ds_read_b64_tr_b16 a[22:23], v19 offset:51200
    v_mfma_f32_16x16x32_bf16 a[72:75], a[56:59], a[172:175], a[72:75]
    v_mfma_f32_16x16x32_bf16 a[80:83], a[60:63], a[168:171], a[80:83]
    ds_read_b64_tr_b16 a[24:25], v21 offset:49152
    ds_read_b64_tr_b16 a[26:27], v21 offset:51200
    v_mfma_f32_16x16x32_bf16 a[88:91], a[60:63], a[172:175], a[88:91]
    buffer_store_dwordx4 v[144:147], v23, s[16:19], s51 offen offset:0
    s_waitcnt lgkmcnt(6)
    v_mfma_f32_16x16x32_bf16 a[96:99], a[0:3], a[168:171], a[96:99]
    ds_read_b64_tr_b16 a[28:29], v31 offset:49152
    ds_read_b64_tr_b16 a[30:31], v31 offset:51200
    v_mfma_f32_16x16x32_bf16 a[104:107], a[0:3], a[172:175], a[104:107]
    v_mfma_f32_16x16x32_bf16 a[112:115], a[4:7], a[168:171], a[112:115]
    ds_read_b64_tr_b16 a[32:33], v17 offset:49408
    ds_read_b64_tr_b16 a[34:35], v17 offset:51456
    v_mfma_f32_16x16x32_bf16 a[120:123], a[4:7], a[172:175], a[120:123]
    v_mfma_f32_16x16x32_bf16 a[128:131], a[8:11], a[168:171], a[128:131]
    ds_read_b64_tr_b16 a[36:37], v19 offset:49408
    ds_read_b64_tr_b16 a[38:39], v19 offset:51456
    v_mfma_f32_16x16x32_bf16 a[136:139], a[8:11], a[172:175], a[136:139]
    v_mfma_f32_16x16x32_bf16 a[144:147], a[12:15], a[168:171], a[144:147]
    ds_read_b64_tr_b16 a[40:41], v21 offset:49408
    ds_read_b64_tr_b16 a[42:43], v21 offset:51456
    v_mfma_f32_16x16x32_bf16 a[152:155], a[12:15], a[172:175], a[152:155]
    s_waitcnt lgkmcnt(6)
    v_mfma_f32_16x16x32_bf16 v[164:167], a[16:19], a[168:171], v[164:167]
    ds_read_b64_tr_b16 a[44:45], v31 offset:49408
    ds_read_b64_tr_b16 a[46:47], v31 offset:51456
    v_mfma_f32_16x16x32_bf16 v[172:175], a[16:19], a[172:175], v[172:175]
    v_mfma_f32_16x16x32_bf16 v[180:183], a[20:23], a[168:171], v[180:183]
    ds_read_b64_tr_b16 a[48:49], v7 offset:8192
    ds_read_b64_tr_b16 a[50:51], v7 offset:9216
    v_mfma_f32_16x16x32_bf16 v[188:191], a[20:23], a[172:175], v[188:191]
    v_mfma_f32_16x16x32_bf16 v[196:199], a[24:27], a[168:171], v[196:199]
    ds_read_b64_tr_b16 a[52:53], v9 offset:8192
    ds_read_b64_tr_b16 a[54:55], v9 offset:9216
    v_mfma_f32_16x16x32_bf16 v[204:207], a[24:27], a[172:175], v[204:207]
    v_mfma_f32_16x16x32_bf16 v[212:215], a[28:31], a[168:171], v[212:215]
    ds_read_b64_tr_b16 a[56:57], v15 offset:8192
    ds_read_b64_tr_b16 a[58:59], v15 offset:9216
    v_mfma_f32_16x16x32_bf16 v[220:223], a[28:31], a[172:175], v[220:223]
    s_waitcnt lgkmcnt(6)
    v_mfma_f32_16x16x32_bf16 v[228:231], a[32:35], a[168:171], v[228:231]
    ds_read_b64_tr_b16 a[60:61], v25 offset:8192
    ds_read_b64_tr_b16 a[62:63], v25 offset:9216
    v_mfma_f32_16x16x32_bf16 v[236:239], a[32:35], a[172:175], v[236:239]
    v_mfma_f32_16x16x32_bf16 v[244:247], a[36:39], a[168:171], v[244:247]
    s_waitcnt vmcnt(31)
    s_barrier
    v_xor_b32 v16, 0x10000, v16
    v_xor_b32 v17, 0x10000, v17
    v_xor_b32 v18, 0x10000, v18
    v_xor_b32 v19, 0x10000, v19
    v_xor_b32 v20, 0x10000, v20
    v_xor_b32 v21, 0x10000, v21
    v_xor_b32 v27, 0x10000, v27
    v_xor_b32 v31, 0x10000, v31
    ds_read_b64_tr_b16 a[0:1], v16 offset:0
    ds_read_b64_tr_b16 a[2:3], v16 offset:2048
    v_mfma_f32_16x16x32_bf16 v[252:255], a[36:39], a[172:175], v[252:255]
    v_mfma_f32_16x16x32_bf16 a[68:71], a[40:43], a[168:171], a[68:71]
    ds_read_b64_tr_b16 a[4:5], v18 offset:0
    ds_read_b64_tr_b16 a[6:7], v18 offset:2048
    v_mfma_f32_16x16x32_bf16 a[76:79], a[40:43], a[172:175], a[76:79]
    v_mfma_f32_16x16x32_bf16 a[84:87], a[44:47], a[168:171], a[84:87]
    ds_read_b64_tr_b16 a[8:9], v20 offset:0
    ds_read_b64_tr_b16 a[10:11], v20 offset:2048
    v_mfma_f32_16x16x32_bf16 a[92:95], a[44:47], a[172:175], a[92:95]
    buffer_store_dwordx4 v[148:151], v23, s[16:19], s51 offen offset:1024
    s_waitcnt lgkmcnt(6)
    v_mfma_f32_16x16x32_bf16 a[100:103], a[48:51], a[168:171], a[100:103]
    ds_read_b64_tr_b16 a[12:13], v27 offset:0
    ds_read_b64_tr_b16 a[14:15], v27 offset:2048
    v_mfma_f32_16x16x32_bf16 a[108:111], a[48:51], a[172:175], a[108:111]
    v_mfma_f32_16x16x32_bf16 a[116:119], a[52:55], a[168:171], a[116:119]
    ds_read_b64_tr_b16 a[16:17], v16 offset:256
    ds_read_b64_tr_b16 a[18:19], v16 offset:2304
    v_mfma_f32_16x16x32_bf16 a[124:127], a[52:55], a[172:175], a[124:127]
    buffer_store_dwordx4 v[152:155], v23, s[16:19], s51 offen offset:2048
    v_mfma_f32_16x16x32_bf16 a[132:135], a[56:59], a[168:171], a[132:135]
    ds_read_b64_tr_b16 a[20:21], v18 offset:256
    ds_read_b64_tr_b16 a[22:23], v18 offset:2304
    v_mfma_f32_16x16x32_bf16 a[140:143], a[56:59], a[172:175], a[140:143]
    v_mfma_f32_16x16x32_bf16 a[148:151], a[60:63], a[168:171], a[148:151]
    ds_read_b64_tr_b16 a[24:25], v20 offset:256
    ds_read_b64_tr_b16 a[26:27], v20 offset:2304
    v_mfma_f32_16x16x32_bf16 a[156:159], a[60:63], a[172:175], a[156:159]
    buffer_store_dwordx4 v[156:159], v23, s[16:19], s51 offen offset:3072
    s_waitcnt lgkmcnt(6)
    v_mfma_f32_16x16x32_bf16 v[160:163], a[0:3], a[176:179], v[160:163]
    ds_read_b64_tr_b16 a[28:29], v27 offset:256
    ds_read_b64_tr_b16 a[30:31], v27 offset:2304
    v_mfma_f32_16x16x32_bf16 v[168:171], a[0:3], a[180:183], v[168:171]
    v_mfma_f32_16x16x32_bf16 v[176:179], a[4:7], a[176:179], v[176:179]
    ds_read_b64_tr_b16 a[32:33], v6 offset:16384
    ds_read_b64_tr_b16 a[34:35], v6 offset:17408
    v_mfma_f32_16x16x32_bf16 v[184:187], a[4:7], a[180:183], v[184:187]
    v_mfma_f32_16x16x32_bf16 v[192:195], a[8:11], a[176:179], v[192:195]
    ds_read_b64_tr_b16 a[36:37], v8 offset:16384
    ds_read_b64_tr_b16 a[38:39], v8 offset:17408
    v_mfma_f32_16x16x32_bf16 v[200:203], a[8:11], a[180:183], v[200:203]
    v_mfma_f32_16x16x32_bf16 v[208:211], a[12:15], a[176:179], v[208:211]
    ds_read_b64_tr_b16 a[40:41], v14 offset:16384
    ds_read_b64_tr_b16 a[42:43], v14 offset:17408
    v_mfma_f32_16x16x32_bf16 v[216:219], a[12:15], a[180:183], v[216:219]
    s_waitcnt lgkmcnt(6)
    v_mfma_f32_16x16x32_bf16 v[224:227], a[16:19], a[176:179], v[224:227]
    ds_read_b64_tr_b16 a[44:45], v24 offset:16384
    ds_read_b64_tr_b16 a[46:47], v24 offset:17408
    v_mfma_f32_16x16x32_bf16 v[232:235], a[16:19], a[180:183], v[232:235]
    v_mfma_f32_16x16x32_bf16 v[240:243], a[20:23], a[176:179], v[240:243]
    ds_read_b64_tr_b16 a[48:49], v17 offset:0
    ds_read_b64_tr_b16 a[50:51], v17 offset:2048
    v_mfma_f32_16x16x32_bf16 v[248:251], a[20:23], a[180:183], v[248:251]
    v_mfma_f32_16x16x32_bf16 a[64:67], a[24:27], a[176:179], a[64:67]
    ds_read_b64_tr_b16 a[52:53], v19 offset:0
    ds_read_b64_tr_b16 a[54:55], v19 offset:2048
    v_mfma_f32_16x16x32_bf16 a[72:75], a[24:27], a[180:183], a[72:75]
    v_mfma_f32_16x16x32_bf16 a[80:83], a[28:31], a[176:179], a[80:83]
    ds_read_b64_tr_b16 a[56:57], v21 offset:0
    ds_read_b64_tr_b16 a[58:59], v21 offset:2048
    v_mfma_f32_16x16x32_bf16 a[88:91], a[28:31], a[180:183], a[88:91]
    s_waitcnt lgkmcnt(6)
    v_mfma_f32_16x16x32_bf16 a[96:99], a[32:35], a[176:179], a[96:99]
    ds_read_b64_tr_b16 a[60:61], v31 offset:0
    ds_read_b64_tr_b16 a[62:63], v31 offset:2048
    v_mfma_f32_16x16x32_bf16 a[104:107], a[32:35], a[180:183], a[104:107]
    v_mfma_f32_16x16x32_bf16 a[112:115], a[36:39], a[176:179], a[112:115]
    ds_read_b64_tr_b16 a[0:1], v17 offset:256
    ds_read_b64_tr_b16 a[2:3], v17 offset:2304
    v_mfma_f32_16x16x32_bf16 a[120:123], a[36:39], a[180:183], a[120:123]
    v_mfma_f32_16x16x32_bf16 a[128:131], a[40:43], a[176:179], a[128:131]
    ds_read_b64_tr_b16 a[4:5], v19 offset:256
    ds_read_b64_tr_b16 a[6:7], v19 offset:2304
    v_mfma_f32_16x16x32_bf16 a[136:139], a[40:43], a[180:183], a[136:139]
    v_mfma_f32_16x16x32_bf16 a[144:147], a[44:47], a[176:179], a[144:147]
    ds_read_b64_tr_b16 a[8:9], v21 offset:256
    ds_read_b64_tr_b16 a[10:11], v21 offset:2304
    v_mfma_f32_16x16x32_bf16 a[152:155], a[44:47], a[180:183], a[152:155]
    s_waitcnt lgkmcnt(6)
    v_mfma_f32_16x16x32_bf16 v[164:167], a[48:51], a[176:179], v[164:167]
    ds_read_b64_tr_b16 a[12:13], v31 offset:256
    ds_read_b64_tr_b16 a[14:15], v31 offset:2304
    v_mfma_f32_16x16x32_bf16 v[172:175], a[48:51], a[180:183], v[172:175]
    v_mfma_f32_16x16x32_bf16 v[180:183], a[52:55], a[176:179], v[180:183]
    ds_read_b64_tr_b16 a[16:17], v7 offset:16384
    ds_read_b64_tr_b16 a[18:19], v7 offset:17408
    v_mfma_f32_16x16x32_bf16 v[188:191], a[52:55], a[180:183], v[188:191]
    v_mfma_f32_16x16x32_bf16 v[196:199], a[56:59], a[176:179], v[196:199]
    ds_read_b64_tr_b16 a[20:21], v9 offset:16384
    ds_read_b64_tr_b16 a[22:23], v9 offset:17408
    v_mfma_f32_16x16x32_bf16 v[204:207], a[56:59], a[180:183], v[204:207]
    v_mfma_f32_16x16x32_bf16 v[212:215], a[60:63], a[176:179], v[212:215]
    ds_read_b64_tr_b16 a[24:25], v15 offset:16384
    ds_read_b64_tr_b16 a[26:27], v15 offset:17408
    v_mfma_f32_16x16x32_bf16 v[220:223], a[60:63], a[180:183], v[220:223]
    s_waitcnt lgkmcnt(6)
    v_mfma_f32_16x16x32_bf16 v[228:231], a[0:3], a[176:179], v[228:231]
    ds_read_b64_tr_b16 a[28:29], v25 offset:16384
    ds_read_b64_tr_b16 a[30:31], v25 offset:17408
    v_mfma_f32_16x16x32_bf16 v[236:239], a[0:3], a[180:183], v[236:239]
    v_mfma_f32_16x16x32_bf16 v[244:247], a[4:7], a[176:179], v[244:247]
    s_waitcnt vmcnt(25)
    s_barrier
    ds_read_b64_tr_b16 a[32:33], v16 offset:16384
    ds_read_b64_tr_b16 a[34:35], v16 offset:18432
    v_mfma_f32_16x16x32_bf16 v[252:255], a[4:7], a[180:183], v[252:255]
    v_mfma_f32_16x16x32_bf16 a[68:71], a[8:11], a[176:179], a[68:71]
    ds_read_b64_tr_b16 a[36:37], v18 offset:16384
    ds_read_b64_tr_b16 a[38:39], v18 offset:18432
    v_mfma_f32_16x16x32_bf16 a[76:79], a[8:11], a[180:183], a[76:79]
    v_mfma_f32_16x16x32_bf16 a[84:87], a[12:15], a[176:179], a[84:87]
    ds_read_b64_tr_b16 a[40:41], v20 offset:16384
    ds_read_b64_tr_b16 a[42:43], v20 offset:18432
    v_mfma_f32_16x16x32_bf16 a[92:95], a[12:15], a[180:183], a[92:95]
    s_waitcnt lgkmcnt(6)
    v_mfma_f32_16x16x32_bf16 a[100:103], a[16:19], a[176:179], a[100:103]
    ds_read_b64_tr_b16 a[44:45], v27 offset:16384
    ds_read_b64_tr_b16 a[46:47], v27 offset:18432
    v_mfma_f32_16x16x32_bf16 a[108:111], a[16:19], a[180:183], a[108:111]
    v_mfma_f32_16x16x32_bf16 a[116:119], a[20:23], a[176:179], a[116:119]
    ds_read_b64_tr_b16 a[48:49], v16 offset:16640
    ds_read_b64_tr_b16 a[50:51], v16 offset:18688
    v_mfma_f32_16x16x32_bf16 a[124:127], a[20:23], a[180:183], a[124:127]
    v_mfma_f32_16x16x32_bf16 a[132:135], a[24:27], a[176:179], a[132:135]
    ds_read_b64_tr_b16 a[52:53], v18 offset:16640
    ds_read_b64_tr_b16 a[54:55], v18 offset:18688
    v_mfma_f32_16x16x32_bf16 a[140:143], a[24:27], a[180:183], a[140:143]
    v_mfma_f32_16x16x32_bf16 a[148:151], a[28:31], a[176:179], a[148:151]
    ds_read_b64_tr_b16 a[56:57], v20 offset:16640
    ds_read_b64_tr_b16 a[58:59], v20 offset:18688
    v_mfma_f32_16x16x32_bf16 a[156:159], a[28:31], a[180:183], a[156:159]
    s_waitcnt lgkmcnt(6)
    v_mfma_f32_16x16x32_bf16 v[160:163], a[32:35], a[184:187], v[160:163]
    ds_read_b64_tr_b16 a[60:61], v27 offset:16640
    ds_read_b64_tr_b16 a[62:63], v27 offset:18688
    v_mfma_f32_16x16x32_bf16 v[168:171], a[32:35], a[188:191], v[168:171]
    v_mfma_f32_16x16x32_bf16 v[176:179], a[36:39], a[184:187], v[176:179]
    ds_read_b64_tr_b16 a[0:1], v6 offset:24576
    ds_read_b64_tr_b16 a[2:3], v6 offset:25600
    v_mfma_f32_16x16x32_bf16 v[184:187], a[36:39], a[188:191], v[184:187]
    v_mfma_f32_16x16x32_bf16 v[192:195], a[40:43], a[184:187], v[192:195]
    ds_read_b64_tr_b16 a[4:5], v8 offset:24576
    ds_read_b64_tr_b16 a[6:7], v8 offset:25600
    v_mfma_f32_16x16x32_bf16 v[200:203], a[40:43], a[188:191], v[200:203]
    v_mfma_f32_16x16x32_bf16 v[208:211], a[44:47], a[184:187], v[208:211]
    ds_read_b64_tr_b16 a[8:9], v14 offset:24576
    ds_read_b64_tr_b16 a[10:11], v14 offset:25600
    v_mfma_f32_16x16x32_bf16 v[216:219], a[44:47], a[188:191], v[216:219]
    s_waitcnt lgkmcnt(6)
    v_mfma_f32_16x16x32_bf16 v[224:227], a[48:51], a[184:187], v[224:227]
    ds_read_b64_tr_b16 a[12:13], v24 offset:24576
    ds_read_b64_tr_b16 a[14:15], v24 offset:25600
    v_mfma_f32_16x16x32_bf16 v[232:235], a[48:51], a[188:191], v[232:235]
    v_mfma_f32_16x16x32_bf16 v[240:243], a[52:55], a[184:187], v[240:243]
    ds_read_b64_tr_b16 a[16:17], v17 offset:16384
    ds_read_b64_tr_b16 a[18:19], v17 offset:18432
    v_mfma_f32_16x16x32_bf16 v[248:251], a[52:55], a[188:191], v[248:251]
    v_mfma_f32_16x16x32_bf16 a[64:67], a[56:59], a[184:187], a[64:67]
    ds_read_b64_tr_b16 a[20:21], v19 offset:16384
    ds_read_b64_tr_b16 a[22:23], v19 offset:18432
    v_mfma_f32_16x16x32_bf16 a[72:75], a[56:59], a[188:191], a[72:75]
    v_mfma_f32_16x16x32_bf16 a[80:83], a[60:63], a[184:187], a[80:83]
    ds_read_b64_tr_b16 a[24:25], v21 offset:16384
    ds_read_b64_tr_b16 a[26:27], v21 offset:18432
    v_mfma_f32_16x16x32_bf16 a[88:91], a[60:63], a[188:191], a[88:91]
    s_waitcnt lgkmcnt(6)
    v_mfma_f32_16x16x32_bf16 a[96:99], a[0:3], a[184:187], a[96:99]
    ds_read_b64_tr_b16 a[28:29], v31 offset:16384
    ds_read_b64_tr_b16 a[30:31], v31 offset:18432
    v_mfma_f32_16x16x32_bf16 a[104:107], a[0:3], a[188:191], a[104:107]
    v_mfma_f32_16x16x32_bf16 a[112:115], a[4:7], a[184:187], a[112:115]
    ds_read_b64_tr_b16 a[32:33], v17 offset:16640
    ds_read_b64_tr_b16 a[34:35], v17 offset:18688
    v_mfma_f32_16x16x32_bf16 a[120:123], a[4:7], a[188:191], a[120:123]
    v_mfma_f32_16x16x32_bf16 a[128:131], a[8:11], a[184:187], a[128:131]
    ds_read_b64_tr_b16 a[36:37], v19 offset:16640
    ds_read_b64_tr_b16 a[38:39], v19 offset:18688
    v_mfma_f32_16x16x32_bf16 a[136:139], a[8:11], a[188:191], a[136:139]
    v_mfma_f32_16x16x32_bf16 a[144:147], a[12:15], a[184:187], a[144:147]
    ds_read_b64_tr_b16 a[40:41], v21 offset:16640
    ds_read_b64_tr_b16 a[42:43], v21 offset:18688
    v_mfma_f32_16x16x32_bf16 a[152:155], a[12:15], a[188:191], a[152:155]
    s_waitcnt lgkmcnt(6)
    v_mfma_f32_16x16x32_bf16 v[164:167], a[16:19], a[184:187], v[164:167]
    ds_read_b64_tr_b16 a[44:45], v31 offset:16640
    ds_read_b64_tr_b16 a[46:47], v31 offset:18688
    v_mfma_f32_16x16x32_bf16 v[172:175], a[16:19], a[188:191], v[172:175]
    v_mfma_f32_16x16x32_bf16 v[180:183], a[20:23], a[184:187], v[180:183]
    ds_read_b64_tr_b16 a[48:49], v7 offset:24576
    ds_read_b64_tr_b16 a[50:51], v7 offset:25600
    v_mfma_f32_16x16x32_bf16 v[188:191], a[20:23], a[188:191], v[188:191]
    v_mfma_f32_16x16x32_bf16 v[196:199], a[24:27], a[184:187], v[196:199]
    ds_read_b64_tr_b16 a[52:53], v9 offset:24576
    ds_read_b64_tr_b16 a[54:55], v9 offset:25600
    v_mfma_f32_16x16x32_bf16 v[204:207], a[24:27], a[188:191], v[204:207]
    v_mfma_f32_16x16x32_bf16 v[212:215], a[28:31], a[184:187], v[212:215]
    ds_read_b64_tr_b16 a[56:57], v15 offset:24576
    ds_read_b64_tr_b16 a[58:59], v15 offset:25600
    v_mfma_f32_16x16x32_bf16 v[220:223], a[28:31], a[188:191], v[220:223]
    s_waitcnt lgkmcnt(6)
    v_mfma_f32_16x16x32_bf16 v[228:231], a[32:35], a[184:187], v[228:231]
    ds_read_b64_tr_b16 a[60:61], v25 offset:24576
    ds_read_b64_tr_b16 a[62:63], v25 offset:25600
    v_mfma_f32_16x16x32_bf16 v[236:239], a[32:35], a[188:191], v[236:239]
    v_mfma_f32_16x16x32_bf16 v[244:247], a[36:39], a[184:187], v[244:247]
    s_waitcnt vmcnt(0)
    s_barrier
    v_xor_b32 v16, 0x10000, v16
    v_xor_b32 v17, 0x10000, v17
    v_xor_b32 v18, 0x10000, v18
    v_xor_b32 v19, 0x10000, v19
    v_xor_b32 v20, 0x10000, v20
    v_xor_b32 v21, 0x10000, v21
    v_xor_b32 v27, 0x10000, v27
    v_xor_b32 v31, 0x10000, v31
    s_cmp_lg_u32 s36, 0
    s_cbranch_scc1 L_km_nosigS
    s_cmp_eq_u32 s68, 32
    s_cbranch_scc1 L_km_sigS
    buffer_wbl2 sc1
    s_waitcnt vmcnt(0)
L_km_sigS:
    s_mov_b64 exec, 1
    buffer_atomic_add v28, v29, s[24:27], s69 offen sc1
    s_mov_b64 exec, -1
L_km_nosigS:
    ds_read_b64_tr_b16 a[0:1], v16 offset:0
    ds_read_b64_tr_b16 a[2:3], v16 offset:2048
    v_mfma_f32_16x16x32_bf16 v[252:255], a[36:39], a[188:191], v[252:255]
    v_mfma_f32_16x16x32_bf16 a[68:71], a[40:43], a[184:187], a[68:71]
    ds_read_b64_tr_b16 a[4:5], v18 offset:0
    ds_read_b64_tr_b16 a[6:7], v18 offset:2048
    v_mfma_f32_16x16x32_bf16 a[76:79], a[40:43], a[188:191], a[76:79]
    v_mfma_f32_16x16x32_bf16 a[84:87], a[44:47], a[184:187], a[84:87]
    ds_read_b64_tr_b16 a[8:9], v20 offset:0
    ds_read_b64_tr_b16 a[10:11], v20 offset:2048
    v_mfma_f32_16x16x32_bf16 a[92:95], a[44:47], a[188:191], a[92:95]
    s_waitcnt lgkmcnt(6)
    v_mfma_f32_16x16x32_bf16 a[100:103], a[48:51], a[184:187], a[100:103]
    ds_read_b64_tr_b16 a[12:13], v27 offset:0
    ds_read_b64_tr_b16 a[14:15], v27 offset:2048
    v_mfma_f32_16x16x32_bf16 a[108:111], a[48:51], a[188:191], a[108:111]
    v_mfma_f32_16x16x32_bf16 a[116:119], a[52:55], a[184:187], a[116:119]
    ds_read_b64_tr_b16 a[16:17], v16 offset:256
    ds_read_b64_tr_b16 a[18:19], v16 offset:2304
    v_mfma_f32_16x16x32_bf16 a[124:127], a[52:55], a[188:191], a[124:127]
    v_mfma_f32_16x16x32_bf16 a[132:135], a[56:59], a[184:187], a[132:135]
    ds_read_b64_tr_b16 a[20:21], v18 offset:256
    ds_read_b64_tr_b16 a[22:23], v18 offset:2304
    v_mfma_f32_16x16x32_bf16 a[140:143], a[56:59], a[188:191], a[140:143]
    v_mfma_f32_16x16x32_bf16 a[148:151], a[60:63], a[184:187], a[148:151]
    ds_read_b64_tr_b16 a[24:25], v20 offset:256
    ds_read_b64_tr_b16 a[26:27], v20 offset:2304
    v_mfma_f32_16x16x32_bf16 a[156:159], a[60:63], a[188:191], a[156:159]
    s_waitcnt lgkmcnt(6)
    v_mfma_f32_16x16x32_bf16 v[160:163], a[0:3], a[192:195], v[160:163]
    ds_read_b64_tr_b16 a[28:29], v27 offset:256
    ds_read_b64_tr_b16 a[30:31], v27 offset:2304
    v_mfma_f32_16x16x32_bf16 v[168:171], a[0:3], a[196:199], v[168:171]
    v_mfma_f32_16x16x32_bf16 v[176:179], a[4:7], a[192:195], v[176:179]
    ds_read_b64_tr_b16 a[32:33], v6 offset:32768
    ds_read_b64_tr_b16 a[34:35], v6 offset:33792
    v_mfma_f32_16x16x32_bf16 v[184:187], a[4:7], a[196:199], v[184:187]
    v_mfma_f32_16x16x32_bf16 v[192:195], a[8:11], a[192:195], v[192:195]
    ds_read_b64_tr_b16 a[36:37], v8 offset:32768
    ds_read_b64_tr_b16 a[38:39], v8 offset:33792
    v_mfma_f32_16x16x32_bf16 v[200:203], a[8:11], a[196:199], v[200:203]
    v_mfma_f32_16x16x32_bf16 v[208:211], a[12:15], a[192:195], v[208:211]
    ds_read_b64_tr_b16 a[40:41], v14 offset:32768
    ds_read_b64_tr_b16 a[42:43], v14 offset:33792
    v_mfma_f32_16x16x32_bf16 v[216:219], a[12:15], a[196:199], v[216:219]
    s_waitcnt lgkmcnt(6)
    v_mfma_f32_16x16x32_bf16 v[224:227], a[16:19], a[192:195], v[224:227]
    ds_read_b64_tr_b16 a[44:45], v24 offset:32768
    ds_read_b64_tr_b16 a[46:47], v24 offset:33792
    v_mfma_f32_16x16x32_bf16 v[232:235], a[16:19], a[196:199], v[232:235]
    v_mfma_f32_16x16x32_bf16 v[240:243], a[20:23], a[192:195], v[240:243]
    ds_read_b64_tr_b16 a[48:49], v17 offset:0
    ds_read_b64_tr_b16 a[50:51], v17 offset:2048
    v_mfma_f32_16x16x32_bf16 v[248:251], a[20:23], a[196:199], v[248:251]
    v_mfma_f32_16x16x32_bf16 a[64:67], a[24:27], a[192:195], a[64:67]
    ds_read_b64_tr_b16 a[52:53], v19 offset:0
    ds_read_b64_tr_b16 a[54:55], v19 offset:2048
    v_mfma_f32_16x16x32_bf16 a[72:75], a[24:27], a[196:199], a[72:75]
    v_mfma_f32_16x16x32_bf16 a[80:83], a[28:31], a[192:195], a[80:83]
    ds_read_b64_tr_b16 a[56:57], v21 offset:0
    ds_read_b64_tr_b16 a[58:59], v21 offset:2048
    v_mfma_f32_16x16x32_bf16 a[88:91], a[28:31], a[196:199], a[88:91]
    s_waitcnt lgkmcnt(6)
    v_mfma_f32_16x16x32_bf16 a[96:99], a[32:35], a[192:195], a[96:99]
    ds_read_b64_tr_b16 a[60:61], v31 offset:0
    ds_read_b64_tr_b16 a[62:63], v31 offset:2048
    v_mfma_f32_16x16x32_bf16 a[104:107], a[32:35], a[196:199], a[104:107]
    v_mfma_f32_16x16x32_bf16 a[112:115], a[36:39], a[192:195], a[112:115]
    ds_read_b64_tr_b16 a[0:1], v17 offset:256
    ds_read_b64_tr_b16 a[2:3], v17 offset:2304
    v_mfma_f32_16x16x32_bf16 a[120:123], a[36:39], a[196:199], a[120:123]
    v_mfma_f32_16x16x32_bf16 a[128:131], a[40:43], a[192:195], a[128:131]
    ds_read_b64_tr_b16 a[4:5], v19 offset:256
    ds_read_b64_tr_b16 a[6:7], v19 offset:2304
    v_mfma_f32_16x16x32_bf16 a[136:139], a[40:43], a[196:199], a[136:139]
    v_mfma_f32_16x16x32_bf16 a[144:147], a[44:47], a[192:195], a[144:147]
    ds_read_b64_tr_b16 a[8:9], v21 offset:256
    ds_read_b64_tr_b16 a[10:11], v21 offset:2304
    v_mfma_f32_16x16x32_bf16 a[152:155], a[44:47], a[196:199], a[152:155]
    s_waitcnt lgkmcnt(6)
    v_mfma_f32_16x16x32_bf16 v[164:167], a[48:51], a[192:195], v[164:167]
    ds_read_b64_tr_b16 a[12:13], v31 offset:256
    ds_read_b64_tr_b16 a[14:15], v31 offset:2304
    v_mfma_f32_16x16x32_bf16 v[172:175], a[48:51], a[196:199], v[172:175]
    v_mfma_f32_16x16x32_bf16 v[180:183], a[52:55], a[192:195], v[180:183]
    ds_read_b64_tr_b16 a[16:17], v7 offset:32768
    ds_read_b64_tr_b16 a[18:19], v7 offset:33792
    v_mfma_f32_16x16x32_bf16 v[188:191], a[52:55], a[196:199], v[188:191]
    v_mfma_f32_16x16x32_bf16 v[196:199], a[56:59], a[192:195], v[196:199]
    ds_read_b64_tr_b16 a[20:21], v9 offset:32768
    ds_read_b64_tr_b16 a[22:23], v9 offset:33792
    v_mfma_f32_16x16x32_bf16 v[204:207], a[56:59], a[196:199], v[204:207]
    v_mfma_f32_16x16x32_bf16 v[212:215], a[60:63], a[192:195], v[212:215]
    ds_read_b64_tr_b16 a[24:25], v15 offset:32768
    ds_read_b64_tr_b16 a[26:27], v15 offset:33792
    v_mfma_f32_16x16x32_bf16 v[220:223], a[60:63], a[196:199], v[220:223]
    s_waitcnt lgkmcnt(6)
    v_mfma_f32_16x16x32_bf16 v[228:231], a[0:3], a[192:195], v[228:231]
    ds_read_b64_tr_b16 a[28:29], v25 offset:32768
    ds_read_b64_tr_b16 a[30:31], v25 offset:33792
    v_mfma_f32_16x16x32_bf16 v[236:239], a[0:3], a[196:199], v[236:239]
    v_mfma_f32_16x16x32_bf16 v[244:247], a[4:7], a[192:195], v[244:247]
    s_waitcnt vmcnt(6)
    s_barrier
    ds_read_b64_tr_b16 a[32:33], v16 offset:16384
    ds_read_b64_tr_b16 a[34:35], v16 offset:18432
    v_mfma_f32_16x16x32_bf16 v[252:255], a[4:7], a[196:199], v[252:255]
    v_mfma_f32_16x16x32_bf16 a[68:71], a[8:11], a[192:195], a[68:71]
    ds_read_b64_tr_b16 a[36:37], v18 offset:16384
    ds_read_b64_tr_b16 a[38:39], v18 offset:18432
    v_mfma_f32_16x16x32_bf16 a[76:79], a[8:11], a[196:199], a[76:79]
    v_mfma_f32_16x16x32_bf16 a[84:87], a[12:15], a[192:195], a[84:87]
    ds_read_b64_tr_b16 a[40:41], v20 offset:16384
    ds_read_b64_tr_b16 a[42:43], v20 offset:18432
    v_mfma_f32_16x16x32_bf16 a[92:95], a[12:15], a[196:199], a[92:95]
    s_waitcnt lgkmcnt(6)
    v_mfma_f32_16x16x32_bf16 a[100:103], a[16:19], a[192:195], a[100:103]
    ds_read_b64_tr_b16 a[44:45], v27 offset:16384
    ds_read_b64_tr_b16 a[46:47], v27 offset:18432
    v_mfma_f32_16x16x32_bf16 a[108:111], a[16:19], a[196:199], a[108:111]
    v_mfma_f32_16x16x32_bf16 a[116:119], a[20:23], a[192:195], a[116:119]
    ds_read_b64_tr_b16 a[48:49], v16 offset:16640
    ds_read_b64_tr_b16 a[50:51], v16 offset:18688
    v_mfma_f32_16x16x32_bf16 a[124:127], a[20:23], a[196:199], a[124:127]
    v_mfma_f32_16x16x32_bf16 a[132:135], a[24:27], a[192:195], a[132:135]
    ds_read_b64_tr_b16 a[52:53], v18 offset:16640
    ds_read_b64_tr_b16 a[54:55], v18 offset:18688
    v_mfma_f32_16x16x32_bf16 a[140:143], a[24:27], a[196:199], a[140:143]
    v_mfma_f32_16x16x32_bf16 a[148:151], a[28:31], a[192:195], a[148:151]
    ds_read_b64_tr_b16 a[56:57], v20 offset:16640
    ds_read_b64_tr_b16 a[58:59], v20 offset:18688
    v_mfma_f32_16x16x32_bf16 a[156:159], a[28:31], a[196:199], a[156:159]
    s_waitcnt lgkmcnt(6)
    v_mfma_f32_16x16x32_bf16 v[160:163], a[32:35], a[200:203], v[160:163]
    ds_read_b64_tr_b16 a[60:61], v27 offset:16640
    ds_read_b64_tr_b16 a[62:63], v27 offset:18688
    v_mfma_f32_16x16x32_bf16 v[168:171], a[32:35], a[204:207], v[168:171]
    v_mfma_f32_16x16x32_bf16 v[176:179], a[36:39], a[200:203], v[176:179]
    ds_read_b64_tr_b16 a[0:1], v6 offset:40960
    ds_read_b64_tr_b16 a[2:3], v6 offset:41984
    v_mfma_f32_16x16x32_bf16 v[184:187], a[36:39], a[204:207], v[184:187]
    v_mfma_f32_16x16x32_bf16 v[192:195], a[40:43], a[200:203], v[192:195]
    ds_read_b64_tr_b16 a[4:5], v8 offset:40960
    ds_read_b64_tr_b16 a[6:7], v8 offset:41984
    v_mfma_f32_16x16x32_bf16 v[200:203], a[40:43], a[204:207], v[200:203]
    v_mfma_f32_16x16x32_bf16 v[208:211], a[44:47], a[200:203], v[208:211]
    ds_read_b64_tr_b16 a[8:9], v14 offset:40960
    ds_read_b64_tr_b16 a[10:11], v14 offset:41984
    v_mfma_f32_16x16x32_bf16 v[216:219], a[44:47], a[204:207], v[216:219]
    s_waitcnt lgkmcnt(6)
    v_mfma_f32_16x16x32_bf16 v[224:227], a[48:51], a[200:203], v[224:227]
    ds_read_b64_tr_b16 a[12:13], v24 offset:40960
    ds_read_b64_tr_b16 a[14:15], v24 offset:41984
    v_mfma_f32_16x16x32_bf16 v[232:235], a[48:51], a[204:207], v[232:235]
    v_mfma_f32_16x16x32_bf16 v[240:243], a[52:55], a[200:203], v[240:243]
    ds_read_b64_tr_b16 a[16:17], v17 offset:16384
    ds_read_b64_tr_b16 a[18:19], v17 offset:18432
    v_mfma_f32_16x16x32_bf16 v[248:251], a[52:55], a[204:207], v[248:251]
    v_mfma_f32_16x16x32_bf16 a[64:67], a[56:59], a[200:203], a[64:67]
    ds_read_b64_tr_b16 a[20:21], v19 offset:16384
    ds_read_b64_tr_b16 a[22:23], v19 offset:18432
    v_mfma_f32_16x16x32_bf16 a[72:75], a[56:59], a[204:207], a[72:75]
    v_mfma_f32_16x16x32_bf16 a[80:83], a[60:63], a[200:203], a[80:83]
    ds_read_b64_tr_b16 a[24:25], v21 offset:16384
    ds_read_b64_tr_b16 a[26:27], v21 offset:18432
    v_mfma_f32_16x16x32_bf16 a[88:91], a[60:63], a[204:207], a[88:91]
    s_waitcnt lgkmcnt(6)
    v_mfma_f32_16x16x32_bf16 a[96:99], a[0:3], a[200:203], a[96:99]
    ds_read_b64_tr_b16 a[28:29], v31 offset:16384
    ds_read_b64_tr_b16 a[30:31], v31 offset:18432
    v_mfma_f32_16x16x32_bf16 a[104:107], a[0:3], a[204:207], a[104:107]
    v_mfma_f32_16x16x32_bf16 a[112:115], a[4:7], a[200:203], a[112:115]
    ds_read_b64_tr_b16 a[32:33], v17 offset:16640
    ds_read_b64_tr_b16 a[34:35], v17 offset:18688
    v_mfma_f32_16x16x32_bf16 a[120:123], a[4:7], a[204:207], a[120:123]
    v_mfma_f32_16x16x32_bf16 a[128:131], a[8:11], a[200:203], a[128:131]
    ds_read_b64_tr_b16 a[36:37], v19 offset:16640
    ds_read_b64_tr_b16 a[38:39], v19 offset:18688
    v_mfma_f32_16x16x32_bf16 a[136:139], a[8:11], a[204:207], a[136:139]
    v_mfma_f32_16x16x32_bf16 a[144:147], a[12:15], a[200:203], a[144:147]
    ds_read_b64_tr_b16 a[40:41], v21 offset:16640
    ds_read_b64_tr_b16 a[42:43], v21 offset:18688
    v_mfma_f32_16x16x32_bf16 a[152:155], a[12:15], a[204:207], a[152:155]
    s_waitcnt lgkmcnt(6)
    v_mfma_f32_16x16x32_bf16 v[164:167], a[16:19], a[200:203], v[164:167]
    ds_read_b64_tr_b16 a[44:45], v31 offset:16640
    ds_read_b64_tr_b16 a[46:47], v31 offset:18688
    v_mfma_f32_16x16x32_bf16 v[172:175], a[16:19], a[204:207], v[172:175]
    buffer_load_dword v30, v29, s[24:27], s3 offen sc1
    v_mfma_f32_16x16x32_bf16 v[180:183], a[20:23], a[200:203], v[180:183]
    ds_read_b64_tr_b16 a[48:49], v7 offset:40960
    ds_read_b64_tr_b16 a[50:51], v7 offset:41984
    v_mfma_f32_16x16x32_bf16 v[188:191], a[20:23], a[204:207], v[188:191]
    v_mfma_f32_16x16x32_bf16 v[196:199], a[24:27], a[200:203], v[196:199]
    ds_read_b64_tr_b16 a[52:53], v9 offset:40960
    ds_read_b64_tr_b16 a[54:55], v9 offset:41984
    v_mfma_f32_16x16x32_bf16 v[204:207], a[24:27], a[204:207], v[204:207]
    v_mfma_f32_16x16x32_bf16 v[212:215], a[28:31], a[200:203], v[212:215]
    ds_read_b64_tr_b16 a[56:57], v15 offset:40960
    ds_read_b64_tr_b16 a[58:59], v15 offset:41984
    v_mfma_f32_16x16x32_bf16 v[220:223], a[28:31], a[204:207], v[220:223]
    s_waitcnt lgkmcnt(6)
    v_mfma_f32_16x16x32_bf16 v[228:231], a[32:35], a[200:203], v[228:231]
    ds_read_b64_tr_b16 a[60:61], v25 offset:40960
    ds_read_b64_tr_b16 a[62:63], v25 offset:41984
    v_mfma_f32_16x16x32_bf16 v[236:239], a[32:35], a[204:207], v[236:239]
    v_mfma_f32_16x16x32_bf16 v[244:247], a[36:39], a[200:203], v[244:247]
    v_mfma_f32_16x16x32_bf16 v[252:255], a[36:39], a[204:207], v[252:255]
    v_mfma_f32_16x16x32_bf16 a[68:71], a[40:43], a[200:203], a[68:71]
    v_mfma_f32_16x16x32_bf16 a[76:79], a[40:43], a[204:207], a[76:79]
    v_mfma_f32_16x16x32_bf16 a[84:87], a[44:47], a[200:203], a[84:87]
    v_mfma_f32_16x16x32_bf16 a[92:95], a[44:47], a[204:207], a[92:95]
    s_waitcnt lgkmcnt(0)
    v_mfma_f32_16x16x32_bf16 a[100:103], a[48:51], a[200:203], a[100:103]
    v_mfma_f32_16x16x32_bf16 a[108:111], a[48:51], a[204:207], a[108:111]
    v_mfma_f32_16x16x32_bf16 a[116:119], a[52:55], a[200:203], a[116:119]
    v_mfma_f32_16x16x32_bf16 a[124:127], a[52:55], a[204:207], a[124:127]
    v_mfma_f32_16x16x32_bf16 a[132:135], a[56:59], a[200:203], a[132:135]
    v_mfma_f32_16x16x32_bf16 a[140:143], a[56:59], a[204:207], a[140:143]
    v_mfma_f32_16x16x32_bf16 a[148:151], a[60:63], a[200:203], a[148:151]
    v_mfma_f32_16x16x32_bf16 a[156:159], a[60:63], a[204:207], a[156:159]
    s_load_dwordx2 s[30:31], s[0:1], 40
    s_load_dwordx2 s[100:101], s[0:1], 64
    s_mov_b32 s42, 32768
    s_mov_b32 s43, 16384
    s_lshl_b32 s44, s36, 12
    s_add_u32 s45, s44, 65536
    s_mov_b32 s55, s45
    s_lshl_b32 s7, s79, 21
    s_add_u32 s7, s7, 2097152
    s_add_u32 s8, s34, s7
    s_addc_u32 s9, s35, 0
    s_mov_b32 s10, 2097152
    v_lshlrev_b32 v2, 4, v1
    v_add_u32 v3, s44, v2
    v_add_u32 v4, s44, v2
    v_add_u32 v5, s44, v2
    v_add_u32 v6, s44, v2
    s_mov_b32 s6, 0
L_k2_kvpS:
    s_waitcnt vmcnt(0)
    v_readfirstlane_b32 s7, v30
    s_nop 3
    s_cmp_ge_u32 s7, 16
    s_cbranch_scc1 L_k2_kvokS
    buffer_load_dword v30, v29, s[24:27], s3 offen sc1
    s_add_u32 s6, s6, 1
    s_cmp_lt_u32 s6, 0x80000
    s_cbranch_scc1 L_k2_kvpS
L_k2_kvokS:
    s_barrier
    s_mov_b32 m0, s44
    s_nop 0
    buffer_load_dwordx4 v3, s[8:11], s73 offen offset:0 sc1 lds
    v_accvgpr_read_b32 v32, a96
    v_accvgpr_read_b32 v33, a97
    v_accvgpr_read_b32 v34, a98
    v_accvgpr_read_b32 v35, a99
    v_accvgpr_read_b32 v36, a100
    v_accvgpr_read_b32 v37, a101
    v_accvgpr_read_b32 v38, a102
    v_accvgpr_read_b32 v39, a103
    v_accvgpr_read_b32 v40, a104
    v_accvgpr_read_b32 v41, a105
    v_accvgpr_read_b32 v42, a106
    v_accvgpr_read_b32 v43, a107
    v_accvgpr_read_b32 v44, a108
    v_accvgpr_read_b32 v45, a109
    v_accvgpr_read_b32 v46, a110
    v_accvgpr_read_b32 v47, a111
    v_cvt_pk_bf16_f32 v32, v32, v33
    v_cvt_pk_bf16_f32 v34, v34, v35
    v_cvt_pk_bf16_f32 v36, v36, v37
    v_cvt_pk_bf16_f32 v38, v38, v39
    buffer_load_dwordx4 v4, s[8:11], s73 offen offset:1024 sc1 lds
    v_cvt_pk_bf16_f32 v40, v40, v41
    v_cvt_pk_bf16_f32 v42, v42, v43
    v_cvt_pk_bf16_f32 v44, v44, v45
    v_cvt_pk_bf16_f32 v46, v46, v47
    s_nop 1
    v_permlane16_swap_b32 v32, v40
    v_permlane16_swap_b32 v34, v42
    v_permlane16_swap_b32 v36, v44
    v_permlane16_swap_b32 v38, v46
    s_nop 0
    v_accvgpr_write_b32 a224, v32
    v_accvgpr_write_b32 a225, v34
    v_accvgpr_write_b32 a226, v36
    v_accvgpr_write_b32 a227, v38
    v_accvgpr_write_b32 a228, v40
    v_accvgpr_write_b32 a229, v42
    v_accvgpr_write_b32 a230, v44
    v_accvgpr_write_b32 a231, v46
    v_accvgpr_read_b32 v32, a112
    v_accvgpr_read_b32 v33, a113
    buffer_load_dwordx4 v5, s[8:11], s73 offen offset:2048 sc1 lds
    v_accvgpr_read_b32 v34, a114
    v_accvgpr_read_b32 v35, a115
    v_accvgpr_read_b32 v36, a116
    v_accvgpr_read_b32 v37, a117
    v_accvgpr_read_b32 v38, a118
    v_accvgpr_read_b32 v39, a119
    v_accvgpr_read_b32 v40, a120
    v_accvgpr_read_b32 v41, a121
    v_accvgpr_read_b32 v42, a122
    v_accvgpr_read_b32 v43, a123
    v_accvgpr_read_b32 v44, a124
    v_accvgpr_read_b32 v45, a125
    v_accvgpr_read_b32 v46, a126
    v_accvgpr_read_b32 v47, a127
    v_cvt_pk_bf16_f32 v32, v32, v33
    v_cvt_pk_bf16_f32 v34, v34, v35
    v_cvt_pk_bf16_f32 v36, v36, v37
    v_cvt_pk_bf16_f32 v38, v38, v39
    v_cvt_pk_bf16_f32 v40, v40, v41
    v_cvt_pk_bf16_f32 v42, v42, v43
    buffer_load_dwordx4 v6, s[8:11], s73 offen offset:3072 sc1 lds
    v_cvt_pk_bf16_f32 v44, v44, v45
    v_cvt_pk_bf16_f32 v46, v46, v47
    s_nop 1
    v_permlane16_swap_b32 v32, v40
    v_permlane16_swap_b32 v34, v42
    v_permlane16_swap_b32 v36, v44
    v_permlane16_swap_b32 v38, v46
    s_nop 0
    v_accvgpr_write_b32 a232, v32
    v_accvgpr_write_b32 a233, v34
    v_accvgpr_write_b32 a234, v36
    v_accvgpr_write_b32 a235, v38
    v_accvgpr_write_b32 a236, v40
    v_accvgpr_write_b32 a237, v42
    v_accvgpr_write_b32 a238, v44
    v_accvgpr_write_b32 a239, v46
    v_accvgpr_read_b32 v32, a128
    v_accvgpr_read_b32 v33, a129
    v_accvgpr_read_b32 v34, a130
    v_accvgpr_read_b32 v35, a131
    s_mov_b32 m0, s45
    s_nop 0
    buffer_load_dwordx4 v3, s[8:11], s74 offen offset:0 sc1 lds
    v_accvgpr_read_b32 v36, a132
    v_accvgpr_read_b32 v37, a133
    v_accvgpr_read_b32 v38, a134
    v_accvgpr_read_b32 v39, a135
    v_accvgpr_read_b32 v40, a136
    v_accvgpr_read_b32 v41, a137
    v_accvgpr_read_b32 v42, a138
    v_accvgpr_read_b32 v43, a139
    v_accvgpr_read_b32 v44, a140
    v_accvgpr_read_b32 v45, a141
    v_accvgpr_read_b32 v46, a142
    v_accvgpr_read_b32 v47, a143
    v_cvt_pk_bf16_f32 v32, v32, v33
    v_cvt_pk_bf16_f32 v34, v34, v35
    v_cvt_pk_bf16_f32 v36, v36, v37
    v_cvt_pk_bf16_f32 v38, v38, v39
    v_cvt_pk_bf16_f32 v40, v40, v41
    v_cvt_pk_bf16_f32 v42, v42, v43
    v_cvt_pk_bf16_f32 v44, v44, v45
    v_cvt_pk_bf16_f32 v46, v46, v47
    buffer_load_dwordx4 v4, s[8:11], s74 offen offset:1024 sc1 lds
    s_nop 1
    v_permlane16_swap_b32 v32, v40
    v_permlane16_swap_b32 v34, v42
    v_permlane16_swap_b32 v36, v44
    v_permlane16_swap_b32 v38, v46
    s_nop 0
    v_accvgpr_write_b32 a240, v32
    v_accvgpr_write_b32 a241, v34
    v_accvgpr_write_b32 a242, v36
    v_accvgpr_write_b32 a243, v38
    v_accvgpr_write_b32 a244, v40
    v_accvgpr_write_b32 a245, v42
    v_accvgpr_write_b32 a246, v44
    v_accvgpr_write_b32 a247, v46
    v_accvgpr_read_b32 v32, a144
    v_accvgpr_read_b32 v33, a145
    v_accvgpr_read_b32 v34, a146
    v_accvgpr_read_b32 v35, a147
    v_accvgpr_read_b32 v36, a148
    v_accvgpr_read_b32 v37, a149
    buffer_load_dwordx4 v5, s[8:11], s74 offen offset:2048 sc1 lds
    v_accvgpr_read_b32 v38, a150
    v_accvgpr_read_b32 v39, a151
    v_accvgpr_read_b32 v40, a152
    v_accvgpr_read_b32 v41, a153
    v_accvgpr_read_b32 v42, a154
    v_accvgpr_read_b32 v43, a155
    v_accvgpr_read_b32 v44, a156
    v_accvgpr_read_b32 v45, a157
    v_accvgpr_read_b32 v46, a158
    v_accvgpr_read_b32 v47, a159
    v_cvt_pk_bf16_f32 v32, v32, v33
    v_cvt_pk_bf16_f32 v34, v34, v35
    v_cvt_pk_bf16_f32 v36, v36, v37
    v_cvt_pk_bf16_f32 v38, v38, v39
    v_cvt_pk_bf16_f32 v40, v40, v41
    v_cvt_pk_bf16_f32 v42, v42, v43
    v_cvt_pk_bf16_f32 v44, v44, v45
    v_cvt_pk_bf16_f32 v46, v46, v47
    s_nop 1
    v_permlane16_swap_b32 v32, v40
    buffer_load_dwordx4 v6, s[8:11], s74 offen offset:3072 sc1 lds
    v_permlane16_swap_b32 v34, v42
    v_permlane16_swap_b32 v36, v44
    v_permlane16_swap_b32 v38, v46
    s_nop 0
    v_accvgpr_write_b32 a248, v32
    v_accvgpr_write_b32 a249, v34
    v_accvgpr_write_b32 a250, v36
    v_accvgpr_write_b32 a251, v38
    v_accvgpr_read_b32 v32, a64
    v_accvgpr_read_b32 v33, a65
    v_accvgpr_read_b32 v34, a66
    v_accvgpr_read_b32 v35, a67
    v_accvgpr_read_b32 v36, a68
    v_accvgpr_read_b32 v37, a69
    v_accvgpr_read_b32 v38, a70
    v_accvgpr_read_b32 v39, a71
    v_accvgpr_read_b32 v40, a72
    v_accvgpr_read_b32 v41, a73
    v_accvgpr_read_b32 v42, a74
    v_accvgpr_read_b32 v43, a75
    s_add_u32 s73, s73, s42
    s_cmp_eq_u32 s73, s72
    s_cselect_b32 s73, 0, s73
    s_add_u32 s74, s73, s43
    s_add_u32 m0, s44, 16384
    s_nop 0
    buffer_load_dwordx4 v3, s[8:11], s73 offen offset:0 sc1 lds
    v_accvgpr_read_b32 v44, a76
    v_accvgpr_read_b32 v45, a77
    v_accvgpr_read_b32 v46, a78
    v_accvgpr_read_b32 v47, a79
    v_pk_mul_f32 v[32:33], v[32:33], s[4:5]
    v_pk_mul_f32 v[34:35], v[34:35], s[4:5]
    v_pk_mul_f32 v[36:37], v[36:37], s[4:5]
    v_pk_mul_f32 v[38:39], v[38:39], s[4:5]
    v_pk_mul_f32 v[40:41], v[40:41], s[4:5]
    v_pk_mul_f32 v[42:43], v[42:43], s[4:5]
    v_pk_mul_f32 v[44:45], v[44:45], s[4:5]
    v_pk_mul_f32 v[46:47], v[46:47], s[4:5]
    v_cvt_pk_bf16_f32 v32, v32, v33
    v_cvt_pk_bf16_f32 v34, v34, v35
    v_cvt_pk_bf16_f32 v36, v36, v37
    v_cvt_pk_bf16_f32 v38, v38, v39
    v_cvt_pk_bf16_f32 v40, v40, v41
    v_cvt_pk_bf16_f32 v42, v42, v43
    v_cvt_pk_bf16_f32 v44, v44, v45
    v_cvt_pk_bf16_f32 v46, v46, v47
    buffer_load_dwordx4 v4, s[8:11], s73 offen offset:1024 sc1 lds
    v_accvgpr_write_b32 a48, v32
    v_accvgpr_write_b32 a49, v34
    v_accvgpr_write_b32 a50, v36
    v_accvgpr_write_b32 a51, v38
    v_accvgpr_write_b32 a52, v40
    v_accvgpr_write_b32 a53, v42
    v_accvgpr_write_b32 a54, v44
    v_accvgpr_write_b32 a55, v46
    v_accvgpr_read_b32 v32, a80
    v_accvgpr_read_b32 v33, a81
    v_accvgpr_read_b32 v34, a82
    v_accvgpr_read_b32 v35, a83
    v_accvgpr_read_b32 v36, a84
    v_accvgpr_read_b32 v37, a85
    v_accvgpr_read_b32 v38, a86
    v_accvgpr_read_b32 v39, a87
    v_accvgpr_read_b32 v40, a88
    v_accvgpr_read_b32 v41, a89
    v_accvgpr_read_b32 v42, a90
    v_accvgpr_read_b32 v43, a91
    buffer_load_dwordx4 v5, s[8:11], s73 offen offset:2048 sc1 lds
    v_accvgpr_read_b32 v44, a92
    v_accvgpr_read_b32 v45, a93
    v_accvgpr_read_b32 v46, a94
    v_accvgpr_read_b32 v47, a95
    v_pk_mul_f32 v[32:33], v[32:33], s[4:5]
    v_pk_mul_f32 v[34:35], v[34:35], s[4:5]
    v_pk_mul_f32 v[36:37], v[36:37], s[4:5]
    v_pk_mul_f32 v[38:39], v[38:39], s[4:5]
    v_pk_mul_f32 v[40:41], v[40:41], s[4:5]
    v_pk_mul_f32 v[42:43], v[42:43], s[4:5]
    v_pk_mul_f32 v[44:45], v[44:45], s[4:5]
    v_pk_mul_f32 v[46:47], v[46:47], s[4:5]
    v_cvt_pk_bf16_f32 v32, v32, v33
    v_cvt_pk_bf16_f32 v34, v34, v35
    v_cvt_pk_bf16_f32 v36, v36, v37
    v_cvt_pk_bf16_f32 v38, v38, v39
    v_cvt_pk_bf16_f32 v40, v40, v41
    v_cvt_pk_bf16_f32 v42, v42, v43
    v_cvt_pk_bf16_f32 v44, v44, v45
    v_cvt_pk_bf16_f32 v46, v46, v47
    buffer_load_dwordx4 v6, s[8:11], s73 offen offset:3072 sc1 lds
    v_accvgpr_write_b32 a56, v32
    v_accvgpr_write_b32 a57, v34
    v_accvgpr_write_b32 a58, v36
    v_accvgpr_write_b32 a59, v38
    v_accvgpr_write_b32 a60, v40
    v_accvgpr_write_b32 a61, v42
    v_accvgpr_write_b32 a62, v44
    v_accvgpr_write_b32 a63, v46
    v_pk_mul_f32 v[160:161], v[160:161], s[4:5]
    v_pk_mul_f32 v[162:163], v[162:163], s[4:5]
    v_pk_mul_f32 v[164:165], v[164:165], s[4:5]
    v_pk_mul_f32 v[166:167], v[166:167], s[4:5]
    v_pk_mul_f32 v[168:169], v[168:169], s[4:5]
    v_pk_mul_f32 v[170:171], v[170:171], s[4:5]
    v_pk_mul_f32 v[172:173], v[172:173], s[4:5]
    v_pk_mul_f32 v[174:175], v[174:175], s[4:5]
    v_cvt_pk_bf16_f32 v160, v160, v161
    v_cvt_pk_bf16_f32 v162, v162, v163
    v_cvt_pk_bf16_f32 v164, v164, v165
    v_cvt_pk_bf16_f32 v166, v166, v167
    s_add_u32 m0, s45, 16384
    s_nop 0
    buffer_load_dwordx4 v3, s[8:11], s74 offen offset:0 sc1 lds
    v_cvt_pk_bf16_f32 v168, v168, v169
    v_cvt_pk_bf16_f32 v170, v170, v171
    v_cvt_pk_bf16_f32 v172, v172, v173
    v_cvt_pk_bf16_f32 v174, v174, v175
    v_accvgpr_write_b32 a0, v160
    v_accvgpr_write_b32 a1, v162
    v_accvgpr_write_b32 a2, v164
    v_accvgpr_write_b32 a3, v166
    v_accvgpr_write_b32 a4, v168
    v_accvgpr_write_b32 a5, v170
    v_accvgpr_write_b32 a6, v172
    v_accvgpr_write_b32 a7, v174
    v_pk_mul_f32 v[176:177], v[176:177], s[4:5]
    v_pk_mul_f32 v[178:179], v[178:179], s[4:5]
    v_pk_mul_f32 v[180:181], v[180:181], s[4:5]
    v_pk_mul_f32 v[182:183], v[182:183], s[4:5]
    v_pk_mul_f32 v[184:185], v[184:185], s[4:5]
    v_pk_mul_f32 v[186:187], v[186:187], s[4:5]
    v_pk_mul_f32 v[188:189], v[188:189], s[4:5]
    v_pk_mul_f32 v[190:191], v[190:191], s[4:5]
    buffer_load_dwordx4 v4, s[8:11], s74 offen offset:1024 sc1 lds
    v_cvt_pk_bf16_f32 v176, v176, v177
    v_cvt_pk_bf16_f32 v178, v178, v179
    v_cvt_pk_bf16_f32 v180, v180, v181
    v_cvt_pk_bf16_f32 v182, v182, v183
    v_cvt_pk_bf16_f32 v184, v184, v185
    v_cvt_pk_bf16_f32 v186, v186, v187
    v_cvt_pk_bf16_f32 v188, v188, v189
    v_cvt_pk_bf16_f32 v190, v190, v191
    v_accvgpr_write_b32 a8, v176
    v_accvgpr_write_b32 a9, v178
    v_accvgpr_write_b32 a10, v180
    v_accvgpr_write_b32 a11, v182
    v_accvgpr_write_b32 a12, v184
    v_accvgpr_write_b32 a13, v186
    v_accvgpr_write_b32 a14, v188
    v_accvgpr_write_b32 a15, v190
    v_pk_mul_f32 v[192:193], v[192:193], s[4:5]
    v_pk_mul_f32 v[194:195], v[194:195], s[4:5]
    v_pk_mul_f32 v[196:197], v[196:197], s[4:5]
    v_pk_mul_f32 v[198:199], v[198:199], s[4:5]
    buffer_load_dwordx4 v5, s[8:11], s74 offen offset:2048 sc1 lds
    v_pk_mul_f32 v[200:201], v[200:201], s[4:5]
    v_pk_mul_f32 v[202:203], v[202:203], s[4:5]
    v_pk_mul_f32 v[204:205], v[204:205], s[4:5]
    v_pk_mul_f32 v[206:207], v[206:207], s[4:5]
    v_cvt_pk_bf16_f32 v192, v192, v193
    v_cvt_pk_bf16_f32 v194, v194, v195
    v_cvt_pk_bf16_f32 v196, v196, v197
    v_cvt_pk_bf16_f32 v198, v198, v199
    v_cvt_pk_bf16_f32 v200, v200, v201
    v_cvt_pk_bf16_f32 v202, v202, v203
    v_cvt_pk_bf16_f32 v204, v204, v205
    v_cvt_pk_bf16_f32 v206, v206, v207
    v_accvgpr_write_b32 a16, v192
    v_accvgpr_write_b32 a17, v194
    v_accvgpr_write_b32 a18, v196
    v_accvgpr_write_b32 a19, v198
    v_accvgpr_write_b32 a20, v200
    v_accvgpr_write_b32 a21, v202
    v_accvgpr_write_b32 a22, v204
    v_accvgpr_write_b32 a23, v206
    buffer_load_dwordx4 v6, s[8:11], s74 offen offset:3072 sc1 lds
    v_pk_mul_f32 v[208:209], v[208:209], s[4:5]
    v_pk_mul_f32 v[210:211], v[210:211], s[4:5]
    v_pk_mul_f32 v[212:213], v[212:213], s[4:5]
    v_pk_mul_f32 v[214:215], v[214:215], s[4:5]
    v_pk_mul_f32 v[216:217], v[216:217], s[4:5]
    v_pk_mul_f32 v[218:219], v[218:219], s[4:5]
    v_pk_mul_f32 v[220:221], v[220:221], s[4:5]
    v_pk_mul_f32 v[222:223], v[222:223], s[4:5]
    v_cvt_pk_bf16_f32 v208, v208, v209
    v_cvt_pk_bf16_f32 v210, v210, v211
    v_cvt_pk_bf16_f32 v212, v212, v213
    v_cvt_pk_bf16_f32 v214, v214, v215
    v_cvt_pk_bf16_f32 v216, v216, v217
    v_cvt_pk_bf16_f32 v218, v218, v219
    v_cvt_pk_bf16_f32 v220, v220, v221
    v_cvt_pk_bf16_f32 v222, v222, v223
    v_accvgpr_write_b32 a24, v208
    v_accvgpr_write_b32 a25, v210
    v_accvgpr_write_b32 a26, v212
    v_accvgpr_write_b32 a27, v214
    s_add_u32 s73, s73, s42
    s_cmp_eq_u32 s73, s72
    s_cselect_b32 s73, 0, s73
    s_add_u32 s74, s73, s43
    s_xor_b32 s44, s44, 0x8000
    s_add_u32 s45, s45, 0x8000
    s_cmp_ge_u32 s45, 163840
    s_cselect_b32 s45, s55, s45
    s_mov_b32 m0, s44
    s_nop 0
    buffer_load_dwordx4 v3, s[8:11], s73 offen offset:0 sc1 lds
    v_accvgpr_write_b32 a28, v216
    v_accvgpr_write_b32 a29, v218
    v_accvgpr_write_b32 a30, v220
    v_accvgpr_write_b32 a31, v222
    v_pk_mul_f32 v[224:225], v[224:225], s[4:5]
    v_pk_mul_f32 v[226:227], v[226:227], s[4:5]
    v_pk_mul_f32 v[228:229], v[228:229], s[4:5]
    v_pk_mul_f32 v[230:231], v[230:231], s[4:5]
    v_pk_mul_f32 v[232:233], v[232:233], s[4:5]
    v_pk_mul_f32 v[234:235], v[234:235], s[4:5]
    v_pk_mul_f32 v[236:237], v[236:237], s[4:5]
    v_pk_mul_f32 v[238:239], v[238:239], s[4:5]
    v_cvt_pk_bf16_f32 v224, v224, v225
    v_cvt_pk_bf16_f32 v226, v226, v227
    v_cvt_pk_bf16_f32 v228, v228, v229
    v_cvt_pk_bf16_f32 v230, v230, v231
    v_cvt_pk_bf16_f32 v232, v232, v233
    v_cvt_pk_bf16_f32 v234, v234, v235
    v_cvt_pk_bf16_f32 v236, v236, v237
    v_cvt_pk_bf16_f32 v238, v238, v239
    buffer_load_dwordx4 v4, s[8:11], s73 offen offset:1024 sc1 lds
    v_accvgpr_write_b32 a32, v224
    v_accvgpr_write_b32 a33, v226
    v_accvgpr_write_b32 a34, v228
    v_accvgpr_write_b32 a35, v230
    v_accvgpr_write_b32 a36, v232
    v_accvgpr_write_b32 a37, v234
    v_accvgpr_write_b32 a38, v236
    v_accvgpr_write_b32 a39, v238
    v_pk_mul_f32 v[240:241], v[240:241], s[4:5]
    v_pk_mul_f32 v[242:243], v[242:243], s[4:5]
    v_pk_mul_f32 v[244:245], v[244:245], s[4:5]
    v_pk_mul_f32 v[246:247], v[246:247], s[4:5]
    v_pk_mul_f32 v[248:249], v[248:249], s[4:5]
    v_pk_mul_f32 v[250:251], v[250:251], s[4:5]
    v_pk_mul_f32 v[252:253], v[252:253], s[4:5]
    v_pk_mul_f32 v[254:255], v[254:255], s[4:5]
    v_cvt_pk_bf16_f32 v240, v240, v241
    v_cvt_pk_bf16_f32 v242, v242, v243
    v_cvt_pk_bf16_f32 v244, v244, v245
    v_cvt_pk_bf16_f32 v246, v246, v247
    buffer_load_dwordx4 v5, s[8:11], s73 offen offset:2048 sc1 lds
    v_cvt_pk_bf16_f32 v248, v248, v249
    v_cvt_pk_bf16_f32 v250, v250, v251
    v_cvt_pk_bf16_f32 v252, v252, v253
    v_cvt_pk_bf16_f32 v254, v254, v255
    v_accvgpr_write_b32 a40, v240
    v_accvgpr_write_b32 a41, v242
    v_accvgpr_write_b32 a42, v244
    v_accvgpr_write_b32 a43, v246
    v_accvgpr_write_b32 a44, v248
    v_accvgpr_write_b32 a45, v250
    v_accvgpr_write_b32 a46, v252
    v_accvgpr_write_b32 a47, v254
    s_mov_b32 s46, 65536
    v_mov_b32 v7, v2
    v_add_u32 v8, 65536, v2
    s_mov_b32 s47, 0x41c00000
    s_mov_b32 s37, 0
    s_mov_b32 s50, 0
    s_mov_b32 s51, 0
    v_mov_b64 v[24:25], 0
    buffer_load_dwordx4 v6, s[8:11], s73 offen offset:3072 sc1 lds
    v_mov_b64 v[26:27], 0
    v_mov_b64 v[28:29], 0
    v_mov_b64 v[30:31], 0
L_k2_go:
    s_waitcnt vmcnt(16) lgkmcnt(0)
    s_barrier
    ds_read_b128 a[128:131], v7 offset:0
    ds_read_b128 a[132:135], v7 offset:1024
    ds_read_b128 a[136:139], v7 offset:2048
    ds_read_b128 a[140:143], v7 offset:3072
    ds_read_b128 a[144:147], v7 offset:4096
    ds_read_b128 a[148:151], v7 offset:5120
    ds_read_b128 a[152:155], v7 offset:6144
    ds_read_b128 a[156:159], v7 offset:7168
    ds_read_b128 a[160:163], v7 offset:8192
    ds_read_b128 a[164:167], v7 offset:9216
    ds_read_b128 a[168:171], v7 offset:10240
    ds_read_b128 a[172:175], v7 offset:11264
    s_waitcnt lgkmcnt(8)
    v_mfma_f32_16x16x32_bf16 v[96:99], a[128:131], a[0:3], v[24:27]
    ds_read_b128 a[176:179], v7 offset:12288
    v_and_b32 v11, 15, v1
    v_lshrrev_b32 v16, 4, v1
    v_mfma_f32_16x16x32_bf16 v[104:107], a[128:131], a[4:7], v[28:31]
    v_lshlrev_b32 v16, 2, v16
    v_sub_u32 v11, v11, v16
    v_mfma_f32_16x16x32_bf16 v[100:103], a[132:135], a[0:3], v[24:27]
    ds_read_b128 a[180:183], v7 offset:13312
    v_mov_b32 v58, 0xf149f2ca
    v_mov_b32 v59, 0xf149f2ca
    v_mfma_f32_16x16x32_bf16 v[108:111], a[132:135], a[4:7], v[28:31]
    v_mov_b32 v14, 0
    v_mov_b32 v15, 0
    v_mfma_f32_16x16x32_bf16 v[96:99], a[136:139], a[8:11], v[96:99]
    ds_read_b128 a[184:187], v7 offset:14336
    v_add_u32 v48, 16384, v3
    v_add_u32 v49, 16384, v4
    v_mfma_f32_16x16x32_bf16 v[104:107], a[136:139], a[12:15], v[104:107]
    v_add_u32 v50, 16384, v5
    v_add_u32 v51, 16384, v6
    v_mfma_f32_16x16x32_bf16 v[100:103], a[140:143], a[8:11], v[100:103]
    ds_read_b128 a[188:191], v7 offset:15360
    v_cmp_gt_i32 s[20:21], 0, v11
    v_cmp_gt_i32 s[22:23], 1, v11
    v_mfma_f32_16x16x32_bf16 v[108:111], a[140:143], a[12:15], v[108:111]
    v_cmp_gt_i32 s[24:25], 2, v11
    v_cmp_gt_i32 s[26:27], 3, v11
    s_waitcnt lgkmcnt(8)
    v_mfma_f32_16x16x32_bf16 v[96:99], a[144:147], a[16:19], v[96:99]
    v_cndmask_b32 v64, 0, v58, s[20:21]
    v_cndmask_b32 v65, 0, v58, s[22:23]
    v_mfma_f32_16x16x32_bf16 v[104:107], a[144:147], a[20:23], v[104:107]
    v_cndmask_b32 v66, 0, v58, s[24:25]
    v_cndmask_b32 v67, 0, v58, s[26:27]
    v_mfma_f32_16x16x32_bf16 v[100:103], a[148:151], a[16:19], v[100:103]
    v_cmp_gt_i32 s[20:21], 16, v11
    v_cmp_gt_i32 s[22:23], 17, v11
    v_mfma_f32_16x16x32_bf16 v[108:111], a[148:151], a[20:23], v[108:111]
    v_cmp_gt_i32 s[24:25], 18, v11
    v_cmp_gt_i32 s[26:27], 19, v11
    v_mfma_f32_16x16x32_bf16 v[96:99], a[152:155], a[24:27], v[96:99]
    v_cndmask_b32 v68, 0, v58, s[20:21]
    v_cndmask_b32 v69, 0, v58, s[22:23]
    v_mfma_f32_16x16x32_bf16 v[104:107], a[152:155], a[28:31], v[104:107]
    v_cndmask_b32 v70, 0, v58, s[24:25]
    v_cndmask_b32 v71, 0, v58, s[26:27]
    v_mfma_f32_16x16x32_bf16 v[100:103], a[156:159], a[24:27], v[100:103]
    v_cmp_gt_i32 s[20:21], -16, v11
    v_cmp_gt_i32 s[22:23], -15, v11
    v_mfma_f32_16x16x32_bf16 v[108:111], a[156:159], a[28:31], v[108:111]
    v_cmp_gt_i32 s[24:25], -14, v11
    v_cmp_gt_i32 s[26:27], -13, v11
    s_waitcnt lgkmcnt(4)
    v_mfma_f32_16x16x32_bf16 v[96:99], a[160:163], a[32:35], v[96:99]
    v_cndmask_b32 v72, 0, v58, s[20:21]
    v_cndmask_b32 v73, 0, v58, s[22:23]
    v_mfma_f32_16x16x32_bf16 v[104:107], a[160:163], a[36:39], v[104:107]
    v_cndmask_b32 v74, 0, v58, s[24:25]
    v_cndmask_b32 v75, 0, v58, s[26:27]
    v_mfma_f32_16x16x32_bf16 v[100:103], a[164:167], a[32:35], v[100:103]
    v_cmp_gt_i32 s[20:21], 0, v11
    v_cmp_gt_i32 s[22:23], 1, v11
    v_mfma_f32_16x16x32_bf16 v[108:111], a[164:167], a[36:39], v[108:111]
    v_cmp_gt_i32 s[24:25], 2, v11
    v_cmp_gt_i32 s[26:27], 3, v11
    v_mfma_f32_16x16x32_bf16 v[96:99], a[168:171], a[40:43], v[96:99]
    v_cndmask_b32 v76, 0, v58, s[20:21]
    v_cndmask_b32 v77, 0, v58, s[22:23]
    v_mfma_f32_16x16x32_bf16 v[104:107], a[168:171], a[44:47], v[104:107]
    v_cndmask_b32 v78, 0, v58, s[24:25]
    v_cndmask_b32 v79, 0, v58, s[26:27]
    v_mfma_f32_16x16x32_bf16 v[100:103], a[172:175], a[40:43], v[100:103]
    v_lshrrev_b32 v16, 5, v1
    v_lshlrev_b32 v16, 2, v16
    v_mfma_f32_16x16x32_bf16 v[108:111], a[172:175], a[44:47], v[108:111]
    v_bfe_u32 v17, v1, 2, 2
    v_add_u32 v16, v16, v17
    s_waitcnt lgkmcnt(0)
    v_mfma_f32_16x16x32_bf16 v[96:99], a[176:179], a[48:51], v[96:99]
    v_mul_u32_u24 v16, 896, v16
    v_bfe_u32 v18, v1, 4, 1
    v_mfma_f32_16x16x32_bf16 v[104:107], a[176:179], a[52:55], v[104:107]
    v_lshlrev_b32 v18, 5, v18
    v_add_u32 v16, v16, v18
    v_mfma_f32_16x16x32_bf16 v[100:103], a[180:183], a[48:51], v[100:103]
    v_and_b32 v18, 3, v1
    v_lshlrev_b32 v18, 3, v18
    v_mfma_f32_16x16x32_bf16 v[108:111], a[180:183], a[52:55], v[108:111]
    v_add_u32 v16, v16, v18
    v_bfe_u32 v17, v1, 3, 1
    v_mfma_f32_16x16x32_bf16 v[96:99], a[184:187], a[56:59], v[96:99]
    v_lshlrev_b32 v17, 6, v17
    v_add_u32 v52, v16, v17
    v_mfma_f32_16x16x32_bf16 v[104:107], a[184:187], a[60:63], v[104:107]
    v_xor_b32 v17, 64, v17
    v_add_u32 v53, v16, v17
    v_mfma_f32_16x16x32_bf16 v[100:103], a[188:191], a[56:59], v[100:103]
    v_mfma_f32_16x16x32_bf16 v[108:111], a[188:191], a[60:63], v[108:111]
    s_waitcnt vmcnt(8)
    s_barrier
    ds_read_b128 a[128:131], v7 offset:16384
    ds_read_b128 a[132:135], v7 offset:17408
    ds_read_b128 a[136:139], v7 offset:18432
    ds_read_b128 a[140:143], v7 offset:19456
    ds_read_b128 a[144:147], v7 offset:20480
    ds_read_b128 a[148:151], v7 offset:21504
    ds_read_b128 a[152:155], v7 offset:22528
    ds_read_b128 a[156:159], v7 offset:23552
    ds_read_b128 a[160:163], v7 offset:24576
    ds_read_b128 a[164:167], v7 offset:25600
    ds_read_b128 a[168:171], v7 offset:26624
    ds_read_b128 a[172:175], v7 offset:27648
    s_cmp_lt_i32 s75, 1
    s_cbranch_scc0 L_k2_p_nomask
    s_cmp_eq_u32 s75, 0
    s_cbranch_scc0 L_k2_pmk_full
    v_pk_add_f32 v[96:97], v[96:97], v[64:65]
    v_pk_add_f32 v[98:99], v[98:99], v[66:67]
    v_pk_add_f32 v[100:101], v[100:101], v[68:69]
    v_pk_add_f32 v[102:103], v[102:103], v[70:71]
    v_pk_add_f32 v[104:105], v[104:105], v[72:73]
    v_pk_add_f32 v[106:107], v[106:107], v[74:75]
    v_pk_add_f32 v[108:109], v[108:109], v[76:77]
    v_pk_add_f32 v[110:111], v[110:111], v[78:79]
    s_branch L_k2_p_nomask
L_k2_pmk_full:
    v_mov_b64 v[96:97], v[58:59]
    v_mov_b64 v[98:99], v[58:59]
    v_mov_b64 v[100:101], v[58:59]
    v_mov_b64 v[102:103], v[58:59]
    v_mov_b64 v[104:105], v[58:59]
    v_mov_b64 v[106:107], v[58:59]
    v_mov_b64 v[108:109], v[58:59]
    v_mov_b64 v[110:111], v[58:59]
    s_branch L_k2_p_nomask
L_k2_p_nomask:
    s_sub_u32 s75, s75, 32
    v_max3_f32 v16, v96, v97, v98
    v_max3_f32 v16, v16, v99, v100
    v_max3_f32 v16, v16, v101, v102
    v_max_f32 v16, v16, v103
    v_max3_f32 v17, v104, v105, v106
    v_max3_f32 v17, v17, v107, v108
    v_max3_f32 v17, v17, v109, v110
    v_max_f32 v17, v17, v111
    v_mov_b32 v18, v16
    s_nop 1
    v_permlane16_swap_b32 v16, v18
    s_nop 1
    v_max_f32 v16, v16, v18
    v_mov_b32 v18, v16
    s_nop 1
    v_permlane32_swap_b32 v16, v18
    s_nop 1
    v_max_f32 v16, v16, v18
    v_mov_b32 v18, v17
    s_nop 1
    v_permlane16_swap_b32 v17, v18
    s_nop 1
    v_max_f32 v17, v17, v18
    v_mov_b32 v18, v17
    s_nop 1
    v_permlane32_swap_b32 v17, v18
    s_nop 1
    v_max_f32 v17, v17, v18
    v_max_f32 v32, 0xe0ad78ec, v16
    v_max_f32 v33, 0xe0ad78ec, v17
    v_mov_b64 v[34:35], 0
    v_pk_add_f32 v[96:97], v[96:97], v[32:33] op_sel:[0,0] op_sel_hi:[1,0] neg_lo:[0,1] neg_hi:[0,1]
    v_pk_add_f32 v[98:99], v[98:99], v[32:33] op_sel:[0,0] op_sel_hi:[1,0] neg_lo:[0,1] neg_hi:[0,1]
    v_pk_add_f32 v[100:101], v[100:101], v[32:33] op_sel:[0,0] op_sel_hi:[1,0] neg_lo:[0,1] neg_hi:[0,1]
    v_pk_add_f32 v[102:103], v[102:103], v[32:33] op_sel:[0,0] op_sel_hi:[1,0] neg_lo:[0,1] neg_hi:[0,1]
    v_pk_add_f32 v[104:105], v[104:105], v[32:33] op_sel:[0,1] op_sel_hi:[1,1] neg_lo:[0,1] neg_hi:[0,1]
    v_pk_add_f32 v[106:107], v[106:107], v[32:33] op_sel:[0,1] op_sel_hi:[1,1] neg_lo:[0,1] neg_hi:[0,1]
    v_pk_add_f32 v[108:109], v[108:109], v[32:33] op_sel:[0,1] op_sel_hi:[1,1] neg_lo:[0,1] neg_hi:[0,1]
    v_pk_add_f32 v[110:111], v[110:111], v[32:33] op_sel:[0,1] op_sel_hi:[1,1] neg_lo:[0,1] neg_hi:[0,1]
    v_sub_f32 v24, 0, v32
    v_sub_f32 v25, 0, v32
    v_sub_f32 v26, 0, v32
    v_sub_f32 v27, 0, v32
    v_sub_f32 v28, 0, v33
    v_sub_f32 v29, 0, v33
    v_sub_f32 v30, 0, v33
    v_sub_f32 v31, 0, v33
    s_waitcnt lgkmcnt(4)
L_k2_p0:
    v_mfma_f32_16x16x32_bf16 v[112:115], a[128:131], a[0:3], v[24:27]
    ds_read_b128 a[176:179], v7 offset:28672
    v_mfma_f32_16x16x32_bf16 v[120:123], a[128:131], a[4:7], v[28:31]
    v_exp_f32 v96, v96
    s_mov_b32 m0, s45
    v_mfma_f32_16x16x32_bf16 v[116:119], a[132:135], a[0:3], v[24:27]
    ds_read_b128 a[180:183], v7 offset:29696
    buffer_load_dwordx4 v3, s[8:11], s74 offen offset:0 sc1 lds
    v_mfma_f32_16x16x32_bf16 v[124:127], a[132:135], a[4:7], v[28:31]
    v_exp_f32 v97, v97
    v_mfma_f32_16x16x32_bf16 v[112:115], a[136:139], a[8:11], v[112:115]
    ds_read_b128 a[184:187], v7 offset:30720
    v_cvt_pk_bf16_f32 v40, v96, v97
    v_mfma_f32_16x16x32_bf16 v[120:123], a[136:139], a[12:15], v[120:123]
    v_exp_f32 v98, v98
    buffer_load_dwordx4 v4, s[8:11], s74 offen offset:1024 sc1 lds
    v_mfma_f32_16x16x32_bf16 v[116:119], a[140:143], a[8:11], v[116:119]
    ds_read_b128 a[188:191], v7 offset:31744
    v_add_f32 v34, v34, v96
    v_mfma_f32_16x16x32_bf16 v[124:127], a[140:143], a[12:15], v[124:127]
    v_exp_f32 v99, v99
    v_mfma_f32_16x16x32_bf16 v[112:115], a[144:147], a[16:19], v[112:115]
    ds_read_b128 a[128:131], v8 offset:0
    v_cvt_pk_bf16_f32 v41, v98, v99
    v_mfma_f32_16x16x32_bf16 v[120:123], a[144:147], a[20:23], v[120:123]
    v_exp_f32 v100, v100
    buffer_load_dwordx4 v5, s[8:11], s74 offen offset:2048 sc1 lds
    v_mfma_f32_16x16x32_bf16 v[116:119], a[148:151], a[16:19], v[116:119]
    ds_read_b128 a[132:135], v8 offset:1024
    v_xor_b32 v7, 0x8000, v7
    v_mfma_f32_16x16x32_bf16 v[124:127], a[148:151], a[20:23], v[124:127]
    v_exp_f32 v101, v101
    v_mfma_f32_16x16x32_bf16 v[112:115], a[152:155], a[24:27], v[112:115]
    ds_read_b128 a[136:139], v8 offset:2048
    v_cvt_pk_bf16_f32 v42, v100, v101
    v_mfma_f32_16x16x32_bf16 v[120:123], a[152:155], a[28:31], v[120:123]
    v_exp_f32 v102, v102
    buffer_load_dwordx4 v6, s[8:11], s74 offen offset:3072 sc1 lds
    s_add_u32 s73, s73, s42
    s_cmp_eq_u32 s73, s72
    s_cselect_b32 s73, 0, s73
    s_add_u32 s74, s73, s43
    s_add_u32 m0, s44, 16384
    v_mfma_f32_16x16x32_bf16 v[116:119], a[156:159], a[24:27], v[116:119]
    ds_read_b128 a[140:143], v8 offset:3072
    s_waitcnt lgkmcnt(4)
    v_mfma_f32_16x16x32_bf16 v[124:127], a[156:159], a[28:31], v[124:127]
    v_exp_f32 v103, v103
    v_mfma_f32_16x16x32_bf16 v[112:115], a[160:163], a[32:35], v[112:115]
    ds_read_b128 a[144:147], v8 offset:4096
    v_cvt_pk_bf16_f32 v43, v102, v103
    v_mfma_f32_16x16x32_bf16 v[120:123], a[160:163], a[36:39], v[120:123]
    v_exp_f32 v104, v104
    buffer_load_dwordx4 v3, s[8:11], s73 offen offset:0 sc1 lds
    v_mfma_f32_16x16x32_bf16 v[116:119], a[164:167], a[32:35], v[116:119]
    ds_read_b128 a[148:151], v8 offset:5120
    v_add_f32 v34, v34, v97
    v_mfma_f32_16x16x32_bf16 v[124:127], a[164:167], a[36:39], v[124:127]
    v_exp_f32 v105, v105
    v_mfma_f32_16x16x32_bf16 v[112:115], a[168:171], a[40:43], v[112:115]
    ds_read_b128 a[152:155], v8 offset:6144
    v_cvt_pk_bf16_f32 v44, v104, v105
    buffer_load_dwordx4 v4, s[8:11], s73 offen offset:1024 sc1 lds
    v_mfma_f32_16x16x32_bf16 v[120:123], a[168:171], a[44:47], v[120:123]
    v_exp_f32 v106, v106
    v_mfma_f32_16x16x32_bf16 v[116:119], a[172:175], a[40:43], v[116:119]
    ds_read_b128 a[156:159], v8 offset:7168
    v_add_f32 v34, v34, v98
    v_mfma_f32_16x16x32_bf16 v[124:127], a[172:175], a[44:47], v[124:127]
    v_exp_f32 v107, v107
    v_mfma_f32_16x16x32_bf16 v[112:115], a[176:179], a[48:51], v[112:115]
    ds_read_b128 a[160:163], v8 offset:8192
    v_cvt_pk_bf16_f32 v45, v106, v107
    buffer_load_dwordx4 v5, s[8:11], s73 offen offset:2048 sc1 lds
    v_mfma_f32_16x16x32_bf16 v[120:123], a[176:179], a[52:55], v[120:123]
    v_exp_f32 v108, v108
    v_mfma_f32_16x16x32_bf16 v[116:119], a[180:183], a[48:51], v[116:119]
    ds_read_b128 a[164:167], v8 offset:9216
    v_add_f32 v34, v34, v99
    v_mfma_f32_16x16x32_bf16 v[124:127], a[180:183], a[52:55], v[124:127]
    v_exp_f32 v109, v109
    v_mfma_f32_16x16x32_bf16 v[112:115], a[184:187], a[56:59], v[112:115]
    ds_read_b128 a[168:171], v8 offset:10240
    v_cvt_pk_bf16_f32 v46, v108, v109
    buffer_load_dwordx4 v6, s[8:11], s73 offen offset:3072 sc1 lds
    v_mfma_f32_16x16x32_bf16 v[120:123], a[184:187], a[60:63], v[120:123]
    v_exp_f32 v110, v110
    v_mfma_f32_16x16x32_bf16 v[116:119], a[188:191], a[56:59], v[116:119]
    ds_read_b128 a[172:175], v8 offset:11264
    s_waitcnt lgkmcnt(4)
    v_mfma_f32_16x16x32_bf16 v[124:127], a[188:191], a[60:63], v[124:127]
    v_exp_f32 v111, v111
    v_mfma_f32_16x16x32_bf16 v[128:131], a[128:131], v[40:43], 0
    ds_read_b128 a[176:179], v8 offset:12288
    v_cvt_pk_bf16_f32 v47, v110, v111
    v_mfma_f32_16x16x32_bf16 v[132:135], a[132:135], v[40:43], 0
    s_waitcnt vmcnt(8)
    s_barrier
    v_mfma_f32_16x16x32_bf16 v[144:147], a[136:139], v[40:43], 0
    ds_read_b128 a[180:183], v8 offset:13312
    v_add_f32 v34, v34, v100
    v_mfma_f32_16x16x32_bf16 v[136:139], a[128:131], v[44:47], 0
    s_bitcmp1_b64 s[80:81], s37
    s_cbranch_scc1 L_k2_p0_evt
L_k2_p0_evt_ret:
    v_mfma_f32_16x16x32_bf16 v[140:143], a[132:135], v[44:47], 0
    ds_read_b128 a[184:187], v8 offset:14336
    s_add_u32 m0, s45, 16384
    v_mfma_f32_16x16x32_bf16 v[152:155], a[136:139], v[44:47], 0
    buffer_load_dwordx4 v3, s[8:11], s74 offen offset:0 sc1 lds
    s_add_u32 s37, s37, 1
    v_mfma_f32_16x16x32_bf16 v[148:151], a[140:143], v[40:43], 0
    ds_read_b128 a[188:191], v8 offset:15360
    v_max3_f32 v12, v112, v113, v114
    v_mfma_f32_16x16x32_bf16 v[156:159], a[140:143], v[44:47], 0
    buffer_load_dwordx4 v4, s[8:11], s74 offen offset:1024 sc1 lds
    v_max3_f32 v12, v12, v115, v116
    v_mfma_f32_16x16x32_bf16 v[160:163], a[144:147], v[40:43], 0
    ds_read_b128 a[128:131], v7 offset:0
    v_max3_f32 v12, v12, v117, v118
    v_mfma_f32_16x16x32_bf16 v[168:171], a[144:147], v[44:47], 0
    buffer_load_dwordx4 v5, s[8:11], s74 offen offset:2048 sc1 lds
    v_max3_f32 v12, v12, v119, v120
    v_mfma_f32_16x16x32_bf16 v[164:167], a[148:151], v[40:43], 0
    ds_read_b128 a[132:135], v7 offset:1024
    v_max3_f32 v12, v12, v121, v122
    v_mfma_f32_16x16x32_bf16 v[172:175], a[148:151], v[44:47], 0
    buffer_load_dwordx4 v6, s[8:11], s74 offen offset:3072 sc1 lds
    s_add_u32 s73, s73, s42
    s_cmp_eq_u32 s73, s72
    s_cselect_b32 s73, 0, s73
    s_add_u32 s74, s73, s43
    s_xor_b32 s44, s44, 0x8000
    s_add_u32 s45, s45, 0x8000
    s_cmp_ge_u32 s45, 163840
    s_cselect_b32 s45, s55, s45
    s_mov_b32 m0, s44
    v_mfma_f32_16x16x32_bf16 v[176:179], a[152:155], v[40:43], 0
    ds_read_b128 a[136:139], v7 offset:2048
    v_max3_f32 v12, v12, v123, v124
    v_mfma_f32_16x16x32_bf16 v[184:187], a[152:155], v[44:47], 0
    buffer_load_dwordx4 v3, s[8:11], s73 offen offset:0 sc1 lds
    v_max3_f32 v12, v12, v125, v126
    v_mfma_f32_16x16x32_bf16 v[180:183], a[156:159], v[40:43], 0
    ds_read_b128 a[140:143], v7 offset:3072
    s_waitcnt lgkmcnt(4)
    v_mfma_f32_16x16x32_bf16 v[188:191], a[156:159], v[44:47], 0
    buffer_load_dwordx4 v4, s[8:11], s73 offen offset:1024 sc1 lds
    v_max_f32 v12, v12, v127
    v_mfma_f32_16x16x32_bf16 v[192:195], a[160:163], v[40:43], 0
    ds_read_b128 a[144:147], v7 offset:4096
    v_cmp_lt_f32 vcc, s47, v12
    v_mfma_f32_16x16x32_bf16 v[200:203], a[160:163], v[44:47], 0
    buffer_load_dwordx4 v5, s[8:11], s73 offen offset:2048 sc1 lds
    v_add_f32 v34, v34, v101
    v_mfma_f32_16x16x32_bf16 v[196:199], a[164:167], v[40:43], 0
    ds_read_b128 a[148:151], v7 offset:5120
    v_add_f32 v34, v34, v102
    v_mfma_f32_16x16x32_bf16 v[204:207], a[164:167], v[44:47], 0
    buffer_load_dwordx4 v6, s[8:11], s73 offen offset:3072 sc1 lds
    s_mov_b32 m0, s45
    v_mfma_f32_16x16x32_bf16 v[208:211], a[168:171], v[40:43], 0
    ds_read_b128 a[152:155], v7 offset:6144
    v_add_f32 v34, v34, v103
    v_mfma_f32_16x16x32_bf16 v[216:219], a[168:171], v[44:47], 0
    buffer_load_dwordx4 v3, s[8:11], s74 offen offset:0 sc1 lds
    v_add_f32 v35, v35, v104
    v_mfma_f32_16x16x32_bf16 v[212:215], a[172:175], v[40:43], 0
    ds_read_b128 a[156:159], v7 offset:7168
    v_add_f32 v35, v35, v105
    v_mfma_f32_16x16x32_bf16 v[220:223], a[172:175], v[44:47], 0
    buffer_load_dwordx4 v4, s[8:11], s74 offen offset:1024 sc1 lds
    v_add_f32 v35, v35, v106
    v_mfma_f32_16x16x32_bf16 v[224:227], a[176:179], v[40:43], 0
    ds_read_b128 a[160:163], v7 offset:8192
    v_add_f32 v35, v35, v107
    v_mfma_f32_16x16x32_bf16 v[232:235], a[176:179], v[44:47], 0
    buffer_load_dwordx4 v5, s[8:11], s74 offen offset:2048 sc1 lds
    v_add_f32 v35, v35, v108
    v_mfma_f32_16x16x32_bf16 v[228:231], a[180:183], v[40:43], 0
    ds_read_b128 a[164:167], v7 offset:9216
    v_add_f32 v35, v35, v109
    v_mfma_f32_16x16x32_bf16 v[236:239], a[180:183], v[44:47], 0
    buffer_load_dwordx4 v6, s[8:11], s74 offen offset:3072 sc1 lds
    s_add_u32 s73, s73, s42
    s_cmp_eq_u32 s73, s72
    s_cselect_b32 s73, 0, s73
    s_add_u32 s74, s73, s43
    v_mfma_f32_16x16x32_bf16 v[240:243], a[184:187], v[40:43], 0
    ds_read_b128 a[168:171], v7 offset:10240
    v_add_f32 v35, v35, v110
    v_mfma_f32_16x16x32_bf16 v[248:251], a[184:187], v[44:47], 0
    v_add_f32 v35, v35, v111
    v_mfma_f32_16x16x32_bf16 v[244:247], a[188:191], v[40:43], 0
    ds_read_b128 a[172:175], v7 offset:11264
    s_waitcnt lgkmcnt(4)
    v_mfma_f32_16x16x32_bf16 v[252:255], a[188:191], v[44:47], 0
    s_cbranch_vccnz L_k2_p0_resc
L_k2_p0_resc_ret:
L_k2_p1:
    v_mfma_f32_16x16x32_bf16 v[96:99], a[128:131], a[0:3], v[24:27]
    ds_read_b128 a[176:179], v7 offset:12288
    v_mfma_f32_16x16x32_bf16 v[104:107], a[128:131], a[4:7], v[28:31]
    v_exp_f32 v112, v112
    s_add_u32 m0, s44, 16384
    v_mfma_f32_16x16x32_bf16 v[100:103], a[132:135], a[0:3], v[24:27]
    ds_read_b128 a[180:183], v7 offset:13312
    buffer_load_dwordx4 v3, s[8:11], s73 offen offset:0 sc1 lds
    v_mfma_f32_16x16x32_bf16 v[108:111], a[132:135], a[4:7], v[28:31]
    v_exp_f32 v113, v113
    v_mfma_f32_16x16x32_bf16 v[96:99], a[136:139], a[8:11], v[96:99]
    ds_read_b128 a[184:187], v7 offset:14336
    v_cvt_pk_bf16_f32 v40, v112, v113
    v_mfma_f32_16x16x32_bf16 v[104:107], a[136:139], a[12:15], v[104:107]
    v_exp_f32 v114, v114
    buffer_load_dwordx4 v4, s[8:11], s73 offen offset:1024 sc1 lds
    v_mfma_f32_16x16x32_bf16 v[100:103], a[140:143], a[8:11], v[100:103]
    ds_read_b128 a[188:191], v7 offset:15360
    v_add_f32 v34, v34, v112
    v_mfma_f32_16x16x32_bf16 v[108:111], a[140:143], a[12:15], v[108:111]
    v_exp_f32 v115, v115
    v_mfma_f32_16x16x32_bf16 v[96:99], a[144:147], a[16:19], v[96:99]
    ds_read_b128 a[128:131], v8 offset:16384
    v_cvt_pk_bf16_f32 v41, v114, v115
    v_mfma_f32_16x16x32_bf16 v[104:107], a[144:147], a[20:23], v[104:107]
    v_exp_f32 v116, v116
    buffer_load_dwordx4 v5, s[8:11], s73 offen offset:2048 sc1 lds
    v_mfma_f32_16x16x32_bf16 v[100:103], a[148:151], a[16:19], v[100:103]
    ds_read_b128 a[132:135], v8 offset:17408
    v_add_f32 v34, v34, v113
    v_mfma_f32_16x16x32_bf16 v[108:111], a[148:151], a[20:23], v[108:111]
    v_exp_f32 v117, v117
    v_mfma_f32_16x16x32_bf16 v[96:99], a[152:155], a[24:27], v[96:99]
    ds_read_b128 a[136:139], v8 offset:18432
    v_cvt_pk_bf16_f32 v42, v116, v117
    v_mfma_f32_16x16x32_bf16 v[104:107], a[152:155], a[28:31], v[104:107]
    v_exp_f32 v118, v118
    buffer_load_dwordx4 v6, s[8:11], s73 offen offset:3072 sc1 lds
    s_add_u32 m0, s45, 16384
    v_mfma_f32_16x16x32_bf16 v[100:103], a[156:159], a[24:27], v[100:103]
    ds_read_b128 a[140:143], v8 offset:19456
    s_waitcnt lgkmcnt(4)
    v_mfma_f32_16x16x32_bf16 v[108:111], a[156:159], a[28:31], v[108:111]
    v_exp_f32 v119, v119
    v_mfma_f32_16x16x32_bf16 v[96:99], a[160:163], a[32:35], v[96:99]
    ds_read_b128 a[144:147], v8 offset:20480
    v_cvt_pk_bf16_f32 v43, v118, v119
    v_mfma_f32_16x16x32_bf16 v[104:107], a[160:163], a[36:39], v[104:107]
    v_exp_f32 v120, v120
    buffer_load_dwordx4 v3, s[8:11], s74 offen offset:0 sc1 lds
    v_mfma_f32_16x16x32_bf16 v[100:103], a[164:167], a[32:35], v[100:103]
    ds_read_b128 a[148:151], v8 offset:21504
    v_add_f32 v34, v34, v114
    v_mfma_f32_16x16x32_bf16 v[108:111], a[164:167], a[36:39], v[108:111]
    v_exp_f32 v121, v121
    v_mfma_f32_16x16x32_bf16 v[96:99], a[168:171], a[40:43], v[96:99]
    ds_read_b128 a[152:155], v8 offset:22528
    v_cvt_pk_bf16_f32 v44, v120, v121
    buffer_load_dwordx4 v4, s[8:11], s74 offen offset:1024 sc1 lds
    v_mfma_f32_16x16x32_bf16 v[104:107], a[168:171], a[44:47], v[104:107]
    v_exp_f32 v122, v122
    v_mfma_f32_16x16x32_bf16 v[100:103], a[172:175], a[40:43], v[100:103]
    ds_read_b128 a[156:159], v8 offset:23552
    v_add_f32 v34, v34, v115
    v_mfma_f32_16x16x32_bf16 v[108:111], a[172:175], a[44:47], v[108:111]
    v_exp_f32 v123, v123
    v_mfma_f32_16x16x32_bf16 v[96:99], a[176:179], a[48:51], v[96:99]
    ds_read_b128 a[160:163], v8 offset:24576
    v_cvt_pk_bf16_f32 v45, v122, v123
    buffer_load_dwordx4 v5, s[8:11], s74 offen offset:2048 sc1 lds
    v_mfma_f32_16x16x32_bf16 v[104:107], a[176:179], a[52:55], v[104:107]
    v_exp_f32 v124, v124
    v_mfma_f32_16x16x32_bf16 v[100:103], a[180:183], a[48:51], v[100:103]
    ds_read_b128 a[164:167], v8 offset:25600
    v_add_f32 v34, v34, v116
    v_mfma_f32_16x16x32_bf16 v[108:111], a[180:183], a[52:55], v[108:111]
    v_exp_f32 v125, v125
    v_mfma_f32_16x16x32_bf16 v[96:99], a[184:187], a[56:59], v[96:99]
    ds_read_b128 a[168:171], v8 offset:26624
    v_cvt_pk_bf16_f32 v46, v124, v125
    buffer_load_dwordx4 v6, s[8:11], s74 offen offset:3072 sc1 lds
    s_add_u32 s73, s73, s42
    s_cmp_eq_u32 s73, s72
    s_cselect_b32 s73, 0, s73
    s_add_u32 s74, s73, s43
    s_xor_b32 s44, s44, 0x8000
    s_add_u32 s45, s45, 0x8000
    s_cmp_ge_u32 s45, 163840
    s_cselect_b32 s45, s55, s45
    v_mfma_f32_16x16x32_bf16 v[104:107], a[184:187], a[60:63], v[104:107]
    v_exp_f32 v126, v126
    v_mfma_f32_16x16x32_bf16 v[100:103], a[188:191], a[56:59], v[100:103]
    ds_read_b128 a[172:175], v8 offset:27648
    s_waitcnt lgkmcnt(4)
    v_mfma_f32_16x16x32_bf16 v[108:111], a[188:191], a[60:63], v[108:111]
    v_exp_f32 v127, v127
    v_mfma_f32_16x16x32_bf16 v[128:131], a[128:131], v[40:43], v[128:131]
    ds_read_b128 a[176:179], v8 offset:28672
    v_cvt_pk_bf16_f32 v47, v126, v127
    v_mfma_f32_16x16x32_bf16 v[132:135], a[132:135], v[40:43], v[132:135]
    s_waitcnt vmcnt(20)
    s_barrier
    v_mfma_f32_16x16x32_bf16 v[144:147], a[136:139], v[40:43], v[144:147]
    ds_read_b128 a[180:183], v8 offset:29696
    v_add_f32 v34, v34, v117
    v_mfma_f32_16x16x32_bf16 v[136:139], a[128:131], v[44:47], v[136:139]
    s_bitcmp1_b64 s[80:81], s37
    s_cbranch_scc1 L_k2_p1_evt
L_k2_p1_evt_ret:
    v_mfma_f32_16x16x32_bf16 v[140:143], a[132:135], v[44:47], v[140:143]
    ds_read_b128 a[184:187], v8 offset:30720
    s_mov_b32 m0, s44
    v_mfma_f32_16x16x32_bf16 v[152:155], a[136:139], v[44:47], v[152:155]
    buffer_load_dwordx4 v3, s[8:11], s73 offen offset:0 sc1 lds
    s_add_u32 s37, s37, 1
    v_mfma_f32_16x16x32_bf16 v[148:151], a[140:143], v[40:43], v[148:151]
    ds_read_b128 a[188:191], v8 offset:31744
    v_max3_f32 v12, v96, v97, v98
    v_mfma_f32_16x16x32_bf16 v[156:159], a[140:143], v[44:47], v[156:159]
    v_max3_f32 v12, v12, v99, v100
    v_max3_f32 v12, v12, v101, v102
    v_mfma_f32_16x16x32_bf16 v[160:163], a[144:147], v[40:43], v[160:163]
    ds_read_b128 a[128:131], v7 offset:16384
    buffer_load_dwordx4 v4, s[8:11], s73 offen offset:1024 sc1 lds
    v_mfma_f32_16x16x32_bf16 v[168:171], a[144:147], v[44:47], v[168:171]
    v_max3_f32 v12, v12, v103, v104
    v_max3_f32 v12, v12, v105, v106
    v_mfma_f32_16x16x32_bf16 v[164:167], a[148:151], v[40:43], v[164:167]
    ds_read_b128 a[132:135], v7 offset:17408
    v_max3_f32 v12, v12, v107, v108
    v_mfma_f32_16x16x32_bf16 v[172:175], a[148:151], v[44:47], v[172:175]
    buffer_load_dwordx4 v5, s[8:11], s73 offen offset:2048 sc1 lds
    v_max3_f32 v12, v12, v109, v110
    v_mfma_f32_16x16x32_bf16 v[176:179], a[152:155], v[40:43], v[176:179]
    ds_read_b128 a[136:139], v7 offset:18432
    v_max_f32 v12, v12, v111
    v_mfma_f32_16x16x32_bf16 v[184:187], a[152:155], v[44:47], v[184:187]
    v_cmp_lt_f32 vcc, s47, v12
    v_add_f32 v34, v34, v118
    v_mfma_f32_16x16x32_bf16 v[180:183], a[156:159], v[40:43], v[180:183]
    ds_read_b128 a[140:143], v7 offset:19456
    s_waitcnt lgkmcnt(4)
    buffer_load_dwordx4 v6, s[8:11], s73 offen offset:3072 sc1 lds
    s_mov_b32 m0, s45
    v_mfma_f32_16x16x32_bf16 v[188:191], a[156:159], v[44:47], v[188:191]
    v_add_f32 v34, v34, v119
    v_add_f32 v35, v35, v120
    v_mfma_f32_16x16x32_bf16 v[192:195], a[160:163], v[40:43], v[192:195]
    ds_read_b128 a[144:147], v7 offset:20480
    v_add_f32 v35, v35, v121
    v_mfma_f32_16x16x32_bf16 v[200:203], a[160:163], v[44:47], v[200:203]
    buffer_load_dwordx4 v3, s[8:11], s74 offen offset:0 sc1 lds
    v_add_f32 v35, v35, v122
    v_mfma_f32_16x16x32_bf16 v[196:199], a[164:167], v[40:43], v[196:199]
    ds_read_b128 a[148:151], v7 offset:21504
    v_add_f32 v35, v35, v123
    v_mfma_f32_16x16x32_bf16 v[204:207], a[164:167], v[44:47], v[204:207]
    v_add_f32 v35, v35, v124
    v_add_f32 v35, v35, v125
    v_mfma_f32_16x16x32_bf16 v[208:211], a[168:171], v[40:43], v[208:211]
    ds_read_b128 a[152:155], v7 offset:22528
    buffer_load_dwordx4 v4, s[8:11], s74 offen offset:1024 sc1 lds
    v_mfma_f32_16x16x32_bf16 v[216:219], a[168:171], v[44:47], v[216:219]
    v_add_f32 v35, v35, v126
    v_add_f32 v35, v35, v127
    v_mfma_f32_16x16x32_bf16 v[212:215], a[172:175], v[40:43], v[212:215]
    ds_read_b128 a[156:159], v7 offset:23552
    v_mfma_f32_16x16x32_bf16 v[220:223], a[172:175], v[44:47], v[220:223]
    buffer_load_dwordx4 v5, s[8:11], s74 offen offset:2048 sc1 lds
    v_mfma_f32_16x16x32_bf16 v[224:227], a[176:179], v[40:43], v[224:227]
    ds_read_b128 a[160:163], v7 offset:24576
    v_mfma_f32_16x16x32_bf16 v[232:235], a[176:179], v[44:47], v[232:235]
    v_mfma_f32_16x16x32_bf16 v[228:231], a[180:183], v[40:43], v[228:231]
    ds_read_b128 a[164:167], v7 offset:25600
    buffer_load_dwordx4 v6, s[8:11], s74 offen offset:3072 sc1 lds
    s_add_u32 s73, s73, s42
    s_cmp_eq_u32 s73, s72
    s_cselect_b32 s73, 0, s73
    s_add_u32 s74, s73, s43
    v_mfma_f32_16x16x32_bf16 v[236:239], a[180:183], v[44:47], v[236:239]
    v_mfma_f32_16x16x32_bf16 v[240:243], a[184:187], v[40:43], v[240:243]
    ds_read_b128 a[168:171], v7 offset:26624
    v_mfma_f32_16x16x32_bf16 v[248:251], a[184:187], v[44:47], v[248:251]
    s_add_u32 s46, s46, 0x8000
    s_cmp_ge_u32 s46, 163840
    s_cselect_b32 s46, 65536, s46
    v_add_u32 v8, s46, v2
    v_mfma_f32_16x16x32_bf16 v[244:247], a[188:191], v[40:43], v[244:247]
    ds_read_b128 a[172:175], v7 offset:27648
    s_waitcnt lgkmcnt(4)
    v_mfma_f32_16x16x32_bf16 v[252:255], a[188:191], v[44:47], v[252:255]
    s_cbranch_vccnz L_k2_p1_resc
L_k2_p1_resc_ret:
L_k2_b0:
    v_mfma_f32_16x16x32_bf16 v[112:115], a[128:131], a[0:3], v[24:27]
    ds_read_b128 a[176:179], v7 offset:28672
    v_mfma_f32_16x16x32_bf16 v[120:123], a[128:131], a[4:7], v[28:31]
    v_exp_f32 v96, v96
    v_mfma_f32_16x16x32_bf16 v[116:119], a[132:135], a[0:3], v[24:27]
    ds_read_b128 a[180:183], v7 offset:29696
    v_add_f32 v34, v34, v96
    v_mfma_f32_16x16x32_bf16 v[124:127], a[132:135], a[4:7], v[28:31]
    v_exp_f32 v97, v97
    v_mfma_f32_16x16x32_bf16 v[112:115], a[136:139], a[8:11], v[112:115]
    ds_read_b128 a[184:187], v7 offset:30720
    v_cvt_pk_bf16_f32 v40, v96, v97
    v_mfma_f32_16x16x32_bf16 v[120:123], a[136:139], a[12:15], v[120:123]
    v_exp_f32 v98, v98
    v_mfma_f32_16x16x32_bf16 v[116:119], a[140:143], a[8:11], v[116:119]
    ds_read_b128 a[188:191], v7 offset:31744
    v_add_f32 v34, v34, v97
    v_mfma_f32_16x16x32_bf16 v[124:127], a[140:143], a[12:15], v[124:127]
    v_exp_f32 v99, v99
    v_mfma_f32_16x16x32_bf16 v[112:115], a[144:147], a[16:19], v[112:115]
    ds_read_b128 a[128:131], v8 offset:0
    v_cvt_pk_bf16_f32 v41, v98, v99
    v_mfma_f32_16x16x32_bf16 v[120:123], a[144:147], a[20:23], v[120:123]
    v_exp_f32 v100, v100
    v_mfma_f32_16x16x32_bf16 v[116:119], a[148:151], a[16:19], v[116:119]
    ds_read_b128 a[132:135], v8 offset:1024
    v_xor_b32 v7, 0x8000, v7
    v_mfma_f32_16x16x32_bf16 v[124:127], a[148:151], a[20:23], v[124:127]
    v_exp_f32 v101, v101
    v_mfma_f32_16x16x32_bf16 v[112:115], a[152:155], a[24:27], v[112:115]
    ds_read_b128 a[136:139], v8 offset:2048
    v_cvt_pk_bf16_f32 v42, v100, v101
    v_mfma_f32_16x16x32_bf16 v[120:123], a[152:155], a[28:31], v[120:123]
    v_exp_f32 v102, v102
    v_mfma_f32_16x16x32_bf16 v[116:119], a[156:159], a[24:27], v[116:119]
    ds_read_b128 a[140:143], v8 offset:3072
    s_waitcnt lgkmcnt(4)
    v_mfma_f32_16x16x32_bf16 v[124:127], a[156:159], a[28:31], v[124:127]
    v_exp_f32 v103, v103
    v_mfma_f32_16x16x32_bf16 v[112:115], a[160:163], a[32:35], v[112:115]
    ds_read_b128 a[144:147], v8 offset:4096
    v_cvt_pk_bf16_f32 v43, v102, v103
    v_mfma_f32_16x16x32_bf16 v[120:123], a[160:163], a[36:39], v[120:123]
    v_exp_f32 v104, v104
    v_mfma_f32_16x16x32_bf16 v[116:119], a[164:167], a[32:35], v[116:119]
    ds_read_b128 a[148:151], v8 offset:5120
    v_add_f32 v34, v34, v98
    v_mfma_f32_16x16x32_bf16 v[124:127], a[164:167], a[36:39], v[124:127]
    v_exp_f32 v105, v105
    v_mfma_f32_16x16x32_bf16 v[112:115], a[168:171], a[40:43], v[112:115]
    ds_read_b128 a[152:155], v8 offset:6144
    v_cvt_pk_bf16_f32 v44, v104, v105
    v_mfma_f32_16x16x32_bf16 v[120:123], a[168:171], a[44:47], v[120:123]
    v_exp_f32 v106, v106
    v_mfma_f32_16x16x32_bf16 v[116:119], a[172:175], a[40:43], v[116:119]
    ds_read_b128 a[156:159], v8 offset:7168
    v_add_f32 v34, v34, v99
    v_mfma_f32_16x16x32_bf16 v[124:127], a[172:175], a[44:47], v[124:127]
    v_exp_f32 v107, v107
    v_mfma_f32_16x16x32_bf16 v[112:115], a[176:179], a[48:51], v[112:115]
    ds_read_b128 a[160:163], v8 offset:8192
    v_cvt_pk_bf16_f32 v45, v106, v107
    v_mfma_f32_16x16x32_bf16 v[120:123], a[176:179], a[52:55], v[120:123]
    v_exp_f32 v108, v108
    v_mfma_f32_16x16x32_bf16 v[116:119], a[180:183], a[48:51], v[116:119]
    ds_read_b128 a[164:167], v8 offset:9216
    v_add_f32 v34, v34, v100
    v_add_f32 v35, v35, v108
    v_mfma_f32_16x16x32_bf16 v[124:127], a[180:183], a[52:55], v[124:127]
    v_exp_f32 v109, v109
    v_mfma_f32_16x16x32_bf16 v[112:115], a[184:187], a[56:59], v[112:115]
    ds_read_b128 a[168:171], v8 offset:10240
    v_cvt_pk_bf16_f32 v46, v108, v109
    v_add_f32 v35, v35, v109
    v_mfma_f32_16x16x32_bf16 v[120:123], a[184:187], a[60:63], v[120:123]
    v_exp_f32 v110, v110
    v_mfma_f32_16x16x32_bf16 v[116:119], a[188:191], a[56:59], v[116:119]
    ds_read_b128 a[172:175], v8 offset:11264
    s_waitcnt lgkmcnt(4)
    v_add_f32 v35, v35, v110
    v_mfma_f32_16x16x32_bf16 v[124:127], a[188:191], a[60:63], v[124:127]
    v_exp_f32 v111, v111
    v_mfma_f32_16x16x32_bf16 v[128:131], a[128:131], v[40:43], v[128:131]
    ds_read_b128 a[176:179], v8 offset:12288
    v_cvt_pk_bf16_f32 v47, v110, v111
    v_add_f32 v35, v35, v111
    v_mfma_f32_16x16x32_bf16 v[132:135], a[132:135], v[40:43], v[132:135]
    s_waitcnt vmcnt(20)
    s_barrier
    v_mfma_f32_16x16x32_bf16 v[144:147], a[136:139], v[40:43], v[144:147]
    ds_read_b128 a[180:183], v8 offset:13312
    v_add_f32 v34, v34, v101
    v_mfma_f32_16x16x32_bf16 v[136:139], a[128:131], v[44:47], v[136:139]
    s_bitcmp1_b64 s[80:81], s37
    s_cbranch_scc1 L_k2_b0_evt
L_k2_b0_evt_ret:
    v_mfma_f32_16x16x32_bf16 v[140:143], a[132:135], v[44:47], v[140:143]
    ds_read_b128 a[184:187], v8 offset:14336
    s_add_u32 m0, s44, 16384
    v_mfma_f32_16x16x32_bf16 v[152:155], a[136:139], v[44:47], v[152:155]
    buffer_load_dwordx4 v3, s[8:11], s73 offen offset:0 sc1 lds
    v_mfma_f32_16x16x32_bf16 v[148:151], a[140:143], v[40:43], v[148:151]
    ds_read_b128 a[188:191], v8 offset:15360
    s_xor_b32 s44, s44, 0x8000
    v_mfma_f32_16x16x32_bf16 v[156:159], a[140:143], v[44:47], v[156:159]
    buffer_load_dwordx4 v4, s[8:11], s73 offen offset:1024 sc1 lds
    v_mfma_f32_16x16x32_bf16 v[160:163], a[144:147], v[40:43], v[160:163]
    ds_read_b128 a[128:131], v7 offset:0
    s_add_u32 s37, s37, 1
    v_mfma_f32_16x16x32_bf16 v[168:171], a[144:147], v[44:47], v[168:171]
    v_max3_f32 v12, v112, v113, v114
    v_max3_f32 v12, v12, v115, v116
    v_mfma_f32_16x16x32_bf16 v[164:167], a[148:151], v[40:43], v[164:167]
    ds_read_b128 a[132:135], v7 offset:1024
    v_max3_f32 v12, v12, v117, v118
    v_mfma_f32_16x16x32_bf16 v[172:175], a[148:151], v[44:47], v[172:175]
    buffer_load_dwordx4 v5, s[8:11], s73 offen offset:2048 sc1 lds
    v_mfma_f32_16x16x32_bf16 v[176:179], a[152:155], v[40:43], v[176:179]
    ds_read_b128 a[136:139], v7 offset:2048
    v_max3_f32 v12, v12, v119, v120
    v_mfma_f32_16x16x32_bf16 v[184:187], a[152:155], v[44:47], v[184:187]
    buffer_load_dwordx4 v6, s[8:11], s73 offen offset:3072 sc1 lds
    v_mfma_f32_16x16x32_bf16 v[180:183], a[156:159], v[40:43], v[180:183]
    ds_read_b128 a[140:143], v7 offset:3072
    s_waitcnt lgkmcnt(4)
    v_mfma_f32_16x16x32_bf16 v[188:191], a[156:159], v[44:47], v[188:191]
    v_max3_f32 v12, v12, v121, v122
    v_max3_f32 v12, v12, v123, v124
    v_mfma_f32_16x16x32_bf16 v[192:195], a[160:163], v[40:43], v[192:195]
    ds_read_b128 a[144:147], v7 offset:4096
    s_add_u32 m0, s45, 16384
    v_mfma_f32_16x16x32_bf16 v[200:203], a[160:163], v[44:47], v[200:203]
    buffer_load_dwordx4 v48, s[8:11], s73 offen offset:0 sc1 lds
    v_mfma_f32_16x16x32_bf16 v[196:199], a[164:167], v[40:43], v[196:199]
    ds_read_b128 a[148:151], v7 offset:5120
    v_max3_f32 v12, v12, v125, v126
    v_mfma_f32_16x16x32_bf16 v[204:207], a[164:167], v[44:47], v[204:207]
    buffer_load_dwordx4 v49, s[8:11], s73 offen offset:1024 sc1 lds
    v_mfma_f32_16x16x32_bf16 v[208:211], a[168:171], v[40:43], v[208:211]
    ds_read_b128 a[152:155], v7 offset:6144
    v_max_f32 v12, v12, v127
    v_mfma_f32_16x16x32_bf16 v[216:219], a[168:171], v[44:47], v[216:219]
    s_add_u32 s45, s45, 0x8000
    s_cmp_ge_u32 s45, 163840
    s_cselect_b32 s45, s55, s45
    v_mfma_f32_16x16x32_bf16 v[212:215], a[172:175], v[40:43], v[212:215]
    ds_read_b128 a[156:159], v7 offset:7168
    v_cmp_lt_f32 vcc, s47, v12
    v_mfma_f32_16x16x32_bf16 v[220:223], a[172:175], v[44:47], v[220:223]
    buffer_load_dwordx4 v50, s[8:11], s73 offen offset:2048 sc1 lds
    v_mfma_f32_16x16x32_bf16 v[224:227], a[176:179], v[40:43], v[224:227]
    ds_read_b128 a[160:163], v7 offset:8192
    v_add_f32 v34, v34, v102
    v_mfma_f32_16x16x32_bf16 v[232:235], a[176:179], v[44:47], v[232:235]
    buffer_load_dwordx4 v51, s[8:11], s73 offen offset:3072 sc1 lds
    v_mfma_f32_16x16x32_bf16 v[228:231], a[180:183], v[40:43], v[228:231]
    ds_read_b128 a[164:167], v7 offset:9216
    s_add_u32 s73, s73, s42
    v_mfma_f32_16x16x32_bf16 v[236:239], a[180:183], v[44:47], v[236:239]
    v_add_f32 v34, v34, v103
    v_add_f32 v35, v35, v104
    v_mfma_f32_16x16x32_bf16 v[240:243], a[184:187], v[40:43], v[240:243]
    ds_read_b128 a[168:171], v7 offset:10240
    v_add_f32 v35, v35, v105
    v_mfma_f32_16x16x32_bf16 v[248:251], a[184:187], v[44:47], v[248:251]
    v_add_f32 v35, v35, v106
    v_add_f32 v35, v35, v107
    v_mfma_f32_16x16x32_bf16 v[244:247], a[188:191], v[40:43], v[244:247]
    ds_read_b128 a[172:175], v7 offset:11264
    s_waitcnt lgkmcnt(4)
    v_mfma_f32_16x16x32_bf16 v[252:255], a[188:191], v[44:47], v[252:255]
    s_cbranch_vccnz L_k2_b0_resc
L_k2_b0_resc_ret:
L_k2_b1:
    v_mfma_f32_16x16x32_bf16 v[96:99], a[128:131], a[0:3], v[24:27]
    ds_read_b128 a[176:179], v7 offset:12288
    v_mfma_f32_16x16x32_bf16 v[104:107], a[128:131], a[4:7], v[28:31]
    v_exp_f32 v112, v112
    v_mfma_f32_16x16x32_bf16 v[100:103], a[132:135], a[0:3], v[24:27]
    ds_read_b128 a[180:183], v7 offset:13312
    v_add_f32 v34, v34, v112
    v_mfma_f32_16x16x32_bf16 v[108:111], a[132:135], a[4:7], v[28:31]
    v_exp_f32 v113, v113
    v_mfma_f32_16x16x32_bf16 v[96:99], a[136:139], a[8:11], v[96:99]
    ds_read_b128 a[184:187], v7 offset:14336
    v_cvt_pk_bf16_f32 v40, v112, v113
    v_mfma_f32_16x16x32_bf16 v[104:107], a[136:139], a[12:15], v[104:107]
    v_exp_f32 v114, v114
    v_mfma_f32_16x16x32_bf16 v[100:103], a[140:143], a[8:11], v[100:103]
    ds_read_b128 a[188:191], v7 offset:15360
    v_add_f32 v34, v34, v113
    v_mfma_f32_16x16x32_bf16 v[108:111], a[140:143], a[12:15], v[108:111]
    v_exp_f32 v115, v115
    v_mfma_f32_16x16x32_bf16 v[96:99], a[144:147], a[16:19], v[96:99]
    ds_read_b128 a[128:131], v8 offset:16384
    v_cvt_pk_bf16_f32 v41, v114, v115
    v_mfma_f32_16x16x32_bf16 v[104:107], a[144:147], a[20:23], v[104:107]
    v_exp_f32 v116, v116
    v_mfma_f32_16x16x32_bf16 v[100:103], a[148:151], a[16:19], v[100:103]
    ds_read_b128 a[132:135], v8 offset:17408
    v_add_f32 v34, v34, v114
    v_mfma_f32_16x16x32_bf16 v[108:111], a[148:151], a[20:23], v[108:111]
    v_exp_f32 v117, v117
    v_mfma_f32_16x16x32_bf16 v[96:99], a[152:155], a[24:27], v[96:99]
    ds_read_b128 a[136:139], v8 offset:18432
    v_cvt_pk_bf16_f32 v42, v116, v117
    v_mfma_f32_16x16x32_bf16 v[104:107], a[152:155], a[28:31], v[104:107]
    v_exp_f32 v118, v118
    v_mfma_f32_16x16x32_bf16 v[100:103], a[156:159], a[24:27], v[100:103]
    ds_read_b128 a[140:143], v8 offset:19456
    s_waitcnt lgkmcnt(4)
    v_mfma_f32_16x16x32_bf16 v[108:111], a[156:159], a[28:31], v[108:111]
    v_exp_f32 v119, v119
    v_mfma_f32_16x16x32_bf16 v[96:99], a[160:163], a[32:35], v[96:99]
    ds_read_b128 a[144:147], v8 offset:20480
    v_cvt_pk_bf16_f32 v43, v118, v119
    v_mfma_f32_16x16x32_bf16 v[104:107], a[160:163], a[36:39], v[104:107]
    v_exp_f32 v120, v120
    v_mfma_f32_16x16x32_bf16 v[100:103], a[164:167], a[32:35], v[100:103]
    ds_read_b128 a[148:151], v8 offset:21504
    v_add_f32 v34, v34, v115
    v_mfma_f32_16x16x32_bf16 v[108:111], a[164:167], a[36:39], v[108:111]
    v_exp_f32 v121, v121
    v_mfma_f32_16x16x32_bf16 v[96:99], a[168:171], a[40:43], v[96:99]
    ds_read_b128 a[152:155], v8 offset:22528
    v_cvt_pk_bf16_f32 v44, v120, v121
    v_mfma_f32_16x16x32_bf16 v[104:107], a[168:171], a[44:47], v[104:107]
    v_exp_f32 v122, v122
    v_mfma_f32_16x16x32_bf16 v[100:103], a[172:175], a[40:43], v[100:103]
    ds_read_b128 a[156:159], v8 offset:23552
    v_add_f32 v34, v34, v116
    v_mfma_f32_16x16x32_bf16 v[108:111], a[172:175], a[44:47], v[108:111]
    v_exp_f32 v123, v123
    v_mfma_f32_16x16x32_bf16 v[96:99], a[176:179], a[48:51], v[96:99]
    ds_read_b128 a[160:163], v8 offset:24576
    v_cvt_pk_bf16_f32 v45, v122, v123
    v_mfma_f32_16x16x32_bf16 v[104:107], a[176:179], a[52:55], v[104:107]
    v_exp_f32 v124, v124
    v_mfma_f32_16x16x32_bf16 v[100:103], a[180:183], a[48:51], v[100:103]
    ds_read_b128 a[164:167], v8 offset:25600
    v_add_f32 v34, v34, v117
    v_mfma_f32_16x16x32_bf16 v[108:111], a[180:183], a[52:55], v[108:111]
    v_exp_f32 v125, v125
    v_mfma_f32_16x16x32_bf16 v[96:99], a[184:187], a[56:59], v[96:99]
    ds_read_b128 a[168:171], v8 offset:26624
    v_cvt_pk_bf16_f32 v46, v124, v125
    v_add_f32 v35, v35, v125
    v_mfma_f32_16x16x32_bf16 v[104:107], a[184:187], a[60:63], v[104:107]
    v_exp_f32 v126, v126
    v_mfma_f32_16x16x32_bf16 v[100:103], a[188:191], a[56:59], v[100:103]
    ds_read_b128 a[172:175], v8 offset:27648
    s_waitcnt lgkmcnt(4)
    v_add_f32 v35, v35, v126
    v_mfma_f32_16x16x32_bf16 v[108:111], a[188:191], a[60:63], v[108:111]
    v_exp_f32 v127, v127
    v_mfma_f32_16x16x32_bf16 v[128:131], a[128:131], v[40:43], v[128:131]
    ds_read_b128 a[176:179], v8 offset:28672
    v_cvt_pk_bf16_f32 v47, v126, v127
    v_add_f32 v35, v35, v127
    v_mfma_f32_16x16x32_bf16 v[132:135], a[132:135], v[40:43], v[132:135]
    s_waitcnt vmcnt(20)
    s_barrier
    v_mfma_f32_16x16x32_bf16 v[144:147], a[136:139], v[40:43], v[144:147]
    ds_read_b128 a[180:183], v8 offset:29696
    v_add_f32 v34, v34, v118
    v_mfma_f32_16x16x32_bf16 v[136:139], a[128:131], v[44:47], v[136:139]
    s_bitcmp1_b64 s[80:81], s37
    s_cbranch_scc1 L_k2_b1_evt
L_k2_b1_evt_ret:
    v_mfma_f32_16x16x32_bf16 v[140:143], a[132:135], v[44:47], v[140:143]
    ds_read_b128 a[184:187], v8 offset:30720
    s_mov_b32 m0, s44
    v_mfma_f32_16x16x32_bf16 v[152:155], a[136:139], v[44:47], v[152:155]
    buffer_load_dwordx4 v3, s[8:11], s73 offen offset:0 sc1 lds
    v_mfma_f32_16x16x32_bf16 v[148:151], a[140:143], v[40:43], v[148:151]
    ds_read_b128 a[188:191], v8 offset:31744
    s_add_u32 s37, s37, 1
    v_mfma_f32_16x16x32_bf16 v[156:159], a[140:143], v[44:47], v[156:159]
    buffer_load_dwordx4 v4, s[8:11], s73 offen offset:1024 sc1 lds
    v_mfma_f32_16x16x32_bf16 v[160:163], a[144:147], v[40:43], v[160:163]
    ds_read_b128 a[128:131], v7 offset:16384
    v_max3_f32 v12, v96, v97, v98
    v_mfma_f32_16x16x32_bf16 v[168:171], a[144:147], v[44:47], v[168:171]
    v_max3_f32 v12, v12, v99, v100
    v_max3_f32 v12, v12, v101, v102
    v_mfma_f32_16x16x32_bf16 v[164:167], a[148:151], v[40:43], v[164:167]
    ds_read_b128 a[132:135], v7 offset:17408
    v_max3_f32 v12, v12, v103, v104
    v_mfma_f32_16x16x32_bf16 v[172:175], a[148:151], v[44:47], v[172:175]
    buffer_load_dwordx4 v5, s[8:11], s73 offen offset:2048 sc1 lds
    v_mfma_f32_16x16x32_bf16 v[176:179], a[152:155], v[40:43], v[176:179]
    ds_read_b128 a[136:139], v7 offset:18432
    v_max3_f32 v12, v12, v105, v106
    v_mfma_f32_16x16x32_bf16 v[184:187], a[152:155], v[44:47], v[184:187]
    buffer_load_dwordx4 v6, s[8:11], s73 offen offset:3072 sc1 lds
    v_mfma_f32_16x16x32_bf16 v[180:183], a[156:159], v[40:43], v[180:183]
    ds_read_b128 a[140:143], v7 offset:19456
    s_waitcnt lgkmcnt(4)
    v_mfma_f32_16x16x32_bf16 v[188:191], a[156:159], v[44:47], v[188:191]
    v_max3_f32 v12, v12, v107, v108
    v_max3_f32 v12, v12, v109, v110
    v_mfma_f32_16x16x32_bf16 v[192:195], a[160:163], v[40:43], v[192:195]
    ds_read_b128 a[144:147], v7 offset:20480
    s_mov_b32 m0, s45
    v_mfma_f32_16x16x32_bf16 v[200:203], a[160:163], v[44:47], v[200:203]
    buffer_load_dwordx4 v48, s[8:11], s73 offen offset:0 sc1 lds
    v_mfma_f32_16x16x32_bf16 v[196:199], a[164:167], v[40:43], v[196:199]
    ds_read_b128 a[148:151], v7 offset:21504
    v_max_f32 v12, v12, v111
    v_mfma_f32_16x16x32_bf16 v[204:207], a[164:167], v[44:47], v[204:207]
    buffer_load_dwordx4 v49, s[8:11], s73 offen offset:1024 sc1 lds
    v_mfma_f32_16x16x32_bf16 v[208:211], a[168:171], v[40:43], v[208:211]
    ds_read_b128 a[152:155], v7 offset:22528
    v_cmp_lt_f32 vcc, s47, v12
    v_mfma_f32_16x16x32_bf16 v[216:219], a[168:171], v[44:47], v[216:219]
    s_add_u32 s46, s46, 0x8000
    s_cmp_ge_u32 s46, 163840
    s_cselect_b32 s46, 65536, s46
    v_mfma_f32_16x16x32_bf16 v[212:215], a[172:175], v[40:43], v[212:215]
    ds_read_b128 a[156:159], v7 offset:23552
    v_add_u32 v8, s46, v2
    v_mfma_f32_16x16x32_bf16 v[220:223], a[172:175], v[44:47], v[220:223]
    buffer_load_dwordx4 v50, s[8:11], s73 offen offset:2048 sc1 lds
    v_mfma_f32_16x16x32_bf16 v[224:227], a[176:179], v[40:43], v[224:227]
    ds_read_b128 a[160:163], v7 offset:24576
    v_add_f32 v34, v34, v119
    v_mfma_f32_16x16x32_bf16 v[232:235], a[176:179], v[44:47], v[232:235]
    buffer_load_dwordx4 v51, s[8:11], s73 offen offset:3072 sc1 lds
    v_mfma_f32_16x16x32_bf16 v[228:231], a[180:183], v[40:43], v[228:231]
    ds_read_b128 a[164:167], v7 offset:25600
    s_add_u32 s73, s73, s42
    v_mfma_f32_16x16x32_bf16 v[236:239], a[180:183], v[44:47], v[236:239]
    v_add_f32 v35, v35, v120
    v_add_f32 v35, v35, v121
    v_mfma_f32_16x16x32_bf16 v[240:243], a[184:187], v[40:43], v[240:243]
    ds_read_b128 a[168:171], v7 offset:26624
    v_add_f32 v35, v35, v122
    v_mfma_f32_16x16x32_bf16 v[248:251], a[184:187], v[44:47], v[248:251]
    v_add_f32 v35, v35, v123
    v_add_f32 v35, v35, v124
    v_mfma_f32_16x16x32_bf16 v[244:247], a[188:191], v[40:43], v[244:247]
    ds_read_b128 a[172:175], v7 offset:27648
    s_waitcnt lgkmcnt(4)
    s_cmp_lt_u32 s37, s86
    v_mfma_f32_16x16x32_bf16 v[252:255], a[188:191], v[44:47], v[252:255]
    s_cbranch_vccnz L_k2_b1_resc
L_k2_b1_resc_ret:
    s_cbranch_scc1 L_k2_b0
    s_waitcnt vmcnt(24)
    v_readfirstlane_b32 s53, v15
    s_nop 3
    s_lshr_b32 s53, s53, s85
    s_and_b32 s51, s53, s78
    s_cselect_b32 s90, 17408, 0
L_k2_f0:
    v_mfma_f32_16x16x32_bf16 v[112:115], a[128:131], a[0:3], v[24:27]
    ds_read_b128 a[176:179], v7 offset:28672
    v_mfma_f32_16x16x32_bf16 v[120:123], a[128:131], a[4:7], v[28:31]
    v_exp_f32 v96, v96
    s_mov_b32 s54, 16384
    v_mfma_f32_16x16x32_bf16 v[116:119], a[132:135], a[0:3], v[24:27]
    ds_read_b128 a[180:183], v7 offset:29696
    buffer_load_dwordx4 v[36:39], v2, s[88:91], s54 offen sc1
    s_mov_b32 s54, 0
    v_mfma_f32_16x16x32_bf16 v[124:127], a[132:135], a[4:7], v[28:31]
    v_exp_f32 v97, v97
    buffer_load_dwordx4 a[64:67], v2, s[88:91], s54 offen offset:0 sc1
    v_mfma_f32_16x16x32_bf16 v[112:115], a[136:139], a[8:11], v[112:115]
    ds_read_b128 a[184:187], v7 offset:30720
    v_cvt_pk_bf16_f32 v40, v96, v97
    v_mfma_f32_16x16x32_bf16 v[120:123], a[136:139], a[12:15], v[120:123]
    v_exp_f32 v98, v98
    buffer_load_dwordx4 a[68:71], v2, s[88:91], s54 offen offset:1024 sc1
    v_mfma_f32_16x16x32_bf16 v[116:119], a[140:143], a[8:11], v[116:119]
    ds_read_b128 a[188:191], v7 offset:31744
    v_add_f32 v34, v34, v96
    v_mfma_f32_16x16x32_bf16 v[124:127], a[140:143], a[12:15], v[124:127]
    v_exp_f32 v99, v99
    buffer_load_dwordx4 a[72:75], v2, s[88:91], s54 offen offset:2048 sc1
    v_mfma_f32_16x16x32_bf16 v[112:115], a[144:147], a[16:19], v[112:115]
    ds_read_b128 a[128:131], v8 offset:0
    v_cvt_pk_bf16_f32 v41, v98, v99
    v_mfma_f32_16x16x32_bf16 v[120:123], a[144:147], a[20:23], v[120:123]
    v_exp_f32 v100, v100
    buffer_load_dwordx4 a[76:79], v2, s[88:91], s54 offen offset:3072 sc1
    s_mov_b32 s54, 4096
    v_mfma_f32_16x16x32_bf16 v[116:119], a[148:151], a[16:19], v[116:119]
    ds_read_b128 a[132:135], v8 offset:1024
    v_xor_b32 v7, 0x8000, v7
    buffer_load_dwordx4 a[80:83], v2, s[88:91], s54 offen offset:0 sc1
    v_mfma_f32_16x16x32_bf16 v[124:127], a[148:151], a[20:23], v[124:127]
    v_exp_f32 v101, v101
    v_mfma_f32_16x16x32_bf16 v[112:115], a[152:155], a[24:27], v[112:115]
    ds_read_b128 a[136:139], v8 offset:2048
    v_cvt_pk_bf16_f32 v42, v100, v101
    buffer_load_dwordx4 a[84:87], v2, s[88:91], s54 offen offset:1024 sc1
    v_mfma_f32_16x16x32_bf16 v[120:123], a[152:155], a[28:31], v[120:123]
    v_exp_f32 v102, v102
    v_mfma_f32_16x16x32_bf16 v[116:119], a[156:159], a[24:27], v[116:119]
    ds_read_b128 a[140:143], v8 offset:3072
    s_waitcnt lgkmcnt(4)
    buffer_load_dwordx4 a[88:91], v2, s[88:91], s54 offen offset:2048 sc1
    v_mfma_f32_16x16x32_bf16 v[124:127], a[156:159], a[28:31], v[124:127]
    v_exp_f32 v103, v103
    v_mfma_f32_16x16x32_bf16 v[112:115], a[160:163], a[32:35], v[112:115]
    ds_read_b128 a[144:147], v8 offset:4096
    v_cvt_pk_bf16_f32 v43, v102, v103
    buffer_load_dwordx4 a[92:95], v2, s[88:91], s54 offen offset:3072 sc1
    s_mov_b32 s54, 8192
    v_mfma_f32_16x16x32_bf16 v[120:123], a[160:163], a[36:39], v[120:123]
    v_exp_f32 v104, v104
    buffer_load_dwordx4 a[96:99], v2, s[88:91], s54 offen offset:0 sc1
    v_mfma_f32_16x16x32_bf16 v[116:119], a[164:167], a[32:35], v[116:119]
    ds_read_b128 a[148:151], v8 offset:5120
    v_add_f32 v34, v34, v97
    v_mfma_f32_16x16x32_bf16 v[124:127], a[164:167], a[36:39], v[124:127]
    v_exp_f32 v105, v105
    buffer_load_dwordx4 a[100:103], v2, s[88:91], s54 offen offset:1024 sc1
    v_mfma_f32_16x16x32_bf16 v[112:115], a[168:171], a[40:43], v[112:115]
    ds_read_b128 a[152:155], v8 offset:6144
    v_cvt_pk_bf16_f32 v44, v104, v105
    v_mfma_f32_16x16x32_bf16 v[120:123], a[168:171], a[44:47], v[120:123]
    v_exp_f32 v106, v106
    buffer_load_dwordx4 a[104:107], v2, s[88:91], s54 offen offset:2048 sc1
    v_mfma_f32_16x16x32_bf16 v[116:119], a[172:175], a[40:43], v[116:119]
    ds_read_b128 a[156:159], v8 offset:7168
    v_add_f32 v34, v34, v98
    v_add_f32 v35, v35, v106
    v_mfma_f32_16x16x32_bf16 v[124:127], a[172:175], a[44:47], v[124:127]
    v_exp_f32 v107, v107
    buffer_load_dwordx4 a[108:111], v2, s[88:91], s54 offen offset:3072 sc1
    s_mov_b32 s54, 12288
    v_mfma_f32_16x16x32_bf16 v[112:115], a[176:179], a[48:51], v[112:115]
    ds_read_b128 a[160:163], v8 offset:8192
    v_cvt_pk_bf16_f32 v45, v106, v107
    buffer_load_dwordx4 a[112:115], v2, s[88:91], s54 offen offset:0 sc1
    v_mfma_f32_16x16x32_bf16 v[120:123], a[176:179], a[52:55], v[120:123]
    v_exp_f32 v108, v108
    v_add_f32 v35, v35, v107
    v_mfma_f32_16x16x32_bf16 v[116:119], a[180:183], a[48:51], v[116:119]
    ds_read_b128 a[164:167], v8 offset:9216
    buffer_load_dwordx4 a[116:119], v2, s[88:91], s54 offen offset:1024 sc1
    v_add_f32 v35, v35, v108
    v_mfma_f32_16x16x32_bf16 v[124:127], a[180:183], a[52:55], v[124:127]
    v_exp_f32 v109, v109
    v_mfma_f32_16x16x32_bf16 v[112:115], a[184:187], a[56:59], v[112:115]
    ds_read_b128 a[168:171], v8 offset:10240
    v_cvt_pk_bf16_f32 v46, v108, v109
    buffer_load_dwordx4 a[120:123], v2, s[88:91], s54 offen offset:2048 sc1
    v_mfma_f32_16x16x32_bf16 v[120:123], a[184:187], a[60:63], v[120:123]
    v_exp_f32 v110, v110
    v_add_f32 v35, v35, v109
    v_mfma_f32_16x16x32_bf16 v[116:119], a[188:191], a[56:59], v[116:119]
    ds_read_b128 a[172:175], v8 offset:11264
    s_waitcnt lgkmcnt(4)
    buffer_load_dwordx4 a[124:127], v2, s[88:91], s54 offen offset:3072 sc1
    v_mfma_f32_16x16x32_bf16 v[124:127], a[188:191], a[60:63], v[124:127]
    v_exp_f32 v111, v111
    v_add_f32 v35, v35, v110
    v_mfma_f32_16x16x32_bf16 v[128:131], a[128:131], v[40:43], v[128:131]
    ds_read_b128 a[176:179], v8 offset:12288
    v_cvt_pk_bf16_f32 v47, v110, v111
    v_add_f32 v35, v35, v111
    v_mfma_f32_16x16x32_bf16 v[132:135], a[132:135], v[40:43], v[132:135]
    s_waitcnt vmcnt(37)
    s_barrier
    v_mfma_f32_16x16x32_bf16 v[144:147], a[136:139], v[40:43], v[144:147]
    ds_read_b128 a[180:183], v8 offset:13312
    v_add_f32 v34, v34, v99
    v_mfma_f32_16x16x32_bf16 v[136:139], a[128:131], v[44:47], v[136:139]
    s_bitcmp1_b64 s[80:81], s37
    s_cbranch_scc1 L_k2_f0_evt
L_k2_f0_evt_ret:
    v_mfma_f32_16x16x32_bf16 v[140:143], a[132:135], v[44:47], v[140:143]
    ds_read_b128 a[184:187], v8 offset:14336
    s_add_u32 m0, s44, 16384
    v_mfma_f32_16x16x32_bf16 v[152:155], a[136:139], v[44:47], v[152:155]
    buffer_load_dwordx4 v3, s[8:11], s73 offen offset:0 sc1 lds
    v_mfma_f32_16x16x32_bf16 v[148:151], a[140:143], v[40:43], v[148:151]
    ds_read_b128 a[188:191], v8 offset:15360
    s_xor_b32 s44, s44, 0x8000
    v_mfma_f32_16x16x32_bf16 v[156:159], a[140:143], v[44:47], v[156:159]
    buffer_load_dwordx4 v4, s[8:11], s73 offen offset:1024 sc1 lds
    v_mfma_f32_16x16x32_bf16 v[160:163], a[144:147], v[40:43], v[160:163]
    ds_read_b128 a[128:131], v7 offset:0
    s_add_u32 s37, s37, 1
    v_mfma_f32_16x16x32_bf16 v[168:171], a[144:147], v[44:47], v[168:171]
    v_max3_f32 v12, v112, v113, v114
    v_max3_f32 v12, v12, v115, v116
    v_mfma_f32_16x16x32_bf16 v[164:167], a[148:151], v[40:43], v[164:167]
    ds_read_b128 a[132:135], v7 offset:1024
    v_max3_f32 v12, v12, v117, v118
    v_mfma_f32_16x16x32_bf16 v[172:175], a[148:151], v[44:47], v[172:175]
    buffer_load_dwordx4 v5, s[8:11], s73 offen offset:2048 sc1 lds
    v_mfma_f32_16x16x32_bf16 v[176:179], a[152:155], v[40:43], v[176:179]
    ds_read_b128 a[136:139], v7 offset:2048
    v_max3_f32 v12, v12, v119, v120
    v_mfma_f32_16x16x32_bf16 v[184:187], a[152:155], v[44:47], v[184:187]
    buffer_load_dwordx4 v6, s[8:11], s73 offen offset:3072 sc1 lds
    v_mfma_f32_16x16x32_bf16 v[180:183], a[156:159], v[40:43], v[180:183]
    ds_read_b128 a[140:143], v7 offset:3072
    s_waitcnt lgkmcnt(4)
    v_mfma_f32_16x16x32_bf16 v[188:191], a[156:159], v[44:47], v[188:191]
    v_max3_f32 v12, v12, v121, v122
    v_max3_f32 v12, v12, v123, v124
    v_mfma_f32_16x16x32_bf16 v[192:195], a[160:163], v[40:43], v[192:195]
    ds_read_b128 a[144:147], v7 offset:4096
    s_add_u32 m0, s45, 16384
    v_mfma_f32_16x16x32_bf16 v[200:203], a[160:163], v[44:47], v[200:203]
    buffer_load_dwordx4 v48, s[8:11], s73 offen offset:0 sc1 lds
    v_mfma_f32_16x16x32_bf16 v[196:199], a[164:167], v[40:43], v[196:199]
    ds_read_b128 a[148:151], v7 offset:5120
    v_max3_f32 v12, v12, v125, v126
    v_mfma_f32_16x16x32_bf16 v[204:207], a[164:167], v[44:47], v[204:207]
    buffer_load_dwordx4 v49, s[8:11], s73 offen offset:1024 sc1 lds
    v_mfma_f32_16x16x32_bf16 v[208:211], a[168:171], v[40:43], v[208:211]
    ds_read_b128 a[152:155], v7 offset:6144
    v_max_f32 v12, v12, v127
    v_mfma_f32_16x16x32_bf16 v[216:219], a[168:171], v[44:47], v[216:219]
    s_add_u32 s45, s45, 0x8000
    s_cmp_ge_u32 s45, 163840
    s_cselect_b32 s45, s55, s45
    v_mfma_f32_16x16x32_bf16 v[212:215], a[172:175], v[40:43], v[212:215]
    ds_read_b128 a[156:159], v7 offset:7168
    v_cmp_lt_f32 vcc, s47, v12
    v_mfma_f32_16x16x32_bf16 v[220:223], a[172:175], v[44:47], v[220:223]
    buffer_load_dwordx4 v50, s[8:11], s73 offen offset:2048 sc1 lds
    v_mfma_f32_16x16x32_bf16 v[224:227], a[176:179], v[40:43], v[224:227]
    ds_read_b128 a[160:163], v7 offset:8192
    v_add_f32 v34, v34, v100
    v_mfma_f32_16x16x32_bf16 v[232:235], a[176:179], v[44:47], v[232:235]
    buffer_load_dwordx4 v51, s[8:11], s73 offen offset:3072 sc1 lds
    v_mfma_f32_16x16x32_bf16 v[228:231], a[180:183], v[40:43], v[228:231]
    ds_read_b128 a[164:167], v7 offset:9216
    s_add_u32 s73, s73, s42
    v_mfma_f32_16x16x32_bf16 v[236:239], a[180:183], v[44:47], v[236:239]
    v_add_f32 v34, v34, v101
    v_add_f32 v34, v34, v102
    v_mfma_f32_16x16x32_bf16 v[240:243], a[184:187], v[40:43], v[240:243]
    ds_read_b128 a[168:171], v7 offset:10240
    v_add_f32 v34, v34, v103
    v_mfma_f32_16x16x32_bf16 v[248:251], a[184:187], v[44:47], v[248:251]
    v_add_f32 v35, v35, v104
    v_add_f32 v35, v35, v105
    v_mfma_f32_16x16x32_bf16 v[244:247], a[188:191], v[40:43], v[244:247]
    ds_read_b128 a[172:175], v7 offset:11264
    s_waitcnt lgkmcnt(4)
    v_mfma_f32_16x16x32_bf16 v[252:255], a[188:191], v[44:47], v[252:255]
    s_cbranch_vccnz L_k2_f0_resc
L_k2_f0_resc_ret:
    s_waitcnt lgkmcnt(0)
    ds_read_b128 a[128:131], v8 offset:16384
    ds_read_b128 a[132:135], v8 offset:17408
    ds_read_b128 a[136:139], v8 offset:18432
    ds_read_b128 a[140:143], v8 offset:19456
    ds_read_b128 a[144:147], v8 offset:20480
    ds_read_b128 a[148:151], v8 offset:21504
    ds_read_b128 a[152:155], v8 offset:22528
    ds_read_b128 a[156:159], v8 offset:23552
    ds_read_b128 a[160:163], v8 offset:24576
    ds_read_b128 a[164:167], v8 offset:25600
    ds_read_b128 a[168:171], v8 offset:26624
    ds_read_b128 a[172:175], v8 offset:27648
    s_cmp_eq_u32 s78, s51
    s_cbranch_scc1 L_k2_nopoll
    s_mov_b32 s52, 0
L_k2_poll:
    buffer_load_dword v15, v14, s[60:63], s84 offen sc1
    s_waitcnt vmcnt(0)
    v_readfirstlane_b32 s3, v15
    s_nop 3
    s_bitcmp1_b32 s3, s85
    s_cbranch_scc1 L_k2_pollok
    s_add_u32 s52, s52, 1
    s_cmp_ge_u32 s52, 0x40000
    s_cbranch_scc1 L_k2_pollok
    s_sleep 2
    s_branch L_k2_poll
L_k2_pollok:
    s_mov_b32 s90, 17408
    s_mov_b32 s54, 16384
    buffer_load_dwordx4 v[36:39], v2, s[88:91], s54 offen sc1
    s_mov_b32 s54, 0
    buffer_load_dwordx4 a[64:67], v2, s[88:91], s54 offen offset:0 sc1
    buffer_load_dwordx4 a[68:71], v2, s[88:91], s54 offen offset:1024 sc1
    buffer_load_dwordx4 a[72:75], v2, s[88:91], s54 offen offset:2048 sc1
    buffer_load_dwordx4 a[76:79], v2, s[88:91], s54 offen offset:3072 sc1
    s_mov_b32 s54, 4096
    buffer_load_dwordx4 a[80:83], v2, s[88:91], s54 offen offset:0 sc1
    buffer_load_dwordx4 a[84:87], v2, s[88:91], s54 offen offset:1024 sc1
    buffer_load_dwordx4 a[88:91], v2, s[88:91], s54 offen offset:2048 sc1
    buffer_load_dwordx4 a[92:95], v2, s[88:91], s54 offen offset:3072 sc1
    s_mov_b32 s54, 8192
    buffer_load_dwordx4 a[96:99], v2, s[88:91], s54 offen offset:0 sc1
    buffer_load_dwordx4 a[100:103], v2, s[88:91], s54 offen offset:1024 sc1
    buffer_load_dwordx4 a[104:107], v2, s[88:91], s54 offen offset:2048 sc1
    buffer_load_dwordx4 a[108:111], v2, s[88:91], s54 offen offset:3072 sc1
    s_mov_b32 s54, 12288
    buffer_load_dwordx4 a[112:115], v2, s[88:91], s54 offen offset:0 sc1
    buffer_load_dwordx4 a[116:119], v2, s[88:91], s54 offen offset:1024 sc1
    buffer_load_dwordx4 a[120:123], v2, s[88:91], s54 offen offset:2048 sc1
    buffer_load_dwordx4 a[124:127], v2, s[88:91], s54 offen offset:3072 sc1
L_k2_nopoll:
    v_exp_f32 v112, v112
    v_exp_f32 v113, v113
    v_exp_f32 v114, v114
    v_exp_f32 v115, v115
    v_cvt_pk_bf16_f32 v40, v112, v113
    v_exp_f32 v116, v116
    v_exp_f32 v117, v117
    v_cvt_pk_bf16_f32 v41, v114, v115
    v_exp_f32 v118, v118
    v_exp_f32 v119, v119
    v_cvt_pk_bf16_f32 v42, v116, v117
    v_exp_f32 v120, v120
    v_exp_f32 v121, v121
    v_cvt_pk_bf16_f32 v43, v118, v119
    v_exp_f32 v122, v122
    v_exp_f32 v123, v123
    v_cvt_pk_bf16_f32 v44, v120, v121
    v_exp_f32 v124, v124
    v_exp_f32 v125, v125
    v_cvt_pk_bf16_f32 v45, v122, v123
    v_exp_f32 v126, v126
    v_exp_f32 v127, v127
    v_cvt_pk_bf16_f32 v46, v124, v125
    s_nop 0
    v_cvt_pk_bf16_f32 v47, v126, v127
    s_nop 1
    ds_read_b128 a[176:179], v8 offset:28672
    ds_read_b128 a[180:183], v8 offset:29696
    ds_read_b128 a[184:187], v8 offset:30720
    ds_read_b128 a[188:191], v8 offset:31744
    s_waitcnt lgkmcnt(4)
    v_mfma_f32_16x16x32_bf16 v[128:131], a[128:131], v[40:43], v[128:131]
    v_add_f32 v34, v34, v112
    v_mfma_f32_16x16x32_bf16 v[132:135], a[132:135], v[40:43], v[132:135]
    v_add_f32 v34, v34, v113
    v_mfma_f32_16x16x32_bf16 v[144:147], a[136:139], v[40:43], v[144:147]
    v_add_f32 v34, v34, v114
    v_mfma_f32_16x16x32_bf16 v[136:139], a[128:131], v[44:47], v[136:139]
    v_add_f32 v34, v34, v115
    v_mfma_f32_16x16x32_bf16 v[140:143], a[132:135], v[44:47], v[140:143]
    v_add_f32 v34, v34, v116
    v_mfma_f32_16x16x32_bf16 v[152:155], a[136:139], v[44:47], v[152:155]
    v_add_f32 v34, v34, v117
    v_mfma_f32_16x16x32_bf16 v[148:151], a[140:143], v[40:43], v[148:151]
    v_add_f32 v34, v34, v118
    v_mfma_f32_16x16x32_bf16 v[156:159], a[140:143], v[44:47], v[156:159]
    v_add_f32 v34, v34, v119
    v_mfma_f32_16x16x32_bf16 v[160:163], a[144:147], v[40:43], v[160:163]
    v_add_f32 v35, v35, v120
    v_mfma_f32_16x16x32_bf16 v[168:171], a[144:147], v[44:47], v[168:171]
    v_add_f32 v35, v35, v121
    v_mfma_f32_16x16x32_bf16 v[164:167], a[148:151], v[40:43], v[164:167]
    v_add_f32 v35, v35, v122
    v_mfma_f32_16x16x32_bf16 v[172:175], a[148:151], v[44:47], v[172:175]
    v_add_f32 v35, v35, v123
    v_mfma_f32_16x16x32_bf16 v[176:179], a[152:155], v[40:43], v[176:179]
    v_add_f32 v35, v35, v124
    v_mfma_f32_16x16x32_bf16 v[184:187], a[152:155], v[44:47], v[184:187]
    v_add_f32 v35, v35, v125
    v_mfma_f32_16x16x32_bf16 v[180:183], a[156:159], v[40:43], v[180:183]
    v_add_f32 v35, v35, v126
    v_mfma_f32_16x16x32_bf16 v[188:191], a[156:159], v[44:47], v[188:191]
    v_add_f32 v35, v35, v127
    s_waitcnt lgkmcnt(0)
    v_mfma_f32_16x16x32_bf16 v[192:195], a[160:163], v[40:43], v[192:195]
    v_mfma_f32_16x16x32_bf16 v[200:203], a[160:163], v[44:47], v[200:203]
    v_mfma_f32_16x16x32_bf16 v[196:199], a[164:167], v[40:43], v[196:199]
    v_mfma_f32_16x16x32_bf16 v[204:207], a[164:167], v[44:47], v[204:207]
    v_mfma_f32_16x16x32_bf16 v[208:211], a[168:171], v[40:43], v[208:211]
    v_mfma_f32_16x16x32_bf16 v[216:219], a[168:171], v[44:47], v[216:219]
    v_mfma_f32_16x16x32_bf16 v[212:215], a[172:175], v[40:43], v[212:215]
    v_mfma_f32_16x16x32_bf16 v[220:223], a[172:175], v[44:47], v[220:223]
    v_mfma_f32_16x16x32_bf16 v[224:227], a[176:179], v[40:43], v[224:227]
    v_mfma_f32_16x16x32_bf16 v[232:235], a[176:179], v[44:47], v[232:235]
    v_mfma_f32_16x16x32_bf16 v[228:231], a[180:183], v[40:43], v[228:231]
    v_mfma_f32_16x16x32_bf16 v[236:239], a[180:183], v[44:47], v[236:239]
    v_mfma_f32_16x16x32_bf16 v[240:243], a[184:187], v[40:43], v[240:243]
    v_mfma_f32_16x16x32_bf16 v[248:251], a[184:187], v[44:47], v[248:251]
    v_mfma_f32_16x16x32_bf16 v[244:247], a[188:191], v[40:43], v[244:247]
    v_mfma_f32_16x16x32_bf16 v[252:255], a[188:191], v[44:47], v[252:255]
    s_add_u32 s74, s73, s43
    s_and_b32 s68, s70, 2
    s_lshl_b32 s68, s68, 14
    s_add_u32 s46, s46, 0x8000
    s_cmp_ge_u32 s46, 163840
    s_cselect_b32 s46, 65536, s46
    s_lshl_b32 s52, s79, 6
    s_add_u32 s52, s52, s77
    s_mul_i32 s52, s52, 28672
    s_add_u32 s52, s52, 100663296
    s_add_u32 s12, s34, s52
    s_addc_u32 s13, s35, 0
    s_mov_b32 s14, 28672
    v_mov_b32 v22, v34
    s_nop 1
    v_permlane16_swap_b32 v34, v22
    s_nop 1
    v_add_f32 v34, v34, v22
    v_mov_b32 v22, v34
    s_nop 1
    v_permlane32_swap_b32 v34, v22
    s_nop 1
    v_add_f32 v34, v34, v22
    v_mov_b32 v22, v35
    s_nop 1
    v_permlane16_swap_b32 v35, v22
    s_nop 1
    v_add_f32 v35, v35, v22
    v_mov_b32 v22, v35
    s_nop 1
    v_permlane32_swap_b32 v35, v22
    s_nop 1
    v_add_f32 v35, v35, v22
    s_cmp_eq_u32 s78, 0
    s_cbranch_scc1 L_k2_fin_nomerge
    s_cmp_eq_u32 s51, 1
    s_cbranch_scc1 L_k2_mg1
    s_waitcnt vmcnt(0)
L_k2_mg1:
    s_waitcnt vmcnt(8)
    v_max_f32 v22, v32, v36
    v_sub_f32 v16, v32, v22
    v_sub_f32 v18, v36, v22
    v_exp_f32 v16, v16
    v_exp_f32 v18, v18
    s_nop 0
    v_mul_f32 v22, v18, v38
    v_fmac_f32 v22, v34, v16
    v_rcp_f32 v22, v22
    s_nop 0
    v_mul_f32 v16, v16, v22
    v_mul_f32 v18, v18, v22
    v_max_f32 v23, v33, v37
    v_sub_f32 v17, v33, v23
    v_sub_f32 v19, v37, v23
    v_exp_f32 v17, v17
    v_exp_f32 v19, v19
    s_nop 0
    v_mul_f32 v23, v19, v39
    v_fmac_f32 v23, v35, v17
    v_rcp_f32 v23, v23
    s_nop 0
    v_mul_f32 v17, v17, v23
    v_mul_f32 v19, v19, v23
    v_accvgpr_read_b32 v96, a64
    v_accvgpr_read_b32 v97, a65
    v_accvgpr_read_b32 v98, a66
    v_accvgpr_read_b32 v99, a67
    v_pk_mul_f32 v[128:129], v[128:129], v[16:17] op_sel:[0,0] op_sel_hi:[1,0]
    v_pk_mul_f32 v[130:131], v[130:131], v[16:17] op_sel:[0,0] op_sel_hi:[1,0]
    v_pk_mul_f32 v[132:133], v[132:133], v[16:17] op_sel:[0,0] op_sel_hi:[1,0]
    v_pk_mul_f32 v[134:135], v[134:135], v[16:17] op_sel:[0,0] op_sel_hi:[1,0]
    v_lshlrev_b32 v100, 16, v96
    v_and_b32 v101, 0xffff0000, v96
    v_lshlrev_b32 v102, 16, v97
    v_and_b32 v103, 0xffff0000, v97
    v_lshlrev_b32 v104, 16, v98
    v_and_b32 v105, 0xffff0000, v98
    v_lshlrev_b32 v106, 16, v99
    v_and_b32 v107, 0xffff0000, v99
    v_pk_fma_f32 v[128:129], v[100:101], v[18:19], v[128:129] op_sel:[0,0,0] op_sel_hi:[1,0,1]
    v_pk_fma_f32 v[130:131], v[102:103], v[18:19], v[130:131] op_sel:[0,0,0] op_sel_hi:[1,0,1]
    v_pk_fma_f32 v[132:133], v[104:105], v[18:19], v[132:133] op_sel:[0,0,0] op_sel_hi:[1,0,1]
    v_pk_fma_f32 v[134:135], v[106:107], v[18:19], v[134:135] op_sel:[0,0,0] op_sel_hi:[1,0,1]
    v_cvt_pk_bf16_f32 v128, v128, v129
    v_cvt_pk_bf16_f32 v129, v130, v131
    v_cvt_pk_bf16_f32 v130, v132, v133
    v_cvt_pk_bf16_f32 v131, v134, v135
    v_accvgpr_read_b32 v112, a68
    v_accvgpr_read_b32 v113, a69
    v_accvgpr_read_b32 v114, a70
    v_accvgpr_read_b32 v115, a71
    v_pk_mul_f32 v[136:137], v[136:137], v[16:17] op_sel:[0,1] op_sel_hi:[1,1]
    v_pk_mul_f32 v[138:139], v[138:139], v[16:17] op_sel:[0,1] op_sel_hi:[1,1]
    v_pk_mul_f32 v[140:141], v[140:141], v[16:17] op_sel:[0,1] op_sel_hi:[1,1]
    v_pk_mul_f32 v[142:143], v[142:143], v[16:17] op_sel:[0,1] op_sel_hi:[1,1]
    v_lshlrev_b32 v116, 16, v112
    v_and_b32 v117, 0xffff0000, v112
    v_lshlrev_b32 v118, 16, v113
    v_and_b32 v119, 0xffff0000, v113
    v_lshlrev_b32 v120, 16, v114
    v_and_b32 v121, 0xffff0000, v114
    v_lshlrev_b32 v122, 16, v115
    v_and_b32 v123, 0xffff0000, v115
    v_pk_fma_f32 v[136:137], v[116:117], v[18:19], v[136:137] op_sel:[0,1,0] op_sel_hi:[1,1,1]
    v_pk_fma_f32 v[138:139], v[118:119], v[18:19], v[138:139] op_sel:[0,1,0] op_sel_hi:[1,1,1]
    v_pk_fma_f32 v[140:141], v[120:121], v[18:19], v[140:141] op_sel:[0,1,0] op_sel_hi:[1,1,1]
    v_pk_fma_f32 v[142:143], v[122:123], v[18:19], v[142:143] op_sel:[0,1,0] op_sel_hi:[1,1,1]
    v_cvt_pk_bf16_f32 v136, v136, v137
    v_cvt_pk_bf16_f32 v137, v138, v139
    v_cvt_pk_bf16_f32 v138, v140, v141
    v_cvt_pk_bf16_f32 v139, v142, v143
    s_nop 1
    v_permlane16_swap_b32 v128, v136
    v_permlane16_swap_b32 v129, v137
    v_permlane16_swap_b32 v130, v138
    v_permlane16_swap_b32 v131, v139
    s_nop 0
    v_accvgpr_write_b32 a0, v128
    v_accvgpr_write_b32 a1, v129
    v_accvgpr_write_b32 a2, v130
    v_accvgpr_write_b32 a3, v131
    v_accvgpr_write_b32 a4, v136
    v_accvgpr_write_b32 a5, v137
    v_accvgpr_write_b32 a6, v138
    v_accvgpr_write_b32 a7, v139
    v_accvgpr_read_b32 v96, a72
    v_accvgpr_read_b32 v97, a73
    v_accvgpr_read_b32 v98, a74
    v_accvgpr_read_b32 v99, a75
    v_pk_mul_f32 v[144:145], v[144:145], v[16:17] op_sel:[0,0] op_sel_hi:[1,0]
    v_pk_mul_f32 v[146:147], v[146:147], v[16:17] op_sel:[0,0] op_sel_hi:[1,0]
    v_pk_mul_f32 v[148:149], v[148:149], v[16:17] op_sel:[0,0] op_sel_hi:[1,0]
    v_pk_mul_f32 v[150:151], v[150:151], v[16:17] op_sel:[0,0] op_sel_hi:[1,0]
    v_lshlrev_b32 v100, 16, v96
    v_and_b32 v101, 0xffff0000, v96
    v_lshlrev_b32 v102, 16, v97
    v_and_b32 v103, 0xffff0000, v97
    v_lshlrev_b32 v104, 16, v98
    v_and_b32 v105, 0xffff0000, v98
    v_lshlrev_b32 v106, 16, v99
    v_and_b32 v107, 0xffff0000, v99
    v_pk_fma_f32 v[144:145], v[100:101], v[18:19], v[144:145] op_sel:[0,0,0] op_sel_hi:[1,0,1]
    v_pk_fma_f32 v[146:147], v[102:103], v[18:19], v[146:147] op_sel:[0,0,0] op_sel_hi:[1,0,1]
    v_pk_fma_f32 v[148:149], v[104:105], v[18:19], v[148:149] op_sel:[0,0,0] op_sel_hi:[1,0,1]
    v_pk_fma_f32 v[150:151], v[106:107], v[18:19], v[150:151] op_sel:[0,0,0] op_sel_hi:[1,0,1]
    v_cvt_pk_bf16_f32 v144, v144, v145
    v_cvt_pk_bf16_f32 v145, v146, v147
    v_cvt_pk_bf16_f32 v146, v148, v149
    v_cvt_pk_bf16_f32 v147, v150, v151
    v_accvgpr_read_b32 v112, a76
    v_accvgpr_read_b32 v113, a77
    v_accvgpr_read_b32 v114, a78
    v_accvgpr_read_b32 v115, a79
    v_pk_mul_f32 v[152:153], v[152:153], v[16:17] op_sel:[0,1] op_sel_hi:[1,1]
    v_pk_mul_f32 v[154:155], v[154:155], v[16:17] op_sel:[0,1] op_sel_hi:[1,1]
    v_pk_mul_f32 v[156:157], v[156:157], v[16:17] op_sel:[0,1] op_sel_hi:[1,1]
    v_pk_mul_f32 v[158:159], v[158:159], v[16:17] op_sel:[0,1] op_sel_hi:[1,1]
    v_lshlrev_b32 v116, 16, v112
    v_and_b32 v117, 0xffff0000, v112
    v_lshlrev_b32 v118, 16, v113
    v_and_b32 v119, 0xffff0000, v113
    v_lshlrev_b32 v120, 16, v114
    v_and_b32 v121, 0xffff0000, v114
    v_lshlrev_b32 v122, 16, v115
    v_and_b32 v123, 0xffff0000, v115
    v_pk_fma_f32 v[152:153], v[116:117], v[18:19], v[152:153] op_sel:[0,1,0] op_sel_hi:[1,1,1]
    v_pk_fma_f32 v[154:155], v[118:119], v[18:19], v[154:155] op_sel:[0,1,0] op_sel_hi:[1,1,1]
    v_pk_fma_f32 v[156:157], v[120:121], v[18:19], v[156:157] op_sel:[0,1,0] op_sel_hi:[1,1,1]
    v_pk_fma_f32 v[158:159], v[122:123], v[18:19], v[158:159] op_sel:[0,1,0] op_sel_hi:[1,1,1]
    v_cvt_pk_bf16_f32 v152, v152, v153
    v_cvt_pk_bf16_f32 v153, v154, v155
    v_cvt_pk_bf16_f32 v154, v156, v157
    v_cvt_pk_bf16_f32 v155, v158, v159
    s_nop 1
    v_permlane16_swap_b32 v144, v152
    v_permlane16_swap_b32 v145, v153
    v_permlane16_swap_b32 v146, v154
    v_permlane16_swap_b32 v147, v155
    s_nop 0
    v_accvgpr_write_b32 a8, v144
    v_accvgpr_write_b32 a9, v145
    v_accvgpr_write_b32 a10, v146
    v_accvgpr_write_b32 a11, v147
    v_accvgpr_write_b32 a12, v152
    v_accvgpr_write_b32 a13, v153
    v_accvgpr_write_b32 a14, v154
    v_accvgpr_write_b32 a15, v155
    v_accvgpr_read_b32 v96, a80
    v_accvgpr_read_b32 v97, a81
    v_accvgpr_read_b32 v98, a82
    v_accvgpr_read_b32 v99, a83
    v_pk_mul_f32 v[160:161], v[160:161], v[16:17] op_sel:[0,0] op_sel_hi:[1,0]
    v_pk_mul_f32 v[162:163], v[162:163], v[16:17] op_sel:[0,0] op_sel_hi:[1,0]
    v_pk_mul_f32 v[164:165], v[164:165], v[16:17] op_sel:[0,0] op_sel_hi:[1,0]
    v_pk_mul_f32 v[166:167], v[166:167], v[16:17] op_sel:[0,0] op_sel_hi:[1,0]
    v_lshlrev_b32 v100, 16, v96
    v_and_b32 v101, 0xffff0000, v96
    v_lshlrev_b32 v102, 16, v97
    v_and_b32 v103, 0xffff0000, v97
    v_lshlrev_b32 v104, 16, v98
    v_and_b32 v105, 0xffff0000, v98
    v_lshlrev_b32 v106, 16, v99
    v_and_b32 v107, 0xffff0000, v99
    v_pk_fma_f32 v[160:161], v[100:101], v[18:19], v[160:161] op_sel:[0,0,0] op_sel_hi:[1,0,1]
    v_pk_fma_f32 v[162:163], v[102:103], v[18:19], v[162:163] op_sel:[0,0,0] op_sel_hi:[1,0,1]
    v_pk_fma_f32 v[164:165], v[104:105], v[18:19], v[164:165] op_sel:[0,0,0] op_sel_hi:[1,0,1]
    v_pk_fma_f32 v[166:167], v[106:107], v[18:19], v[166:167] op_sel:[0,0,0] op_sel_hi:[1,0,1]
    v_cvt_pk_bf16_f32 v160, v160, v161
    v_cvt_pk_bf16_f32 v161, v162, v163
    v_cvt_pk_bf16_f32 v162, v164, v165
    v_cvt_pk_bf16_f32 v163, v166, v167
    v_accvgpr_read_b32 v112, a84
    v_accvgpr_read_b32 v113, a85
    v_accvgpr_read_b32 v114, a86
    v_accvgpr_read_b32 v115, a87
    v_pk_mul_f32 v[168:169], v[168:169], v[16:17] op_sel:[0,1] op_sel_hi:[1,1]
    v_pk_mul_f32 v[170:171], v[170:171], v[16:17] op_sel:[0,1] op_sel_hi:[1,1]
    v_pk_mul_f32 v[172:173], v[172:173], v[16:17] op_sel:[0,1] op_sel_hi:[1,1]
    v_pk_mul_f32 v[174:175], v[174:175], v[16:17] op_sel:[0,1] op_sel_hi:[1,1]
    v_lshlrev_b32 v116, 16, v112
    v_and_b32 v117, 0xffff0000, v112
    v_lshlrev_b32 v118, 16, v113
    v_and_b32 v119, 0xffff0000, v113
    v_lshlrev_b32 v120, 16, v114
    v_and_b32 v121, 0xffff0000, v114
    v_lshlrev_b32 v122, 16, v115
    v_and_b32 v123, 0xffff0000, v115
    v_pk_fma_f32 v[168:169], v[116:117], v[18:19], v[168:169] op_sel:[0,1,0] op_sel_hi:[1,1,1]
    v_pk_fma_f32 v[170:171], v[118:119], v[18:19], v[170:171] op_sel:[0,1,0] op_sel_hi:[1,1,1]
    v_pk_fma_f32 v[172:173], v[120:121], v[18:19], v[172:173] op_sel:[0,1,0] op_sel_hi:[1,1,1]
    v_pk_fma_f32 v[174:175], v[122:123], v[18:19], v[174:175] op_sel:[0,1,0] op_sel_hi:[1,1,1]
    v_cvt_pk_bf16_f32 v168, v168, v169
    v_cvt_pk_bf16_f32 v169, v170, v171
    v_cvt_pk_bf16_f32 v170, v172, v173
    v_cvt_pk_bf16_f32 v171, v174, v175
    s_nop 1
    v_permlane16_swap_b32 v160, v168
    v_permlane16_swap_b32 v161, v169
    v_permlane16_swap_b32 v162, v170
    v_permlane16_swap_b32 v163, v171
    s_nop 0
    v_accvgpr_write_b32 a16, v160
    v_accvgpr_write_b32 a17, v161
    v_accvgpr_write_b32 a18, v162
    v_accvgpr_write_b32 a19, v163
    v_accvgpr_write_b32 a20, v168
    v_accvgpr_write_b32 a21, v169
    v_accvgpr_write_b32 a22, v170
    v_accvgpr_write_b32 a23, v171
    v_accvgpr_read_b32 v96, a88
    v_accvgpr_read_b32 v97, a89
    v_accvgpr_read_b32 v98, a90
    v_accvgpr_read_b32 v99, a91
    v_pk_mul_f32 v[176:177], v[176:177], v[16:17] op_sel:[0,0] op_sel_hi:[1,0]
    v_pk_mul_f32 v[178:179], v[178:179], v[16:17] op_sel:[0,0] op_sel_hi:[1,0]
    v_pk_mul_f32 v[180:181], v[180:181], v[16:17] op_sel:[0,0] op_sel_hi:[1,0]
    v_pk_mul_f32 v[182:183], v[182:183], v[16:17] op_sel:[0,0] op_sel_hi:[1,0]
    v_lshlrev_b32 v100, 16, v96
    v_and_b32 v101, 0xffff0000, v96
    v_lshlrev_b32 v102, 16, v97
    v_and_b32 v103, 0xffff0000, v97
    v_lshlrev_b32 v104, 16, v98
    v_and_b32 v105, 0xffff0000, v98
    v_lshlrev_b32 v106, 16, v99
    v_and_b32 v107, 0xffff0000, v99
    v_pk_fma_f32 v[176:177], v[100:101], v[18:19], v[176:177] op_sel:[0,0,0] op_sel_hi:[1,0,1]
    v_pk_fma_f32 v[178:179], v[102:103], v[18:19], v[178:179] op_sel:[0,0,0] op_sel_hi:[1,0,1]
    v_pk_fma_f32 v[180:181], v[104:105], v[18:19], v[180:181] op_sel:[0,0,0] op_sel_hi:[1,0,1]
    v_pk_fma_f32 v[182:183], v[106:107], v[18:19], v[182:183] op_sel:[0,0,0] op_sel_hi:[1,0,1]
    v_cvt_pk_bf16_f32 v176, v176, v177
    v_cvt_pk_bf16_f32 v177, v178, v179
    v_cvt_pk_bf16_f32 v178, v180, v181
    v_cvt_pk_bf16_f32 v179, v182, v183
    v_accvgpr_read_b32 v112, a92
    v_accvgpr_read_b32 v113, a93
    v_accvgpr_read_b32 v114, a94
    v_accvgpr_read_b32 v115, a95
    v_pk_mul_f32 v[184:185], v[184:185], v[16:17] op_sel:[0,1] op_sel_hi:[1,1]
    v_pk_mul_f32 v[186:187], v[186:187], v[16:17] op_sel:[0,1] op_sel_hi:[1,1]
    v_pk_mul_f32 v[188:189], v[188:189], v[16:17] op_sel:[0,1] op_sel_hi:[1,1]
    v_pk_mul_f32 v[190:191], v[190:191], v[16:17] op_sel:[0,1] op_sel_hi:[1,1]
    v_lshlrev_b32 v116, 16, v112
    v_and_b32 v117, 0xffff0000, v112
    v_lshlrev_b32 v118, 16, v113
    v_and_b32 v119, 0xffff0000, v113
    v_lshlrev_b32 v120, 16, v114
    v_and_b32 v121, 0xffff0000, v114
    v_lshlrev_b32 v122, 16, v115
    v_and_b32 v123, 0xffff0000, v115
    v_pk_fma_f32 v[184:185], v[116:117], v[18:19], v[184:185] op_sel:[0,1,0] op_sel_hi:[1,1,1]
    v_pk_fma_f32 v[186:187], v[118:119], v[18:19], v[186:187] op_sel:[0,1,0] op_sel_hi:[1,1,1]
    v_pk_fma_f32 v[188:189], v[120:121], v[18:19], v[188:189] op_sel:[0,1,0] op_sel_hi:[1,1,1]
    v_pk_fma_f32 v[190:191], v[122:123], v[18:19], v[190:191] op_sel:[0,1,0] op_sel_hi:[1,1,1]
    v_cvt_pk_bf16_f32 v184, v184, v185
    v_cvt_pk_bf16_f32 v185, v186, v187
    v_cvt_pk_bf16_f32 v186, v188, v189
    v_cvt_pk_bf16_f32 v187, v190, v191
    s_nop 1
    v_permlane16_swap_b32 v176, v184
    v_permlane16_swap_b32 v177, v185
    v_permlane16_swap_b32 v178, v186
    v_permlane16_swap_b32 v179, v187
    s_nop 0
    v_accvgpr_write_b32 a24, v176
    v_accvgpr_write_b32 a25, v177
    v_accvgpr_write_b32 a26, v178
    v_accvgpr_write_b32 a27, v179
    v_accvgpr_write_b32 a28, v184
    v_accvgpr_write_b32 a29, v185
    v_accvgpr_write_b32 a30, v186
    v_accvgpr_write_b32 a31, v187
    v_accvgpr_read_b32 v96, a96
    v_accvgpr_read_b32 v97, a97
    v_accvgpr_read_b32 v98, a98
    v_accvgpr_read_b32 v99, a99
    v_pk_mul_f32 v[192:193], v[192:193], v[16:17] op_sel:[0,0] op_sel_hi:[1,0]
    v_pk_mul_f32 v[194:195], v[194:195], v[16:17] op_sel:[0,0] op_sel_hi:[1,0]
    v_pk_mul_f32 v[196:197], v[196:197], v[16:17] op_sel:[0,0] op_sel_hi:[1,0]
    v_pk_mul_f32 v[198:199], v[198:199], v[16:17] op_sel:[0,0] op_sel_hi:[1,0]
    v_lshlrev_b32 v100, 16, v96
    v_and_b32 v101, 0xffff0000, v96
    v_lshlrev_b32 v102, 16, v97
    v_and_b32 v103, 0xffff0000, v97
    v_lshlrev_b32 v104, 16, v98
    v_and_b32 v105, 0xffff0000, v98
    v_lshlrev_b32 v106, 16, v99
    v_and_b32 v107, 0xffff0000, v99
    v_pk_fma_f32 v[192:193], v[100:101], v[18:19], v[192:193] op_sel:[0,0,0] op_sel_hi:[1,0,1]
    v_pk_fma_f32 v[194:195], v[102:103], v[18:19], v[194:195] op_sel:[0,0,0] op_sel_hi:[1,0,1]
    v_pk_fma_f32 v[196:197], v[104:105], v[18:19], v[196:197] op_sel:[0,0,0] op_sel_hi:[1,0,1]
    v_pk_fma_f32 v[198:199], v[106:107], v[18:19], v[198:199] op_sel:[0,0,0] op_sel_hi:[1,0,1]
    v_cvt_pk_bf16_f32 v192, v192, v193
    v_cvt_pk_bf16_f32 v193, v194, v195
    v_cvt_pk_bf16_f32 v194, v196, v197
    v_cvt_pk_bf16_f32 v195, v198, v199
    v_accvgpr_read_b32 v112, a100
    v_accvgpr_read_b32 v113, a101
    v_accvgpr_read_b32 v114, a102
    v_accvgpr_read_b32 v115, a103
    v_pk_mul_f32 v[200:201], v[200:201], v[16:17] op_sel:[0,1] op_sel_hi:[1,1]
    v_pk_mul_f32 v[202:203], v[202:203], v[16:17] op_sel:[0,1] op_sel_hi:[1,1]
    v_pk_mul_f32 v[204:205], v[204:205], v[16:17] op_sel:[0,1] op_sel_hi:[1,1]
    v_pk_mul_f32 v[206:207], v[206:207], v[16:17] op_sel:[0,1] op_sel_hi:[1,1]
    v_lshlrev_b32 v116, 16, v112
    v_and_b32 v117, 0xffff0000, v112
    v_lshlrev_b32 v118, 16, v113
    v_and_b32 v119, 0xffff0000, v113
    v_lshlrev_b32 v120, 16, v114
    v_and_b32 v121, 0xffff0000, v114
    v_lshlrev_b32 v122, 16, v115
    v_and_b32 v123, 0xffff0000, v115
    v_pk_fma_f32 v[200:201], v[116:117], v[18:19], v[200:201] op_sel:[0,1,0] op_sel_hi:[1,1,1]
    v_pk_fma_f32 v[202:203], v[118:119], v[18:19], v[202:203] op_sel:[0,1,0] op_sel_hi:[1,1,1]
    v_pk_fma_f32 v[204:205], v[120:121], v[18:19], v[204:205] op_sel:[0,1,0] op_sel_hi:[1,1,1]
    v_pk_fma_f32 v[206:207], v[122:123], v[18:19], v[206:207] op_sel:[0,1,0] op_sel_hi:[1,1,1]
    v_cvt_pk_bf16_f32 v200, v200, v201
    v_cvt_pk_bf16_f32 v201, v202, v203
    v_cvt_pk_bf16_f32 v202, v204, v205
    v_cvt_pk_bf16_f32 v203, v206, v207
    s_nop 1
    v_permlane16_swap_b32 v192, v200
    v_permlane16_swap_b32 v193, v201
    v_permlane16_swap_b32 v194, v202
    v_permlane16_swap_b32 v195, v203
    s_nop 0
    v_accvgpr_write_b32 a32, v192
    v_accvgpr_write_b32 a33, v193
    v_accvgpr_write_b32 a34, v194
    v_accvgpr_write_b32 a35, v195
    v_accvgpr_write_b32 a36, v200
    v_accvgpr_write_b32 a37, v201
    v_accvgpr_write_b32 a38, v202
    v_accvgpr_write_b32 a39, v203
    v_accvgpr_read_b32 v96, a104
    v_accvgpr_read_b32 v97, a105
    v_accvgpr_read_b32 v98, a106
    v_accvgpr_read_b32 v99, a107
    v_pk_mul_f32 v[208:209], v[208:209], v[16:17] op_sel:[0,0] op_sel_hi:[1,0]
    v_pk_mul_f32 v[210:211], v[210:211], v[16:17] op_sel:[0,0] op_sel_hi:[1,0]
    v_pk_mul_f32 v[212:213], v[212:213], v[16:17] op_sel:[0,0] op_sel_hi:[1,0]
    v_pk_mul_f32 v[214:215], v[214:215], v[16:17] op_sel:[0,0] op_sel_hi:[1,0]
    v_lshlrev_b32 v100, 16, v96
    v_and_b32 v101, 0xffff0000, v96
    v_lshlrev_b32 v102, 16, v97
    v_and_b32 v103, 0xffff0000, v97
    v_lshlrev_b32 v104, 16, v98
    v_and_b32 v105, 0xffff0000, v98
    v_lshlrev_b32 v106, 16, v99
    v_and_b32 v107, 0xffff0000, v99
    v_pk_fma_f32 v[208:209], v[100:101], v[18:19], v[208:209] op_sel:[0,0,0] op_sel_hi:[1,0,1]
    v_pk_fma_f32 v[210:211], v[102:103], v[18:19], v[210:211] op_sel:[0,0,0] op_sel_hi:[1,0,1]
    v_pk_fma_f32 v[212:213], v[104:105], v[18:19], v[212:213] op_sel:[0,0,0] op_sel_hi:[1,0,1]
    v_pk_fma_f32 v[214:215], v[106:107], v[18:19], v[214:215] op_sel:[0,0,0] op_sel_hi:[1,0,1]
    v_cvt_pk_bf16_f32 v208, v208, v209
    v_cvt_pk_bf16_f32 v209, v210, v211
    v_cvt_pk_bf16_f32 v210, v212, v213
    v_cvt_pk_bf16_f32 v211, v214, v215
    v_accvgpr_read_b32 v112, a108
    v_accvgpr_read_b32 v113, a109
    v_accvgpr_read_b32 v114, a110
    v_accvgpr_read_b32 v115, a111
    v_pk_mul_f32 v[216:217], v[216:217], v[16:17] op_sel:[0,1] op_sel_hi:[1,1]
    v_pk_mul_f32 v[218:219], v[218:219], v[16:17] op_sel:[0,1] op_sel_hi:[1,1]
    v_pk_mul_f32 v[220:221], v[220:221], v[16:17] op_sel:[0,1] op_sel_hi:[1,1]
    v_pk_mul_f32 v[222:223], v[222:223], v[16:17] op_sel:[0,1] op_sel_hi:[1,1]
    v_lshlrev_b32 v116, 16, v112
    v_and_b32 v117, 0xffff0000, v112
    v_lshlrev_b32 v118, 16, v113
    v_and_b32 v119, 0xffff0000, v113
    v_lshlrev_b32 v120, 16, v114
    v_and_b32 v121, 0xffff0000, v114
    v_lshlrev_b32 v122, 16, v115
    v_and_b32 v123, 0xffff0000, v115
    v_pk_fma_f32 v[216:217], v[116:117], v[18:19], v[216:217] op_sel:[0,1,0] op_sel_hi:[1,1,1]
    v_pk_fma_f32 v[218:219], v[118:119], v[18:19], v[218:219] op_sel:[0,1,0] op_sel_hi:[1,1,1]
    v_pk_fma_f32 v[220:221], v[120:121], v[18:19], v[220:221] op_sel:[0,1,0] op_sel_hi:[1,1,1]
    v_pk_fma_f32 v[222:223], v[122:123], v[18:19], v[222:223] op_sel:[0,1,0] op_sel_hi:[1,1,1]
    v_cvt_pk_bf16_f32 v216, v216, v217
    v_cvt_pk_bf16_f32 v217, v218, v219
    v_cvt_pk_bf16_f32 v218, v220, v221
    v_cvt_pk_bf16_f32 v219, v222, v223
    s_nop 1
    v_permlane16_swap_b32 v208, v216
    v_permlane16_swap_b32 v209, v217
    v_permlane16_swap_b32 v210, v218
    v_permlane16_swap_b32 v211, v219
    s_nop 0
    v_accvgpr_write_b32 a40, v208
    v_accvgpr_write_b32 a41, v209
    v_accvgpr_write_b32 a42, v210
    v_accvgpr_write_b32 a43, v211
    v_accvgpr_write_b32 a44, v216
    v_accvgpr_write_b32 a45, v217
    v_accvgpr_write_b32 a46, v218
    v_accvgpr_write_b32 a47, v219
    v_accvgpr_read_b32 v96, a112
    v_accvgpr_read_b32 v97, a113
    v_accvgpr_read_b32 v98, a114
    v_accvgpr_read_b32 v99, a115
    v_pk_mul_f32 v[224:225], v[224:225], v[16:17] op_sel:[0,0] op_sel_hi:[1,0]
    v_pk_mul_f32 v[226:227], v[226:227], v[16:17] op_sel:[0,0] op_sel_hi:[1,0]
    v_pk_mul_f32 v[228:229], v[228:229], v[16:17] op_sel:[0,0] op_sel_hi:[1,0]
    v_pk_mul_f32 v[230:231], v[230:231], v[16:17] op_sel:[0,0] op_sel_hi:[1,0]
    v_lshlrev_b32 v100, 16, v96
    v_and_b32 v101, 0xffff0000, v96
    v_lshlrev_b32 v102, 16, v97
    v_and_b32 v103, 0xffff0000, v97
    v_lshlrev_b32 v104, 16, v98
    v_and_b32 v105, 0xffff0000, v98
    v_lshlrev_b32 v106, 16, v99
    v_and_b32 v107, 0xffff0000, v99
    v_pk_fma_f32 v[224:225], v[100:101], v[18:19], v[224:225] op_sel:[0,0,0] op_sel_hi:[1,0,1]
    v_pk_fma_f32 v[226:227], v[102:103], v[18:19], v[226:227] op_sel:[0,0,0] op_sel_hi:[1,0,1]
    v_pk_fma_f32 v[228:229], v[104:105], v[18:19], v[228:229] op_sel:[0,0,0] op_sel_hi:[1,0,1]
    v_pk_fma_f32 v[230:231], v[106:107], v[18:19], v[230:231] op_sel:[0,0,0] op_sel_hi:[1,0,1]
    v_cvt_pk_bf16_f32 v224, v224, v225
    v_cvt_pk_bf16_f32 v225, v226, v227
    v_cvt_pk_bf16_f32 v226, v228, v229
    v_cvt_pk_bf16_f32 v227, v230, v231
    v_accvgpr_read_b32 v112, a116
    v_accvgpr_read_b32 v113, a117
    v_accvgpr_read_b32 v114, a118
    v_accvgpr_read_b32 v115, a119
    v_pk_mul_f32 v[232:233], v[232:233], v[16:17] op_sel:[0,1] op_sel_hi:[1,1]
    v_pk_mul_f32 v[234:235], v[234:235], v[16:17] op_sel:[0,1] op_sel_hi:[1,1]
    v_pk_mul_f32 v[236:237], v[236:237], v[16:17] op_sel:[0,1] op_sel_hi:[1,1]
    v_pk_mul_f32 v[238:239], v[238:239], v[16:17] op_sel:[0,1] op_sel_hi:[1,1]
    v_lshlrev_b32 v116, 16, v112
    v_and_b32 v117, 0xffff0000, v112
    v_lshlrev_b32 v118, 16, v113
    v_and_b32 v119, 0xffff0000, v113
    v_lshlrev_b32 v120, 16, v114
    v_and_b32 v121, 0xffff0000, v114
    v_lshlrev_b32 v122, 16, v115
    v_and_b32 v123, 0xffff0000, v115
    v_pk_fma_f32 v[232:233], v[116:117], v[18:19], v[232:233] op_sel:[0,1,0] op_sel_hi:[1,1,1]
    v_pk_fma_f32 v[234:235], v[118:119], v[18:19], v[234:235] op_sel:[0,1,0] op_sel_hi:[1,1,1]
    v_pk_fma_f32 v[236:237], v[120:121], v[18:19], v[236:237] op_sel:[0,1,0] op_sel_hi:[1,1,1]
    v_pk_fma_f32 v[238:239], v[122:123], v[18:19], v[238:239] op_sel:[0,1,0] op_sel_hi:[1,1,1]
    v_cvt_pk_bf16_f32 v232, v232, v233
    v_cvt_pk_bf16_f32 v233, v234, v235
    v_cvt_pk_bf16_f32 v234, v236, v237
    v_cvt_pk_bf16_f32 v235, v238, v239
    s_nop 1
    v_permlane16_swap_b32 v224, v232
    v_permlane16_swap_b32 v225, v233
    v_permlane16_swap_b32 v226, v234
    v_permlane16_swap_b32 v227, v235
    s_nop 0
    v_accvgpr_write_b32 a48, v224
    v_accvgpr_write_b32 a49, v225
    v_accvgpr_write_b32 a50, v226
    v_accvgpr_write_b32 a51, v227
    v_accvgpr_write_b32 a52, v232
    v_accvgpr_write_b32 a53, v233
    v_accvgpr_write_b32 a54, v234
    v_accvgpr_write_b32 a55, v235
    v_accvgpr_read_b32 v96, a120
    v_accvgpr_read_b32 v97, a121
    v_accvgpr_read_b32 v98, a122
    v_accvgpr_read_b32 v99, a123
    v_pk_mul_f32 v[240:241], v[240:241], v[16:17] op_sel:[0,0] op_sel_hi:[1,0]
    v_pk_mul_f32 v[242:243], v[242:243], v[16:17] op_sel:[0,0] op_sel_hi:[1,0]
    v_pk_mul_f32 v[244:245], v[244:245], v[16:17] op_sel:[0,0] op_sel_hi:[1,0]
    v_pk_mul_f32 v[246:247], v[246:247], v[16:17] op_sel:[0,0] op_sel_hi:[1,0]
    v_lshlrev_b32 v100, 16, v96
    v_and_b32 v101, 0xffff0000, v96
    v_lshlrev_b32 v102, 16, v97
    v_and_b32 v103, 0xffff0000, v97
    v_lshlrev_b32 v104, 16, v98
    v_and_b32 v105, 0xffff0000, v98
    v_lshlrev_b32 v106, 16, v99
    v_and_b32 v107, 0xffff0000, v99
    v_pk_fma_f32 v[240:241], v[100:101], v[18:19], v[240:241] op_sel:[0,0,0] op_sel_hi:[1,0,1]
    v_pk_fma_f32 v[242:243], v[102:103], v[18:19], v[242:243] op_sel:[0,0,0] op_sel_hi:[1,0,1]
    v_pk_fma_f32 v[244:245], v[104:105], v[18:19], v[244:245] op_sel:[0,0,0] op_sel_hi:[1,0,1]
    v_pk_fma_f32 v[246:247], v[106:107], v[18:19], v[246:247] op_sel:[0,0,0] op_sel_hi:[1,0,1]
    v_cvt_pk_bf16_f32 v240, v240, v241
    v_cvt_pk_bf16_f32 v241, v242, v243
    v_cvt_pk_bf16_f32 v242, v244, v245
    v_cvt_pk_bf16_f32 v243, v246, v247
    v_accvgpr_read_b32 v112, a124
    v_accvgpr_read_b32 v113, a125
    v_accvgpr_read_b32 v114, a126
    v_accvgpr_read_b32 v115, a127
    v_pk_mul_f32 v[248:249], v[248:249], v[16:17] op_sel:[0,1] op_sel_hi:[1,1]
    v_pk_mul_f32 v[250:251], v[250:251], v[16:17] op_sel:[0,1] op_sel_hi:[1,1]
    v_pk_mul_f32 v[252:253], v[252:253], v[16:17] op_sel:[0,1] op_sel_hi:[1,1]
    v_pk_mul_f32 v[254:255], v[254:255], v[16:17] op_sel:[0,1] op_sel_hi:[1,1]
    v_lshlrev_b32 v116, 16, v112
    v_and_b32 v117, 0xffff0000, v112
    v_lshlrev_b32 v118, 16, v113
    v_and_b32 v119, 0xffff0000, v113
    v_lshlrev_b32 v120, 16, v114
    v_and_b32 v121, 0xffff0000, v114
    v_lshlrev_b32 v122, 16, v115
    v_and_b32 v123, 0xffff0000, v115
    v_pk_fma_f32 v[248:249], v[116:117], v[18:19], v[248:249] op_sel:[0,1,0] op_sel_hi:[1,1,1]
    v_pk_fma_f32 v[250:251], v[118:119], v[18:19], v[250:251] op_sel:[0,1,0] op_sel_hi:[1,1,1]
    v_pk_fma_f32 v[252:253], v[120:121], v[18:19], v[252:253] op_sel:[0,1,0] op_sel_hi:[1,1,1]
    v_pk_fma_f32 v[254:255], v[122:123], v[18:19], v[254:255] op_sel:[0,1,0] op_sel_hi:[1,1,1]
    v_cvt_pk_bf16_f32 v248, v248, v249
    v_cvt_pk_bf16_f32 v249, v250, v251
    v_cvt_pk_bf16_f32 v250, v252, v253
    v_cvt_pk_bf16_f32 v251, v254, v255
    s_nop 1
    v_permlane16_swap_b32 v240, v248
    v_permlane16_swap_b32 v241, v249
    v_permlane16_swap_b32 v242, v250
    v_permlane16_swap_b32 v243, v251
    s_nop 0
    v_accvgpr_write_b32 a56, v240
    v_accvgpr_write_b32 a57, v241
    v_accvgpr_write_b32 a58, v242
    v_accvgpr_write_b32 a59, v243
    v_accvgpr_write_b32 a60, v248
    v_accvgpr_write_b32 a61, v249
    v_accvgpr_write_b32 a62, v250
    v_accvgpr_write_b32 a63, v251
    s_branch L_k2_op
L_k2_fin_nomerge:
    v_max_f32 v22, 0x00800000, v34
    v_rcp_f32 v16, v22
    v_max_f32 v23, 0x00800000, v35
    v_rcp_f32 v17, v23
    s_nop 0
    v_pk_mul_f32 v[128:129], v[128:129], v[16:17] op_sel:[0,0] op_sel_hi:[1,0]
    v_pk_mul_f32 v[130:131], v[130:131], v[16:17] op_sel:[0,0] op_sel_hi:[1,0]
    v_pk_mul_f32 v[132:133], v[132:133], v[16:17] op_sel:[0,0] op_sel_hi:[1,0]
    v_pk_mul_f32 v[134:135], v[134:135], v[16:17] op_sel:[0,0] op_sel_hi:[1,0]
    v_cvt_pk_bf16_f32 v128, v128, v129
    v_cvt_pk_bf16_f32 v129, v130, v131
    v_cvt_pk_bf16_f32 v130, v132, v133
    v_cvt_pk_bf16_f32 v131, v134, v135
    v_pk_mul_f32 v[136:137], v[136:137], v[16:17] op_sel:[0,1] op_sel_hi:[1,1]
    v_pk_mul_f32 v[138:139], v[138:139], v[16:17] op_sel:[0,1] op_sel_hi:[1,1]
    v_pk_mul_f32 v[140:141], v[140:141], v[16:17] op_sel:[0,1] op_sel_hi:[1,1]
    v_pk_mul_f32 v[142:143], v[142:143], v[16:17] op_sel:[0,1] op_sel_hi:[1,1]
    v_cvt_pk_bf16_f32 v136, v136, v137
    v_cvt_pk_bf16_f32 v137, v138, v139
    v_cvt_pk_bf16_f32 v138, v140, v141
    v_cvt_pk_bf16_f32 v139, v142, v143
    s_nop 1
    v_permlane16_swap_b32 v128, v136
    v_permlane16_swap_b32 v129, v137
    v_permlane16_swap_b32 v130, v138
    v_permlane16_swap_b32 v131, v139
    s_nop 0
    v_accvgpr_write_b32 a0, v128
    v_accvgpr_write_b32 a1, v129
    v_accvgpr_write_b32 a2, v130
    v_accvgpr_write_b32 a3, v131
    v_accvgpr_write_b32 a4, v136
    v_accvgpr_write_b32 a5, v137
    v_accvgpr_write_b32 a6, v138
    v_accvgpr_write_b32 a7, v139
    v_pk_mul_f32 v[144:145], v[144:145], v[16:17] op_sel:[0,0] op_sel_hi:[1,0]
    v_pk_mul_f32 v[146:147], v[146:147], v[16:17] op_sel:[0,0] op_sel_hi:[1,0]
    v_pk_mul_f32 v[148:149], v[148:149], v[16:17] op_sel:[0,0] op_sel_hi:[1,0]
    v_pk_mul_f32 v[150:151], v[150:151], v[16:17] op_sel:[0,0] op_sel_hi:[1,0]
    v_cvt_pk_bf16_f32 v144, v144, v145
    v_cvt_pk_bf16_f32 v145, v146, v147
    v_cvt_pk_bf16_f32 v146, v148, v149
    v_cvt_pk_bf16_f32 v147, v150, v151
    v_pk_mul_f32 v[152:153], v[152:153], v[16:17] op_sel:[0,1] op_sel_hi:[1,1]
    v_pk_mul_f32 v[154:155], v[154:155], v[16:17] op_sel:[0,1] op_sel_hi:[1,1]
    v_pk_mul_f32 v[156:157], v[156:157], v[16:17] op_sel:[0,1] op_sel_hi:[1,1]
    v_pk_mul_f32 v[158:159], v[158:159], v[16:17] op_sel:[0,1] op_sel_hi:[1,1]
    v_cvt_pk_bf16_f32 v152, v152, v153
    v_cvt_pk_bf16_f32 v153, v154, v155
    v_cvt_pk_bf16_f32 v154, v156, v157
    v_cvt_pk_bf16_f32 v155, v158, v159
    s_nop 1
    v_permlane16_swap_b32 v144, v152
    v_permlane16_swap_b32 v145, v153
    v_permlane16_swap_b32 v146, v154
    v_permlane16_swap_b32 v147, v155
    s_nop 0
    v_accvgpr_write_b32 a8, v144
    v_accvgpr_write_b32 a9, v145
    v_accvgpr_write_b32 a10, v146
    v_accvgpr_write_b32 a11, v147
    v_accvgpr_write_b32 a12, v152
    v_accvgpr_write_b32 a13, v153
    v_accvgpr_write_b32 a14, v154
    v_accvgpr_write_b32 a15, v155
    v_pk_mul_f32 v[160:161], v[160:161], v[16:17] op_sel:[0,0] op_sel_hi:[1,0]
    v_pk_mul_f32 v[162:163], v[162:163], v[16:17] op_sel:[0,0] op_sel_hi:[1,0]
    v_pk_mul_f32 v[164:165], v[164:165], v[16:17] op_sel:[0,0] op_sel_hi:[1,0]
    v_pk_mul_f32 v[166:167], v[166:167], v[16:17] op_sel:[0,0] op_sel_hi:[1,0]
    v_cvt_pk_bf16_f32 v160, v160, v161
    v_cvt_pk_bf16_f32 v161, v162, v163
    v_cvt_pk_bf16_f32 v162, v164, v165
    v_cvt_pk_bf16_f32 v163, v166, v167
    v_pk_mul_f32 v[168:169], v[168:169], v[16:17] op_sel:[0,1] op_sel_hi:[1,1]
    v_pk_mul_f32 v[170:171], v[170:171], v[16:17] op_sel:[0,1] op_sel_hi:[1,1]
    v_pk_mul_f32 v[172:173], v[172:173], v[16:17] op_sel:[0,1] op_sel_hi:[1,1]
    v_pk_mul_f32 v[174:175], v[174:175], v[16:17] op_sel:[0,1] op_sel_hi:[1,1]
    v_cvt_pk_bf16_f32 v168, v168, v169
    v_cvt_pk_bf16_f32 v169, v170, v171
    v_cvt_pk_bf16_f32 v170, v172, v173
    v_cvt_pk_bf16_f32 v171, v174, v175
    s_nop 1
    v_permlane16_swap_b32 v160, v168
    v_permlane16_swap_b32 v161, v169
    v_permlane16_swap_b32 v162, v170
    v_permlane16_swap_b32 v163, v171
    s_nop 0
    v_accvgpr_write_b32 a16, v160
    v_accvgpr_write_b32 a17, v161
    v_accvgpr_write_b32 a18, v162
    v_accvgpr_write_b32 a19, v163
    v_accvgpr_write_b32 a20, v168
    v_accvgpr_write_b32 a21, v169
    v_accvgpr_write_b32 a22, v170
    v_accvgpr_write_b32 a23, v171
    v_pk_mul_f32 v[176:177], v[176:177], v[16:17] op_sel:[0,0] op_sel_hi:[1,0]
    v_pk_mul_f32 v[178:179], v[178:179], v[16:17] op_sel:[0,0] op_sel_hi:[1,0]
    v_pk_mul_f32 v[180:181], v[180:181], v[16:17] op_sel:[0,0] op_sel_hi:[1,0]
    v_pk_mul_f32 v[182:183], v[182:183], v[16:17] op_sel:[0,0] op_sel_hi:[1,0]
    v_cvt_pk_bf16_f32 v176, v176, v177
    v_cvt_pk_bf16_f32 v177, v178, v179
    v_cvt_pk_bf16_f32 v178, v180, v181
    v_cvt_pk_bf16_f32 v179, v182, v183
    v_pk_mul_f32 v[184:185], v[184:185], v[16:17] op_sel:[0,1] op_sel_hi:[1,1]
    v_pk_mul_f32 v[186:187], v[186:187], v[16:17] op_sel:[0,1] op_sel_hi:[1,1]
    v_pk_mul_f32 v[188:189], v[188:189], v[16:17] op_sel:[0,1] op_sel_hi:[1,1]
    v_pk_mul_f32 v[190:191], v[190:191], v[16:17] op_sel:[0,1] op_sel_hi:[1,1]
    v_cvt_pk_bf16_f32 v184, v184, v185
    v_cvt_pk_bf16_f32 v185, v186, v187
    v_cvt_pk_bf16_f32 v186, v188, v189
    v_cvt_pk_bf16_f32 v187, v190, v191
    s_nop 1
    v_permlane16_swap_b32 v176, v184
    v_permlane16_swap_b32 v177, v185
    v_permlane16_swap_b32 v178, v186
    v_permlane16_swap_b32 v179, v187
    s_nop 0
    v_accvgpr_write_b32 a24, v176
    v_accvgpr_write_b32 a25, v177
    v_accvgpr_write_b32 a26, v178
    v_accvgpr_write_b32 a27, v179
    v_accvgpr_write_b32 a28, v184
    v_accvgpr_write_b32 a29, v185
    v_accvgpr_write_b32 a30, v186
    v_accvgpr_write_b32 a31, v187
    v_pk_mul_f32 v[192:193], v[192:193], v[16:17] op_sel:[0,0] op_sel_hi:[1,0]
    v_pk_mul_f32 v[194:195], v[194:195], v[16:17] op_sel:[0,0] op_sel_hi:[1,0]
    v_pk_mul_f32 v[196:197], v[196:197], v[16:17] op_sel:[0,0] op_sel_hi:[1,0]
    v_pk_mul_f32 v[198:199], v[198:199], v[16:17] op_sel:[0,0] op_sel_hi:[1,0]
    v_cvt_pk_bf16_f32 v192, v192, v193
    v_cvt_pk_bf16_f32 v193, v194, v195
    v_cvt_pk_bf16_f32 v194, v196, v197
    v_cvt_pk_bf16_f32 v195, v198, v199
    v_pk_mul_f32 v[200:201], v[200:201], v[16:17] op_sel:[0,1] op_sel_hi:[1,1]
    v_pk_mul_f32 v[202:203], v[202:203], v[16:17] op_sel:[0,1] op_sel_hi:[1,1]
    v_pk_mul_f32 v[204:205], v[204:205], v[16:17] op_sel:[0,1] op_sel_hi:[1,1]
    v_pk_mul_f32 v[206:207], v[206:207], v[16:17] op_sel:[0,1] op_sel_hi:[1,1]
    v_cvt_pk_bf16_f32 v200, v200, v201
    v_cvt_pk_bf16_f32 v201, v202, v203
    v_cvt_pk_bf16_f32 v202, v204, v205
    v_cvt_pk_bf16_f32 v203, v206, v207
    s_nop 1
    v_permlane16_swap_b32 v192, v200
    v_permlane16_swap_b32 v193, v201
    v_permlane16_swap_b32 v194, v202
    v_permlane16_swap_b32 v195, v203
    s_nop 0
    v_accvgpr_write_b32 a32, v192
    v_accvgpr_write_b32 a33, v193
    v_accvgpr_write_b32 a34, v194
    v_accvgpr_write_b32 a35, v195
    v_accvgpr_write_b32 a36, v200
    v_accvgpr_write_b32 a37, v201
    v_accvgpr_write_b32 a38, v202
    v_accvgpr_write_b32 a39, v203
    v_pk_mul_f32 v[208:209], v[208:209], v[16:17] op_sel:[0,0] op_sel_hi:[1,0]
    v_pk_mul_f32 v[210:211], v[210:211], v[16:17] op_sel:[0,0] op_sel_hi:[1,0]
    v_pk_mul_f32 v[212:213], v[212:213], v[16:17] op_sel:[0,0] op_sel_hi:[1,0]
    v_pk_mul_f32 v[214:215], v[214:215], v[16:17] op_sel:[0,0] op_sel_hi:[1,0]
    v_cvt_pk_bf16_f32 v208, v208, v209
    v_cvt_pk_bf16_f32 v209, v210, v211
    v_cvt_pk_bf16_f32 v210, v212, v213
    v_cvt_pk_bf16_f32 v211, v214, v215
    v_pk_mul_f32 v[216:217], v[216:217], v[16:17] op_sel:[0,1] op_sel_hi:[1,1]
    v_pk_mul_f32 v[218:219], v[218:219], v[16:17] op_sel:[0,1] op_sel_hi:[1,1]
    v_pk_mul_f32 v[220:221], v[220:221], v[16:17] op_sel:[0,1] op_sel_hi:[1,1]
    v_pk_mul_f32 v[222:223], v[222:223], v[16:17] op_sel:[0,1] op_sel_hi:[1,1]
    v_cvt_pk_bf16_f32 v216, v216, v217
    v_cvt_pk_bf16_f32 v217, v218, v219
    v_cvt_pk_bf16_f32 v218, v220, v221
    v_cvt_pk_bf16_f32 v219, v222, v223
    s_nop 1
    v_permlane16_swap_b32 v208, v216
    v_permlane16_swap_b32 v209, v217
    v_permlane16_swap_b32 v210, v218
    v_permlane16_swap_b32 v211, v219
    s_nop 0
    v_accvgpr_write_b32 a40, v208
    v_accvgpr_write_b32 a41, v209
    v_accvgpr_write_b32 a42, v210
    v_accvgpr_write_b32 a43, v211
    v_accvgpr_write_b32 a44, v216
    v_accvgpr_write_b32 a45, v217
    v_accvgpr_write_b32 a46, v218
    v_accvgpr_write_b32 a47, v219
    v_pk_mul_f32 v[224:225], v[224:225], v[16:17] op_sel:[0,0] op_sel_hi:[1,0]
    v_pk_mul_f32 v[226:227], v[226:227], v[16:17] op_sel:[0,0] op_sel_hi:[1,0]
    v_pk_mul_f32 v[228:229], v[228:229], v[16:17] op_sel:[0,0] op_sel_hi:[1,0]
    v_pk_mul_f32 v[230:231], v[230:231], v[16:17] op_sel:[0,0] op_sel_hi:[1,0]
    v_cvt_pk_bf16_f32 v224, v224, v225
    v_cvt_pk_bf16_f32 v225, v226, v227
    v_cvt_pk_bf16_f32 v226, v228, v229
    v_cvt_pk_bf16_f32 v227, v230, v231
    v_pk_mul_f32 v[232:233], v[232:233], v[16:17] op_sel:[0,1] op_sel_hi:[1,1]
    v_pk_mul_f32 v[234:235], v[234:235], v[16:17] op_sel:[0,1] op_sel_hi:[1,1]
    v_pk_mul_f32 v[236:237], v[236:237], v[16:17] op_sel:[0,1] op_sel_hi:[1,1]
    v_pk_mul_f32 v[238:239], v[238:239], v[16:17] op_sel:[0,1] op_sel_hi:[1,1]
    v_cvt_pk_bf16_f32 v232, v232, v233
    v_cvt_pk_bf16_f32 v233, v234, v235
    v_cvt_pk_bf16_f32 v234, v236, v237
    v_cvt_pk_bf16_f32 v235, v238, v239
    s_nop 1
    v_permlane16_swap_b32 v224, v232
    v_permlane16_swap_b32 v225, v233
    v_permlane16_swap_b32 v226, v234
    v_permlane16_swap_b32 v227, v235
    s_nop 0
    v_accvgpr_write_b32 a48, v224
    v_accvgpr_write_b32 a49, v225
    v_accvgpr_write_b32 a50, v226
    v_accvgpr_write_b32 a51, v227
    v_accvgpr_write_b32 a52, v232
    v_accvgpr_write_b32 a53, v233
    v_accvgpr_write_b32 a54, v234
    v_accvgpr_write_b32 a55, v235
    v_pk_mul_f32 v[240:241], v[240:241], v[16:17] op_sel:[0,0] op_sel_hi:[1,0]
    v_pk_mul_f32 v[242:243], v[242:243], v[16:17] op_sel:[0,0] op_sel_hi:[1,0]
    v_pk_mul_f32 v[244:245], v[244:245], v[16:17] op_sel:[0,0] op_sel_hi:[1,0]
    v_pk_mul_f32 v[246:247], v[246:247], v[16:17] op_sel:[0,0] op_sel_hi:[1,0]
    v_cvt_pk_bf16_f32 v240, v240, v241
    v_cvt_pk_bf16_f32 v241, v242, v243
    v_cvt_pk_bf16_f32 v242, v244, v245
    v_cvt_pk_bf16_f32 v243, v246, v247
    v_pk_mul_f32 v[248:249], v[248:249], v[16:17] op_sel:[0,1] op_sel_hi:[1,1]
    v_pk_mul_f32 v[250:251], v[250:251], v[16:17] op_sel:[0,1] op_sel_hi:[1,1]
    v_pk_mul_f32 v[252:253], v[252:253], v[16:17] op_sel:[0,1] op_sel_hi:[1,1]
    v_pk_mul_f32 v[254:255], v[254:255], v[16:17] op_sel:[0,1] op_sel_hi:[1,1]
    v_cvt_pk_bf16_f32 v248, v248, v249
    v_cvt_pk_bf16_f32 v249, v250, v251
    v_cvt_pk_bf16_f32 v250, v252, v253
    v_cvt_pk_bf16_f32 v251, v254, v255
    s_nop 1
    v_permlane16_swap_b32 v240, v248
    v_permlane16_swap_b32 v241, v249
    v_permlane16_swap_b32 v242, v250
    v_permlane16_swap_b32 v243, v251
    s_nop 0
    v_accvgpr_write_b32 a56, v240
    v_accvgpr_write_b32 a57, v241
    v_accvgpr_write_b32 a58, v242
    v_accvgpr_write_b32 a59, v243
    v_accvgpr_write_b32 a60, v248
    v_accvgpr_write_b32 a61, v249
    v_accvgpr_write_b32 a62, v250
    v_accvgpr_write_b32 a63, v251
L_k2_op:
    v_mov_b32 v20, v52
    v_mov_b32 v21, v53
    v_add_u32 v16, s68, v20
    v_add_u32 v17, s68, v21
    v_add_u32 v18, s46, v20
    v_add_u32 v19, s46, v21
    s_waitcnt vmcnt(41)
    s_barrier
    ds_read_b64_tr_b16 a[128:129], v16 offset:0
    ds_read_b64_tr_b16 a[130:131], v16 offset:7168
    ds_read_b64_tr_b16 a[132:133], v17 offset:0
    ds_read_b64_tr_b16 a[134:135], v17 offset:7168
    ds_read_b64_tr_b16 a[136:137], v16 offset:128
    ds_read_b64_tr_b16 a[138:139], v16 offset:7296
    ds_read_b64_tr_b16 a[140:141], v17 offset:128
    ds_read_b64_tr_b16 a[142:143], v17 offset:7296
    ds_read_b64_tr_b16 a[144:145], v16 offset:256
    ds_read_b64_tr_b16 a[146:147], v16 offset:7424
    ds_read_b64_tr_b16 a[148:149], v17 offset:256
    ds_read_b64_tr_b16 a[150:151], v17 offset:7424
    ds_read_b64_tr_b16 a[152:153], v16 offset:384
    ds_read_b64_tr_b16 a[154:155], v16 offset:7552
    s_waitcnt lgkmcnt(10)
    v_mfma_f32_32x32x16_bf16 v[32:47], a[128:131], a[0:3], 0
    ds_read_b64_tr_b16 a[156:157], v17 offset:384
    ds_read_b64_tr_b16 a[158:159], v17 offset:7552
    v_accvgpr_read_b32 v22, a224
    v_lshlrev_b32 v23, 16, v22
    v_and_b32 v24, 0xffff0000, v22
    v_mul_f32 v25, 0xbfb8aa3b, v23
    v_mfma_f32_32x32x16_bf16 v[48:63], a[132:135], a[0:3], 0
    ds_read_b64_tr_b16 a[160:161], v16 offset:512
    ds_read_b64_tr_b16 a[162:163], v16 offset:7680
    v_mul_f32 v26, 0xbfb8aa3b, v24
    v_exp_f32 v25, v25
    s_waitcnt lgkmcnt(10)
    v_mfma_f32_32x32x16_bf16 v[64:79], a[136:139], a[0:3], 0
    ds_read_b64_tr_b16 a[164:165], v17 offset:512
    ds_read_b64_tr_b16 a[166:167], v17 offset:7680
    v_exp_f32 v26, v26
    v_add_f32 v25, 1.0, v25
    v_add_f32 v26, 1.0, v26
    v_mfma_f32_32x32x16_bf16 v[80:95], a[140:143], a[0:3], 0
    ds_read_b64_tr_b16 a[168:169], v16 offset:640
    ds_read_b64_tr_b16 a[170:171], v16 offset:7808
    v_rcp_f32 v25, v25
    s_waitcnt lgkmcnt(10)
    v_mfma_f32_32x32x16_bf16 v[96:111], a[144:147], a[0:3], 0
    ds_read_b64_tr_b16 a[172:173], v17 offset:640
    ds_read_b64_tr_b16 a[174:175], v17 offset:7808
    v_rcp_f32 v26, v26
    v_mul_f32 v23, v23, v25
    v_mul_f32 v24, v24, v26
    v_mfma_f32_32x32x16_bf16 v[112:127], a[148:151], a[0:3], 0
    ds_read_b64_tr_b16 a[176:177], v16 offset:768
    ds_read_b64_tr_b16 a[178:179], v16 offset:7936
    v_cvt_pk_bf16_f32 v22, v23, v24
    v_accvgpr_write_b32 a224, v22
    v_accvgpr_read_b32 v7, a225
    s_waitcnt lgkmcnt(10)
    v_mfma_f32_32x32x16_bf16 v[128:143], a[152:155], a[0:3], 0
    ds_read_b64_tr_b16 a[180:181], v17 offset:768
    ds_read_b64_tr_b16 a[182:183], v17 offset:7936
    v_lshlrev_b32 v8, 16, v7
    v_and_b32 v9, 0xffff0000, v7
    v_mul_f32 v10, 0xbfb8aa3b, v8
    v_mul_f32 v11, 0xbfb8aa3b, v9
    v_mfma_f32_32x32x16_bf16 v[144:159], a[156:159], a[0:3], 0
    ds_read_b64_tr_b16 a[184:185], v18 offset:0
    ds_read_b64_tr_b16 a[186:187], v18 offset:7168
    v_exp_f32 v10, v10
    s_waitcnt lgkmcnt(10)
    v_mfma_f32_32x32x16_bf16 v[160:175], a[160:163], a[0:3], 0
    ds_read_b64_tr_b16 a[188:189], v19 offset:0
    ds_read_b64_tr_b16 a[190:191], v19 offset:7168
    v_exp_f32 v11, v11
    v_add_f32 v10, 1.0, v10
    v_add_f32 v11, 1.0, v11
    v_mfma_f32_32x32x16_bf16 v[176:191], a[164:167], a[0:3], 0
    ds_read_b64_tr_b16 a[128:129], v18 offset:128
    ds_read_b64_tr_b16 a[130:131], v18 offset:7296
    v_rcp_f32 v10, v10
    s_waitcnt lgkmcnt(10)
    v_mfma_f32_32x32x16_bf16 v[192:207], a[168:171], a[0:3], 0
    ds_read_b64_tr_b16 a[132:133], v19 offset:128
    ds_read_b64_tr_b16 a[134:135], v19 offset:7296
    v_rcp_f32 v11, v11
    v_mul_f32 v8, v8, v10
    v_mul_f32 v9, v9, v11
    v_mfma_f32_32x32x16_bf16 v[208:223], a[172:175], a[0:3], 0
    ds_read_b64_tr_b16 a[136:137], v18 offset:256
    ds_read_b64_tr_b16 a[138:139], v18 offset:7424
    v_cvt_pk_bf16_f32 v7, v8, v9
    v_accvgpr_write_b32 a225, v7
    v_accvgpr_read_b32 v22, a226
    s_waitcnt lgkmcnt(10)
    v_mfma_f32_32x32x16_bf16 v[224:239], a[176:179], a[0:3], 0
    ds_read_b64_tr_b16 a[140:141], v19 offset:256
    ds_read_b64_tr_b16 a[142:143], v19 offset:7424
    v_lshlrev_b32 v23, 16, v22
    v_and_b32 v24, 0xffff0000, v22
    v_mul_f32 v25, 0xbfb8aa3b, v23
    v_mul_f32 v26, 0xbfb8aa3b, v24
    v_mfma_f32_32x32x16_bf16 v[240:255], a[180:183], a[0:3], 0
    ds_read_b64_tr_b16 a[144:145], v18 offset:384
    ds_read_b64_tr_b16 a[146:147], v18 offset:7552
    v_exp_f32 v25, v25
    s_waitcnt lgkmcnt(10)
    v_mfma_f32_32x32x16_bf16 v[32:47], a[184:187], a[4:7], v[32:47]
    ds_read_b64_tr_b16 a[148:149], v19 offset:384
    ds_read_b64_tr_b16 a[150:151], v19 offset:7552
    v_exp_f32 v26, v26
    v_add_f32 v25, 1.0, v25
    v_add_f32 v26, 1.0, v26
    v_mfma_f32_32x32x16_bf16 v[48:63], a[188:191], a[4:7], v[48:63]
    ds_read_b64_tr_b16 a[152:153], v18 offset:512
    ds_read_b64_tr_b16 a[154:155], v18 offset:7680
    v_rcp_f32 v25, v25
    s_waitcnt lgkmcnt(10)
    v_mfma_f32_32x32x16_bf16 v[64:79], a[128:131], a[4:7], v[64:79]
    ds_read_b64_tr_b16 a[156:157], v19 offset:512
    ds_read_b64_tr_b16 a[158:159], v19 offset:7680
    v_rcp_f32 v26, v26
    v_mul_f32 v23, v23, v25
    v_mul_f32 v24, v24, v26
    v_mfma_f32_32x32x16_bf16 v[80:95], a[132:135], a[4:7], v[80:95]
    ds_read_b64_tr_b16 a[160:161], v18 offset:640
    ds_read_b64_tr_b16 a[162:163], v18 offset:7808
    v_cvt_pk_bf16_f32 v22, v23, v24
    v_accvgpr_write_b32 a226, v22
    v_accvgpr_read_b32 v7, a227
    s_waitcnt lgkmcnt(10)
    v_mfma_f32_32x32x16_bf16 v[96:111], a[136:139], a[4:7], v[96:111]
    ds_read_b64_tr_b16 a[164:165], v19 offset:640
    ds_read_b64_tr_b16 a[166:167], v19 offset:7808
    v_lshlrev_b32 v8, 16, v7
    v_and_b32 v9, 0xffff0000, v7
    v_mul_f32 v10, 0xbfb8aa3b, v8
    v_mul_f32 v11, 0xbfb8aa3b, v9
    v_mfma_f32_32x32x16_bf16 v[112:127], a[140:143], a[4:7], v[112:127]
    ds_read_b64_tr_b16 a[168:169], v18 offset:768
    ds_read_b64_tr_b16 a[170:171], v18 offset:7936
    v_exp_f32 v10, v10
    s_waitcnt lgkmcnt(10)
    v_mfma_f32_32x32x16_bf16 v[128:143], a[144:147], a[4:7], v[128:143]
    ds_read_b64_tr_b16 a[172:173], v19 offset:768
    ds_read_b64_tr_b16 a[174:175], v19 offset:7936
    v_exp_f32 v11, v11
    v_add_f32 v10, 1.0, v10
    v_add_f32 v11, 1.0, v11
    v_mfma_f32_32x32x16_bf16 v[144:159], a[148:151], a[4:7], v[144:159]
    s_waitcnt vmcnt(33)
    s_barrier
    ds_read_b64_tr_b16 a[176:177], v16 offset:16384
    ds_read_b64_tr_b16 a[178:179], v16 offset:23552
    s_waitcnt lgkmcnt(10)
    v_mfma_f32_32x32x16_bf16 v[160:175], a[152:155], a[4:7], v[160:175]
    ds_read_b64_tr_b16 a[180:181], v17 offset:16384
    ds_read_b64_tr_b16 a[182:183], v17 offset:23552
    s_mov_b32 m0, s44
    v_rcp_f32 v10, v10
    v_mfma_f32_32x32x16_bf16 v[176:191], a[156:159], a[4:7], v[176:191]
    ds_read_b64_tr_b16 a[184:185], v16 offset:16512
    ds_read_b64_tr_b16 a[186:187], v16 offset:23680
    buffer_load_dwordx4 v3, s[8:11], s73 offen offset:0 sc1 lds
    v_rcp_f32 v11, v11
    s_waitcnt lgkmcnt(10)
    v_mfma_f32_32x32x16_bf16 v[192:207], a[160:163], a[4:7], v[192:207]
    ds_read_b64_tr_b16 a[188:189], v17 offset:16512
    ds_read_b64_tr_b16 a[190:191], v17 offset:23680
    v_mul_f32 v8, v8, v10
    v_mul_f32 v9, v9, v11
    v_cvt_pk_bf16_f32 v7, v8, v9
    v_accvgpr_write_b32 a227, v7
    v_mfma_f32_32x32x16_bf16 v[208:223], a[164:167], a[4:7], v[208:223]
    ds_read_b64_tr_b16 a[128:129], v16 offset:16640
    ds_read_b64_tr_b16 a[130:131], v16 offset:23808
    buffer_load_dwordx4 v4, s[8:11], s73 offen offset:1024 sc1 lds
    v_accvgpr_read_b32 v22, a228
    v_lshlrev_b32 v23, 16, v22
    s_waitcnt lgkmcnt(10)
    v_mfma_f32_32x32x16_bf16 v[224:239], a[168:171], a[4:7], v[224:239]
    ds_read_b64_tr_b16 a[132:133], v17 offset:16640
    ds_read_b64_tr_b16 a[134:135], v17 offset:23808
    v_and_b32 v24, 0xffff0000, v22
    v_mul_f32 v25, 0xbfb8aa3b, v23
    v_mul_f32 v26, 0xbfb8aa3b, v24
    v_mfma_f32_32x32x16_bf16 v[240:255], a[172:175], a[4:7], v[240:255]
    ds_read_b64_tr_b16 a[136:137], v16 offset:16768
    ds_read_b64_tr_b16 a[138:139], v16 offset:23936
    buffer_load_dwordx4 v5, s[8:11], s73 offen offset:2048 sc1 lds
    v_exp_f32 v25, v25
    s_waitcnt lgkmcnt(10)
    v_mfma_f32_32x32x16_bf16 v[32:47], a[176:179], a[8:11], v[32:47]
    ds_read_b64_tr_b16 a[140:141], v17 offset:16768
    ds_read_b64_tr_b16 a[142:143], v17 offset:23936
    v_exp_f32 v26, v26
    v_add_f32 v25, 1.0, v25
    v_add_f32 v26, 1.0, v26
    v_mfma_f32_32x32x16_bf16 v[48:63], a[180:183], a[8:11], v[48:63]
    ds_read_b64_tr_b16 a[144:145], v16 offset:16896
    ds_read_b64_tr_b16 a[146:147], v16 offset:24064
    buffer_load_dwordx4 v6, s[8:11], s73 offen offset:3072 sc1 lds
    v_rcp_f32 v25, v25
    s_waitcnt lgkmcnt(10)
    v_mfma_f32_32x32x16_bf16 v[64:79], a[184:187], a[8:11], v[64:79]
    ds_read_b64_tr_b16 a[148:149], v17 offset:16896
    ds_read_b64_tr_b16 a[150:151], v17 offset:24064
    s_mov_b32 m0, s45
    v_rcp_f32 v26, v26
    v_mul_f32 v23, v23, v25
    v_mfma_f32_32x32x16_bf16 v[80:95], a[188:191], a[8:11], v[80:95]
    ds_read_b64_tr_b16 a[152:153], v16 offset:17024
    ds_read_b64_tr_b16 a[154:155], v16 offset:24192
    buffer_load_dwordx4 v3, s[8:11], s74 offen offset:0 sc1 lds
    v_mul_f32 v24, v24, v26
    v_cvt_pk_bf16_f32 v22, v23, v24
    s_waitcnt lgkmcnt(10)
    v_mfma_f32_32x32x16_bf16 v[96:111], a[128:131], a[8:11], v[96:111]
    ds_read_b64_tr_b16 a[156:157], v17 offset:17024
    ds_read_b64_tr_b16 a[158:159], v17 offset:24192
    v_accvgpr_write_b32 a228, v22
    v_accvgpr_read_b32 v7, a229
    v_lshlrev_b32 v8, 16, v7
    v_and_b32 v9, 0xffff0000, v7
    v_mfma_f32_32x32x16_bf16 v[112:127], a[132:135], a[8:11], v[112:127]
    ds_read_b64_tr_b16 a[160:161], v16 offset:17152
    ds_read_b64_tr_b16 a[162:163], v16 offset:24320
    buffer_load_dwordx4 v4, s[8:11], s74 offen offset:1024 sc1 lds
    v_mul_f32 v10, 0xbfb8aa3b, v8
    v_mul_f32 v11, 0xbfb8aa3b, v9
    s_waitcnt lgkmcnt(10)
    v_mfma_f32_32x32x16_bf16 v[128:143], a[136:139], a[8:11], v[128:143]
    ds_read_b64_tr_b16 a[164:165], v17 offset:17152
    ds_read_b64_tr_b16 a[166:167], v17 offset:24320
    v_exp_f32 v10, v10
    v_exp_f32 v11, v11
    v_mfma_f32_32x32x16_bf16 v[144:159], a[140:143], a[8:11], v[144:159]
    ds_read_b64_tr_b16 a[168:169], v18 offset:16384
    ds_read_b64_tr_b16 a[170:171], v18 offset:23552
    buffer_load_dwordx4 v5, s[8:11], s74 offen offset:2048 sc1 lds
    v_add_f32 v10, 1.0, v10
    v_add_f32 v11, 1.0, v11
    s_waitcnt lgkmcnt(10)
    v_mfma_f32_32x32x16_bf16 v[160:175], a[144:147], a[8:11], v[160:175]
    ds_read_b64_tr_b16 a[172:173], v19 offset:16384
    ds_read_b64_tr_b16 a[174:175], v19 offset:23552
    v_rcp_f32 v10, v10
    v_rcp_f32 v11, v11
    v_mfma_f32_32x32x16_bf16 v[176:191], a[148:151], a[8:11], v[176:191]
    ds_read_b64_tr_b16 a[176:177], v18 offset:16512
    ds_read_b64_tr_b16 a[178:179], v18 offset:23680
    buffer_load_dwordx4 v6, s[8:11], s74 offen offset:3072 sc1 lds
    v_mul_f32 v8, v8, v10
    v_mul_f32 v9, v9, v11
    s_waitcnt lgkmcnt(10)
    v_mfma_f32_32x32x16_bf16 v[192:207], a[152:155], a[8:11], v[192:207]
    ds_read_b64_tr_b16 a[180:181], v19 offset:16512
    ds_read_b64_tr_b16 a[182:183], v19 offset:23680
    s_add_u32 s73, s73, s42
    s_cmp_eq_u32 s73, s72
    s_cselect_b32 s73, 0, s73
    s_add_u32 s74, s73, s43
    v_mfma_f32_32x32x16_bf16 v[208:223], a[156:159], a[8:11], v[208:223]
    ds_read_b64_tr_b16 a[184:185], v18 offset:16640
    ds_read_b64_tr_b16 a[186:187], v18 offset:23808
    v_cvt_pk_bf16_f32 v7, v8, v9
    v_accvgpr_write_b32 a229, v7
    v_accvgpr_read_b32 v22, a230
    s_waitcnt lgkmcnt(10)
    v_mfma_f32_32x32x16_bf16 v[224:239], a[160:163], a[8:11], v[224:239]
    ds_read_b64_tr_b16 a[188:189], v19 offset:16640
    ds_read_b64_tr_b16 a[190:191], v19 offset:23808
    v_lshlrev_b32 v23, 16, v22
    v_and_b32 v24, 0xffff0000, v22
    v_mul_f32 v25, 0xbfb8aa3b, v23
    v_mul_f32 v26, 0xbfb8aa3b, v24
    v_mfma_f32_32x32x16_bf16 v[240:255], a[164:167], a[8:11], v[240:255]
    ds_read_b64_tr_b16 a[128:129], v18 offset:16768
    ds_read_b64_tr_b16 a[130:131], v18 offset:23936
    v_exp_f32 v25, v25
    s_waitcnt lgkmcnt(10)
    v_mfma_f32_32x32x16_bf16 v[32:47], a[168:171], a[12:15], v[32:47]
    ds_read_b64_tr_b16 a[132:133], v19 offset:16768
    ds_read_b64_tr_b16 a[134:135], v19 offset:23936
    v_exp_f32 v26, v26
    v_add_f32 v25, 1.0, v25
    v_add_f32 v26, 1.0, v26
    v_mfma_f32_32x32x16_bf16 v[48:63], a[172:175], a[12:15], v[48:63]
    ds_read_b64_tr_b16 a[136:137], v18 offset:16896
    ds_read_b64_tr_b16 a[138:139], v18 offset:24064
    v_rcp_f32 v25, v25
    s_waitcnt lgkmcnt(10)
    v_mfma_f32_32x32x16_bf16 v[64:79], a[176:179], a[12:15], v[64:79]
    ds_read_b64_tr_b16 a[140:141], v19 offset:16896
    ds_read_b64_tr_b16 a[142:143], v19 offset:24064
    v_rcp_f32 v26, v26
    v_mul_f32 v23, v23, v25
    v_mul_f32 v24, v24, v26
    v_mfma_f32_32x32x16_bf16 v[80:95], a[180:183], a[12:15], v[80:95]
    ds_read_b64_tr_b16 a[144:145], v18 offset:17024
    ds_read_b64_tr_b16 a[146:147], v18 offset:24192
    v_cvt_pk_bf16_f32 v22, v23, v24
    v_accvgpr_write_b32 a230, v22
    v_accvgpr_read_b32 v7, a231
    s_waitcnt lgkmcnt(10)
    v_mfma_f32_32x32x16_bf16 v[96:111], a[184:187], a[12:15], v[96:111]
    ds_read_b64_tr_b16 a[148:149], v19 offset:17024
    ds_read_b64_tr_b16 a[150:151], v19 offset:24192
    v_lshlrev_b32 v8, 16, v7
    v_and_b32 v9, 0xffff0000, v7
    v_mul_f32 v10, 0xbfb8aa3b, v8
    v_mul_f32 v11, 0xbfb8aa3b, v9
    v_mfma_f32_32x32x16_bf16 v[112:127], a[188:191], a[12:15], v[112:127]
    ds_read_b64_tr_b16 a[152:153], v18 offset:17152
    ds_read_b64_tr_b16 a[154:155], v18 offset:24320
    v_exp_f32 v10, v10
    s_waitcnt lgkmcnt(10)
    v_mfma_f32_32x32x16_bf16 v[128:143], a[128:131], a[12:15], v[128:143]
    ds_read_b64_tr_b16 a[156:157], v19 offset:17152
    ds_read_b64_tr_b16 a[158:159], v19 offset:24320
    v_exp_f32 v11, v11
    v_add_f32 v10, 1.0, v10
    v_add_f32 v11, 1.0, v11
    v_mfma_f32_32x32x16_bf16 v[144:159], a[132:135], a[12:15], v[144:159]
    s_waitcnt vmcnt(33)
    s_barrier
    s_xor_b32 s68, s68, 0x8000
    s_add_u32 s46, s46, 0x8000
    s_cmp_ge_u32 s46, 163840
    s_cselect_b32 s46, 65536, s46
    v_add_u32 v16, s68, v20
    v_add_u32 v17, s68, v21
    v_add_u32 v18, s46, v20
    v_add_u32 v19, s46, v21
    ds_read_b64_tr_b16 a[160:161], v16 offset:0
    ds_read_b64_tr_b16 a[162:163], v16 offset:7168
    s_waitcnt lgkmcnt(10)
    v_mfma_f32_32x32x16_bf16 v[160:175], a[136:139], a[12:15], v[160:175]
    ds_read_b64_tr_b16 a[164:165], v17 offset:0
    ds_read_b64_tr_b16 a[166:167], v17 offset:7168
    s_add_u32 m0, s44, 16384
    v_rcp_f32 v10, v10
    v_mfma_f32_32x32x16_bf16 v[176:191], a[140:143], a[12:15], v[176:191]
    ds_read_b64_tr_b16 a[168:169], v16 offset:128
    ds_read_b64_tr_b16 a[170:171], v16 offset:7296
    buffer_load_dwordx4 v3, s[8:11], s73 offen offset:0 sc1 lds
    v_rcp_f32 v11, v11
    s_waitcnt lgkmcnt(10)
    v_mfma_f32_32x32x16_bf16 v[192:207], a[144:147], a[12:15], v[192:207]
    ds_read_b64_tr_b16 a[172:173], v17 offset:128
    ds_read_b64_tr_b16 a[174:175], v17 offset:7296
    buffer_load_dwordx4 v4, s[8:11], s73 offen offset:1024 sc1 lds
    v_mul_f32 v8, v8, v10
    v_mul_f32 v9, v9, v11
    v_cvt_pk_bf16_f32 v7, v8, v9
    v_mfma_f32_32x32x16_bf16 v[208:223], a[148:151], a[12:15], v[208:223]
    ds_read_b64_tr_b16 a[176:177], v16 offset:256
    ds_read_b64_tr_b16 a[178:179], v16 offset:7424
    buffer_load_dwordx4 v5, s[8:11], s73 offen offset:2048 sc1 lds
    v_accvgpr_write_b32 a231, v7
    v_accvgpr_read_b32 v22, a232
    s_waitcnt lgkmcnt(10)
    v_mfma_f32_32x32x16_bf16 v[224:239], a[152:155], a[12:15], v[224:239]
    ds_read_b64_tr_b16 a[180:181], v17 offset:256
    ds_read_b64_tr_b16 a[182:183], v17 offset:7424
    v_lshlrev_b32 v23, 16, v22
    v_and_b32 v24, 0xffff0000, v22
    v_mul_f32 v25, 0xbfb8aa3b, v23
    v_mul_f32 v26, 0xbfb8aa3b, v24
    v_mfma_f32_32x32x16_bf16 v[240:255], a[156:159], a[12:15], v[240:255]
    ds_read_b64_tr_b16 a[184:185], v16 offset:384
    ds_read_b64_tr_b16 a[186:187], v16 offset:7552
    buffer_load_dwordx4 v6, s[8:11], s73 offen offset:3072 sc1 lds
    v_exp_f32 v25, v25
    s_waitcnt lgkmcnt(10)
    v_mfma_f32_32x32x16_bf16 v[32:47], a[160:163], a[16:19], v[32:47]
    ds_read_b64_tr_b16 a[188:189], v17 offset:384
    ds_read_b64_tr_b16 a[190:191], v17 offset:7552
    s_add_u32 m0, s45, 16384
    v_exp_f32 v26, v26
    v_add_f32 v25, 1.0, v25
    v_mfma_f32_32x32x16_bf16 v[48:63], a[164:167], a[16:19], v[48:63]
    ds_read_b64_tr_b16 a[128:129], v16 offset:512
    ds_read_b64_tr_b16 a[130:131], v16 offset:7680
    buffer_load_dwordx4 v3, s[8:11], s74 offen offset:0 sc1 lds
    v_add_f32 v26, 1.0, v26
    s_waitcnt lgkmcnt(10)
    v_mfma_f32_32x32x16_bf16 v[64:79], a[168:171], a[16:19], v[64:79]
    ds_read_b64_tr_b16 a[132:133], v17 offset:512
    ds_read_b64_tr_b16 a[134:135], v17 offset:7680
    v_rcp_f32 v25, v25
    v_rcp_f32 v26, v26
    v_mfma_f32_32x32x16_bf16 v[80:95], a[172:175], a[16:19], v[80:95]
    ds_read_b64_tr_b16 a[136:137], v16 offset:640
    ds_read_b64_tr_b16 a[138:139], v16 offset:7808
    buffer_load_dwordx4 v4, s[8:11], s74 offen offset:1024 sc1 lds
    v_mul_f32 v23, v23, v25
    v_mul_f32 v24, v24, v26
    s_waitcnt lgkmcnt(10)
    v_mfma_f32_32x32x16_bf16 v[96:111], a[176:179], a[16:19], v[96:111]
    ds_read_b64_tr_b16 a[140:141], v17 offset:640
    ds_read_b64_tr_b16 a[142:143], v17 offset:7808
    v_cvt_pk_bf16_f32 v22, v23, v24
    v_accvgpr_write_b32 a232, v22
    v_accvgpr_read_b32 v7, a233
    v_lshlrev_b32 v8, 16, v7
    v_mfma_f32_32x32x16_bf16 v[112:127], a[180:183], a[16:19], v[112:127]
    ds_read_b64_tr_b16 a[144:145], v16 offset:768
    ds_read_b64_tr_b16 a[146:147], v16 offset:7936
    buffer_load_dwordx4 v5, s[8:11], s74 offen offset:2048 sc1 lds
    v_and_b32 v9, 0xffff0000, v7
    v_mul_f32 v10, 0xbfb8aa3b, v8
    s_waitcnt lgkmcnt(10)
    v_mfma_f32_32x32x16_bf16 v[128:143], a[184:187], a[16:19], v[128:143]
    ds_read_b64_tr_b16 a[148:149], v17 offset:768
    ds_read_b64_tr_b16 a[150:151], v17 offset:7936
    v_mul_f32 v11, 0xbfb8aa3b, v9
    v_exp_f32 v10, v10
    v_mfma_f32_32x32x16_bf16 v[144:159], a[188:191], a[16:19], v[144:159]
    ds_read_b64_tr_b16 a[152:153], v18 offset:0
    ds_read_b64_tr_b16 a[154:155], v18 offset:7168
    buffer_load_dwordx4 v6, s[8:11], s74 offen offset:3072 sc1 lds
    v_exp_f32 v11, v11
    s_waitcnt lgkmcnt(10)
    v_mfma_f32_32x32x16_bf16 v[160:175], a[128:131], a[16:19], v[160:175]
    ds_read_b64_tr_b16 a[156:157], v19 offset:0
    ds_read_b64_tr_b16 a[158:159], v19 offset:7168
    s_add_u32 s73, s73, s42
    s_cmp_eq_u32 s73, s72
    s_cselect_b32 s73, 0, s73
    s_add_u32 s74, s73, s43
    v_mfma_f32_32x32x16_bf16 v[176:191], a[132:135], a[16:19], v[176:191]
    ds_read_b64_tr_b16 a[160:161], v18 offset:128
    ds_read_b64_tr_b16 a[162:163], v18 offset:7296
    s_xor_b32 s44, s44, 0x8000
    s_add_u32 s45, s45, 0x8000
    s_cmp_ge_u32 s45, 163840
    s_cselect_b32 s45, s55, s45
    s_waitcnt lgkmcnt(10)
    v_mfma_f32_32x32x16_bf16 v[192:207], a[136:139], a[16:19], v[192:207]
    ds_read_b64_tr_b16 a[164:165], v19 offset:128
    ds_read_b64_tr_b16 a[166:167], v19 offset:7296
    v_add_f32 v10, 1.0, v10
    v_add_f32 v11, 1.0, v11
    v_rcp_f32 v10, v10
    v_mfma_f32_32x32x16_bf16 v[208:223], a[140:143], a[16:19], v[208:223]
    ds_read_b64_tr_b16 a[168:169], v18 offset:256
    ds_read_b64_tr_b16 a[170:171], v18 offset:7424
    v_rcp_f32 v11, v11
    v_mul_f32 v8, v8, v10
    s_waitcnt lgkmcnt(10)
    v_mfma_f32_32x32x16_bf16 v[224:239], a[144:147], a[16:19], v[224:239]
    ds_read_b64_tr_b16 a[172:173], v19 offset:256
    ds_read_b64_tr_b16 a[174:175], v19 offset:7424
    v_mul_f32 v9, v9, v11
    v_cvt_pk_bf16_f32 v7, v8, v9
    v_accvgpr_write_b32 a233, v7
    v_accvgpr_read_b32 v22, a234
    v_mfma_f32_32x32x16_bf16 v[240:255], a[148:151], a[16:19], v[240:255]
    ds_read_b64_tr_b16 a[176:177], v18 offset:384
    ds_read_b64_tr_b16 a[178:179], v18 offset:7552
    v_lshlrev_b32 v23, 16, v22
    v_and_b32 v24, 0xffff0000, v22
    v_mul_f32 v25, 0xbfb8aa3b, v23
    s_waitcnt lgkmcnt(10)
    v_mfma_f32_32x32x16_bf16 v[32:47], a[152:155], a[20:23], v[32:47]
    ds_read_b64_tr_b16 a[180:181], v19 offset:384
    ds_read_b64_tr_b16 a[182:183], v19 offset:7552
    v_mul_f32 v26, 0xbfb8aa3b, v24
    v_exp_f32 v25, v25
    v_mfma_f32_32x32x16_bf16 v[48:63], a[156:159], a[20:23], v[48:63]
    ds_read_b64_tr_b16 a[184:185], v18 offset:512
    ds_read_b64_tr_b16 a[186:187], v18 offset:7680
    v_exp_f32 v26, v26
    v_add_f32 v25, 1.0, v25
    s_waitcnt lgkmcnt(10)
    v_mfma_f32_32x32x16_bf16 v[64:79], a[160:163], a[20:23], v[64:79]
    ds_read_b64_tr_b16 a[188:189], v19 offset:512
    ds_read_b64_tr_b16 a[190:191], v19 offset:7680
    v_add_f32 v26, 1.0, v26
    v_rcp_f32 v25, v25
    v_mfma_f32_32x32x16_bf16 v[80:95], a[164:167], a[20:23], v[80:95]
    ds_read_b64_tr_b16 a[128:129], v18 offset:640
    ds_read_b64_tr_b16 a[130:131], v18 offset:7808
    v_rcp_f32 v26, v26
    v_mul_f32 v23, v23, v25
    s_waitcnt lgkmcnt(10)
    v_mfma_f32_32x32x16_bf16 v[96:111], a[168:171], a[20:23], v[96:111]
    ds_read_b64_tr_b16 a[132:133], v19 offset:640
    ds_read_b64_tr_b16 a[134:135], v19 offset:7808
    v_mul_f32 v24, v24, v26
    v_cvt_pk_bf16_f32 v22, v23, v24
    v_accvgpr_write_b32 a234, v22
    v_accvgpr_read_b32 v7, a235
    v_mfma_f32_32x32x16_bf16 v[112:127], a[172:175], a[20:23], v[112:127]
    ds_read_b64_tr_b16 a[136:137], v18 offset:768
    ds_read_b64_tr_b16 a[138:139], v18 offset:7936
    v_lshlrev_b32 v8, 16, v7
    v_and_b32 v9, 0xffff0000, v7
    v_mul_f32 v10, 0xbfb8aa3b, v8
    s_waitcnt lgkmcnt(10)
    v_mfma_f32_32x32x16_bf16 v[128:143], a[176:179], a[20:23], v[128:143]
    ds_read_b64_tr_b16 a[140:141], v19 offset:768
    ds_read_b64_tr_b16 a[142:143], v19 offset:7936
    v_mul_f32 v11, 0xbfb8aa3b, v9
    v_exp_f32 v10, v10
    v_mfma_f32_32x32x16_bf16 v[144:159], a[180:183], a[20:23], v[144:159]
    s_waitcnt vmcnt(16)
    s_barrier
    ds_read_b64_tr_b16 a[144:145], v16 offset:16384
    ds_read_b64_tr_b16 a[146:147], v16 offset:23552
    s_waitcnt lgkmcnt(10)
    v_mfma_f32_32x32x16_bf16 v[160:175], a[184:187], a[20:23], v[160:175]
    ds_read_b64_tr_b16 a[148:149], v17 offset:16384
    ds_read_b64_tr_b16 a[150:151], v17 offset:23552
    s_mov_b32 m0, s44
    v_exp_f32 v11, v11
    v_add_f32 v10, 1.0, v10
    v_mfma_f32_32x32x16_bf16 v[176:191], a[188:191], a[20:23], v[176:191]
    ds_read_b64_tr_b16 a[152:153], v16 offset:16512
    ds_read_b64_tr_b16 a[154:155], v16 offset:23680
    buffer_load_dwordx4 v3, s[8:11], s73 offen offset:0 sc1 lds
    v_add_f32 v11, 1.0, v11
    s_waitcnt lgkmcnt(10)
    v_mfma_f32_32x32x16_bf16 v[192:207], a[128:131], a[20:23], v[192:207]
    ds_read_b64_tr_b16 a[156:157], v17 offset:16512
    ds_read_b64_tr_b16 a[158:159], v17 offset:23680
    v_rcp_f32 v10, v10
    v_rcp_f32 v11, v11
    v_mfma_f32_32x32x16_bf16 v[208:223], a[132:135], a[20:23], v[208:223]
    ds_read_b64_tr_b16 a[160:161], v16 offset:16640
    ds_read_b64_tr_b16 a[162:163], v16 offset:23808
    buffer_load_dwordx4 v4, s[8:11], s73 offen offset:1024 sc1 lds
    v_mul_f32 v8, v8, v10
    v_mul_f32 v9, v9, v11
    s_waitcnt lgkmcnt(10)
    v_mfma_f32_32x32x16_bf16 v[224:239], a[136:139], a[20:23], v[224:239]
    ds_read_b64_tr_b16 a[164:165], v17 offset:16640
    ds_read_b64_tr_b16 a[166:167], v17 offset:23808
    v_cvt_pk_bf16_f32 v7, v8, v9
    v_accvgpr_write_b32 a235, v7
    v_accvgpr_read_b32 v22, a236
    v_lshlrev_b32 v23, 16, v22
    v_mfma_f32_32x32x16_bf16 v[240:255], a[140:143], a[20:23], v[240:255]
    ds_read_b64_tr_b16 a[168:169], v16 offset:16768
    ds_read_b64_tr_b16 a[170:171], v16 offset:23936
    buffer_load_dwordx4 v5, s[8:11], s73 offen offset:2048 sc1 lds
    v_and_b32 v24, 0xffff0000, v22
    v_mul_f32 v25, 0xbfb8aa3b, v23
    s_waitcnt lgkmcnt(10)
    v_mfma_f32_32x32x16_bf16 v[32:47], a[144:147], a[24:27], v[32:47]
    ds_read_b64_tr_b16 a[172:173], v17 offset:16768
    ds_read_b64_tr_b16 a[174:175], v17 offset:23936
    v_mul_f32 v26, 0xbfb8aa3b, v24
    v_exp_f32 v25, v25
    v_mfma_f32_32x32x16_bf16 v[48:63], a[148:151], a[24:27], v[48:63]
    ds_read_b64_tr_b16 a[176:177], v16 offset:16896
    ds_read_b64_tr_b16 a[178:179], v16 offset:24064
    buffer_load_dwordx4 v6, s[8:11], s73 offen offset:3072 sc1 lds
    v_exp_f32 v26, v26
    s_waitcnt lgkmcnt(10)
    v_mfma_f32_32x32x16_bf16 v[64:79], a[152:155], a[24:27], v[64:79]
    ds_read_b64_tr_b16 a[180:181], v17 offset:16896
    ds_read_b64_tr_b16 a[182:183], v17 offset:24064
    s_mov_b32 m0, s45
    v_add_f32 v25, 1.0, v25
    v_add_f32 v26, 1.0, v26
    v_mfma_f32_32x32x16_bf16 v[80:95], a[156:159], a[24:27], v[80:95]
    ds_read_b64_tr_b16 a[184:185], v16 offset:17024
    ds_read_b64_tr_b16 a[186:187], v16 offset:24192
    buffer_load_dwordx4 v3, s[8:11], s74 offen offset:0 sc1 lds
    v_rcp_f32 v25, v25
    s_waitcnt lgkmcnt(10)
    v_mfma_f32_32x32x16_bf16 v[96:111], a[160:163], a[24:27], v[96:111]
    ds_read_b64_tr_b16 a[188:189], v17 offset:17024
    ds_read_b64_tr_b16 a[190:191], v17 offset:24192
    v_rcp_f32 v26, v26
    v_mul_f32 v23, v23, v25
    v_mul_f32 v24, v24, v26
    v_mfma_f32_32x32x16_bf16 v[112:127], a[164:167], a[24:27], v[112:127]
    ds_read_b64_tr_b16 a[128:129], v16 offset:17152
    ds_read_b64_tr_b16 a[130:131], v16 offset:24320
    buffer_load_dwordx4 v4, s[8:11], s74 offen offset:1024 sc1 lds
    v_cvt_pk_bf16_f32 v22, v23, v24
    v_accvgpr_write_b32 a236, v22
    s_waitcnt lgkmcnt(10)
    v_mfma_f32_32x32x16_bf16 v[128:143], a[168:171], a[24:27], v[128:143]
    ds_read_b64_tr_b16 a[132:133], v17 offset:17152
    ds_read_b64_tr_b16 a[134:135], v17 offset:24320
    v_accvgpr_read_b32 v7, a237
    v_lshlrev_b32 v8, 16, v7
    v_and_b32 v9, 0xffff0000, v7
    v_mul_f32 v10, 0xbfb8aa3b, v8
    v_mfma_f32_32x32x16_bf16 v[144:159], a[172:175], a[24:27], v[144:159]
    ds_read_b64_tr_b16 a[136:137], v18 offset:16384
    ds_read_b64_tr_b16 a[138:139], v18 offset:23552
    buffer_load_dwordx4 v5, s[8:11], s74 offen offset:2048 sc1 lds
    v_mul_f32 v11, 0xbfb8aa3b, v9
    s_waitcnt lgkmcnt(10)
    v_mfma_f32_32x32x16_bf16 v[160:175], a[176:179], a[24:27], v[160:175]
    ds_read_b64_tr_b16 a[140:141], v19 offset:16384
    ds_read_b64_tr_b16 a[142:143], v19 offset:23552
    v_exp_f32 v10, v10
    v_exp_f32 v11, v11
    v_mfma_f32_32x32x16_bf16 v[176:191], a[180:183], a[24:27], v[176:191]
    ds_read_b64_tr_b16 a[144:145], v18 offset:16512
    ds_read_b64_tr_b16 a[146:147], v18 offset:23680
    buffer_load_dwordx4 v6, s[8:11], s74 offen offset:3072 sc1 lds
    v_add_f32 v10, 1.0, v10
    v_add_f32 v11, 1.0, v11
    s_waitcnt lgkmcnt(10)
    v_mfma_f32_32x32x16_bf16 v[192:207], a[184:187], a[24:27], v[192:207]
    ds_read_b64_tr_b16 a[148:149], v19 offset:16512
    ds_read_b64_tr_b16 a[150:151], v19 offset:23680
    s_add_u32 s73, s73, s42
    s_cmp_eq_u32 s73, s72
    s_cselect_b32 s73, 0, s73
    s_add_u32 s74, s73, s43
    v_mfma_f32_32x32x16_bf16 v[208:223], a[188:191], a[24:27], v[208:223]
    ds_read_b64_tr_b16 a[152:153], v18 offset:16640
    ds_read_b64_tr_b16 a[154:155], v18 offset:23808
    v_rcp_f32 v10, v10
    s_waitcnt lgkmcnt(10)
    v_mfma_f32_32x32x16_bf16 v[224:239], a[128:131], a[24:27], v[224:239]
    ds_read_b64_tr_b16 a[156:157], v19 offset:16640
    ds_read_b64_tr_b16 a[158:159], v19 offset:23808
    v_rcp_f32 v11, v11
    v_mul_f32 v8, v8, v10
    v_mul_f32 v9, v9, v11
    v_mfma_f32_32x32x16_bf16 v[240:255], a[132:135], a[24:27], v[240:255]
    ds_read_b64_tr_b16 a[160:161], v18 offset:16768
    ds_read_b64_tr_b16 a[162:163], v18 offset:23936
    v_cvt_pk_bf16_f32 v7, v8, v9
    v_accvgpr_write_b32 a237, v7
    v_accvgpr_read_b32 v22, a238
    s_waitcnt lgkmcnt(10)
    v_mfma_f32_32x32x16_bf16 v[32:47], a[136:139], a[28:31], v[32:47]
    ds_read_b64_tr_b16 a[164:165], v19 offset:16768
    ds_read_b64_tr_b16 a[166:167], v19 offset:23936
    v_lshlrev_b32 v23, 16, v22
    v_and_b32 v24, 0xffff0000, v22
    v_mul_f32 v25, 0xbfb8aa3b, v23
    v_mul_f32 v26, 0xbfb8aa3b, v24
    v_mfma_f32_32x32x16_bf16 v[48:63], a[140:143], a[28:31], v[48:63]
    ds_read_b64_tr_b16 a[168:169], v18 offset:16896
    ds_read_b64_tr_b16 a[170:171], v18 offset:24064
    v_exp_f32 v25, v25
    s_waitcnt lgkmcnt(10)
    v_mfma_f32_32x32x16_bf16 v[64:79], a[144:147], a[28:31], v[64:79]
    ds_read_b64_tr_b16 a[172:173], v19 offset:16896
    ds_read_b64_tr_b16 a[174:175], v19 offset:24064
    v_exp_f32 v26, v26
    v_add_f32 v25, 1.0, v25
    v_add_f32 v26, 1.0, v26
    v_mfma_f32_32x32x16_bf16 v[80:95], a[148:151], a[28:31], v[80:95]
    ds_read_b64_tr_b16 a[176:177], v18 offset:17024
    ds_read_b64_tr_b16 a[178:179], v18 offset:24192
    v_rcp_f32 v25, v25
    s_waitcnt lgkmcnt(10)
    v_mfma_f32_32x32x16_bf16 v[96:111], a[152:155], a[28:31], v[96:111]
    ds_read_b64_tr_b16 a[180:181], v19 offset:17024
    ds_read_b64_tr_b16 a[182:183], v19 offset:24192
    v_rcp_f32 v26, v26
    v_mul_f32 v23, v23, v25
    v_mul_f32 v24, v24, v26
    v_mfma_f32_32x32x16_bf16 v[112:127], a[156:159], a[28:31], v[112:127]
    ds_read_b64_tr_b16 a[184:185], v18 offset:17152
    ds_read_b64_tr_b16 a[186:187], v18 offset:24320
    v_cvt_pk_bf16_f32 v22, v23, v24
    v_accvgpr_write_b32 a238, v22
    v_accvgpr_read_b32 v7, a239
    s_waitcnt lgkmcnt(10)
    v_mfma_f32_32x32x16_bf16 v[128:143], a[160:163], a[28:31], v[128:143]
    ds_read_b64_tr_b16 a[188:189], v19 offset:17152
    ds_read_b64_tr_b16 a[190:191], v19 offset:24320
    v_lshlrev_b32 v8, 16, v7
    v_and_b32 v9, 0xffff0000, v7
    v_mul_f32 v10, 0xbfb8aa3b, v8
    v_mul_f32 v11, 0xbfb8aa3b, v9
    v_mfma_f32_32x32x16_bf16 v[144:159], a[164:167], a[28:31], v[144:159]
    s_waitcnt vmcnt(16)
    s_barrier
    s_xor_b32 s68, s68, 0x8000
    s_add_u32 s46, s46, 0x8000
    s_cmp_ge_u32 s46, 163840
    s_cselect_b32 s46, 65536, s46
    v_add_u32 v16, s68, v20
    v_add_u32 v17, s68, v21
    v_add_u32 v18, s46, v20
    v_add_u32 v19, s46, v21
    ds_read_b64_tr_b16 a[128:129], v16 offset:0
    ds_read_b64_tr_b16 a[130:131], v16 offset:7168
    s_waitcnt lgkmcnt(10)
    v_mfma_f32_32x32x16_bf16 v[160:175], a[168:171], a[28:31], v[160:175]
    ds_read_b64_tr_b16 a[132:133], v17 offset:0
    ds_read_b64_tr_b16 a[134:135], v17 offset:7168
    s_add_u32 m0, s44, 16384
    v_exp_f32 v10, v10
    v_mfma_f32_32x32x16_bf16 v[176:191], a[172:175], a[28:31], v[176:191]
    ds_read_b64_tr_b16 a[136:137], v16 offset:128
    ds_read_b64_tr_b16 a[138:139], v16 offset:7296
    buffer_load_dwordx4 v3, s[8:11], s73 offen offset:0 sc1 lds
    v_exp_f32 v11, v11
    s_waitcnt lgkmcnt(10)
    v_mfma_f32_32x32x16_bf16 v[192:207], a[176:179], a[28:31], v[192:207]
    ds_read_b64_tr_b16 a[140:141], v17 offset:128
    ds_read_b64_tr_b16 a[142:143], v17 offset:7296
    buffer_load_dwordx4 v4, s[8:11], s73 offen offset:1024 sc1 lds
    v_add_f32 v10, 1.0, v10
    v_add_f32 v11, 1.0, v11
    v_mfma_f32_32x32x16_bf16 v[208:223], a[180:183], a[28:31], v[208:223]
    ds_read_b64_tr_b16 a[144:145], v16 offset:256
    ds_read_b64_tr_b16 a[146:147], v16 offset:7424
    buffer_load_dwordx4 v5, s[8:11], s73 offen offset:2048 sc1 lds
    v_rcp_f32 v10, v10
    s_waitcnt lgkmcnt(10)
    v_mfma_f32_32x32x16_bf16 v[224:239], a[184:187], a[28:31], v[224:239]
    ds_read_b64_tr_b16 a[148:149], v17 offset:256
    ds_read_b64_tr_b16 a[150:151], v17 offset:7424
    v_rcp_f32 v11, v11
    v_mul_f32 v8, v8, v10
    v_mul_f32 v9, v9, v11
    v_mfma_f32_32x32x16_bf16 v[240:255], a[188:191], a[28:31], v[240:255]
    ds_read_b64_tr_b16 a[152:153], v16 offset:384
    ds_read_b64_tr_b16 a[154:155], v16 offset:7552
    buffer_load_dwordx4 v6, s[8:11], s73 offen offset:3072 sc1 lds
    v_cvt_pk_bf16_f32 v7, v8, v9
    v_accvgpr_write_b32 a239, v7
    s_waitcnt lgkmcnt(10)
    v_mfma_f32_32x32x16_bf16 v[32:47], a[128:131], a[32:35], v[32:47]
    ds_read_b64_tr_b16 a[156:157], v17 offset:384
    ds_read_b64_tr_b16 a[158:159], v17 offset:7552
    s_add_u32 m0, s45, 16384
    v_accvgpr_read_b32 v22, a240
    v_lshlrev_b32 v23, 16, v22
    v_and_b32 v24, 0xffff0000, v22
    v_mfma_f32_32x32x16_bf16 v[48:63], a[132:135], a[32:35], v[48:63]
    ds_read_b64_tr_b16 a[160:161], v16 offset:512
    ds_read_b64_tr_b16 a[162:163], v16 offset:7680
    buffer_load_dwordx4 v3, s[8:11], s74 offen offset:0 sc1 lds
    v_mul_f32 v25, 0xbfb8aa3b, v23
    v_mul_f32 v26, 0xbfb8aa3b, v24
    s_waitcnt lgkmcnt(10)
    v_mfma_f32_32x32x16_bf16 v[64:79], a[136:139], a[32:35], v[64:79]
    ds_read_b64_tr_b16 a[164:165], v17 offset:512
    ds_read_b64_tr_b16 a[166:167], v17 offset:7680
    v_exp_f32 v25, v25
    v_exp_f32 v26, v26
    v_mfma_f32_32x32x16_bf16 v[80:95], a[140:143], a[32:35], v[80:95]
    ds_read_b64_tr_b16 a[168:169], v16 offset:640
    ds_read_b64_tr_b16 a[170:171], v16 offset:7808
    buffer_load_dwordx4 v4, s[8:11], s74 offen offset:1024 sc1 lds
    v_add_f32 v25, 1.0, v25
    v_add_f32 v26, 1.0, v26
    s_waitcnt lgkmcnt(10)
    v_mfma_f32_32x32x16_bf16 v[96:111], a[144:147], a[32:35], v[96:111]
    ds_read_b64_tr_b16 a[172:173], v17 offset:640
    ds_read_b64_tr_b16 a[174:175], v17 offset:7808
    v_rcp_f32 v25, v25
    v_rcp_f32 v26, v26
    v_mfma_f32_32x32x16_bf16 v[112:127], a[148:151], a[32:35], v[112:127]
    ds_read_b64_tr_b16 a[176:177], v16 offset:768
    ds_read_b64_tr_b16 a[178:179], v16 offset:7936
    buffer_load_dwordx4 v5, s[8:11], s74 offen offset:2048 sc1 lds
    v_mul_f32 v23, v23, v25
    v_mul_f32 v24, v24, v26
    s_waitcnt lgkmcnt(10)
    v_mfma_f32_32x32x16_bf16 v[128:143], a[152:155], a[32:35], v[128:143]
    ds_read_b64_tr_b16 a[180:181], v17 offset:768
    ds_read_b64_tr_b16 a[182:183], v17 offset:7936
    v_cvt_pk_bf16_f32 v22, v23, v24
    v_accvgpr_write_b32 a240, v22
    v_accvgpr_read_b32 v7, a241
    v_lshlrev_b32 v8, 16, v7
    v_mfma_f32_32x32x16_bf16 v[144:159], a[156:159], a[32:35], v[144:159]
    ds_read_b64_tr_b16 a[184:185], v18 offset:0
    ds_read_b64_tr_b16 a[186:187], v18 offset:7168
    buffer_load_dwordx4 v6, s[8:11], s74 offen offset:3072 sc1 lds
    v_and_b32 v9, 0xffff0000, v7
    v_mul_f32 v10, 0xbfb8aa3b, v8
    s_waitcnt lgkmcnt(10)
    v_mfma_f32_32x32x16_bf16 v[160:175], a[160:163], a[32:35], v[160:175]
    ds_read_b64_tr_b16 a[188:189], v19 offset:0
    ds_read_b64_tr_b16 a[190:191], v19 offset:7168
    s_add_u32 s73, s73, s42
    s_cmp_eq_u32 s73, s72
    s_cselect_b32 s73, 0, s73
    s_add_u32 s74, s73, s43
    v_mfma_f32_32x32x16_bf16 v[176:191], a[164:167], a[32:35], v[176:191]
    ds_read_b64_tr_b16 a[128:129], v18 offset:128
    ds_read_b64_tr_b16 a[130:131], v18 offset:7296
    s_xor_b32 s44, s44, 0x8000
    s_add_u32 s45, s45, 0x8000
    s_cmp_ge_u32 s45, 163840
    s_cselect_b32 s45, s55, s45
    s_waitcnt lgkmcnt(10)
    v_mfma_f32_32x32x16_bf16 v[192:207], a[168:171], a[32:35], v[192:207]
    ds_read_b64_tr_b16 a[132:133], v19 offset:128
    ds_read_b64_tr_b16 a[134:135], v19 offset:7296
    v_mul_f32 v11, 0xbfb8aa3b, v9
    v_exp_f32 v10, v10
    v_mfma_f32_32x32x16_bf16 v[208:223], a[172:175], a[32:35], v[208:223]
    ds_read_b64_tr_b16 a[136:137], v18 offset:256
    ds_read_b64_tr_b16 a[138:139], v18 offset:7424
    v_exp_f32 v11, v11
    v_add_f32 v10, 1.0, v10
    s_waitcnt lgkmcnt(10)
    v_mfma_f32_32x32x16_bf16 v[224:239], a[176:179], a[32:35], v[224:239]
    ds_read_b64_tr_b16 a[140:141], v19 offset:256
    ds_read_b64_tr_b16 a[142:143], v19 offset:7424
    v_add_f32 v11, 1.0, v11
    v_rcp_f32 v10, v10
    v_mfma_f32_32x32x16_bf16 v[240:255], a[180:183], a[32:35], v[240:255]
    ds_read_b64_tr_b16 a[144:145], v18 offset:384
    ds_read_b64_tr_b16 a[146:147], v18 offset:7552
    v_rcp_f32 v11, v11
    v_mul_f32 v8, v8, v10
    s_waitcnt lgkmcnt(10)
    v_mfma_f32_32x32x16_bf16 v[32:47], a[184:187], a[36:39], v[32:47]
    ds_read_b64_tr_b16 a[148:149], v19 offset:384
    ds_read_b64_tr_b16 a[150:151], v19 offset:7552
    v_mul_f32 v9, v9, v11
    v_cvt_pk_bf16_f32 v7, v8, v9
    v_accvgpr_write_b32 a241, v7
    v_accvgpr_read_b32 v22, a242
    v_mfma_f32_32x32x16_bf16 v[48:63], a[188:191], a[36:39], v[48:63]
    ds_read_b64_tr_b16 a[152:153], v18 offset:512
    ds_read_b64_tr_b16 a[154:155], v18 offset:7680
    v_lshlrev_b32 v23, 16, v22
    v_and_b32 v24, 0xffff0000, v22
    v_mul_f32 v25, 0xbfb8aa3b, v23
    s_waitcnt lgkmcnt(10)
    v_mfma_f32_32x32x16_bf16 v[64:79], a[128:131], a[36:39], v[64:79]
    ds_read_b64_tr_b16 a[156:157], v19 offset:512
    ds_read_b64_tr_b16 a[158:159], v19 offset:7680
    v_mul_f32 v26, 0xbfb8aa3b, v24
    v_exp_f32 v25, v25
    v_mfma_f32_32x32x16_bf16 v[80:95], a[132:135], a[36:39], v[80:95]
    ds_read_b64_tr_b16 a[160:161], v18 offset:640
    ds_read_b64_tr_b16 a[162:163], v18 offset:7808
    v_exp_f32 v26, v26
    v_add_f32 v25, 1.0, v25
    s_waitcnt lgkmcnt(10)
    v_mfma_f32_32x32x16_bf16 v[96:111], a[136:139], a[36:39], v[96:111]
    ds_read_b64_tr_b16 a[164:165], v19 offset:640
    ds_read_b64_tr_b16 a[166:167], v19 offset:7808
    v_add_f32 v26, 1.0, v26
    v_rcp_f32 v25, v25
    v_mfma_f32_32x32x16_bf16 v[112:127], a[140:143], a[36:39], v[112:127]
    ds_read_b64_tr_b16 a[168:169], v18 offset:768
    ds_read_b64_tr_b16 a[170:171], v18 offset:7936
    v_rcp_f32 v26, v26
    v_mul_f32 v23, v23, v25
    s_waitcnt lgkmcnt(10)
    v_mfma_f32_32x32x16_bf16 v[128:143], a[144:147], a[36:39], v[128:143]
    ds_read_b64_tr_b16 a[172:173], v19 offset:768
    ds_read_b64_tr_b16 a[174:175], v19 offset:7936
    v_mul_f32 v24, v24, v26
    v_cvt_pk_bf16_f32 v22, v23, v24
    v_accvgpr_write_b32 a242, v22
    v_accvgpr_read_b32 v7, a243
    v_mfma_f32_32x32x16_bf16 v[144:159], a[148:151], a[36:39], v[144:159]
    s_waitcnt vmcnt(16)
    s_barrier
    ds_read_b64_tr_b16 a[176:177], v16 offset:16384
    ds_read_b64_tr_b16 a[178:179], v16 offset:23552
    v_lshlrev_b32 v8, 16, v7
    s_waitcnt lgkmcnt(10)
    v_mfma_f32_32x32x16_bf16 v[160:175], a[152:155], a[36:39], v[160:175]
    ds_read_b64_tr_b16 a[180:181], v17 offset:16384
    ds_read_b64_tr_b16 a[182:183], v17 offset:23552
    s_mul_i32 s53, s79, 100352
    s_add_u32 s8, s100, s53
    s_addc_u32 s9, s101, 0
    v_and_b32 v9, 0xffff0000, v7
    v_mfma_f32_32x32x16_bf16 v[176:191], a[156:159], a[36:39], v[176:191]
    ds_read_b64_tr_b16 a[184:185], v16 offset:16512
    ds_read_b64_tr_b16 a[186:187], v16 offset:23680
    s_mov_b32 s10, 100352
    s_mov_b32 s73, 0
    s_mov_b32 s74, 14336
    s_waitcnt lgkmcnt(10)
    v_mfma_f32_32x32x16_bf16 v[192:207], a[160:163], a[36:39], v[192:207]
    ds_read_b64_tr_b16 a[188:189], v17 offset:16512
    ds_read_b64_tr_b16 a[190:191], v17 offset:23680
    s_mov_b32 m0, s44
    v_mul_f32 v10, 0xbfb8aa3b, v8
    v_mul_f32 v11, 0xbfb8aa3b, v9
    v_mfma_f32_32x32x16_bf16 v[208:223], a[164:167], a[36:39], v[208:223]
    ds_read_b64_tr_b16 a[128:129], v16 offset:16640
    ds_read_b64_tr_b16 a[130:131], v16 offset:23808
    buffer_load_dwordx4 v3, s[8:11], s73 offen offset:0 sc1 lds
    v_exp_f32 v10, v10
    s_waitcnt lgkmcnt(10)
    v_mfma_f32_32x32x16_bf16 v[224:239], a[168:171], a[36:39], v[224:239]
    ds_read_b64_tr_b16 a[132:133], v17 offset:16640
    ds_read_b64_tr_b16 a[134:135], v17 offset:23808
    v_exp_f32 v11, v11
    v_add_f32 v10, 1.0, v10
    v_add_f32 v11, 1.0, v11
    v_mfma_f32_32x32x16_bf16 v[240:255], a[172:175], a[36:39], v[240:255]
    ds_read_b64_tr_b16 a[136:137], v16 offset:16768
    ds_read_b64_tr_b16 a[138:139], v16 offset:23936
    buffer_load_dwordx4 v4, s[8:11], s73 offen offset:1024 sc1 lds
    v_rcp_f32 v10, v10
    s_waitcnt lgkmcnt(10)
    v_mfma_f32_32x32x16_bf16 v[32:47], a[176:179], a[40:43], v[32:47]
    ds_read_b64_tr_b16 a[140:141], v17 offset:16768
    ds_read_b64_tr_b16 a[142:143], v17 offset:23936
    v_rcp_f32 v11, v11
    v_mul_f32 v8, v8, v10
    v_mul_f32 v9, v9, v11
    v_mfma_f32_32x32x16_bf16 v[48:63], a[180:183], a[40:43], v[48:63]
    ds_read_b64_tr_b16 a[144:145], v16 offset:16896
    ds_read_b64_tr_b16 a[146:147], v16 offset:24064
    buffer_load_dwordx4 v5, s[8:11], s73 offen offset:2048 sc1 lds
    v_cvt_pk_bf16_f32 v7, v8, v9
    v_accvgpr_write_b32 a243, v7
    s_waitcnt lgkmcnt(10)
    v_mfma_f32_32x32x16_bf16 v[64:79], a[184:187], a[40:43], v[64:79]
    ds_read_b64_tr_b16 a[148:149], v17 offset:16896
    ds_read_b64_tr_b16 a[150:151], v17 offset:24064
    v_accvgpr_read_b32 v22, a244
    v_lshlrev_b32 v23, 16, v22
    v_and_b32 v24, 0xffff0000, v22
    v_mul_f32 v25, 0xbfb8aa3b, v23
    v_mfma_f32_32x32x16_bf16 v[80:95], a[188:191], a[40:43], v[80:95]
    ds_read_b64_tr_b16 a[152:153], v16 offset:17024
    ds_read_b64_tr_b16 a[154:155], v16 offset:24192
    buffer_load_dwordx4 v6, s[8:11], s73 offen offset:3072 sc1 lds
    v_mul_f32 v26, 0xbfb8aa3b, v24
    s_waitcnt lgkmcnt(10)
    v_mfma_f32_32x32x16_bf16 v[96:111], a[128:131], a[40:43], v[96:111]
    ds_read_b64_tr_b16 a[156:157], v17 offset:17024
    ds_read_b64_tr_b16 a[158:159], v17 offset:24192
    s_mov_b32 m0, s45
    v_exp_f32 v25, v25
    v_mfma_f32_32x32x16_bf16 v[112:127], a[132:135], a[40:43], v[112:127]
    ds_read_b64_tr_b16 a[160:161], v16 offset:17152
    ds_read_b64_tr_b16 a[162:163], v16 offset:24320
    buffer_load_dwordx4 v3, s[8:11], s74 offen offset:0 sc1 lds
    v_exp_f32 v26, v26
    s_waitcnt lgkmcnt(10)
    v_mfma_f32_32x32x16_bf16 v[128:143], a[136:139], a[40:43], v[128:143]
    ds_read_b64_tr_b16 a[164:165], v17 offset:17152
    ds_read_b64_tr_b16 a[166:167], v17 offset:24320
    v_add_f32 v25, 1.0, v25
    v_add_f32 v26, 1.0, v26
    v_rcp_f32 v25, v25
    v_mfma_f32_32x32x16_bf16 v[144:159], a[140:143], a[40:43], v[144:159]
    ds_read_b64_tr_b16 a[168:169], v18 offset:16384
    ds_read_b64_tr_b16 a[170:171], v18 offset:23552
    buffer_load_dwordx4 v4, s[8:11], s74 offen offset:1024 sc1 lds
    v_rcp_f32 v26, v26
    s_waitcnt lgkmcnt(10)
    v_mfma_f32_32x32x16_bf16 v[160:175], a[144:147], a[40:43], v[160:175]
    ds_read_b64_tr_b16 a[172:173], v19 offset:16384
    ds_read_b64_tr_b16 a[174:175], v19 offset:23552
    v_mul_f32 v23, v23, v25
    v_mul_f32 v24, v24, v26
    v_cvt_pk_bf16_f32 v22, v23, v24
    v_accvgpr_write_b32 a244, v22
    v_mfma_f32_32x32x16_bf16 v[176:191], a[148:151], a[40:43], v[176:191]
    ds_read_b64_tr_b16 a[176:177], v18 offset:16512
    ds_read_b64_tr_b16 a[178:179], v18 offset:23680
    buffer_load_dwordx4 v5, s[8:11], s74 offen offset:2048 sc1 lds
    v_accvgpr_read_b32 v7, a245
    v_lshlrev_b32 v8, 16, v7
    s_waitcnt lgkmcnt(10)
    v_mfma_f32_32x32x16_bf16 v[192:207], a[152:155], a[40:43], v[192:207]
    ds_read_b64_tr_b16 a[180:181], v19 offset:16512
    ds_read_b64_tr_b16 a[182:183], v19 offset:23680
    v_and_b32 v9, 0xffff0000, v7
    v_mul_f32 v10, 0xbfb8aa3b, v8
    v_mul_f32 v11, 0xbfb8aa3b, v9
    v_mfma_f32_32x32x16_bf16 v[208:223], a[156:159], a[40:43], v[208:223]
    ds_read_b64_tr_b16 a[184:185], v18 offset:16640
    ds_read_b64_tr_b16 a[186:187], v18 offset:23808
    buffer_load_dwordx4 v6, s[8:11], s74 offen offset:3072 sc1 lds
    v_exp_f32 v10, v10
    s_waitcnt lgkmcnt(10)
    v_mfma_f32_32x32x16_bf16 v[224:239], a[160:163], a[40:43], v[224:239]
    ds_read_b64_tr_b16 a[188:189], v19 offset:16640
    ds_read_b64_tr_b16 a[190:191], v19 offset:23808
    s_add_u32 s73, s73, s42
    s_cmp_eq_u32 s73, s72
    s_cselect_b32 s73, 0, s73
    s_add_u32 s74, s73, s43
    v_mfma_f32_32x32x16_bf16 v[240:255], a[164:167], a[40:43], v[240:255]
    ds_read_b64_tr_b16 a[128:129], v18 offset:16768
    ds_read_b64_tr_b16 a[130:131], v18 offset:23936
    v_exp_f32 v11, v11
    v_add_f32 v10, 1.0, v10
    s_waitcnt lgkmcnt(10)
    v_mfma_f32_32x32x16_bf16 v[32:47], a[168:171], a[44:47], v[32:47]
    ds_read_b64_tr_b16 a[132:133], v19 offset:16768
    ds_read_b64_tr_b16 a[134:135], v19 offset:23936
    v_add_f32 v11, 1.0, v11
    v_rcp_f32 v10, v10
    v_mfma_f32_32x32x16_bf16 v[48:63], a[172:175], a[44:47], v[48:63]
    ds_read_b64_tr_b16 a[136:137], v18 offset:16896
    ds_read_b64_tr_b16 a[138:139], v18 offset:24064
    v_rcp_f32 v11, v11
    v_mul_f32 v8, v8, v10
    s_waitcnt lgkmcnt(10)
    v_mfma_f32_32x32x16_bf16 v[64:79], a[176:179], a[44:47], v[64:79]
    ds_read_b64_tr_b16 a[140:141], v19 offset:16896
    ds_read_b64_tr_b16 a[142:143], v19 offset:24064
    v_mul_f32 v9, v9, v11
    v_cvt_pk_bf16_f32 v7, v8, v9
    v_accvgpr_write_b32 a245, v7
    v_accvgpr_read_b32 v22, a246
    v_mfma_f32_32x32x16_bf16 v[80:95], a[180:183], a[44:47], v[80:95]
    ds_read_b64_tr_b16 a[144:145], v18 offset:17024
    ds_read_b64_tr_b16 a[146:147], v18 offset:24192
    v_lshlrev_b32 v23, 16, v22
    v_and_b32 v24, 0xffff0000, v22
    v_mul_f32 v25, 0xbfb8aa3b, v23
    s_waitcnt lgkmcnt(10)
    v_mfma_f32_32x32x16_bf16 v[96:111], a[184:187], a[44:47], v[96:111]
    ds_read_b64_tr_b16 a[148:149], v19 offset:17024
    ds_read_b64_tr_b16 a[150:151], v19 offset:24192
    v_mul_f32 v26, 0xbfb8aa3b, v24
    v_exp_f32 v25, v25
    v_mfma_f32_32x32x16_bf16 v[112:127], a[188:191], a[44:47], v[112:127]
    ds_read_b64_tr_b16 a[152:153], v18 offset:17152
    ds_read_b64_tr_b16 a[154:155], v18 offset:24320
    v_exp_f32 v26, v26
    v_add_f32 v25, 1.0, v25
    s_waitcnt lgkmcnt(10)
    v_mfma_f32_32x32x16_bf16 v[128:143], a[128:131], a[44:47], v[128:143]
    ds_read_b64_tr_b16 a[156:157], v19 offset:17152
    ds_read_b64_tr_b16 a[158:159], v19 offset:24320
    v_add_f32 v26, 1.0, v26
    v_rcp_f32 v25, v25
    v_mfma_f32_32x32x16_bf16 v[144:159], a[132:135], a[44:47], v[144:159]
    s_waitcnt vmcnt(16)
    s_barrier
    s_xor_b32 s68, s68, 0x8000
    s_add_u32 s46, s46, 0x8000
    s_cmp_ge_u32 s46, 163840
    s_cselect_b32 s46, 65536, s46
    v_add_u32 v16, s68, v20
    v_add_u32 v17, s68, v21
    v_add_u32 v18, s46, v20
    v_add_u32 v19, s46, v21
    ds_read_b64_tr_b16 a[160:161], v16 offset:0
    ds_read_b64_tr_b16 a[162:163], v16 offset:7168
    s_waitcnt lgkmcnt(10)
    v_mfma_f32_32x32x16_bf16 v[160:175], a[136:139], a[44:47], v[160:175]
    ds_read_b64_tr_b16 a[164:165], v17 offset:0
    ds_read_b64_tr_b16 a[166:167], v17 offset:7168
    s_add_u32 m0, s44, 16384
    v_rcp_f32 v26, v26
    v_mul_f32 v23, v23, v25
    v_mfma_f32_32x32x16_bf16 v[176:191], a[140:143], a[44:47], v[176:191]
    ds_read_b64_tr_b16 a[168:169], v16 offset:128
    ds_read_b64_tr_b16 a[170:171], v16 offset:7296
    buffer_load_dwordx4 v3, s[8:11], s73 offen offset:0 sc1 lds
    v_mul_f32 v24, v24, v26
    v_cvt_pk_bf16_f32 v22, v23, v24
    s_waitcnt lgkmcnt(10)
    v_mfma_f32_32x32x16_bf16 v[192:207], a[144:147], a[44:47], v[192:207]
    ds_read_b64_tr_b16 a[172:173], v17 offset:128
    ds_read_b64_tr_b16 a[174:175], v17 offset:7296
    buffer_load_dwordx4 v4, s[8:11], s73 offen offset:1024 sc1 lds
    v_accvgpr_write_b32 a246, v22
    v_accvgpr_read_b32 v7, a247
    v_lshlrev_b32 v8, 16, v7
    v_mfma_f32_32x32x16_bf16 v[208:223], a[148:151], a[44:47], v[208:223]
    ds_read_b64_tr_b16 a[176:177], v16 offset:256
    ds_read_b64_tr_b16 a[178:179], v16 offset:7424
    buffer_load_dwordx4 v5, s[8:11], s73 offen offset:2048 sc1 lds
    v_and_b32 v9, 0xffff0000, v7
    v_mul_f32 v10, 0xbfb8aa3b, v8
    s_waitcnt lgkmcnt(10)
    v_mfma_f32_32x32x16_bf16 v[224:239], a[152:155], a[44:47], v[224:239]
    ds_read_b64_tr_b16 a[180:181], v17 offset:256
    ds_read_b64_tr_b16 a[182:183], v17 offset:7424
    v_mul_f32 v11, 0xbfb8aa3b, v9
    v_exp_f32 v10, v10
    v_mfma_f32_32x32x16_bf16 v[240:255], a[156:159], a[44:47], v[240:255]
    ds_read_b64_tr_b16 a[184:185], v16 offset:384
    ds_read_b64_tr_b16 a[186:187], v16 offset:7552
    buffer_load_dwordx4 v6, s[8:11], s73 offen offset:3072 sc1 lds
    v_exp_f32 v11, v11
    s_waitcnt lgkmcnt(10)
    v_mfma_f32_32x32x16_bf16 v[32:47], a[160:163], a[48:51], v[32:47]
    ds_read_b64_tr_b16 a[188:189], v17 offset:384
    ds_read_b64_tr_b16 a[190:191], v17 offset:7552
    s_add_u32 m0, s45, 16384
    v_add_f32 v10, 1.0, v10
    v_add_f32 v11, 1.0, v11
    v_mfma_f32_32x32x16_bf16 v[48:63], a[164:167], a[48:51], v[48:63]
    ds_read_b64_tr_b16 a[128:129], v16 offset:512
    ds_read_b64_tr_b16 a[130:131], v16 offset:7680
    buffer_load_dwordx4 v3, s[8:11], s74 offen offset:0 sc1 lds
    v_rcp_f32 v10, v10
    s_waitcnt lgkmcnt(10)
    v_mfma_f32_32x32x16_bf16 v[64:79], a[168:171], a[48:51], v[64:79]
    ds_read_b64_tr_b16 a[132:133], v17 offset:512
    ds_read_b64_tr_b16 a[134:135], v17 offset:7680
    v_rcp_f32 v11, v11
    v_mul_f32 v8, v8, v10
    v_mul_f32 v9, v9, v11
    v_mfma_f32_32x32x16_bf16 v[80:95], a[172:175], a[48:51], v[80:95]
    ds_read_b64_tr_b16 a[136:137], v16 offset:640
    ds_read_b64_tr_b16 a[138:139], v16 offset:7808
    buffer_load_dwordx4 v4, s[8:11], s74 offen offset:1024 sc1 lds
    v_cvt_pk_bf16_f32 v7, v8, v9
    v_accvgpr_write_b32 a247, v7
    s_waitcnt lgkmcnt(10)
    v_mfma_f32_32x32x16_bf16 v[96:111], a[176:179], a[48:51], v[96:111]
    ds_read_b64_tr_b16 a[140:141], v17 offset:640
    ds_read_b64_tr_b16 a[142:143], v17 offset:7808
    v_accvgpr_read_b32 v22, a248
    v_lshlrev_b32 v23, 16, v22
    v_and_b32 v24, 0xffff0000, v22
    v_mul_f32 v25, 0xbfb8aa3b, v23
    v_mfma_f32_32x32x16_bf16 v[112:127], a[180:183], a[48:51], v[112:127]
    ds_read_b64_tr_b16 a[144:145], v16 offset:768
    ds_read_b64_tr_b16 a[146:147], v16 offset:7936
    buffer_load_dwordx4 v5, s[8:11], s74 offen offset:2048 sc1 lds
    v_mul_f32 v26, 0xbfb8aa3b, v24
    s_waitcnt lgkmcnt(10)
    v_mfma_f32_32x32x16_bf16 v[128:143], a[184:187], a[48:51], v[128:143]
    ds_read_b64_tr_b16 a[148:149], v17 offset:768
    ds_read_b64_tr_b16 a[150:151], v17 offset:7936
    v_exp_f32 v25, v25
    v_exp_f32 v26, v26
    v_mfma_f32_32x32x16_bf16 v[144:159], a[188:191], a[48:51], v[144:159]
    ds_read_b64_tr_b16 a[152:153], v18 offset:0
    ds_read_b64_tr_b16 a[154:155], v18 offset:7168
    buffer_load_dwordx4 v6, s[8:11], s74 offen offset:3072 sc1 lds
    v_add_f32 v25, 1.0, v25
    v_add_f32 v26, 1.0, v26
    s_waitcnt lgkmcnt(10)
    v_mfma_f32_32x32x16_bf16 v[160:175], a[128:131], a[48:51], v[160:175]
    ds_read_b64_tr_b16 a[156:157], v19 offset:0
    ds_read_b64_tr_b16 a[158:159], v19 offset:7168
    s_add_u32 s73, s73, s42
    s_cmp_eq_u32 s73, s72
    s_cselect_b32 s73, 0, s73
    s_add_u32 s74, s73, s43
    v_mfma_f32_32x32x16_bf16 v[176:191], a[132:135], a[48:51], v[176:191]
    ds_read_b64_tr_b16 a[160:161], v18 offset:128
    ds_read_b64_tr_b16 a[162:163], v18 offset:7296
    s_xor_b32 s44, s44, 0x8000
    s_add_u32 s45, s45, 0x8000
    s_cmp_ge_u32 s45, 163840
    s_cselect_b32 s45, s55, s45
    s_waitcnt lgkmcnt(10)
    v_mfma_f32_32x32x16_bf16 v[192:207], a[136:139], a[48:51], v[192:207]
    ds_read_b64_tr_b16 a[164:165], v19 offset:128
    ds_read_b64_tr_b16 a[166:167], v19 offset:7296
    v_rcp_f32 v25, v25
    v_rcp_f32 v26, v26
    v_mfma_f32_32x32x16_bf16 v[208:223], a[140:143], a[48:51], v[208:223]
    ds_read_b64_tr_b16 a[168:169], v18 offset:256
    ds_read_b64_tr_b16 a[170:171], v18 offset:7424
    v_mul_f32 v23, v23, v25
    v_mul_f32 v24, v24, v26
    v_cvt_pk_bf16_f32 v22, v23, v24
    s_waitcnt lgkmcnt(10)
    v_mfma_f32_32x32x16_bf16 v[224:239], a[144:147], a[48:51], v[224:239]
    ds_read_b64_tr_b16 a[172:173], v19 offset:256
    ds_read_b64_tr_b16 a[174:175], v19 offset:7424
    v_accvgpr_write_b32 a248, v22
    v_accvgpr_read_b32 v7, a249
    v_lshlrev_b32 v8, 16, v7
    v_and_b32 v9, 0xffff0000, v7
    v_mfma_f32_32x32x16_bf16 v[240:255], a[148:151], a[48:51], v[240:255]
    ds_read_b64_tr_b16 a[176:177], v18 offset:384
    ds_read_b64_tr_b16 a[178:179], v18 offset:7552
    v_mul_f32 v10, 0xbfb8aa3b, v8
    v_mul_f32 v11, 0xbfb8aa3b, v9
    s_waitcnt lgkmcnt(10)
    v_mfma_f32_32x32x16_bf16 v[32:47], a[152:155], a[52:55], v[32:47]
    ds_read_b64_tr_b16 a[180:181], v19 offset:384
    ds_read_b64_tr_b16 a[182:183], v19 offset:7552
    v_exp_f32 v10, v10
    v_exp_f32 v11, v11
    v_mfma_f32_32x32x16_bf16 v[48:63], a[156:159], a[52:55], v[48:63]
    ds_read_b64_tr_b16 a[184:185], v18 offset:512
    ds_read_b64_tr_b16 a[186:187], v18 offset:7680
    v_add_f32 v10, 1.0, v10
    v_add_f32 v11, 1.0, v11
    s_waitcnt lgkmcnt(10)
    v_mfma_f32_32x32x16_bf16 v[64:79], a[160:163], a[52:55], v[64:79]
    ds_read_b64_tr_b16 a[188:189], v19 offset:512
    ds_read_b64_tr_b16 a[190:191], v19 offset:7680
    v_rcp_f32 v10, v10
    v_rcp_f32 v11, v11
    v_mfma_f32_32x32x16_bf16 v[80:95], a[164:167], a[52:55], v[80:95]
    ds_read_b64_tr_b16 a[128:129], v18 offset:640
    ds_read_b64_tr_b16 a[130:131], v18 offset:7808
    v_mul_f32 v8, v8, v10
    v_mul_f32 v9, v9, v11
    v_cvt_pk_bf16_f32 v7, v8, v9
    s_waitcnt lgkmcnt(10)
    v_mfma_f32_32x32x16_bf16 v[96:111], a[168:171], a[52:55], v[96:111]
    ds_read_b64_tr_b16 a[132:133], v19 offset:640
    ds_read_b64_tr_b16 a[134:135], v19 offset:7808
    v_accvgpr_write_b32 a249, v7
    v_accvgpr_read_b32 v22, a250
    v_lshlrev_b32 v23, 16, v22
    v_and_b32 v24, 0xffff0000, v22
    v_mfma_f32_32x32x16_bf16 v[112:127], a[172:175], a[52:55], v[112:127]
    ds_read_b64_tr_b16 a[136:137], v18 offset:768
    ds_read_b64_tr_b16 a[138:139], v18 offset:7936
    v_mul_f32 v25, 0xbfb8aa3b, v23
    v_mul_f32 v26, 0xbfb8aa3b, v24
    s_waitcnt lgkmcnt(10)
    v_mfma_f32_32x32x16_bf16 v[128:143], a[176:179], a[52:55], v[128:143]
    ds_read_b64_tr_b16 a[140:141], v19 offset:768
    ds_read_b64_tr_b16 a[142:143], v19 offset:7936
    v_exp_f32 v25, v25
    v_exp_f32 v26, v26
    v_mfma_f32_32x32x16_bf16 v[144:159], a[180:183], a[52:55], v[144:159]
    s_waitcnt vmcnt(16)
    s_barrier
    ds_read_b64_tr_b16 a[144:145], v16 offset:16384
    ds_read_b64_tr_b16 a[146:147], v16 offset:23552
    v_add_f32 v25, 1.0, v25
    s_waitcnt lgkmcnt(10)
    v_mfma_f32_32x32x16_bf16 v[160:175], a[184:187], a[52:55], v[160:175]
    ds_read_b64_tr_b16 a[148:149], v17 offset:16384
    ds_read_b64_tr_b16 a[150:151], v17 offset:23552
    s_mov_b32 m0, s44
    v_add_f32 v26, 1.0, v26
    v_rcp_f32 v25, v25
    v_mfma_f32_32x32x16_bf16 v[176:191], a[188:191], a[52:55], v[176:191]
    ds_read_b64_tr_b16 a[152:153], v16 offset:16512
    ds_read_b64_tr_b16 a[154:155], v16 offset:23680
    buffer_load_dwordx4 v3, s[8:11], s73 offen offset:0 sc1 lds
    v_rcp_f32 v26, v26
    s_waitcnt lgkmcnt(10)
    v_mfma_f32_32x32x16_bf16 v[192:207], a[128:131], a[52:55], v[192:207]
    ds_read_b64_tr_b16 a[156:157], v17 offset:16512
    ds_read_b64_tr_b16 a[158:159], v17 offset:23680
    buffer_load_dwordx4 v4, s[8:11], s73 offen offset:1024 sc1 lds
    v_mul_f32 v23, v23, v25
    v_mul_f32 v24, v24, v26
    v_cvt_pk_bf16_f32 v22, v23, v24
    v_mfma_f32_32x32x16_bf16 v[208:223], a[132:135], a[52:55], v[208:223]
    ds_read_b64_tr_b16 a[160:161], v16 offset:16640
    ds_read_b64_tr_b16 a[162:163], v16 offset:23808
    buffer_load_dwordx4 v5, s[8:11], s73 offen offset:2048 sc1 lds
    v_accvgpr_write_b32 a250, v22
    v_accvgpr_read_b32 v7, a251
    s_waitcnt lgkmcnt(10)
    v_mfma_f32_32x32x16_bf16 v[224:239], a[136:139], a[52:55], v[224:239]
    ds_read_b64_tr_b16 a[164:165], v17 offset:16640
    ds_read_b64_tr_b16 a[166:167], v17 offset:23808
    buffer_load_dwordx4 v6, s[8:11], s73 offen offset:3072 sc1 lds
    v_lshlrev_b32 v8, 16, v7
    v_and_b32 v9, 0xffff0000, v7
    v_mul_f32 v10, 0xbfb8aa3b, v8
    v_mfma_f32_32x32x16_bf16 v[240:255], a[140:143], a[52:55], v[240:255]
    ds_read_b64_tr_b16 a[168:169], v16 offset:16768
    ds_read_b64_tr_b16 a[170:171], v16 offset:23936
    s_mov_b32 m0, s45
    v_mul_f32 v11, 0xbfb8aa3b, v9
    s_waitcnt lgkmcnt(10)
    v_mfma_f32_32x32x16_bf16 v[32:47], a[144:147], a[56:59], v[32:47]
    ds_read_b64_tr_b16 a[172:173], v17 offset:16768
    ds_read_b64_tr_b16 a[174:175], v17 offset:23936
    buffer_load_dwordx4 v3, s[8:11], s74 offen offset:0 sc1 lds
    v_exp_f32 v10, v10
    v_mfma_f32_32x32x16_bf16 v[48:63], a[148:151], a[56:59], v[48:63]
    ds_read_b64_tr_b16 a[176:177], v16 offset:16896
    ds_read_b64_tr_b16 a[178:179], v16 offset:24064
    buffer_load_dwordx4 v4, s[8:11], s74 offen offset:1024 sc1 lds
    v_exp_f32 v11, v11
    s_waitcnt lgkmcnt(10)
    v_mfma_f32_32x32x16_bf16 v[64:79], a[152:155], a[56:59], v[64:79]
    ds_read_b64_tr_b16 a[180:181], v17 offset:16896
    ds_read_b64_tr_b16 a[182:183], v17 offset:24064
    v_add_f32 v10, 1.0, v10
    v_add_f32 v11, 1.0, v11
    v_rcp_f32 v10, v10
    v_mfma_f32_32x32x16_bf16 v[80:95], a[156:159], a[56:59], v[80:95]
    ds_read_b64_tr_b16 a[184:185], v16 offset:17024
    ds_read_b64_tr_b16 a[186:187], v16 offset:24192
    buffer_load_dwordx4 v5, s[8:11], s74 offen offset:2048 sc1 lds
    v_rcp_f32 v11, v11
    s_waitcnt lgkmcnt(10)
    v_mfma_f32_32x32x16_bf16 v[96:111], a[160:163], a[56:59], v[96:111]
    ds_read_b64_tr_b16 a[188:189], v17 offset:17024
    ds_read_b64_tr_b16 a[190:191], v17 offset:24192
    v_mul_f32 v8, v8, v10
    v_mul_f32 v9, v9, v11
    v_cvt_pk_bf16_f32 v7, v8, v9
    v_accvgpr_write_b32 a251, v7
    v_mfma_f32_32x32x16_bf16 v[112:127], a[164:167], a[56:59], v[112:127]
    ds_read_b64_tr_b16 a[128:129], v16 offset:17152
    ds_read_b64_tr_b16 a[130:131], v16 offset:24320
    buffer_load_dwordx4 v6, s[8:11], s74 offen offset:3072 sc1 lds
    s_waitcnt lgkmcnt(10)
    v_mfma_f32_32x32x16_bf16 v[128:143], a[168:171], a[56:59], v[128:143]
    ds_read_b64_tr_b16 a[132:133], v17 offset:17152
    ds_read_b64_tr_b16 a[134:135], v17 offset:24320
    s_add_u32 s74, s74, 14336
    v_mfma_f32_32x32x16_bf16 v[144:159], a[172:175], a[56:59], v[144:159]
    ds_read_b64_tr_b16 a[136:137], v18 offset:16384
    ds_read_b64_tr_b16 a[138:139], v18 offset:23552
    s_add_u32 m0, s45, 16384
    s_waitcnt lgkmcnt(10)
    v_mfma_f32_32x32x16_bf16 v[160:175], a[176:179], a[56:59], v[160:175]
    ds_read_b64_tr_b16 a[140:141], v19 offset:16384
    ds_read_b64_tr_b16 a[142:143], v19 offset:23552
    v_mfma_f32_32x32x16_bf16 v[176:191], a[180:183], a[56:59], v[176:191]
    ds_read_b64_tr_b16 a[144:145], v18 offset:16512
    ds_read_b64_tr_b16 a[146:147], v18 offset:23680
    buffer_load_dwordx4 v3, s[8:11], s74 offen offset:0 sc1 lds
    s_waitcnt lgkmcnt(10)
    v_mfma_f32_32x32x16_bf16 v[192:207], a[184:187], a[56:59], v[192:207]
    ds_read_b64_tr_b16 a[148:149], v19 offset:16512
    ds_read_b64_tr_b16 a[150:151], v19 offset:23680
    v_mfma_f32_32x32x16_bf16 v[208:223], a[188:191], a[56:59], v[208:223]
    ds_read_b64_tr_b16 a[152:153], v18 offset:16640
    ds_read_b64_tr_b16 a[154:155], v18 offset:23808
    buffer_load_dwordx4 v4, s[8:11], s74 offen offset:1024 sc1 lds
    s_waitcnt lgkmcnt(10)
    v_mfma_f32_32x32x16_bf16 v[224:239], a[128:131], a[56:59], v[224:239]
    ds_read_b64_tr_b16 a[156:157], v19 offset:16640
    ds_read_b64_tr_b16 a[158:159], v19 offset:23808
    v_mfma_f32_32x32x16_bf16 v[240:255], a[132:135], a[56:59], v[240:255]
    ds_read_b64_tr_b16 a[160:161], v18 offset:16768
    ds_read_b64_tr_b16 a[162:163], v18 offset:23936
    buffer_load_dwordx4 v5, s[8:11], s74 offen offset:2048 sc1 lds
    s_waitcnt lgkmcnt(10)
    v_mfma_f32_32x32x16_bf16 v[32:47], a[136:139], a[60:63], v[32:47]
    ds_read_b64_tr_b16 a[164:165], v19 offset:16768
    ds_read_b64_tr_b16 a[166:167], v19 offset:23936
    v_mfma_f32_32x32x16_bf16 v[48:63], a[140:143], a[60:63], v[48:63]
    ds_read_b64_tr_b16 a[168:169], v18 offset:16896
    ds_read_b64_tr_b16 a[170:171], v18 offset:24064
    buffer_load_dwordx4 v6, s[8:11], s74 offen offset:3072 sc1 lds
    s_waitcnt lgkmcnt(10)
    v_mfma_f32_32x32x16_bf16 v[64:79], a[144:147], a[60:63], v[64:79]
    ds_read_b64_tr_b16 a[172:173], v19 offset:16896
    ds_read_b64_tr_b16 a[174:175], v19 offset:24064
    v_mfma_f32_32x32x16_bf16 v[80:95], a[148:151], a[60:63], v[80:95]
    ds_read_b64_tr_b16 a[176:177], v18 offset:17024
    ds_read_b64_tr_b16 a[178:179], v18 offset:24192
    s_waitcnt lgkmcnt(10)
    v_mfma_f32_32x32x16_bf16 v[96:111], a[152:155], a[60:63], v[96:111]
    ds_read_b64_tr_b16 a[180:181], v19 offset:17024
    ds_read_b64_tr_b16 a[182:183], v19 offset:24192
    v_mfma_f32_32x32x16_bf16 v[112:127], a[156:159], a[60:63], v[112:127]
    ds_read_b64_tr_b16 a[184:185], v18 offset:17152
    ds_read_b64_tr_b16 a[186:187], v18 offset:24320
    s_waitcnt lgkmcnt(10)
    v_mfma_f32_32x32x16_bf16 v[128:143], a[160:163], a[60:63], v[128:143]
    ds_read_b64_tr_b16 a[188:189], v19 offset:17152
    ds_read_b64_tr_b16 a[190:191], v19 offset:24320
    v_mfma_f32_32x32x16_bf16 v[144:159], a[164:167], a[60:63], v[144:159]
    s_waitcnt vmcnt(20)
    s_barrier
    s_xor_b32 s68, s68, 0x8000
    s_add_u32 s46, s46, 0x8000
    s_cmp_ge_u32 s46, 163840
    s_cselect_b32 s46, 65536, s46
    v_add_u32 v16, s68, v20
    v_add_u32 v17, s68, v21
    v_add_u32 v18, s46, v20
    v_add_u32 v19, s46, v21
    ds_read_b64_tr_b16 a[128:129], v16 offset:0
    ds_read_b64_tr_b16 a[130:131], v16 offset:7168
    s_waitcnt lgkmcnt(10)
    v_mfma_f32_32x32x16_bf16 v[160:175], a[168:171], a[60:63], v[160:175]
    ds_read_b64_tr_b16 a[132:133], v17 offset:0
    ds_read_b64_tr_b16 a[134:135], v17 offset:7168
    v_mfma_f32_32x32x16_bf16 v[176:191], a[172:175], a[60:63], v[176:191]
    ds_read_b64_tr_b16 a[136:137], v16 offset:128
    ds_read_b64_tr_b16 a[138:139], v16 offset:7296
    s_waitcnt lgkmcnt(10)
    v_mfma_f32_32x32x16_bf16 v[192:207], a[176:179], a[60:63], v[192:207]
    ds_read_b64_tr_b16 a[140:141], v17 offset:128
    ds_read_b64_tr_b16 a[142:143], v17 offset:7296
    v_mfma_f32_32x32x16_bf16 v[208:223], a[180:183], a[60:63], v[208:223]
    ds_read_b64_tr_b16 a[144:145], v16 offset:256
    ds_read_b64_tr_b16 a[146:147], v16 offset:7424
    s_waitcnt lgkmcnt(10)
    v_mfma_f32_32x32x16_bf16 v[224:239], a[184:187], a[60:63], v[224:239]
    ds_read_b64_tr_b16 a[148:149], v17 offset:256
    ds_read_b64_tr_b16 a[150:151], v17 offset:7424
    v_mfma_f32_32x32x16_bf16 v[240:255], a[188:191], a[60:63], v[240:255]
    ds_read_b64_tr_b16 a[152:153], v16 offset:384
    ds_read_b64_tr_b16 a[154:155], v16 offset:7552
    s_waitcnt lgkmcnt(10)
    v_mfma_f32_32x32x16_bf16 v[32:47], a[128:131], a[224:227], v[32:47]
    ds_read_b64_tr_b16 a[156:157], v17 offset:384
    ds_read_b64_tr_b16 a[158:159], v17 offset:7552
    v_mfma_f32_32x32x16_bf16 v[48:63], a[132:135], a[224:227], v[48:63]
    ds_read_b64_tr_b16 a[160:161], v16 offset:512
    ds_read_b64_tr_b16 a[162:163], v16 offset:7680
    s_waitcnt lgkmcnt(10)
    v_mfma_f32_32x32x16_bf16 v[64:79], a[136:139], a[224:227], v[64:79]
    ds_read_b64_tr_b16 a[164:165], v17 offset:512
    ds_read_b64_tr_b16 a[166:167], v17 offset:7680
    v_mfma_f32_32x32x16_bf16 v[80:95], a[140:143], a[224:227], v[80:95]
    ds_read_b64_tr_b16 a[168:169], v16 offset:640
    ds_read_b64_tr_b16 a[170:171], v16 offset:7808
    s_waitcnt lgkmcnt(10)
    v_mfma_f32_32x32x16_bf16 v[96:111], a[144:147], a[224:227], v[96:111]
    ds_read_b64_tr_b16 a[172:173], v17 offset:640
    ds_read_b64_tr_b16 a[174:175], v17 offset:7808
    v_mfma_f32_32x32x16_bf16 v[112:127], a[148:151], a[224:227], v[112:127]
    ds_read_b64_tr_b16 a[176:177], v16 offset:768
    ds_read_b64_tr_b16 a[178:179], v16 offset:7936
    s_waitcnt lgkmcnt(10)
    v_mfma_f32_32x32x16_bf16 v[128:143], a[152:155], a[224:227], v[128:143]
    ds_read_b64_tr_b16 a[180:181], v17 offset:768
    ds_read_b64_tr_b16 a[182:183], v17 offset:7936
    v_mfma_f32_32x32x16_bf16 v[144:159], a[156:159], a[224:227], v[144:159]
    ds_read_b64_tr_b16 a[184:185], v18 offset:0
    ds_read_b64_tr_b16 a[186:187], v18 offset:7168
    s_waitcnt lgkmcnt(10)
    v_mfma_f32_32x32x16_bf16 v[160:175], a[160:163], a[224:227], v[160:175]
    ds_read_b64_tr_b16 a[188:189], v19 offset:0
    ds_read_b64_tr_b16 a[190:191], v19 offset:7168
    v_mfma_f32_32x32x16_bf16 v[176:191], a[164:167], a[224:227], v[176:191]
    ds_read_b64_tr_b16 a[128:129], v18 offset:128
    ds_read_b64_tr_b16 a[130:131], v18 offset:7296
    s_waitcnt lgkmcnt(10)
    v_mfma_f32_32x32x16_bf16 v[192:207], a[168:171], a[224:227], v[192:207]
    ds_read_b64_tr_b16 a[132:133], v19 offset:128
    ds_read_b64_tr_b16 a[134:135], v19 offset:7296
    v_mfma_f32_32x32x16_bf16 v[208:223], a[172:175], a[224:227], v[208:223]
    ds_read_b64_tr_b16 a[136:137], v18 offset:256
    ds_read_b64_tr_b16 a[138:139], v18 offset:7424
    s_waitcnt lgkmcnt(10)
    v_mfma_f32_32x32x16_bf16 v[224:239], a[176:179], a[224:227], v[224:239]
    ds_read_b64_tr_b16 a[140:141], v19 offset:256
    ds_read_b64_tr_b16 a[142:143], v19 offset:7424
    v_mfma_f32_32x32x16_bf16 v[240:255], a[180:183], a[224:227], v[240:255]
    ds_read_b64_tr_b16 a[144:145], v18 offset:384
    ds_read_b64_tr_b16 a[146:147], v18 offset:7552
    s_waitcnt lgkmcnt(10)
    v_mfma_f32_32x32x16_bf16 v[32:47], a[184:187], a[228:231], v[32:47]
    ds_read_b64_tr_b16 a[148:149], v19 offset:384
    ds_read_b64_tr_b16 a[150:151], v19 offset:7552
    v_mfma_f32_32x32x16_bf16 v[48:63], a[188:191], a[228:231], v[48:63]
    ds_read_b64_tr_b16 a[152:153], v18 offset:512
    ds_read_b64_tr_b16 a[154:155], v18 offset:7680
    s_waitcnt lgkmcnt(10)
    v_mfma_f32_32x32x16_bf16 v[64:79], a[128:131], a[228:231], v[64:79]
    ds_read_b64_tr_b16 a[156:157], v19 offset:512
    ds_read_b64_tr_b16 a[158:159], v19 offset:7680
    v_mfma_f32_32x32x16_bf16 v[80:95], a[132:135], a[228:231], v[80:95]
    ds_read_b64_tr_b16 a[160:161], v18 offset:640
    ds_read_b64_tr_b16 a[162:163], v18 offset:7808
    s_waitcnt lgkmcnt(10)
    v_mfma_f32_32x32x16_bf16 v[96:111], a[136:139], a[228:231], v[96:111]
    ds_read_b64_tr_b16 a[164:165], v19 offset:640
    ds_read_b64_tr_b16 a[166:167], v19 offset:7808
    v_mfma_f32_32x32x16_bf16 v[112:127], a[140:143], a[228:231], v[112:127]
    ds_read_b64_tr_b16 a[168:169], v18 offset:768
    ds_read_b64_tr_b16 a[170:171], v18 offset:7936
    s_waitcnt lgkmcnt(10)
    v_mfma_f32_32x32x16_bf16 v[128:143], a[144:147], a[228:231], v[128:143]
    ds_read_b64_tr_b16 a[172:173], v19 offset:768
    ds_read_b64_tr_b16 a[174:175], v19 offset:7936
    v_mfma_f32_32x32x16_bf16 v[144:159], a[148:151], a[228:231], v[144:159]
    s_waitcnt vmcnt(0)
    s_barrier
    s_xor_b32 s68, s68, 0x8000
    s_add_u32 s46, s46, 0x8000
    s_cmp_ge_u32 s46, 163840
    s_cselect_b32 s46, 65536, s46
    v_add_u32 v27, s68, v20
    v_add_u32 v28, s68, v21
    v_add_u32 v29, s46, v20
    v_add_u32 v30, s46, v21
    ds_read_b64_tr_b16 a[176:177], v16 offset:16384
    ds_read_b64_tr_b16 a[178:179], v16 offset:23552
    s_waitcnt lgkmcnt(10)
    v_mfma_f32_32x32x16_bf16 v[160:175], a[152:155], a[228:231], v[160:175]
    ds_read_b64_tr_b16 a[180:181], v18 offset:16384
    ds_read_b64_tr_b16 a[182:183], v18 offset:23552
    v_mfma_f32_32x32x16_bf16 v[176:191], a[156:159], a[228:231], v[176:191]
    ds_read_b64_tr_b16 a[184:185], v27 offset:0
    ds_read_b64_tr_b16 a[186:187], v27 offset:7168
    s_waitcnt lgkmcnt(10)
    v_mfma_f32_32x32x16_bf16 v[192:207], a[160:163], a[228:231], v[192:207]
    ds_read_b64_tr_b16 a[188:189], v29 offset:0
    ds_read_b64_tr_b16 a[190:191], v29 offset:7168
    v_mfma_f32_32x32x16_bf16 v[208:223], a[164:167], a[228:231], v[208:223]
    ds_read_b64_tr_b16 a[128:129], v29 offset:16384
    ds_read_b64_tr_b16 a[130:131], v29 offset:23552
    s_waitcnt lgkmcnt(10)
    v_mfma_f32_32x32x16_bf16 v[224:239], a[168:171], a[228:231], v[224:239]
    ds_read_b64_tr_b16 a[132:133], v17 offset:16384
    ds_read_b64_tr_b16 a[134:135], v17 offset:23552
    v_mfma_f32_32x32x16_bf16 v[240:255], a[172:175], a[228:231], v[240:255]
    ds_read_b64_tr_b16 a[136:137], v19 offset:16384
    ds_read_b64_tr_b16 a[138:139], v19 offset:23552
    s_waitcnt lgkmcnt(10)
    v_mfma_f32_32x32x16_bf16 v[32:47], a[176:179], a[232:235], v[32:47]
    ds_read_b64_tr_b16 a[140:141], v28 offset:0
    ds_read_b64_tr_b16 a[142:143], v28 offset:7168
    v_mfma_f32_32x32x16_bf16 v[32:47], a[180:183], a[236:239], v[32:47]
    ds_read_b64_tr_b16 a[144:145], v30 offset:0
    ds_read_b64_tr_b16 a[146:147], v30 offset:7168
    s_waitcnt lgkmcnt(10)
    v_mfma_f32_32x32x16_bf16 v[32:47], a[184:187], a[240:243], v[32:47]
    ds_read_b64_tr_b16 a[148:149], v30 offset:16384
    ds_read_b64_tr_b16 a[150:151], v30 offset:23552
    v_mfma_f32_32x32x16_bf16 v[32:47], a[188:191], a[244:247], v[32:47]
    ds_read_b64_tr_b16 a[152:153], v16 offset:16512
    ds_read_b64_tr_b16 a[154:155], v16 offset:23680
    s_waitcnt lgkmcnt(10)
    v_mfma_f32_32x32x16_bf16 v[32:47], a[128:131], a[248:251], v[32:47]
    ds_read_b64_tr_b16 a[156:157], v18 offset:16512
    ds_read_b64_tr_b16 a[158:159], v18 offset:23680
    v_mfma_f32_32x32x16_bf16 v[48:63], a[132:135], a[232:235], v[48:63]
    ds_read_b64_tr_b16 a[160:161], v27 offset:128
    ds_read_b64_tr_b16 a[162:163], v27 offset:7296
    s_waitcnt lgkmcnt(10)
    v_mfma_f32_32x32x16_bf16 v[48:63], a[136:139], a[236:239], v[48:63]
    ds_read_b64_tr_b16 a[164:165], v29 offset:128
    ds_read_b64_tr_b16 a[166:167], v29 offset:7296
    v_mfma_f32_32x32x16_bf16 v[48:63], a[140:143], a[240:243], v[48:63]
    ds_read_b64_tr_b16 a[168:169], v29 offset:16512
    ds_read_b64_tr_b16 a[170:171], v29 offset:23680
    v_cvt_pk_bf16_f32 v32, v32, v33
    v_cvt_pk_bf16_f32 v33, v34, v35
    v_cvt_pk_bf16_f32 v34, v36, v37
    s_waitcnt lgkmcnt(10)
    v_mfma_f32_32x32x16_bf16 v[48:63], a[144:147], a[244:247], v[48:63]
    ds_read_b64_tr_b16 a[172:173], v17 offset:16512
    ds_read_b64_tr_b16 a[174:175], v17 offset:23680
    v_cvt_pk_bf16_f32 v35, v38, v39
    s_mov_b32 s54, 0
    buffer_store_dwordx4 v[32:35], v2, s[12:15], s54 offen offset:0 sc1
    v_mfma_f32_32x32x16_bf16 v[48:63], a[148:151], a[248:251], v[48:63]
    ds_read_b64_tr_b16 a[176:177], v19 offset:16512
    ds_read_b64_tr_b16 a[178:179], v19 offset:23680
    v_cvt_pk_bf16_f32 v40, v40, v41
    v_cvt_pk_bf16_f32 v41, v42, v43
    v_cvt_pk_bf16_f32 v42, v44, v45
    s_waitcnt lgkmcnt(10)
    v_mfma_f32_32x32x16_bf16 v[64:79], a[152:155], a[232:235], v[64:79]
    ds_read_b64_tr_b16 a[180:181], v28 offset:128
    ds_read_b64_tr_b16 a[182:183], v28 offset:7296
    v_cvt_pk_bf16_f32 v43, v46, v47
    buffer_store_dwordx4 v[40:43], v2, s[12:15], s54 offen offset:1024 sc1
    v_mfma_f32_32x32x16_bf16 v[64:79], a[156:159], a[236:239], v[64:79]
    ds_read_b64_tr_b16 a[184:185], v30 offset:128
    ds_read_b64_tr_b16 a[186:187], v30 offset:7296
    s_waitcnt lgkmcnt(10)
    v_mfma_f32_32x32x16_bf16 v[64:79], a[160:163], a[240:243], v[64:79]
    ds_read_b64_tr_b16 a[188:189], v30 offset:16512
    ds_read_b64_tr_b16 a[190:191], v30 offset:23680
    v_cvt_pk_bf16_f32 v48, v48, v49
    v_cvt_pk_bf16_f32 v49, v50, v51
    v_cvt_pk_bf16_f32 v50, v52, v53
    v_mfma_f32_32x32x16_bf16 v[64:79], a[164:167], a[244:247], v[64:79]
    ds_read_b64_tr_b16 a[128:129], v16 offset:16640
    ds_read_b64_tr_b16 a[130:131], v16 offset:23808
    v_cvt_pk_bf16_f32 v51, v54, v55
    buffer_store_dwordx4 v[48:51], v2, s[12:15], s54 offen offset:2048 sc1
    v_cvt_pk_bf16_f32 v56, v56, v57
    s_waitcnt lgkmcnt(10)
    v_mfma_f32_32x32x16_bf16 v[64:79], a[168:171], a[248:251], v[64:79]
    ds_read_b64_tr_b16 a[132:133], v18 offset:16640
    ds_read_b64_tr_b16 a[134:135], v18 offset:23808
    v_cvt_pk_bf16_f32 v57, v58, v59
    v_cvt_pk_bf16_f32 v58, v60, v61
    v_cvt_pk_bf16_f32 v59, v62, v63
    v_mfma_f32_32x32x16_bf16 v[80:95], a[172:175], a[232:235], v[80:95]
    ds_read_b64_tr_b16 a[136:137], v27 offset:256
    ds_read_b64_tr_b16 a[138:139], v27 offset:7424
    buffer_store_dwordx4 v[56:59], v2, s[12:15], s54 offen offset:3072 sc1
    s_waitcnt lgkmcnt(10)
    v_mfma_f32_32x32x16_bf16 v[80:95], a[176:179], a[236:239], v[80:95]
    ds_read_b64_tr_b16 a[140:141], v29 offset:256
    ds_read_b64_tr_b16 a[142:143], v29 offset:7424
    v_mfma_f32_32x32x16_bf16 v[80:95], a[180:183], a[240:243], v[80:95]
    ds_read_b64_tr_b16 a[144:145], v29 offset:16640
    ds_read_b64_tr_b16 a[146:147], v29 offset:23808
    v_cvt_pk_bf16_f32 v64, v64, v65
    v_cvt_pk_bf16_f32 v65, v66, v67
    v_cvt_pk_bf16_f32 v66, v68, v69
    s_waitcnt lgkmcnt(10)
    v_mfma_f32_32x32x16_bf16 v[80:95], a[184:187], a[244:247], v[80:95]
    ds_read_b64_tr_b16 a[148:149], v17 offset:16640
    ds_read_b64_tr_b16 a[150:151], v17 offset:23808
    v_cvt_pk_bf16_f32 v67, v70, v71
    s_mov_b32 s54, 4096
    buffer_store_dwordx4 v[64:67], v2, s[12:15], s54 offen offset:0 sc1
    v_mfma_f32_32x32x16_bf16 v[80:95], a[188:191], a[248:251], v[80:95]
    ds_read_b64_tr_b16 a[152:153], v19 offset:16640
    ds_read_b64_tr_b16 a[154:155], v19 offset:23808
    v_cvt_pk_bf16_f32 v72, v72, v73
    v_cvt_pk_bf16_f32 v73, v74, v75
    v_cvt_pk_bf16_f32 v74, v76, v77
    s_waitcnt lgkmcnt(10)
    v_mfma_f32_32x32x16_bf16 v[96:111], a[128:131], a[232:235], v[96:111]
    ds_read_b64_tr_b16 a[156:157], v28 offset:256
    ds_read_b64_tr_b16 a[158:159], v28 offset:7424
    v_cvt_pk_bf16_f32 v75, v78, v79
    buffer_store_dwordx4 v[72:75], v2, s[12:15], s54 offen offset:1024 sc1
    v_mfma_f32_32x32x16_bf16 v[96:111], a[132:135], a[236:239], v[96:111]
    ds_read_b64_tr_b16 a[160:161], v30 offset:256
    ds_read_b64_tr_b16 a[162:163], v30 offset:7424
    s_waitcnt lgkmcnt(10)
    v_mfma_f32_32x32x16_bf16 v[96:111], a[136:139], a[240:243], v[96:111]
    ds_read_b64_tr_b16 a[164:165], v30 offset:16640
    ds_read_b64_tr_b16 a[166:167], v30 offset:23808
    v_cvt_pk_bf16_f32 v80, v80, v81
    v_cvt_pk_bf16_f32 v81, v82, v83
    v_cvt_pk_bf16_f32 v82, v84, v85
    v_mfma_f32_32x32x16_bf16 v[96:111], a[140:143], a[244:247], v[96:111]
    ds_read_b64_tr_b16 a[168:169], v16 offset:16768
    ds_read_b64_tr_b16 a[170:171], v16 offset:23936
    v_cvt_pk_bf16_f32 v83, v86, v87
    buffer_store_dwordx4 v[80:83], v2, s[12:15], s54 offen offset:2048 sc1
    v_cvt_pk_bf16_f32 v88, v88, v89
    s_waitcnt lgkmcnt(10)
    v_mfma_f32_32x32x16_bf16 v[96:111], a[144:147], a[248:251], v[96:111]
    ds_read_b64_tr_b16 a[172:173], v18 offset:16768
    ds_read_b64_tr_b16 a[174:175], v18 offset:23936
    v_cvt_pk_bf16_f32 v89, v90, v91
    v_cvt_pk_bf16_f32 v90, v92, v93
    v_cvt_pk_bf16_f32 v91, v94, v95
    v_mfma_f32_32x32x16_bf16 v[112:127], a[148:151], a[232:235], v[112:127]
    ds_read_b64_tr_b16 a[176:177], v27 offset:384
    ds_read_b64_tr_b16 a[178:179], v27 offset:7552
    buffer_store_dwordx4 v[88:91], v2, s[12:15], s54 offen offset:3072 sc1
    s_waitcnt lgkmcnt(10)
    v_mfma_f32_32x32x16_bf16 v[112:127], a[152:155], a[236:239], v[112:127]
    ds_read_b64_tr_b16 a[180:181], v29 offset:384
    ds_read_b64_tr_b16 a[182:183], v29 offset:7552
    v_mfma_f32_32x32x16_bf16 v[112:127], a[156:159], a[240:243], v[112:127]
    ds_read_b64_tr_b16 a[184:185], v29 offset:16768
    ds_read_b64_tr_b16 a[186:187], v29 offset:23936
    v_cvt_pk_bf16_f32 v96, v96, v97
    v_cvt_pk_bf16_f32 v97, v98, v99
    v_cvt_pk_bf16_f32 v98, v100, v101
    s_waitcnt lgkmcnt(10)
    v_mfma_f32_32x32x16_bf16 v[112:127], a[160:163], a[244:247], v[112:127]
    ds_read_b64_tr_b16 a[188:189], v17 offset:16768
    ds_read_b64_tr_b16 a[190:191], v17 offset:23936
    v_cvt_pk_bf16_f32 v99, v102, v103
    s_mov_b32 s54, 8192
    buffer_store_dwordx4 v[96:99], v2, s[12:15], s54 offen offset:0 sc1
    v_mfma_f32_32x32x16_bf16 v[112:127], a[164:167], a[248:251], v[112:127]
    ds_read_b64_tr_b16 a[128:129], v19 offset:16768
    ds_read_b64_tr_b16 a[130:131], v19 offset:23936
    v_cvt_pk_bf16_f32 v104, v104, v105
    v_cvt_pk_bf16_f32 v105, v106, v107
    v_cvt_pk_bf16_f32 v106, v108, v109
    s_waitcnt lgkmcnt(10)
    v_mfma_f32_32x32x16_bf16 v[128:143], a[168:171], a[232:235], v[128:143]
    ds_read_b64_tr_b16 a[132:133], v28 offset:384
    ds_read_b64_tr_b16 a[134:135], v28 offset:7552
    v_cvt_pk_bf16_f32 v107, v110, v111
    buffer_store_dwordx4 v[104:107], v2, s[12:15], s54 offen offset:1024 sc1
    v_mfma_f32_32x32x16_bf16 v[128:143], a[172:175], a[236:239], v[128:143]
    ds_read_b64_tr_b16 a[136:137], v30 offset:384
    ds_read_b64_tr_b16 a[138:139], v30 offset:7552
    s_waitcnt lgkmcnt(10)
    v_mfma_f32_32x32x16_bf16 v[128:143], a[176:179], a[240:243], v[128:143]
    ds_read_b64_tr_b16 a[140:141], v30 offset:16768
    ds_read_b64_tr_b16 a[142:143], v30 offset:23936
    v_cvt_pk_bf16_f32 v112, v112, v113
    v_cvt_pk_bf16_f32 v113, v114, v115
    v_cvt_pk_bf16_f32 v114, v116, v117
    v_mfma_f32_32x32x16_bf16 v[128:143], a[180:183], a[244:247], v[128:143]
    ds_read_b64_tr_b16 a[144:145], v16 offset:16896
    ds_read_b64_tr_b16 a[146:147], v16 offset:24064
    v_cvt_pk_bf16_f32 v115, v118, v119
    buffer_store_dwordx4 v[112:115], v2, s[12:15], s54 offen offset:2048 sc1
    v_cvt_pk_bf16_f32 v120, v120, v121
    s_waitcnt lgkmcnt(10)
    v_mfma_f32_32x32x16_bf16 v[128:143], a[184:187], a[248:251], v[128:143]
    ds_read_b64_tr_b16 a[148:149], v18 offset:16896
    ds_read_b64_tr_b16 a[150:151], v18 offset:24064
    v_cvt_pk_bf16_f32 v121, v122, v123
    v_cvt_pk_bf16_f32 v122, v124, v125
    v_cvt_pk_bf16_f32 v123, v126, v127
    v_mfma_f32_32x32x16_bf16 v[144:159], a[188:191], a[232:235], v[144:159]
    ds_read_b64_tr_b16 a[152:153], v27 offset:512
    ds_read_b64_tr_b16 a[154:155], v27 offset:7680
    buffer_store_dwordx4 v[120:123], v2, s[12:15], s54 offen offset:3072 sc1
    s_waitcnt lgkmcnt(10)
    v_mfma_f32_32x32x16_bf16 v[144:159], a[128:131], a[236:239], v[144:159]
    ds_read_b64_tr_b16 a[156:157], v29 offset:512
    ds_read_b64_tr_b16 a[158:159], v29 offset:7680
    v_mfma_f32_32x32x16_bf16 v[144:159], a[132:135], a[240:243], v[144:159]
    ds_read_b64_tr_b16 a[160:161], v29 offset:16896
    ds_read_b64_tr_b16 a[162:163], v29 offset:24064
    v_cvt_pk_bf16_f32 v128, v128, v129
    v_cvt_pk_bf16_f32 v129, v130, v131
    v_cvt_pk_bf16_f32 v130, v132, v133
    s_waitcnt lgkmcnt(10)
    v_mfma_f32_32x32x16_bf16 v[144:159], a[136:139], a[244:247], v[144:159]
    ds_read_b64_tr_b16 a[164:165], v17 offset:16896
    ds_read_b64_tr_b16 a[166:167], v17 offset:24064
    v_cvt_pk_bf16_f32 v131, v134, v135
    s_mov_b32 s54, 12288
    buffer_store_dwordx4 v[128:131], v2, s[12:15], s54 offen offset:0 sc1
    v_mfma_f32_32x32x16_bf16 v[144:159], a[140:143], a[248:251], v[144:159]
    ds_read_b64_tr_b16 a[168:169], v19 offset:16896
    ds_read_b64_tr_b16 a[170:171], v19 offset:24064
    v_cvt_pk_bf16_f32 v136, v136, v137
    v_cvt_pk_bf16_f32 v137, v138, v139
    v_cvt_pk_bf16_f32 v138, v140, v141
    s_waitcnt lgkmcnt(10)
    v_mfma_f32_32x32x16_bf16 v[160:175], a[144:147], a[232:235], v[160:175]
    ds_read_b64_tr_b16 a[172:173], v28 offset:512
    ds_read_b64_tr_b16 a[174:175], v28 offset:7680
    v_cvt_pk_bf16_f32 v139, v142, v143
    buffer_store_dwordx4 v[136:139], v2, s[12:15], s54 offen offset:1024 sc1
    v_mfma_f32_32x32x16_bf16 v[160:175], a[148:151], a[236:239], v[160:175]
    ds_read_b64_tr_b16 a[176:177], v30 offset:512
    ds_read_b64_tr_b16 a[178:179], v30 offset:7680
    s_waitcnt lgkmcnt(10)
    v_mfma_f32_32x32x16_bf16 v[160:175], a[152:155], a[240:243], v[160:175]
    ds_read_b64_tr_b16 a[180:181], v30 offset:16896
    ds_read_b64_tr_b16 a[182:183], v30 offset:24064
    v_cvt_pk_bf16_f32 v144, v144, v145
    v_cvt_pk_bf16_f32 v145, v146, v147
    v_cvt_pk_bf16_f32 v146, v148, v149
    v_mfma_f32_32x32x16_bf16 v[160:175], a[156:159], a[244:247], v[160:175]
    ds_read_b64_tr_b16 a[184:185], v16 offset:17024
    ds_read_b64_tr_b16 a[186:187], v16 offset:24192
    v_cvt_pk_bf16_f32 v147, v150, v151
    buffer_store_dwordx4 v[144:147], v2, s[12:15], s54 offen offset:2048 sc1
    v_cvt_pk_bf16_f32 v152, v152, v153
    s_waitcnt lgkmcnt(10)
    v_mfma_f32_32x32x16_bf16 v[160:175], a[160:163], a[248:251], v[160:175]
    ds_read_b64_tr_b16 a[188:189], v18 offset:17024
    ds_read_b64_tr_b16 a[190:191], v18 offset:24192
    v_cvt_pk_bf16_f32 v153, v154, v155
    v_cvt_pk_bf16_f32 v154, v156, v157
    v_cvt_pk_bf16_f32 v155, v158, v159
    v_mfma_f32_32x32x16_bf16 v[176:191], a[164:167], a[232:235], v[176:191]
    ds_read_b64_tr_b16 a[128:129], v27 offset:640
    ds_read_b64_tr_b16 a[130:131], v27 offset:7808
    buffer_store_dwordx4 v[152:155], v2, s[12:15], s54 offen offset:3072 sc1
    s_waitcnt lgkmcnt(10)
    v_mfma_f32_32x32x16_bf16 v[176:191], a[168:171], a[236:239], v[176:191]
    ds_read_b64_tr_b16 a[132:133], v29 offset:640
    ds_read_b64_tr_b16 a[134:135], v29 offset:7808
    v_mfma_f32_32x32x16_bf16 v[176:191], a[172:175], a[240:243], v[176:191]
    ds_read_b64_tr_b16 a[136:137], v29 offset:17024
    ds_read_b64_tr_b16 a[138:139], v29 offset:24192
    v_cvt_pk_bf16_f32 v160, v160, v161
    v_cvt_pk_bf16_f32 v161, v162, v163
    v_cvt_pk_bf16_f32 v162, v164, v165
    s_waitcnt lgkmcnt(10)
    v_mfma_f32_32x32x16_bf16 v[176:191], a[176:179], a[244:247], v[176:191]
    ds_read_b64_tr_b16 a[140:141], v17 offset:17024
    ds_read_b64_tr_b16 a[142:143], v17 offset:24192
    v_cvt_pk_bf16_f32 v163, v166, v167
    s_mov_b32 s54, 16384
    buffer_store_dwordx4 v[160:163], v2, s[12:15], s54 offen offset:0 sc1
    v_mfma_f32_32x32x16_bf16 v[176:191], a[180:183], a[248:251], v[176:191]
    ds_read_b64_tr_b16 a[144:145], v19 offset:17024
    ds_read_b64_tr_b16 a[146:147], v19 offset:24192
    v_cvt_pk_bf16_f32 v168, v168, v169
    v_cvt_pk_bf16_f32 v169, v170, v171
    v_cvt_pk_bf16_f32 v170, v172, v173
    s_waitcnt lgkmcnt(10)
    v_mfma_f32_32x32x16_bf16 v[192:207], a[184:187], a[232:235], v[192:207]
    ds_read_b64_tr_b16 a[148:149], v28 offset:640
    ds_read_b64_tr_b16 a[150:151], v28 offset:7808
    v_cvt_pk_bf16_f32 v171, v174, v175
    buffer_store_dwordx4 v[168:171], v2, s[12:15], s54 offen offset:1024 sc1
    v_mfma_f32_32x32x16_bf16 v[192:207], a[188:191], a[236:239], v[192:207]
    ds_read_b64_tr_b16 a[152:153], v30 offset:640
    ds_read_b64_tr_b16 a[154:155], v30 offset:7808
    s_waitcnt lgkmcnt(10)
    v_mfma_f32_32x32x16_bf16 v[192:207], a[128:131], a[240:243], v[192:207]
    ds_read_b64_tr_b16 a[156:157], v30 offset:17024
    ds_read_b64_tr_b16 a[158:159], v30 offset:24192
    v_cvt_pk_bf16_f32 v176, v176, v177
    v_cvt_pk_bf16_f32 v177, v178, v179
    v_cvt_pk_bf16_f32 v178, v180, v181
    v_mfma_f32_32x32x16_bf16 v[192:207], a[132:135], a[244:247], v[192:207]
    ds_read_b64_tr_b16 a[160:161], v16 offset:17152
    ds_read_b64_tr_b16 a[162:163], v16 offset:24320
    v_cvt_pk_bf16_f32 v179, v182, v183
    buffer_store_dwordx4 v[176:179], v2, s[12:15], s54 offen offset:2048 sc1
    v_cvt_pk_bf16_f32 v184, v184, v185
    s_waitcnt lgkmcnt(10)
    v_mfma_f32_32x32x16_bf16 v[192:207], a[136:139], a[248:251], v[192:207]
    ds_read_b64_tr_b16 a[164:165], v18 offset:17152
    ds_read_b64_tr_b16 a[166:167], v18 offset:24320
    v_cvt_pk_bf16_f32 v185, v186, v187
    v_cvt_pk_bf16_f32 v186, v188, v189
    v_cvt_pk_bf16_f32 v187, v190, v191
    v_mfma_f32_32x32x16_bf16 v[208:223], a[140:143], a[232:235], v[208:223]
    ds_read_b64_tr_b16 a[168:169], v27 offset:768
    ds_read_b64_tr_b16 a[170:171], v27 offset:7936
    buffer_store_dwordx4 v[184:187], v2, s[12:15], s54 offen offset:3072 sc1
    s_waitcnt lgkmcnt(10)
    v_mfma_f32_32x32x16_bf16 v[208:223], a[144:147], a[236:239], v[208:223]
    ds_read_b64_tr_b16 a[172:173], v29 offset:768
    ds_read_b64_tr_b16 a[174:175], v29 offset:7936
    v_mfma_f32_32x32x16_bf16 v[208:223], a[148:151], a[240:243], v[208:223]
    ds_read_b64_tr_b16 a[176:177], v29 offset:17152
    ds_read_b64_tr_b16 a[178:179], v29 offset:24320
    v_cvt_pk_bf16_f32 v192, v192, v193
    v_cvt_pk_bf16_f32 v193, v194, v195
    v_cvt_pk_bf16_f32 v194, v196, v197
    s_waitcnt lgkmcnt(10)
    v_mfma_f32_32x32x16_bf16 v[208:223], a[152:155], a[244:247], v[208:223]
    ds_read_b64_tr_b16 a[180:181], v17 offset:17152
    ds_read_b64_tr_b16 a[182:183], v17 offset:24320
    v_cvt_pk_bf16_f32 v195, v198, v199
    s_mov_b32 s54, 20480
    buffer_store_dwordx4 v[192:195], v2, s[12:15], s54 offen offset:0 sc1
    v_mfma_f32_32x32x16_bf16 v[208:223], a[156:159], a[248:251], v[208:223]
    ds_read_b64_tr_b16 a[184:185], v19 offset:17152
    ds_read_b64_tr_b16 a[186:187], v19 offset:24320
    v_cvt_pk_bf16_f32 v200, v200, v201
    v_cvt_pk_bf16_f32 v201, v202, v203
    v_cvt_pk_bf16_f32 v202, v204, v205
    s_waitcnt lgkmcnt(10)
    v_mfma_f32_32x32x16_bf16 v[224:239], a[160:163], a[232:235], v[224:239]
    ds_read_b64_tr_b16 a[188:189], v28 offset:768
    ds_read_b64_tr_b16 a[190:191], v28 offset:7936
    v_cvt_pk_bf16_f32 v203, v206, v207
    buffer_store_dwordx4 v[200:203], v2, s[12:15], s54 offen offset:1024 sc1
    v_mfma_f32_32x32x16_bf16 v[224:239], a[164:167], a[236:239], v[224:239]
    ds_read_b64_tr_b16 a[128:129], v30 offset:768
    ds_read_b64_tr_b16 a[130:131], v30 offset:7936
    s_waitcnt lgkmcnt(10)
    v_mfma_f32_32x32x16_bf16 v[224:239], a[168:171], a[240:243], v[224:239]
    ds_read_b64_tr_b16 a[132:133], v30 offset:17152
    ds_read_b64_tr_b16 a[134:135], v30 offset:24320
    v_mfma_f32_32x32x16_bf16 v[224:239], a[172:175], a[244:247], v[224:239]
    s_waitcnt lgkmcnt(8)
    v_mfma_f32_32x32x16_bf16 v[224:239], a[176:179], a[248:251], v[224:239]
    v_mfma_f32_32x32x16_bf16 v[240:255], a[180:183], a[232:235], v[240:255]
    s_waitcnt lgkmcnt(4)
    v_mfma_f32_32x32x16_bf16 v[240:255], a[184:187], a[236:239], v[240:255]
    v_mfma_f32_32x32x16_bf16 v[240:255], a[188:191], a[240:243], v[240:255]
    s_waitcnt lgkmcnt(0)
    v_mfma_f32_32x32x16_bf16 v[240:255], a[128:131], a[244:247], v[240:255]
    v_mfma_f32_32x32x16_bf16 v[240:255], a[132:135], a[248:251], v[240:255]
    s_nop 7
    v_cvt_pk_bf16_f32 v208, v208, v209
    v_cvt_pk_bf16_f32 v209, v210, v211
    v_cvt_pk_bf16_f32 v210, v212, v213
    v_cvt_pk_bf16_f32 v211, v214, v215
    buffer_store_dwordx4 v[208:211], v2, s[12:15], s54 offen offset:2048 sc1
    v_cvt_pk_bf16_f32 v216, v216, v217
    v_cvt_pk_bf16_f32 v217, v218, v219
    v_cvt_pk_bf16_f32 v218, v220, v221
    v_cvt_pk_bf16_f32 v219, v222, v223
    buffer_store_dwordx4 v[216:219], v2, s[12:15], s54 offen offset:3072 sc1
    v_cvt_pk_bf16_f32 v224, v224, v225
    v_cvt_pk_bf16_f32 v225, v226, v227
    v_cvt_pk_bf16_f32 v226, v228, v229
    v_cvt_pk_bf16_f32 v227, v230, v231
    s_mov_b32 s54, 24576
    buffer_store_dwordx4 v[224:227], v2, s[12:15], s54 offen offset:0 sc1
    v_cvt_pk_bf16_f32 v232, v232, v233
    v_cvt_pk_bf16_f32 v233, v234, v235
    v_cvt_pk_bf16_f32 v234, v236, v237
    v_cvt_pk_bf16_f32 v235, v238, v239
    buffer_store_dwordx4 v[232:235], v2, s[12:15], s54 offen offset:1024 sc1
    v_cvt_pk_bf16_f32 v240, v240, v241
    v_cvt_pk_bf16_f32 v241, v242, v243
    v_cvt_pk_bf16_f32 v242, v244, v245
    v_cvt_pk_bf16_f32 v243, v246, v247
    buffer_store_dwordx4 v[240:243], v2, s[12:15], s54 offen offset:2048 sc1
    v_cvt_pk_bf16_f32 v248, v248, v249
    v_cvt_pk_bf16_f32 v249, v250, v251
    v_cvt_pk_bf16_f32 v250, v252, v253
    v_cvt_pk_bf16_f32 v251, v254, v255
    buffer_store_dwordx4 v[248:251], v2, s[12:15], s54 offen offset:3072 sc1
    s_load_dwordx2 s[24:25], s[0:1], 0
    s_load_dwordx2 s[26:27], s[0:1], 72
    s_add_u32 s60, s34, 99614720
    s_addc_u32 s61, s35, 0
    s_mov_b32 s62, 10240
    s_add_u32 s88, s34, 100663296
    s_addc_u32 s89, s35, 0
    s_mov_b32 s90, 29360128
    v_mov_b32 v13, 1
    v_mov_b32 v14, 0
    v_and_b32 v21, 31, v1
    v_mul_u32_u24 v21, 896, v21
    v_lshrrev_b32 v7, 5, v1
    v_lshl_add_u32 v21, v7, 4, v21
    s_lshl_b32 s50, s79, 2
    s_add_u32 s50, s50, s36
    s_bfe_u32 s51, s2, 0x30004
    s_lshl_b32 s51, s51, 2
    s_sub_u32 s52, 60, s51
    s_add_u32 s53, s50, 64
    s_mul_i32 s4, s50, 147
    s_lshr_b32 s4, s4, 12
    s_mul_i32 s5, s4, 28
    s_sub_u32 s5, s50, s5
    s_add_u32 s4, s4, s51
    s_mul_i32 s40, s4, 28672
    s_mov_b32 s41, s40
    s_lshl_b32 s6, s5, 10
    s_add_u32 s40, s40, s6
    s_lshl_b32 s6, s5, 5
    s_add_u32 s41, s41, s6
    s_add_u32 s42, s4, 16
    s_lshl_b32 s42, s42, 7
    s_mul_i32 s4, s53, 147
    s_lshr_b32 s4, s4, 12
    s_mul_i32 s5, s4, 28
    s_sub_u32 s5, s53, s5
    s_add_u32 s4, s4, s51
    s_mul_i32 s43, s4, 28672
    s_mov_b32 s44, s43
    s_lshl_b32 s6, s5, 10
    s_add_u32 s43, s43, s6
    s_lshl_b32 s6, s5, 5
    s_add_u32 s44, s44, s6
    s_add_u32 s45, s4, 16
    s_lshl_b32 s45, s45, 7
    s_cmp_lt_u32 s2, 128
    s_cselect_b32 s54, s50, s53
    s_mul_i32 s4, s54, 147
    s_lshr_b32 s4, s4, 12
    s_mul_i32 s5, s4, 28
    s_sub_u32 s5, s54, s5
    s_add_u32 s4, s4, s52
    s_mul_i32 s46, s4, 28672
    s_mov_b32 s47, s46
    s_lshl_b32 s6, s5, 10
    s_add_u32 s46, s46, s6
    s_lshl_b32 s6, s5, 5
    s_add_u32 s47, s47, s6
    s_add_u32 s48, s4, 16
    s_lshl_b32 s48, s48, 7
    s_add_u32 s55, s77, 16
    s_lshl_b32 s55, s55, 7
    s_waitcnt vmcnt(0) lgkmcnt(0)
    s_mov_b64 exec, 1
    buffer_atomic_add v13, v14, s[60:63], s55 offen sc1
    s_mov_b64 exec, -1
    s_mov_b32 s20, s24
    s_mov_b32 s21, s25
    s_mov_b32 s22, 1835008
    s_mov_b32 s23, 0x00020000
    s_mov_b32 s8, s26
    s_mov_b32 s9, s27
    s_mov_b32 s10, 1835008
    s_cmp_ge_u32 s2, 128
    s_cbranch_scc1 L_k2_r2
    s_mov_b32 s6, 0
L_k2_rp0:
    buffer_load_dword v15, v14, s[60:63], s42 offen sc1
    s_waitcnt vmcnt(0)
    v_readfirstlane_b32 s7, v15
    s_nop 3
    s_cmp_ge_u32 s7, 16
    s_cbranch_scc1 L_k2_rp0_ok
    s_add_u32 s6, s6, 1
    s_cmp_ge_u32 s6, 0x80000
    s_cbranch_scc1 L_k2_rp0_ok
    s_sleep 4
    s_branch L_k2_rp0
L_k2_rp0_ok:
    s_cmp_ge_u32 s53, 112
    s_cbranch_scc1 L_k2_r1only
    s_mov_b32 s6, 0
L_k2_rp1:
    buffer_load_dword v15, v14, s[60:63], s45 offen sc1
    s_waitcnt vmcnt(0)
    v_readfirstlane_b32 s7, v15
    s_nop 3
    s_cmp_ge_u32 s7, 16
    s_cbranch_scc1 L_k2_rp1_ok
    s_add_u32 s6, s6, 1
    s_cmp_ge_u32 s6, 0x80000
    s_cbranch_scc1 L_k2_rp1_ok
    s_sleep 4
    s_branch L_k2_rp1
L_k2_rp1_ok:
    buffer_load_dwordx4 v[32:35], v2, s[88:91], s40 offen sc1
    s_add_u32 s40, s40, 1835008
    buffer_load_dwordx4 v[36:39], v2, s[88:91], s40 offen sc1
    s_add_u32 s40, s40, 1835008
    buffer_load_dwordx4 v[40:43], v2, s[88:91], s40 offen sc1
    s_add_u32 s40, s40, 1835008
    buffer_load_dwordx4 v[44:47], v2, s[88:91], s40 offen sc1
    s_add_u32 s40, s40, 1835008
    buffer_load_dwordx4 v[48:51], v2, s[88:91], s40 offen sc1
    s_add_u32 s40, s40, 1835008
    buffer_load_dwordx4 v[52:55], v2, s[88:91], s40 offen sc1
    s_add_u32 s40, s40, 1835008
    buffer_load_dwordx4 v[56:59], v2, s[88:91], s40 offen sc1
    s_add_u32 s40, s40, 1835008
    buffer_load_dwordx4 v[60:63], v2, s[88:91], s40 offen sc1
    s_add_u32 s40, s40, 1835008
    buffer_load_dwordx4 v[64:67], v2, s[88:91], s40 offen sc1
    s_add_u32 s40, s40, 1835008
    buffer_load_dwordx4 v[68:71], v2, s[88:91], s40 offen sc1
    s_add_u32 s40, s40, 1835008
    buffer_load_dwordx4 v[72:75], v2, s[88:91], s40 offen sc1
    s_add_u32 s40, s40, 1835008
    buffer_load_dwordx4 v[76:79], v2, s[88:91], s40 offen sc1
    s_add_u32 s40, s40, 1835008
    buffer_load_dwordx4 v[80:83], v2, s[88:91], s40 offen sc1
    s_add_u32 s40, s40, 1835008
    buffer_load_dwordx4 v[84:87], v2, s[88:91], s40 offen sc1
    s_add_u32 s40, s40, 1835008
    buffer_load_dwordx4 v[88:91], v2, s[88:91], s40 offen sc1
    s_add_u32 s40, s40, 1835008
    buffer_load_dwordx4 v[92:95], v2, s[88:91], s40 offen sc1
    buffer_load_dwordx4 v[96:99], v21, s[20:23], s41 offen
    buffer_load_dwordx4 v[112:115], v2, s[88:91], s43 offen sc1
    s_add_u32 s43, s43, 1835008
    buffer_load_dwordx4 v[116:119], v2, s[88:91], s43 offen sc1
    s_add_u32 s43, s43, 1835008
    buffer_load_dwordx4 v[120:123], v2, s[88:91], s43 offen sc1
    s_add_u32 s43, s43, 1835008
    buffer_load_dwordx4 v[124:127], v2, s[88:91], s43 offen sc1
    s_add_u32 s43, s43, 1835008
    buffer_load_dwordx4 v[128:131], v2, s[88:91], s43 offen sc1
    s_add_u32 s43, s43, 1835008
    buffer_load_dwordx4 v[132:135], v2, s[88:91], s43 offen sc1
    s_add_u32 s43, s43, 1835008
    buffer_load_dwordx4 v[136:139], v2, s[88:91], s43 offen sc1
    s_add_u32 s43, s43, 1835008
    buffer_load_dwordx4 v[140:143], v2, s[88:91], s43 offen sc1
    s_add_u32 s43, s43, 1835008
    buffer_load_dwordx4 v[144:147], v2, s[88:91], s43 offen sc1
    s_add_u32 s43, s43, 1835008
    buffer_load_dwordx4 v[148:151], v2, s[88:91], s43 offen sc1
    s_add_u32 s43, s43, 1835008
    buffer_load_dwordx4 v[152:155], v2, s[88:91], s43 offen sc1
    s_add_u32 s43, s43, 1835008
    buffer_load_dwordx4 v[156:159], v2, s[88:91], s43 offen sc1
    s_add_u32 s43, s43, 1835008
    buffer_load_dwordx4 v[160:163], v2, s[88:91], s43 offen sc1
    s_add_u32 s43, s43, 1835008
    buffer_load_dwordx4 v[164:167], v2, s[88:91], s43 offen sc1
    s_add_u32 s43, s43, 1835008
    buffer_load_dwordx4 v[168:171], v2, s[88:91], s43 offen sc1
    s_add_u32 s43, s43, 1835008
    buffer_load_dwordx4 v[172:175], v2, s[88:91], s43 offen sc1
    buffer_load_dwordx4 v[176:179], v21, s[20:23], s44 offen
    s_waitcnt vmcnt(33)
    v_lshlrev_b32 v100, 16, v32
    v_and_b32 v101, 0xffff0000, v32
    v_lshlrev_b32 v102, 16, v33
    v_and_b32 v103, 0xffff0000, v33
    v_lshlrev_b32 v104, 16, v34
    v_and_b32 v105, 0xffff0000, v34
    v_lshlrev_b32 v106, 16, v35
    v_and_b32 v107, 0xffff0000, v35
    s_waitcnt vmcnt(32)
    v_lshlrev_b32 v24, 16, v36
    v_and_b32 v25, 0xffff0000, v36
    v_pk_add_f32 v[100:101], v[100:101], v[24:25]
    v_lshlrev_b32 v26, 16, v37
    v_and_b32 v27, 0xffff0000, v37
    v_pk_add_f32 v[102:103], v[102:103], v[26:27]
    v_lshlrev_b32 v24, 16, v38
    v_and_b32 v25, 0xffff0000, v38
    v_pk_add_f32 v[104:105], v[104:105], v[24:25]
    v_lshlrev_b32 v26, 16, v39
    v_and_b32 v27, 0xffff0000, v39
    v_pk_add_f32 v[106:107], v[106:107], v[26:27]
    s_waitcnt vmcnt(31)
    v_lshlrev_b32 v24, 16, v40
    v_and_b32 v25, 0xffff0000, v40
    v_pk_add_f32 v[100:101], v[100:101], v[24:25]
    v_lshlrev_b32 v26, 16, v41
    v_and_b32 v27, 0xffff0000, v41
    v_pk_add_f32 v[102:103], v[102:103], v[26:27]
    v_lshlrev_b32 v24, 16, v42
    v_and_b32 v25, 0xffff0000, v42
    v_pk_add_f32 v[104:105], v[104:105], v[24:25]
    v_lshlrev_b32 v26, 16, v43
    v_and_b32 v27, 0xffff0000, v43
    v_pk_add_f32 v[106:107], v[106:107], v[26:27]
    s_waitcnt vmcnt(30)
    v_lshlrev_b32 v24, 16, v44
    v_and_b32 v25, 0xffff0000, v44
    v_pk_add_f32 v[100:101], v[100:101], v[24:25]
    v_lshlrev_b32 v26, 16, v45
    v_and_b32 v27, 0xffff0000, v45
    v_pk_add_f32 v[102:103], v[102:103], v[26:27]
    v_lshlrev_b32 v24, 16, v46
    v_and_b32 v25, 0xffff0000, v46
    v_pk_add_f32 v[104:105], v[104:105], v[24:25]
    v_lshlrev_b32 v26, 16, v47
    v_and_b32 v27, 0xffff0000, v47
    v_pk_add_f32 v[106:107], v[106:107], v[26:27]
    s_waitcnt vmcnt(29)
    v_lshlrev_b32 v24, 16, v48
    v_and_b32 v25, 0xffff0000, v48
    v_pk_add_f32 v[100:101], v[100:101], v[24:25]
    v_lshlrev_b32 v26, 16, v49
    v_and_b32 v27, 0xffff0000, v49
    v_pk_add_f32 v[102:103], v[102:103], v[26:27]
    v_lshlrev_b32 v24, 16, v50
    v_and_b32 v25, 0xffff0000, v50
    v_pk_add_f32 v[104:105], v[104:105], v[24:25]
    v_lshlrev_b32 v26, 16, v51
    v_and_b32 v27, 0xffff0000, v51
    v_pk_add_f32 v[106:107], v[106:107], v[26:27]
    s_waitcnt vmcnt(28)
    v_lshlrev_b32 v24, 16, v52
    v_and_b32 v25, 0xffff0000, v52
    v_pk_add_f32 v[100:101], v[100:101], v[24:25]
    v_lshlrev_b32 v26, 16, v53
    v_and_b32 v27, 0xffff0000, v53
    v_pk_add_f32 v[102:103], v[102:103], v[26:27]
    v_lshlrev_b32 v24, 16, v54
    v_and_b32 v25, 0xffff0000, v54
    v_pk_add_f32 v[104:105], v[104:105], v[24:25]
    v_lshlrev_b32 v26, 16, v55
    v_and_b32 v27, 0xffff0000, v55
    v_pk_add_f32 v[106:107], v[106:107], v[26:27]
    s_waitcnt vmcnt(27)
    v_lshlrev_b32 v24, 16, v56
    v_and_b32 v25, 0xffff0000, v56
    v_pk_add_f32 v[100:101], v[100:101], v[24:25]
    v_lshlrev_b32 v26, 16, v57
    v_and_b32 v27, 0xffff0000, v57
    v_pk_add_f32 v[102:103], v[102:103], v[26:27]
    v_lshlrev_b32 v24, 16, v58
    v_and_b32 v25, 0xffff0000, v58
    v_pk_add_f32 v[104:105], v[104:105], v[24:25]
    v_lshlrev_b32 v26, 16, v59
    v_and_b32 v27, 0xffff0000, v59
    v_pk_add_f32 v[106:107], v[106:107], v[26:27]
    s_waitcnt vmcnt(26)
    v_lshlrev_b32 v24, 16, v60
    v_and_b32 v25, 0xffff0000, v60
    v_pk_add_f32 v[100:101], v[100:101], v[24:25]
    v_lshlrev_b32 v26, 16, v61
    v_and_b32 v27, 0xffff0000, v61
    v_pk_add_f32 v[102:103], v[102:103], v[26:27]
    v_lshlrev_b32 v24, 16, v62
    v_and_b32 v25, 0xffff0000, v62
    v_pk_add_f32 v[104:105], v[104:105], v[24:25]
    v_lshlrev_b32 v26, 16, v63
    v_and_b32 v27, 0xffff0000, v63
    v_pk_add_f32 v[106:107], v[106:107], v[26:27]
    s_waitcnt vmcnt(25)
    v_lshlrev_b32 v24, 16, v64
    v_and_b32 v25, 0xffff0000, v64
    v_pk_add_f32 v[100:101], v[100:101], v[24:25]
    v_lshlrev_b32 v26, 16, v65
    v_and_b32 v27, 0xffff0000, v65
    v_pk_add_f32 v[102:103], v[102:103], v[26:27]
    v_lshlrev_b32 v24, 16, v66
    v_and_b32 v25, 0xffff0000, v66
    v_pk_add_f32 v[104:105], v[104:105], v[24:25]
    v_lshlrev_b32 v26, 16, v67
    v_and_b32 v27, 0xffff0000, v67
    v_pk_add_f32 v[106:107], v[106:107], v[26:27]
    s_waitcnt vmcnt(24)
    v_lshlrev_b32 v24, 16, v68
    v_and_b32 v25, 0xffff0000, v68
    v_pk_add_f32 v[100:101], v[100:101], v[24:25]
    v_lshlrev_b32 v26, 16, v69
    v_and_b32 v27, 0xffff0000, v69
    v_pk_add_f32 v[102:103], v[102:103], v[26:27]
    v_lshlrev_b32 v24, 16, v70
    v_and_b32 v25, 0xffff0000, v70
    v_pk_add_f32 v[104:105], v[104:105], v[24:25]
    v_lshlrev_b32 v26, 16, v71
    v_and_b32 v27, 0xffff0000, v71
    v_pk_add_f32 v[106:107], v[106:107], v[26:27]
    s_waitcnt vmcnt(23)
    v_lshlrev_b32 v24, 16, v72
    v_and_b32 v25, 0xffff0000, v72
    v_pk_add_f32 v[100:101], v[100:101], v[24:25]
    v_lshlrev_b32 v26, 16, v73
    v_and_b32 v27, 0xffff0000, v73
    v_pk_add_f32 v[102:103], v[102:103], v[26:27]
    v_lshlrev_b32 v24, 16, v74
    v_and_b32 v25, 0xffff0000, v74
    v_pk_add_f32 v[104:105], v[104:105], v[24:25]
    v_lshlrev_b32 v26, 16, v75
    v_and_b32 v27, 0xffff0000, v75
    v_pk_add_f32 v[106:107], v[106:107], v[26:27]
    s_waitcnt vmcnt(22)
    v_lshlrev_b32 v24, 16, v76
    v_and_b32 v25, 0xffff0000, v76
    v_pk_add_f32 v[100:101], v[100:101], v[24:25]
    v_lshlrev_b32 v26, 16, v77
    v_and_b32 v27, 0xffff0000, v77
    v_pk_add_f32 v[102:103], v[102:103], v[26:27]
    v_lshlrev_b32 v24, 16, v78
    v_and_b32 v25, 0xffff0000, v78
    v_pk_add_f32 v[104:105], v[104:105], v[24:25]
    v_lshlrev_b32 v26, 16, v79
    v_and_b32 v27, 0xffff0000, v79
    v_pk_add_f32 v[106:107], v[106:107], v[26:27]
    s_waitcnt vmcnt(21)
    v_lshlrev_b32 v24, 16, v80
    v_and_b32 v25, 0xffff0000, v80
    v_pk_add_f32 v[100:101], v[100:101], v[24:25]
    v_lshlrev_b32 v26, 16, v81
    v_and_b32 v27, 0xffff0000, v81
    v_pk_add_f32 v[102:103], v[102:103], v[26:27]
    v_lshlrev_b32 v24, 16, v82
    v_and_b32 v25, 0xffff0000, v82
    v_pk_add_f32 v[104:105], v[104:105], v[24:25]
    v_lshlrev_b32 v26, 16, v83
    v_and_b32 v27, 0xffff0000, v83
    v_pk_add_f32 v[106:107], v[106:107], v[26:27]
    s_waitcnt vmcnt(20)
    v_lshlrev_b32 v24, 16, v84
    v_and_b32 v25, 0xffff0000, v84
    v_pk_add_f32 v[100:101], v[100:101], v[24:25]
    v_lshlrev_b32 v26, 16, v85
    v_and_b32 v27, 0xffff0000, v85
    v_pk_add_f32 v[102:103], v[102:103], v[26:27]
    v_lshlrev_b32 v24, 16, v86
    v_and_b32 v25, 0xffff0000, v86
    v_pk_add_f32 v[104:105], v[104:105], v[24:25]
    v_lshlrev_b32 v26, 16, v87
    v_and_b32 v27, 0xffff0000, v87
    v_pk_add_f32 v[106:107], v[106:107], v[26:27]
    s_waitcnt vmcnt(19)
    v_lshlrev_b32 v24, 16, v88
    v_and_b32 v25, 0xffff0000, v88
    v_pk_add_f32 v[100:101], v[100:101], v[24:25]
    v_lshlrev_b32 v26, 16, v89
    v_and_b32 v27, 0xffff0000, v89
    v_pk_add_f32 v[102:103], v[102:103], v[26:27]
    v_lshlrev_b32 v24, 16, v90
    v_and_b32 v25, 0xffff0000, v90
    v_pk_add_f32 v[104:105], v[104:105], v[24:25]
    v_lshlrev_b32 v26, 16, v91
    v_and_b32 v27, 0xffff0000, v91
    v_pk_add_f32 v[106:107], v[106:107], v[26:27]
    s_waitcnt vmcnt(18)
    v_lshlrev_b32 v24, 16, v92
    v_and_b32 v25, 0xffff0000, v92
    v_pk_add_f32 v[100:101], v[100:101], v[24:25]
    v_lshlrev_b32 v26, 16, v93
    v_and_b32 v27, 0xffff0000, v93
    v_pk_add_f32 v[102:103], v[102:103], v[26:27]
    v_lshlrev_b32 v24, 16, v94
    v_and_b32 v25, 0xffff0000, v94
    v_pk_add_f32 v[104:105], v[104:105], v[24:25]
    v_lshlrev_b32 v26, 16, v95
    v_and_b32 v27, 0xffff0000, v95
    v_pk_add_f32 v[106:107], v[106:107], v[26:27]
    s_waitcnt vmcnt(17)
    v_permlane32_swap_b32 v96, v98
    v_permlane32_swap_b32 v97, v99
    s_nop 1
    v_lshlrev_b32 v24, 16, v96
    v_and_b32 v25, 0xffff0000, v96
    v_pk_add_f32 v[100:101], v[100:101], v[24:25]
    v_lshlrev_b32 v26, 16, v97
    v_and_b32 v27, 0xffff0000, v97
    v_pk_add_f32 v[102:103], v[102:103], v[26:27]
    v_lshlrev_b32 v24, 16, v98
    v_and_b32 v25, 0xffff0000, v98
    v_pk_add_f32 v[104:105], v[104:105], v[24:25]
    v_lshlrev_b32 v26, 16, v99
    v_and_b32 v27, 0xffff0000, v99
    v_pk_add_f32 v[106:107], v[106:107], v[26:27]
    v_cvt_pk_bf16_f32 v96, v100, v101
    v_cvt_pk_bf16_f32 v97, v102, v103
    v_cvt_pk_bf16_f32 v98, v104, v105
    v_cvt_pk_bf16_f32 v99, v106, v107
    s_nop 1
    v_permlane32_swap_b32 v96, v98
    v_permlane32_swap_b32 v97, v99
    s_nop 1
    buffer_store_dwordx4 v[96:99], v21, s[8:11], s41 offen
    s_waitcnt vmcnt(17)
    v_lshlrev_b32 v180, 16, v112
    v_and_b32 v181, 0xffff0000, v112
    v_lshlrev_b32 v182, 16, v113
    v_and_b32 v183, 0xffff0000, v113
    v_lshlrev_b32 v184, 16, v114
    v_and_b32 v185, 0xffff0000, v114
    v_lshlrev_b32 v186, 16, v115
    v_and_b32 v187, 0xffff0000, v115
    s_waitcnt vmcnt(16)
    v_lshlrev_b32 v24, 16, v116
    v_and_b32 v25, 0xffff0000, v116
    v_pk_add_f32 v[180:181], v[180:181], v[24:25]
    v_lshlrev_b32 v26, 16, v117
    v_and_b32 v27, 0xffff0000, v117
    v_pk_add_f32 v[182:183], v[182:183], v[26:27]
    v_lshlrev_b32 v24, 16, v118
    v_and_b32 v25, 0xffff0000, v118
    v_pk_add_f32 v[184:185], v[184:185], v[24:25]
    v_lshlrev_b32 v26, 16, v119
    v_and_b32 v27, 0xffff0000, v119
    v_pk_add_f32 v[186:187], v[186:187], v[26:27]
    s_waitcnt vmcnt(15)
    v_lshlrev_b32 v24, 16, v120
    v_and_b32 v25, 0xffff0000, v120
    v_pk_add_f32 v[180:181], v[180:181], v[24:25]
    v_lshlrev_b32 v26, 16, v121
    v_and_b32 v27, 0xffff0000, v121
    v_pk_add_f32 v[182:183], v[182:183], v[26:27]
    v_lshlrev_b32 v24, 16, v122
    v_and_b32 v25, 0xffff0000, v122
    v_pk_add_f32 v[184:185], v[184:185], v[24:25]
    v_lshlrev_b32 v26, 16, v123
    v_and_b32 v27, 0xffff0000, v123
    v_pk_add_f32 v[186:187], v[186:187], v[26:27]
    s_waitcnt vmcnt(14)
    v_lshlrev_b32 v24, 16, v124
    v_and_b32 v25, 0xffff0000, v124
    v_pk_add_f32 v[180:181], v[180:181], v[24:25]
    v_lshlrev_b32 v26, 16, v125
    v_and_b32 v27, 0xffff0000, v125
    v_pk_add_f32 v[182:183], v[182:183], v[26:27]
    v_lshlrev_b32 v24, 16, v126
    v_and_b32 v25, 0xffff0000, v126
    v_pk_add_f32 v[184:185], v[184:185], v[24:25]
    v_lshlrev_b32 v26, 16, v127
    v_and_b32 v27, 0xffff0000, v127
    v_pk_add_f32 v[186:187], v[186:187], v[26:27]
    s_waitcnt vmcnt(13)
    v_lshlrev_b32 v24, 16, v128
    v_and_b32 v25, 0xffff0000, v128
    v_pk_add_f32 v[180:181], v[180:181], v[24:25]
    v_lshlrev_b32 v26, 16, v129
    v_and_b32 v27, 0xffff0000, v129
    v_pk_add_f32 v[182:183], v[182:183], v[26:27]
    v_lshlrev_b32 v24, 16, v130
    v_and_b32 v25, 0xffff0000, v130
    v_pk_add_f32 v[184:185], v[184:185], v[24:25]
    v_lshlrev_b32 v26, 16, v131
    v_and_b32 v27, 0xffff0000, v131
    v_pk_add_f32 v[186:187], v[186:187], v[26:27]
    s_waitcnt vmcnt(12)
    v_lshlrev_b32 v24, 16, v132
    v_and_b32 v25, 0xffff0000, v132
    v_pk_add_f32 v[180:181], v[180:181], v[24:25]
    v_lshlrev_b32 v26, 16, v133
    v_and_b32 v27, 0xffff0000, v133
    v_pk_add_f32 v[182:183], v[182:183], v[26:27]
    v_lshlrev_b32 v24, 16, v134
    v_and_b32 v25, 0xffff0000, v134
    v_pk_add_f32 v[184:185], v[184:185], v[24:25]
    v_lshlrev_b32 v26, 16, v135
    v_and_b32 v27, 0xffff0000, v135
    v_pk_add_f32 v[186:187], v[186:187], v[26:27]
    s_waitcnt vmcnt(11)
    v_lshlrev_b32 v24, 16, v136
    v_and_b32 v25, 0xffff0000, v136
    v_pk_add_f32 v[180:181], v[180:181], v[24:25]
    v_lshlrev_b32 v26, 16, v137
    v_and_b32 v27, 0xffff0000, v137
    v_pk_add_f32 v[182:183], v[182:183], v[26:27]
    v_lshlrev_b32 v24, 16, v138
    v_and_b32 v25, 0xffff0000, v138
    v_pk_add_f32 v[184:185], v[184:185], v[24:25]
    v_lshlrev_b32 v26, 16, v139
    v_and_b32 v27, 0xffff0000, v139
    v_pk_add_f32 v[186:187], v[186:187], v[26:27]
    s_waitcnt vmcnt(10)
    v_lshlrev_b32 v24, 16, v140
    v_and_b32 v25, 0xffff0000, v140
    v_pk_add_f32 v[180:181], v[180:181], v[24:25]
    v_lshlrev_b32 v26, 16, v141
    v_and_b32 v27, 0xffff0000, v141
    v_pk_add_f32 v[182:183], v[182:183], v[26:27]
    v_lshlrev_b32 v24, 16, v142
    v_and_b32 v25, 0xffff0000, v142
    v_pk_add_f32 v[184:185], v[184:185], v[24:25]
    v_lshlrev_b32 v26, 16, v143
    v_and_b32 v27, 0xffff0000, v143
    v_pk_add_f32 v[186:187], v[186:187], v[26:27]
    s_waitcnt vmcnt(9)
    v_lshlrev_b32 v24, 16, v144
    v_and_b32 v25, 0xffff0000, v144
    v_pk_add_f32 v[180:181], v[180:181], v[24:25]
    v_lshlrev_b32 v26, 16, v145
    v_and_b32 v27, 0xffff0000, v145
    v_pk_add_f32 v[182:183], v[182:183], v[26:27]
    v_lshlrev_b32 v24, 16, v146
    v_and_b32 v25, 0xffff0000, v146
    v_pk_add_f32 v[184:185], v[184:185], v[24:25]
    v_lshlrev_b32 v26, 16, v147
    v_and_b32 v27, 0xffff0000, v147
    v_pk_add_f32 v[186:187], v[186:187], v[26:27]
    s_waitcnt vmcnt(8)
    v_lshlrev_b32 v24, 16, v148
    v_and_b32 v25, 0xffff0000, v148
    v_pk_add_f32 v[180:181], v[180:181], v[24:25]
    v_lshlrev_b32 v26, 16, v149
    v_and_b32 v27, 0xffff0000, v149
    v_pk_add_f32 v[182:183], v[182:183], v[26:27]
    v_lshlrev_b32 v24, 16, v150
    v_and_b32 v25, 0xffff0000, v150
    v_pk_add_f32 v[184:185], v[184:185], v[24:25]
    v_lshlrev_b32 v26, 16, v151
    v_and_b32 v27, 0xffff0000, v151
    v_pk_add_f32 v[186:187], v[186:187], v[26:27]
    s_waitcnt vmcnt(7)
    v_lshlrev_b32 v24, 16, v152
    v_and_b32 v25, 0xffff0000, v152
    v_pk_add_f32 v[180:181], v[180:181], v[24:25]
    v_lshlrev_b32 v26, 16, v153
    v_and_b32 v27, 0xffff0000, v153
    v_pk_add_f32 v[182:183], v[182:183], v[26:27]
    v_lshlrev_b32 v24, 16, v154
    v_and_b32 v25, 0xffff0000, v154
    v_pk_add_f32 v[184:185], v[184:185], v[24:25]
    v_lshlrev_b32 v26, 16, v155
    v_and_b32 v27, 0xffff0000, v155
    v_pk_add_f32 v[186:187], v[186:187], v[26:27]
    s_waitcnt vmcnt(6)
    v_lshlrev_b32 v24, 16, v156
    v_and_b32 v25, 0xffff0000, v156
    v_pk_add_f32 v[180:181], v[180:181], v[24:25]
    v_lshlrev_b32 v26, 16, v157
    v_and_b32 v27, 0xffff0000, v157
    v_pk_add_f32 v[182:183], v[182:183], v[26:27]
    v_lshlrev_b32 v24, 16, v158
    v_and_b32 v25, 0xffff0000, v158
    v_pk_add_f32 v[184:185], v[184:185], v[24:25]
    v_lshlrev_b32 v26, 16, v159
    v_and_b32 v27, 0xffff0000, v159
    v_pk_add_f32 v[186:187], v[186:187], v[26:27]
    s_waitcnt vmcnt(5)
    v_lshlrev_b32 v24, 16, v160
    v_and_b32 v25, 0xffff0000, v160
    v_pk_add_f32 v[180:181], v[180:181], v[24:25]
    v_lshlrev_b32 v26, 16, v161
    v_and_b32 v27, 0xffff0000, v161
    v_pk_add_f32 v[182:183], v[182:183], v[26:27]
    v_lshlrev_b32 v24, 16, v162
    v_and_b32 v25, 0xffff0000, v162
    v_pk_add_f32 v[184:185], v[184:185], v[24:25]
    v_lshlrev_b32 v26, 16, v163
    v_and_b32 v27, 0xffff0000, v163
    v_pk_add_f32 v[186:187], v[186:187], v[26:27]
    s_waitcnt vmcnt(4)
    v_lshlrev_b32 v24, 16, v164
    v_and_b32 v25, 0xffff0000, v164
    v_pk_add_f32 v[180:181], v[180:181], v[24:25]
    v_lshlrev_b32 v26, 16, v165
    v_and_b32 v27, 0xffff0000, v165
    v_pk_add_f32 v[182:183], v[182:183], v[26:27]
    v_lshlrev_b32 v24, 16, v166
    v_and_b32 v25, 0xffff0000, v166
    v_pk_add_f32 v[184:185], v[184:185], v[24:25]
    v_lshlrev_b32 v26, 16, v167
    v_and_b32 v27, 0xffff0000, v167
    v_pk_add_f32 v[186:187], v[186:187], v[26:27]
    s_waitcnt vmcnt(3)
    v_lshlrev_b32 v24, 16, v168
    v_and_b32 v25, 0xffff0000, v168
    v_pk_add_f32 v[180:181], v[180:181], v[24:25]
    v_lshlrev_b32 v26, 16, v169
    v_and_b32 v27, 0xffff0000, v169
    v_pk_add_f32 v[182:183], v[182:183], v[26:27]
    v_lshlrev_b32 v24, 16, v170
    v_and_b32 v25, 0xffff0000, v170
    v_pk_add_f32 v[184:185], v[184:185], v[24:25]
    v_lshlrev_b32 v26, 16, v171
    v_and_b32 v27, 0xffff0000, v171
    v_pk_add_f32 v[186:187], v[186:187], v[26:27]
    s_waitcnt vmcnt(2)
    v_lshlrev_b32 v24, 16, v172
    v_and_b32 v25, 0xffff0000, v172
    v_pk_add_f32 v[180:181], v[180:181], v[24:25]
    v_lshlrev_b32 v26, 16, v173
    v_and_b32 v27, 0xffff0000, v173
    v_pk_add_f32 v[182:183], v[182:183], v[26:27]
    v_lshlrev_b32 v24, 16, v174
    v_and_b32 v25, 0xffff0000, v174
    v_pk_add_f32 v[184:185], v[184:185], v[24:25]
    v_lshlrev_b32 v26, 16, v175
    v_and_b32 v27, 0xffff0000, v175
    v_pk_add_f32 v[186:187], v[186:187], v[26:27]
    s_waitcnt vmcnt(1)
    v_permlane32_swap_b32 v176, v178
    v_permlane32_swap_b32 v177, v179
    s_nop 1
    v_lshlrev_b32 v24, 16, v176
    v_and_b32 v25, 0xffff0000, v176
    v_pk_add_f32 v[180:181], v[180:181], v[24:25]
    v_lshlrev_b32 v26, 16, v177
    v_and_b32 v27, 0xffff0000, v177
    v_pk_add_f32 v[182:183], v[182:183], v[26:27]
    v_lshlrev_b32 v24, 16, v178
    v_and_b32 v25, 0xffff0000, v178
    v_pk_add_f32 v[184:185], v[184:185], v[24:25]
    v_lshlrev_b32 v26, 16, v179
    v_and_b32 v27, 0xffff0000, v179
    v_pk_add_f32 v[186:187], v[186:187], v[26:27]
    v_cvt_pk_bf16_f32 v176, v180, v181
    v_cvt_pk_bf16_f32 v177, v182, v183
    v_cvt_pk_bf16_f32 v178, v184, v185
    v_cvt_pk_bf16_f32 v179, v186, v187
    s_nop 1
    v_permlane32_swap_b32 v176, v178
    v_permlane32_swap_b32 v177, v179
    s_nop 1
    buffer_store_dwordx4 v[176:179], v21, s[8:11], s44 offen
    s_branch L_k2_r2
L_k2_r1only:
    buffer_load_dwordx4 v[32:35], v2, s[88:91], s40 offen sc1
    s_add_u32 s40, s40, 1835008
    buffer_load_dwordx4 v[36:39], v2, s[88:91], s40 offen sc1
    s_add_u32 s40, s40, 1835008
    buffer_load_dwordx4 v[40:43], v2, s[88:91], s40 offen sc1
    s_add_u32 s40, s40, 1835008
    buffer_load_dwordx4 v[44:47], v2, s[88:91], s40 offen sc1
    s_add_u32 s40, s40, 1835008
    buffer_load_dwordx4 v[48:51], v2, s[88:91], s40 offen sc1
    s_add_u32 s40, s40, 1835008
    buffer_load_dwordx4 v[52:55], v2, s[88:91], s40 offen sc1
    s_add_u32 s40, s40, 1835008
    buffer_load_dwordx4 v[56:59], v2, s[88:91], s40 offen sc1
    s_add_u32 s40, s40, 1835008
    buffer_load_dwordx4 v[60:63], v2, s[88:91], s40 offen sc1
    s_add_u32 s40, s40, 1835008
    buffer_load_dwordx4 v[64:67], v2, s[88:91], s40 offen sc1
    s_add_u32 s40, s40, 1835008
    buffer_load_dwordx4 v[68:71], v2, s[88:91], s40 offen sc1
    s_add_u32 s40, s40, 1835008
    buffer_load_dwordx4 v[72:75], v2, s[88:91], s40 offen sc1
    s_add_u32 s40, s40, 1835008
    buffer_load_dwordx4 v[76:79], v2, s[88:91], s40 offen sc1
    s_add_u32 s40, s40, 1835008
    buffer_load_dwordx4 v[80:83], v2, s[88:91], s40 offen sc1
    s_add_u32 s40, s40, 1835008
    buffer_load_dwordx4 v[84:87], v2, s[88:91], s40 offen sc1
    s_add_u32 s40, s40, 1835008
    buffer_load_dwordx4 v[88:91], v2, s[88:91], s40 offen sc1
    s_add_u32 s40, s40, 1835008
    buffer_load_dwordx4 v[92:95], v2, s[88:91], s40 offen sc1
    buffer_load_dwordx4 v[96:99], v21, s[20:23], s41 offen
    s_waitcnt vmcnt(16)
    v_lshlrev_b32 v100, 16, v32
    v_and_b32 v101, 0xffff0000, v32
    v_lshlrev_b32 v102, 16, v33
    v_and_b32 v103, 0xffff0000, v33
    v_lshlrev_b32 v104, 16, v34
    v_and_b32 v105, 0xffff0000, v34
    v_lshlrev_b32 v106, 16, v35
    v_and_b32 v107, 0xffff0000, v35
    s_waitcnt vmcnt(15)
    v_lshlrev_b32 v24, 16, v36
    v_and_b32 v25, 0xffff0000, v36
    v_pk_add_f32 v[100:101], v[100:101], v[24:25]
    v_lshlrev_b32 v26, 16, v37
    v_and_b32 v27, 0xffff0000, v37
    v_pk_add_f32 v[102:103], v[102:103], v[26:27]
    v_lshlrev_b32 v24, 16, v38
    v_and_b32 v25, 0xffff0000, v38
    v_pk_add_f32 v[104:105], v[104:105], v[24:25]
    v_lshlrev_b32 v26, 16, v39
    v_and_b32 v27, 0xffff0000, v39
    v_pk_add_f32 v[106:107], v[106:107], v[26:27]
    s_waitcnt vmcnt(14)
    v_lshlrev_b32 v24, 16, v40
    v_and_b32 v25, 0xffff0000, v40
    v_pk_add_f32 v[100:101], v[100:101], v[24:25]
    v_lshlrev_b32 v26, 16, v41
    v_and_b32 v27, 0xffff0000, v41
    v_pk_add_f32 v[102:103], v[102:103], v[26:27]
    v_lshlrev_b32 v24, 16, v42
    v_and_b32 v25, 0xffff0000, v42
    v_pk_add_f32 v[104:105], v[104:105], v[24:25]
    v_lshlrev_b32 v26, 16, v43
    v_and_b32 v27, 0xffff0000, v43
    v_pk_add_f32 v[106:107], v[106:107], v[26:27]
    s_waitcnt vmcnt(13)
    v_lshlrev_b32 v24, 16, v44
    v_and_b32 v25, 0xffff0000, v44
    v_pk_add_f32 v[100:101], v[100:101], v[24:25]
    v_lshlrev_b32 v26, 16, v45
    v_and_b32 v27, 0xffff0000, v45
    v_pk_add_f32 v[102:103], v[102:103], v[26:27]
    v_lshlrev_b32 v24, 16, v46
    v_and_b32 v25, 0xffff0000, v46
    v_pk_add_f32 v[104:105], v[104:105], v[24:25]
    v_lshlrev_b32 v26, 16, v47
    v_and_b32 v27, 0xffff0000, v47
    v_pk_add_f32 v[106:107], v[106:107], v[26:27]
    s_waitcnt vmcnt(12)
    v_lshlrev_b32 v24, 16, v48
    v_and_b32 v25, 0xffff0000, v48
    v_pk_add_f32 v[100:101], v[100:101], v[24:25]
    v_lshlrev_b32 v26, 16, v49
    v_and_b32 v27, 0xffff0000, v49
    v_pk_add_f32 v[102:103], v[102:103], v[26:27]
    v_lshlrev_b32 v24, 16, v50
    v_and_b32 v25, 0xffff0000, v50
    v_pk_add_f32 v[104:105], v[104:105], v[24:25]
    v_lshlrev_b32 v26, 16, v51
    v_and_b32 v27, 0xffff0000, v51
    v_pk_add_f32 v[106:107], v[106:107], v[26:27]
    s_waitcnt vmcnt(11)
    v_lshlrev_b32 v24, 16, v52
    v_and_b32 v25, 0xffff0000, v52
    v_pk_add_f32 v[100:101], v[100:101], v[24:25]
    v_lshlrev_b32 v26, 16, v53
    v_and_b32 v27, 0xffff0000, v53
    v_pk_add_f32 v[102:103], v[102:103], v[26:27]
    v_lshlrev_b32 v24, 16, v54
    v_and_b32 v25, 0xffff0000, v54
    v_pk_add_f32 v[104:105], v[104:105], v[24:25]
    v_lshlrev_b32 v26, 16, v55
    v_and_b32 v27, 0xffff0000, v55
    v_pk_add_f32 v[106:107], v[106:107], v[26:27]
    s_waitcnt vmcnt(10)
    v_lshlrev_b32 v24, 16, v56
    v_and_b32 v25, 0xffff0000, v56
    v_pk_add_f32 v[100:101], v[100:101], v[24:25]
    v_lshlrev_b32 v26, 16, v57
    v_and_b32 v27, 0xffff0000, v57
    v_pk_add_f32 v[102:103], v[102:103], v[26:27]
    v_lshlrev_b32 v24, 16, v58
    v_and_b32 v25, 0xffff0000, v58
    v_pk_add_f32 v[104:105], v[104:105], v[24:25]
    v_lshlrev_b32 v26, 16, v59
    v_and_b32 v27, 0xffff0000, v59
    v_pk_add_f32 v[106:107], v[106:107], v[26:27]
    s_waitcnt vmcnt(9)
    v_lshlrev_b32 v24, 16, v60
    v_and_b32 v25, 0xffff0000, v60
    v_pk_add_f32 v[100:101], v[100:101], v[24:25]
    v_lshlrev_b32 v26, 16, v61
    v_and_b32 v27, 0xffff0000, v61
    v_pk_add_f32 v[102:103], v[102:103], v[26:27]
    v_lshlrev_b32 v24, 16, v62
    v_and_b32 v25, 0xffff0000, v62
    v_pk_add_f32 v[104:105], v[104:105], v[24:25]
    v_lshlrev_b32 v26, 16, v63
    v_and_b32 v27, 0xffff0000, v63
    v_pk_add_f32 v[106:107], v[106:107], v[26:27]
    s_waitcnt vmcnt(8)
    v_lshlrev_b32 v24, 16, v64
    v_and_b32 v25, 0xffff0000, v64
    v_pk_add_f32 v[100:101], v[100:101], v[24:25]
    v_lshlrev_b32 v26, 16, v65
    v_and_b32 v27, 0xffff0000, v65
    v_pk_add_f32 v[102:103], v[102:103], v[26:27]
    v_lshlrev_b32 v24, 16, v66
    v_and_b32 v25, 0xffff0000, v66
    v_pk_add_f32 v[104:105], v[104:105], v[24:25]
    v_lshlrev_b32 v26, 16, v67
    v_and_b32 v27, 0xffff0000, v67
    v_pk_add_f32 v[106:107], v[106:107], v[26:27]
    s_waitcnt vmcnt(7)
    v_lshlrev_b32 v24, 16, v68
    v_and_b32 v25, 0xffff0000, v68
    v_pk_add_f32 v[100:101], v[100:101], v[24:25]
    v_lshlrev_b32 v26, 16, v69
    v_and_b32 v27, 0xffff0000, v69
    v_pk_add_f32 v[102:103], v[102:103], v[26:27]
    v_lshlrev_b32 v24, 16, v70
    v_and_b32 v25, 0xffff0000, v70
    v_pk_add_f32 v[104:105], v[104:105], v[24:25]
    v_lshlrev_b32 v26, 16, v71
    v_and_b32 v27, 0xffff0000, v71
    v_pk_add_f32 v[106:107], v[106:107], v[26:27]
    s_waitcnt vmcnt(6)
    v_lshlrev_b32 v24, 16, v72
    v_and_b32 v25, 0xffff0000, v72
    v_pk_add_f32 v[100:101], v[100:101], v[24:25]
    v_lshlrev_b32 v26, 16, v73
    v_and_b32 v27, 0xffff0000, v73
    v_pk_add_f32 v[102:103], v[102:103], v[26:27]
    v_lshlrev_b32 v24, 16, v74
    v_and_b32 v25, 0xffff0000, v74
    v_pk_add_f32 v[104:105], v[104:105], v[24:25]
    v_lshlrev_b32 v26, 16, v75
    v_and_b32 v27, 0xffff0000, v75
    v_pk_add_f32 v[106:107], v[106:107], v[26:27]
    s_waitcnt vmcnt(5)
    v_lshlrev_b32 v24, 16, v76
    v_and_b32 v25, 0xffff0000, v76
    v_pk_add_f32 v[100:101], v[100:101], v[24:25]
    v_lshlrev_b32 v26, 16, v77
    v_and_b32 v27, 0xffff0000, v77
    v_pk_add_f32 v[102:103], v[102:103], v[26:27]
    v_lshlrev_b32 v24, 16, v78
    v_and_b32 v25, 0xffff0000, v78
    v_pk_add_f32 v[104:105], v[104:105], v[24:25]
    v_lshlrev_b32 v26, 16, v79
    v_and_b32 v27, 0xffff0000, v79
    v_pk_add_f32 v[106:107], v[106:107], v[26:27]
    s_waitcnt vmcnt(4)
    v_lshlrev_b32 v24, 16, v80
    v_and_b32 v25, 0xffff0000, v80
    v_pk_add_f32 v[100:101], v[100:101], v[24:25]
    v_lshlrev_b32 v26, 16, v81
    v_and_b32 v27, 0xffff0000, v81
    v_pk_add_f32 v[102:103], v[102:103], v[26:27]
    v_lshlrev_b32 v24, 16, v82
    v_and_b32 v25, 0xffff0000, v82
    v_pk_add_f32 v[104:105], v[104:105], v[24:25]
    v_lshlrev_b32 v26, 16, v83
    v_and_b32 v27, 0xffff0000, v83
    v_pk_add_f32 v[106:107], v[106:107], v[26:27]
    s_waitcnt vmcnt(3)
    v_lshlrev_b32 v24, 16, v84
    v_and_b32 v25, 0xffff0000, v84
    v_pk_add_f32 v[100:101], v[100:101], v[24:25]
    v_lshlrev_b32 v26, 16, v85
    v_and_b32 v27, 0xffff0000, v85
    v_pk_add_f32 v[102:103], v[102:103], v[26:27]
    v_lshlrev_b32 v24, 16, v86
    v_and_b32 v25, 0xffff0000, v86
    v_pk_add_f32 v[104:105], v[104:105], v[24:25]
    v_lshlrev_b32 v26, 16, v87
    v_and_b32 v27, 0xffff0000, v87
    v_pk_add_f32 v[106:107], v[106:107], v[26:27]
    s_waitcnt vmcnt(2)
    v_lshlrev_b32 v24, 16, v88
    v_and_b32 v25, 0xffff0000, v88
    v_pk_add_f32 v[100:101], v[100:101], v[24:25]
    v_lshlrev_b32 v26, 16, v89
    v_and_b32 v27, 0xffff0000, v89
    v_pk_add_f32 v[102:103], v[102:103], v[26:27]
    v_lshlrev_b32 v24, 16, v90
    v_and_b32 v25, 0xffff0000, v90
    v_pk_add_f32 v[104:105], v[104:105], v[24:25]
    v_lshlrev_b32 v26, 16, v91
    v_and_b32 v27, 0xffff0000, v91
    v_pk_add_f32 v[106:107], v[106:107], v[26:27]
    s_waitcnt vmcnt(1)
    v_lshlrev_b32 v24, 16, v92
    v_and_b32 v25, 0xffff0000, v92
    v_pk_add_f32 v[100:101], v[100:101], v[24:25]
    v_lshlrev_b32 v26, 16, v93
    v_and_b32 v27, 0xffff0000, v93
    v_pk_add_f32 v[102:103], v[102:103], v[26:27]
    v_lshlrev_b32 v24, 16, v94
    v_and_b32 v25, 0xffff0000, v94
    v_pk_add_f32 v[104:105], v[104:105], v[24:25]
    v_lshlrev_b32 v26, 16, v95
    v_and_b32 v27, 0xffff0000, v95
    v_pk_add_f32 v[106:107], v[106:107], v[26:27]
    s_waitcnt vmcnt(0)
    v_permlane32_swap_b32 v96, v98
    v_permlane32_swap_b32 v97, v99
    s_nop 1
    v_lshlrev_b32 v24, 16, v96
    v_and_b32 v25, 0xffff0000, v96
    v_pk_add_f32 v[100:101], v[100:101], v[24:25]
    v_lshlrev_b32 v26, 16, v97
    v_and_b32 v27, 0xffff0000, v97
    v_pk_add_f32 v[102:103], v[102:103], v[26:27]
    v_lshlrev_b32 v24, 16, v98
    v_and_b32 v25, 0xffff0000, v98
    v_pk_add_f32 v[104:105], v[104:105], v[24:25]
    v_lshlrev_b32 v26, 16, v99
    v_and_b32 v27, 0xffff0000, v99
    v_pk_add_f32 v[106:107], v[106:107], v[26:27]
    v_cvt_pk_bf16_f32 v96, v100, v101
    v_cvt_pk_bf16_f32 v97, v102, v103
    v_cvt_pk_bf16_f32 v98, v104, v105
    v_cvt_pk_bf16_f32 v99, v106, v107
    s_nop 1
    v_permlane32_swap_b32 v96, v98
    v_permlane32_swap_b32 v97, v99
    s_nop 1
    buffer_store_dwordx4 v[96:99], v21, s[8:11], s41 offen
L_k2_r2:
    s_cmp_ge_u32 s54, 112
    s_cbranch_scc1 L_k2_rdone
    s_mov_b32 s6, 0
L_k2_rp2:
    buffer_load_dword v15, v14, s[60:63], s48 offen sc1
    s_waitcnt vmcnt(0)
    v_readfirstlane_b32 s7, v15
    s_nop 3
    s_cmp_ge_u32 s7, 16
    s_cbranch_scc1 L_k2_rp2_ok
    s_add_u32 s6, s6, 1
    s_cmp_ge_u32 s6, 0x80000
    s_cbranch_scc1 L_k2_rp2_ok
    s_sleep 4
    s_branch L_k2_rp2
L_k2_rp2_ok:
    buffer_load_dwordx4 v[32:35], v2, s[88:91], s46 offen sc1
    s_add_u32 s46, s46, 1835008
    buffer_load_dwordx4 v[36:39], v2, s[88:91], s46 offen sc1
    s_add_u32 s46, s46, 1835008
    buffer_load_dwordx4 v[40:43], v2, s[88:91], s46 offen sc1
    s_add_u32 s46, s46, 1835008
    buffer_load_dwordx4 v[44:47], v2, s[88:91], s46 offen sc1
    s_add_u32 s46, s46, 1835008
    buffer_load_dwordx4 v[48:51], v2, s[88:91], s46 offen sc1
    s_add_u32 s46, s46, 1835008
    buffer_load_dwordx4 v[52:55], v2, s[88:91], s46 offen sc1
    s_add_u32 s46, s46, 1835008
    buffer_load_dwordx4 v[56:59], v2, s[88:91], s46 offen sc1
    s_add_u32 s46, s46, 1835008
    buffer_load_dwordx4 v[60:63], v2, s[88:91], s46 offen sc1
    s_add_u32 s46, s46, 1835008
    buffer_load_dwordx4 v[64:67], v2, s[88:91], s46 offen sc1
    s_add_u32 s46, s46, 1835008
    buffer_load_dwordx4 v[68:71], v2, s[88:91], s46 offen sc1
    s_add_u32 s46, s46, 1835008
    buffer_load_dwordx4 v[72:75], v2, s[88:91], s46 offen sc1
    s_add_u32 s46, s46, 1835008
    buffer_load_dwordx4 v[76:79], v2, s[88:91], s46 offen sc1
    s_add_u32 s46, s46, 1835008
    buffer_load_dwordx4 v[80:83], v2, s[88:91], s46 offen sc1
    s_add_u32 s46, s46, 1835008
    buffer_load_dwordx4 v[84:87], v2, s[88:91], s46 offen sc1
    s_add_u32 s46, s46, 1835008
    buffer_load_dwordx4 v[88:91], v2, s[88:91], s46 offen sc1
    s_add_u32 s46, s46, 1835008
    buffer_load_dwordx4 v[92:95], v2, s[88:91], s46 offen sc1
    buffer_load_dwordx4 v[96:99], v21, s[20:23], s47 offen
    s_waitcnt vmcnt(16)
    v_lshlrev_b32 v100, 16, v32
    v_and_b32 v101, 0xffff0000, v32
    v_lshlrev_b32 v102, 16, v33
    v_and_b32 v103, 0xffff0000, v33
    v_lshlrev_b32 v104, 16, v34
    v_and_b32 v105, 0xffff0000, v34
    v_lshlrev_b32 v106, 16, v35
    v_and_b32 v107, 0xffff0000, v35
    s_waitcnt vmcnt(15)
    v_lshlrev_b32 v24, 16, v36
    v_and_b32 v25, 0xffff0000, v36
    v_pk_add_f32 v[100:101], v[100:101], v[24:25]
    v_lshlrev_b32 v26, 16, v37
    v_and_b32 v27, 0xffff0000, v37
    v_pk_add_f32 v[102:103], v[102:103], v[26:27]
    v_lshlrev_b32 v24, 16, v38
    v_and_b32 v25, 0xffff0000, v38
    v_pk_add_f32 v[104:105], v[104:105], v[24:25]
    v_lshlrev_b32 v26, 16, v39
    v_and_b32 v27, 0xffff0000, v39
    v_pk_add_f32 v[106:107], v[106:107], v[26:27]
    s_waitcnt vmcnt(14)
    v_lshlrev_b32 v24, 16, v40
    v_and_b32 v25, 0xffff0000, v40
    v_pk_add_f32 v[100:101], v[100:101], v[24:25]
    v_lshlrev_b32 v26, 16, v41
    v_and_b32 v27, 0xffff0000, v41
    v_pk_add_f32 v[102:103], v[102:103], v[26:27]
    v_lshlrev_b32 v24, 16, v42
    v_and_b32 v25, 0xffff0000, v42
    v_pk_add_f32 v[104:105], v[104:105], v[24:25]
    v_lshlrev_b32 v26, 16, v43
    v_and_b32 v27, 0xffff0000, v43
    v_pk_add_f32 v[106:107], v[106:107], v[26:27]
    s_waitcnt vmcnt(13)
    v_lshlrev_b32 v24, 16, v44
    v_and_b32 v25, 0xffff0000, v44
    v_pk_add_f32 v[100:101], v[100:101], v[24:25]
    v_lshlrev_b32 v26, 16, v45
    v_and_b32 v27, 0xffff0000, v45
    v_pk_add_f32 v[102:103], v[102:103], v[26:27]
    v_lshlrev_b32 v24, 16, v46
    v_and_b32 v25, 0xffff0000, v46
    v_pk_add_f32 v[104:105], v[104:105], v[24:25]
    v_lshlrev_b32 v26, 16, v47
    v_and_b32 v27, 0xffff0000, v47
    v_pk_add_f32 v[106:107], v[106:107], v[26:27]
    s_waitcnt vmcnt(12)
    v_lshlrev_b32 v24, 16, v48
    v_and_b32 v25, 0xffff0000, v48
    v_pk_add_f32 v[100:101], v[100:101], v[24:25]
    v_lshlrev_b32 v26, 16, v49
    v_and_b32 v27, 0xffff0000, v49
    v_pk_add_f32 v[102:103], v[102:103], v[26:27]
    v_lshlrev_b32 v24, 16, v50
    v_and_b32 v25, 0xffff0000, v50
    v_pk_add_f32 v[104:105], v[104:105], v[24:25]
    v_lshlrev_b32 v26, 16, v51
    v_and_b32 v27, 0xffff0000, v51
    v_pk_add_f32 v[106:107], v[106:107], v[26:27]
    s_waitcnt vmcnt(11)
    v_lshlrev_b32 v24, 16, v52
    v_and_b32 v25, 0xffff0000, v52
    v_pk_add_f32 v[100:101], v[100:101], v[24:25]
    v_lshlrev_b32 v26, 16, v53
    v_and_b32 v27, 0xffff0000, v53
    v_pk_add_f32 v[102:103], v[102:103], v[26:27]
    v_lshlrev_b32 v24, 16, v54
    v_and_b32 v25, 0xffff0000, v54
    v_pk_add_f32 v[104:105], v[104:105], v[24:25]
    v_lshlrev_b32 v26, 16, v55
    v_and_b32 v27, 0xffff0000, v55
    v_pk_add_f32 v[106:107], v[106:107], v[26:27]
    s_waitcnt vmcnt(10)
    v_lshlrev_b32 v24, 16, v56
    v_and_b32 v25, 0xffff0000, v56
    v_pk_add_f32 v[100:101], v[100:101], v[24:25]
    v_lshlrev_b32 v26, 16, v57
    v_and_b32 v27, 0xffff0000, v57
    v_pk_add_f32 v[102:103], v[102:103], v[26:27]
    v_lshlrev_b32 v24, 16, v58
    v_and_b32 v25, 0xffff0000, v58
    v_pk_add_f32 v[104:105], v[104:105], v[24:25]
    v_lshlrev_b32 v26, 16, v59
    v_and_b32 v27, 0xffff0000, v59
    v_pk_add_f32 v[106:107], v[106:107], v[26:27]
    s_waitcnt vmcnt(9)
    v_lshlrev_b32 v24, 16, v60
    v_and_b32 v25, 0xffff0000, v60
    v_pk_add_f32 v[100:101], v[100:101], v[24:25]
    v_lshlrev_b32 v26, 16, v61
    v_and_b32 v27, 0xffff0000, v61
    v_pk_add_f32 v[102:103], v[102:103], v[26:27]
    v_lshlrev_b32 v24, 16, v62
    v_and_b32 v25, 0xffff0000, v62
    v_pk_add_f32 v[104:105], v[104:105], v[24:25]
    v_lshlrev_b32 v26, 16, v63
    v_and_b32 v27, 0xffff0000, v63
    v_pk_add_f32 v[106:107], v[106:107], v[26:27]
    s_waitcnt vmcnt(8)
    v_lshlrev_b32 v24, 16, v64
    v_and_b32 v25, 0xffff0000, v64
    v_pk_add_f32 v[100:101], v[100:101], v[24:25]
    v_lshlrev_b32 v26, 16, v65
    v_and_b32 v27, 0xffff0000, v65
    v_pk_add_f32 v[102:103], v[102:103], v[26:27]
    v_lshlrev_b32 v24, 16, v66
    v_and_b32 v25, 0xffff0000, v66
    v_pk_add_f32 v[104:105], v[104:105], v[24:25]
    v_lshlrev_b32 v26, 16, v67
    v_and_b32 v27, 0xffff0000, v67
    v_pk_add_f32 v[106:107], v[106:107], v[26:27]
    s_waitcnt vmcnt(7)
    v_lshlrev_b32 v24, 16, v68
    v_and_b32 v25, 0xffff0000, v68
    v_pk_add_f32 v[100:101], v[100:101], v[24:25]
    v_lshlrev_b32 v26, 16, v69
    v_and_b32 v27, 0xffff0000, v69
    v_pk_add_f32 v[102:103], v[102:103], v[26:27]
    v_lshlrev_b32 v24, 16, v70
    v_and_b32 v25, 0xffff0000, v70
    v_pk_add_f32 v[104:105], v[104:105], v[24:25]
    v_lshlrev_b32 v26, 16, v71
    v_and_b32 v27, 0xffff0000, v71
    v_pk_add_f32 v[106:107], v[106:107], v[26:27]
    s_waitcnt vmcnt(6)
    v_lshlrev_b32 v24, 16, v72
    v_and_b32 v25, 0xffff0000, v72
    v_pk_add_f32 v[100:101], v[100:101], v[24:25]
    v_lshlrev_b32 v26, 16, v73
    v_and_b32 v27, 0xffff0000, v73
    v_pk_add_f32 v[102:103], v[102:103], v[26:27]
    v_lshlrev_b32 v24, 16, v74
    v_and_b32 v25, 0xffff0000, v74
    v_pk_add_f32 v[104:105], v[104:105], v[24:25]
    v_lshlrev_b32 v26, 16, v75
    v_and_b32 v27, 0xffff0000, v75
    v_pk_add_f32 v[106:107], v[106:107], v[26:27]
    s_waitcnt vmcnt(5)
    v_lshlrev_b32 v24, 16, v76
    v_and_b32 v25, 0xffff0000, v76
    v_pk_add_f32 v[100:101], v[100:101], v[24:25]
    v_lshlrev_b32 v26, 16, v77
    v_and_b32 v27, 0xffff0000, v77
    v_pk_add_f32 v[102:103], v[102:103], v[26:27]
    v_lshlrev_b32 v24, 16, v78
    v_and_b32 v25, 0xffff0000, v78
    v_pk_add_f32 v[104:105], v[104:105], v[24:25]
    v_lshlrev_b32 v26, 16, v79
    v_and_b32 v27, 0xffff0000, v79
    v_pk_add_f32 v[106:107], v[106:107], v[26:27]
    s_waitcnt vmcnt(4)
    v_lshlrev_b32 v24, 16, v80
    v_and_b32 v25, 0xffff0000, v80
    v_pk_add_f32 v[100:101], v[100:101], v[24:25]
    v_lshlrev_b32 v26, 16, v81
    v_and_b32 v27, 0xffff0000, v81
    v_pk_add_f32 v[102:103], v[102:103], v[26:27]
    v_lshlrev_b32 v24, 16, v82
    v_and_b32 v25, 0xffff0000, v82
    v_pk_add_f32 v[104:105], v[104:105], v[24:25]
    v_lshlrev_b32 v26, 16, v83
    v_and_b32 v27, 0xffff0000, v83
    v_pk_add_f32 v[106:107], v[106:107], v[26:27]
    s_waitcnt vmcnt(3)
    v_lshlrev_b32 v24, 16, v84
    v_and_b32 v25, 0xffff0000, v84
    v_pk_add_f32 v[100:101], v[100:101], v[24:25]
    v_lshlrev_b32 v26, 16, v85
    v_and_b32 v27, 0xffff0000, v85
    v_pk_add_f32 v[102:103], v[102:103], v[26:27]
    v_lshlrev_b32 v24, 16, v86
    v_and_b32 v25, 0xffff0000, v86
    v_pk_add_f32 v[104:105], v[104:105], v[24:25]
    v_lshlrev_b32 v26, 16, v87
    v_and_b32 v27, 0xffff0000, v87
    v_pk_add_f32 v[106:107], v[106:107], v[26:27]
    s_waitcnt vmcnt(2)
    v_lshlrev_b32 v24, 16, v88
    v_and_b32 v25, 0xffff0000, v88
    v_pk_add_f32 v[100:101], v[100:101], v[24:25]
    v_lshlrev_b32 v26, 16, v89
    v_and_b32 v27, 0xffff0000, v89
    v_pk_add_f32 v[102:103], v[102:103], v[26:27]
    v_lshlrev_b32 v24, 16, v90
    v_and_b32 v25, 0xffff0000, v90
    v_pk_add_f32 v[104:105], v[104:105], v[24:25]
    v_lshlrev_b32 v26, 16, v91
    v_and_b32 v27, 0xffff0000, v91
    v_pk_add_f32 v[106:107], v[106:107], v[26:27]
    s_waitcnt vmcnt(1)
    v_lshlrev_b32 v24, 16, v92
    v_and_b32 v25, 0xffff0000, v92
    v_pk_add_f32 v[100:101], v[100:101], v[24:25]
    v_lshlrev_b32 v26, 16, v93
    v_and_b32 v27, 0xffff0000, v93
    v_pk_add_f32 v[102:103], v[102:103], v[26:27]
    v_lshlrev_b32 v24, 16, v94
    v_and_b32 v25, 0xffff0000, v94
    v_pk_add_f32 v[104:105], v[104:105], v[24:25]
    v_lshlrev_b32 v26, 16, v95
    v_and_b32 v27, 0xffff0000, v95
    v_pk_add_f32 v[106:107], v[106:107], v[26:27]
    s_waitcnt vmcnt(0)
    v_permlane32_swap_b32 v96, v98
    v_permlane32_swap_b32 v97, v99
    s_nop 1
    v_lshlrev_b32 v24, 16, v96
    v_and_b32 v25, 0xffff0000, v96
    v_pk_add_f32 v[100:101], v[100:101], v[24:25]
    v_lshlrev_b32 v26, 16, v97
    v_and_b32 v27, 0xffff0000, v97
    v_pk_add_f32 v[102:103], v[102:103], v[26:27]
    v_lshlrev_b32 v24, 16, v98
    v_and_b32 v25, 0xffff0000, v98
    v_pk_add_f32 v[104:105], v[104:105], v[24:25]
    v_lshlrev_b32 v26, 16, v99
    v_and_b32 v27, 0xffff0000, v99
    v_pk_add_f32 v[106:107], v[106:107], v[26:27]
    v_cvt_pk_bf16_f32 v96, v100, v101
    v_cvt_pk_bf16_f32 v97, v102, v103
    v_cvt_pk_bf16_f32 v98, v104, v105
    v_cvt_pk_bf16_f32 v99, v106, v107
    s_nop 1
    v_permlane32_swap_b32 v96, v98
    v_permlane32_swap_b32 v97, v99
    s_nop 1
    buffer_store_dwordx4 v[96:99], v21, s[8:11], s47 offen
L_k2_rdone:
L_k2_end:
    s_endpgm
L_k1_loopK_evt:
    s_cmp_eq_u32 s43, 16
    s_cbranch_scc1 L_k1_mid
    s_call_b64 s[6:7], L_k1_evt
    s_branch L_k1_loopK
L_k1_loopV_evt:
    s_cmp_eq_u32 s43, 16
    s_cbranch_scc1 L_k1_mid
    s_call_b64 s[6:7], L_k1_evt
    s_branch L_k1_loopV
L_k1_evt:
    s_cmp_eq_u32 s43, 14
    s_cbranch_scc1 L_k1_evt_sw
    s_cmp_ge_u32 s36, 2
    s_cbranch_scc1 L_k1_evt2
    s_cmp_eq_u32 s36, 0
    s_cbranch_scc0 L_k1_evt1
    s_getreg_b32 s54, hwreg(HW_REG_XCC_ID, 0, 3)
    s_lshl_b32 s54, s54, 3
    s_lshl_b64 s[4:5], 1, s54
    v_mov_b32 v252, s4
    v_mov_b32 v253, s5
    s_and_b32 s54, s2, 7
    s_lshl_b32 s54, s54, 3
    s_mov_b64 exec, 1
    buffer_atomic_add_x2 v[252:253], v29, s[60:63], s54 offen offset:192 sc1
    buffer_atomic_add v28, v29, s[60:63], 0 offen offset:128 sc1
    s_mov_b64 exec, -1
    s_setpc_b64 s[6:7]
L_k1_evt1:
    s_getpc_b64 s[4:5]
L_km_pc:
    s_sub_u32 s4, s4, L_km_pc-L_k1_mid
    s_subb_u32 s5, s5, 0
    s_lshr_b32 s54, s2, 3
    s_lshl_b32 s54, s54, 12
    v_lshlrev_b32 v24, 7, v1
    v_add_u32 v24, s54, v24
    v_min_u32 v24, L_km_codeend-L_k1_mid, v24
    s_mov_b32 exec_hi, 0
    global_load_dword v255, v24, s[4:5]
    s_mov_b32 exec_hi, -1
    s_setpc_b64 s[6:7]
L_k1_evt2:
    s_lshr_b32 s54, s2, 4
    s_mul_i32 s54, s54, 28
    s_mul_i32 s55, s38, 14
    s_add_u32 s54, s54, s55
    v_lshrrev_b32 v24, 2, v1
    v_add_u32 v24, s54, v24
    v_and_b32 v25, 3, v1
    v_lshlrev_b32 v26, 13, v24
    v_lshl_add_u32 v26, v25, 7, v26
    v_mul_u32_u24 v24, 3584, v24
    v_mul_u32_u24 v25, 84, v25
    v_add_u32 v24, v24, v25
    s_mov_b32 exec_hi, 0xffffff
    buffer_load_dword v255, v26, s[28:31], 0 offen
    buffer_load_dword v255, v24, s[20:23], 0 offen
    s_mov_b32 exec_hi, -1
    s_setpc_b64 s[6:7]
L_k1_evt_sw:
    buffer_load_dword v30, v29, s[60:63], 0 offen offset:128 sc1
    s_and_b32 s54, s2, 7
    s_lshl_b32 s54, s54, 3
    buffer_load_dwordx2 v[250:251], v29, s[60:63], s54 offen offset:192 sc1
    s_mov_b32 s8, s20
    s_mov_b32 s12, s28
    s_mov_b32 s9, s21
    s_mov_b32 s13, s29
    s_mov_b32 s10, s22
    s_mov_b32 s14, s30
    s_mov_b32 s39, 0
    s_mov_b32 s40, 0
    s_mov_b32 s64, 458752
    s_mov_b32 s52, -1
    v_lshrrev_b32 v24, 4, v1
    v_lshlrev_b32 v25, 2, v24
    v_and_b32 v26, 15, v1
    v_xor_b32 v25, v25, v26
    v_lshlrev_b32 v25, 4, v25
    s_lshl_b32 s54, s36, 5
    v_add_u32 v24, s54, v24
    v_mul_u32_u24 v24, 3584, v24
    v_add_u32 v2, v24, v25
    v_xor_b32 v25, 16, v25
    v_add_u32 v24, v24, v25
    v_add_u32 v3, 13312, v2
    v_add_u32 v4, 26624, v24
    v_add_u32 v5, 39936, v24
    v_add_u32 v6, 57344, v2
    v_add_u32 v7, 70656, v2
    v_add_u32 v8, 83968, v24
    v_add_u32 v9, 97280, v24
    s_setpc_b64 s[6:7]
L_k2_p0_evt:
    s_call_b64 s[98:99], L_k2_h0_evt
    s_branch L_k2_p0_evt_ret
L_k2_p0_resc:
    s_call_b64 s[98:99], L_k2_h0_resc
    s_branch L_k2_p0_resc_ret
L_k2_p1_evt:
    s_call_b64 s[98:99], L_k2_h1_evt
    s_branch L_k2_p1_evt_ret
L_k2_p1_resc:
    s_call_b64 s[98:99], L_k2_h1_resc
    s_branch L_k2_p1_resc_ret
L_k2_b0_evt:
    s_call_b64 s[98:99], L_k2_h0_evt
    s_branch L_k2_b0_evt_ret
L_k2_b0_resc:
    s_call_b64 s[98:99], L_k2_h0_resc
    s_branch L_k2_b0_resc_ret
L_k2_b1_evt:
    s_call_b64 s[98:99], L_k2_h1_evt
    s_branch L_k2_b1_evt_ret
L_k2_b1_resc:
    s_call_b64 s[98:99], L_k2_h1_resc
    s_cmp_lt_u32 s37, s86
    s_branch L_k2_b1_resc_ret
L_k2_f0_evt:
    s_call_b64 s[98:99], L_k2_h0_evt
    s_branch L_k2_f0_evt_ret
L_k2_f0_resc:
    s_call_b64 s[98:99], L_k2_h0_resc
    s_branch L_k2_f0_resc_ret
L_k2_h0_evt:
    s_bitcmp1_b64 s[82:83], s37
    s_cbranch_scc1 L_k2_h0_other
L_k2_h0_mask:
    s_lshl_b32 s52, s37, 5
    s_sub_u32 s52, s75, s52
    s_cmp_lt_i32 s52, 1
    s_cbranch_scc0 L_k2_h0_ret
    s_cmp_eq_u32 s52, 0
    s_cbranch_scc0 L_k2_h0_mk_full
    v_pk_add_f32 v[112:113], v[112:113], v[64:65]
    v_pk_add_f32 v[114:115], v[114:115], v[66:67]
    v_pk_add_f32 v[116:117], v[116:117], v[68:69]
    v_pk_add_f32 v[118:119], v[118:119], v[70:71]
    v_pk_add_f32 v[120:121], v[120:121], v[72:73]
    v_pk_add_f32 v[122:123], v[122:123], v[74:75]
    v_pk_add_f32 v[124:125], v[124:125], v[76:77]
    v_pk_add_f32 v[126:127], v[126:127], v[78:79]
    s_setpc_b64 s[98:99]
L_k2_h0_mk_full:
    v_mov_b64 v[112:113], v[58:59]
    v_mov_b64 v[114:115], v[58:59]
    v_mov_b64 v[116:117], v[58:59]
    v_mov_b64 v[118:119], v[58:59]
    v_mov_b64 v[120:121], v[58:59]
    v_mov_b64 v[122:123], v[58:59]
    v_mov_b64 v[124:125], v[58:59]
    v_mov_b64 v[126:127], v[58:59]
    s_setpc_b64 s[98:99]
L_k2_h0_ret:
    s_setpc_b64 s[98:99]
L_k2_h0_other:
    s_sub_u32 s53, s37, 2
    s_cmp_eq_u32 s53, s71
    s_cbranch_scc0 L_k2_h0_e1
    s_waitcnt vmcnt(16)
    s_lshl_b32 s53, 1, s85
    v_mov_b32 v16, s53
    s_mov_b64 exec, 1
    buffer_atomic_or v16, v14, s[60:63], s84 offen sc1
    s_mov_b64 exec, -1
    s_branch L_k2_h0_mask
L_k2_h0_e1:
    v_accvgpr_mov_b32 a0, a64
    v_accvgpr_mov_b32 a1, a65
    v_accvgpr_mov_b32 a2, a66
    v_accvgpr_mov_b32 a3, a67
    v_accvgpr_mov_b32 a4, a68
    v_accvgpr_mov_b32 a5, a69
    v_accvgpr_mov_b32 a6, a70
    v_accvgpr_mov_b32 a7, a71
    v_accvgpr_mov_b32 a8, a72
    v_accvgpr_mov_b32 a9, a73
    v_accvgpr_mov_b32 a10, a74
    v_accvgpr_mov_b32 a11, a75
    v_accvgpr_mov_b32 a12, a76
    v_accvgpr_mov_b32 a13, a77
    v_accvgpr_mov_b32 a14, a78
    v_accvgpr_mov_b32 a15, a79
    v_accvgpr_mov_b32 a16, a80
    v_accvgpr_mov_b32 a17, a81
    v_accvgpr_mov_b32 a18, a82
    v_accvgpr_mov_b32 a19, a83
    v_accvgpr_mov_b32 a20, a84
    v_accvgpr_mov_b32 a21, a85
    v_accvgpr_mov_b32 a22, a86
    v_accvgpr_mov_b32 a23, a87
    v_accvgpr_mov_b32 a24, a88
    v_accvgpr_mov_b32 a25, a89
    v_accvgpr_mov_b32 a26, a90
    v_accvgpr_mov_b32 a27, a91
    v_accvgpr_mov_b32 a28, a92
    v_accvgpr_mov_b32 a29, a93
    v_accvgpr_mov_b32 a30, a94
    v_accvgpr_mov_b32 a31, a95
    v_accvgpr_mov_b32 a32, a96
    v_accvgpr_mov_b32 a33, a97
    v_accvgpr_mov_b32 a34, a98
    v_accvgpr_mov_b32 a35, a99
    v_accvgpr_mov_b32 a36, a100
    v_accvgpr_mov_b32 a37, a101
    v_accvgpr_mov_b32 a38, a102
    v_accvgpr_mov_b32 a39, a103
    v_accvgpr_mov_b32 a40, a104
    v_accvgpr_mov_b32 a41, a105
    v_accvgpr_mov_b32 a42, a106
    v_accvgpr_mov_b32 a43, a107
    v_accvgpr_mov_b32 a44, a108
    v_accvgpr_mov_b32 a45, a109
    v_accvgpr_mov_b32 a46, a110
    v_accvgpr_mov_b32 a47, a111
    v_accvgpr_mov_b32 a48, a112
    v_accvgpr_mov_b32 a49, a113
    v_accvgpr_mov_b32 a50, a114
    v_accvgpr_mov_b32 a51, a115
    v_accvgpr_mov_b32 a52, a116
    v_accvgpr_mov_b32 a53, a117
    v_accvgpr_mov_b32 a54, a118
    v_accvgpr_mov_b32 a55, a119
    v_accvgpr_mov_b32 a56, a120
    v_accvgpr_mov_b32 a57, a121
    v_accvgpr_mov_b32 a58, a122
    v_accvgpr_mov_b32 a59, a123
    v_accvgpr_mov_b32 a60, a124
    v_accvgpr_mov_b32 a61, a125
    v_accvgpr_mov_b32 a62, a126
    v_accvgpr_mov_b32 a63, a127
    v_mov_b64 v[24:25], 0
    v_mov_b64 v[26:27], 0
    v_mov_b64 v[28:29], 0
    v_mov_b64 v[30:31], 0
    s_mov_b32 s50, 1
    s_branch L_k2_h0_mask
L_k2_h0_resc:
    s_mov_b32 s47, 0x41c00000
    v_max3_f32 v16, v112, v113, v114
    v_max3_f32 v16, v16, v115, v116
    v_max3_f32 v16, v16, v117, v118
    v_max_f32 v16, v16, v119
    v_max3_f32 v17, v120, v121, v122
    v_max3_f32 v17, v17, v123, v124
    v_max3_f32 v17, v17, v125, v126
    v_max_f32 v17, v17, v127
    v_mov_b32 v18, v16
    s_nop 1
    v_permlane16_swap_b32 v16, v18
    s_nop 1
    v_max_f32 v16, v16, v18
    v_mov_b32 v18, v16
    s_nop 1
    v_permlane32_swap_b32 v16, v18
    s_nop 1
    v_max_f32 v16, v16, v18
    v_mov_b32 v18, v17
    s_nop 1
    v_permlane16_swap_b32 v17, v18
    s_nop 1
    v_max_f32 v17, v17, v18
    v_mov_b32 v18, v17
    s_nop 1
    v_permlane32_swap_b32 v17, v18
    s_nop 1
    v_max_f32 v17, v17, v18
    v_max_f32 v16, 0, v16
    v_sub_f32 v20, 0, v16
    v_exp_f32 v20, v20
    v_add_f32 v32, v32, v16
    v_max_f32 v17, 0, v17
    v_sub_f32 v21, 0, v17
    v_exp_f32 v21, v21
    v_add_f32 v33, v33, v17
    v_pk_add_f32 v[112:113], v[112:113], v[16:17] op_sel:[0,0] op_sel_hi:[1,0] neg_lo:[0,1] neg_hi:[0,1]
    v_pk_add_f32 v[114:115], v[114:115], v[16:17] op_sel:[0,0] op_sel_hi:[1,0] neg_lo:[0,1] neg_hi:[0,1]
    v_pk_add_f32 v[116:117], v[116:117], v[16:17] op_sel:[0,0] op_sel_hi:[1,0] neg_lo:[0,1] neg_hi:[0,1]
    v_pk_add_f32 v[118:119], v[118:119], v[16:17] op_sel:[0,0] op_sel_hi:[1,0] neg_lo:[0,1] neg_hi:[0,1]
    v_pk_add_f32 v[120:121], v[120:121], v[16:17] op_sel:[0,1] op_sel_hi:[1,1] neg_lo:[0,1] neg_hi:[0,1]
    v_pk_add_f32 v[122:123], v[122:123], v[16:17] op_sel:[0,1] op_sel_hi:[1,1] neg_lo:[0,1] neg_hi:[0,1]
    v_pk_add_f32 v[124:125], v[124:125], v[16:17] op_sel:[0,1] op_sel_hi:[1,1] neg_lo:[0,1] neg_hi:[0,1]
    v_pk_add_f32 v[126:127], v[126:127], v[16:17] op_sel:[0,1] op_sel_hi:[1,1] neg_lo:[0,1] neg_hi:[0,1]
    s_bitcmp1_b32 s50, 0
    s_cbranch_scc1 L_k2_h0_nofill
    v_sub_f32 v24, 0, v32
    v_sub_f32 v25, 0, v32
    v_sub_f32 v26, 0, v32
    v_sub_f32 v27, 0, v32
    v_sub_f32 v28, 0, v33
    v_sub_f32 v29, 0, v33
    v_sub_f32 v30, 0, v33
    v_sub_f32 v31, 0, v33
L_k2_h0_nofill:
    v_pk_mul_f32 v[34:35], v[34:35], v[20:21]
    v_pk_mul_f32 v[128:129], v[128:129], v[20:21] op_sel:[0,0] op_sel_hi:[1,0]
    v_pk_mul_f32 v[130:131], v[130:131], v[20:21] op_sel:[0,0] op_sel_hi:[1,0]
    v_pk_mul_f32 v[132:133], v[132:133], v[20:21] op_sel:[0,0] op_sel_hi:[1,0]
    v_pk_mul_f32 v[134:135], v[134:135], v[20:21] op_sel:[0,0] op_sel_hi:[1,0]
    v_pk_mul_f32 v[136:137], v[136:137], v[20:21] op_sel:[0,1] op_sel_hi:[1,1]
    v_pk_mul_f32 v[138:139], v[138:139], v[20:21] op_sel:[0,1] op_sel_hi:[1,1]
    v_pk_mul_f32 v[140:141], v[140:141], v[20:21] op_sel:[0,1] op_sel_hi:[1,1]
    v_pk_mul_f32 v[142:143], v[142:143], v[20:21] op_sel:[0,1] op_sel_hi:[1,1]
    v_pk_mul_f32 v[144:145], v[144:145], v[20:21] op_sel:[0,0] op_sel_hi:[1,0]
    v_pk_mul_f32 v[146:147], v[146:147], v[20:21] op_sel:[0,0] op_sel_hi:[1,0]
    v_pk_mul_f32 v[148:149], v[148:149], v[20:21] op_sel:[0,0] op_sel_hi:[1,0]
    v_pk_mul_f32 v[150:151], v[150:151], v[20:21] op_sel:[0,0] op_sel_hi:[1,0]
    v_pk_mul_f32 v[152:153], v[152:153], v[20:21] op_sel:[0,1] op_sel_hi:[1,1]
    v_pk_mul_f32 v[154:155], v[154:155], v[20:21] op_sel:[0,1] op_sel_hi:[1,1]
    v_pk_mul_f32 v[156:157], v[156:157], v[20:21] op_sel:[0,1] op_sel_hi:[1,1]
    v_pk_mul_f32 v[158:159], v[158:159], v[20:21] op_sel:[0,1] op_sel_hi:[1,1]
    v_pk_mul_f32 v[160:161], v[160:161], v[20:21] op_sel:[0,0] op_sel_hi:[1,0]
    v_pk_mul_f32 v[162:163], v[162:163], v[20:21] op_sel:[0,0] op_sel_hi:[1,0]
    v_pk_mul_f32 v[164:165], v[164:165], v[20:21] op_sel:[0,0] op_sel_hi:[1,0]
    v_pk_mul_f32 v[166:167], v[166:167], v[20:21] op_sel:[0,0] op_sel_hi:[1,0]
    v_pk_mul_f32 v[168:169], v[168:169], v[20:21] op_sel:[0,1] op_sel_hi:[1,1]
    v_pk_mul_f32 v[170:171], v[170:171], v[20:21] op_sel:[0,1] op_sel_hi:[1,1]
    v_pk_mul_f32 v[172:173], v[172:173], v[20:21] op_sel:[0,1] op_sel_hi:[1,1]
    v_pk_mul_f32 v[174:175], v[174:175], v[20:21] op_sel:[0,1] op_sel_hi:[1,1]
    v_pk_mul_f32 v[176:177], v[176:177], v[20:21] op_sel:[0,0] op_sel_hi:[1,0]
    v_pk_mul_f32 v[178:179], v[178:179], v[20:21] op_sel:[0,0] op_sel_hi:[1,0]
    v_pk_mul_f32 v[180:181], v[180:181], v[20:21] op_sel:[0,0] op_sel_hi:[1,0]
    v_pk_mul_f32 v[182:183], v[182:183], v[20:21] op_sel:[0,0] op_sel_hi:[1,0]
    v_pk_mul_f32 v[184:185], v[184:185], v[20:21] op_sel:[0,1] op_sel_hi:[1,1]
    v_pk_mul_f32 v[186:187], v[186:187], v[20:21] op_sel:[0,1] op_sel_hi:[1,1]
    v_pk_mul_f32 v[188:189], v[188:189], v[20:21] op_sel:[0,1] op_sel_hi:[1,1]
    v_pk_mul_f32 v[190:191], v[190:191], v[20:21] op_sel:[0,1] op_sel_hi:[1,1]
    v_pk_mul_f32 v[192:193], v[192:193], v[20:21] op_sel:[0,0] op_sel_hi:[1,0]
    v_pk_mul_f32 v[194:195], v[194:195], v[20:21] op_sel:[0,0] op_sel_hi:[1,0]
    v_pk_mul_f32 v[196:197], v[196:197], v[20:21] op_sel:[0,0] op_sel_hi:[1,0]
    v_pk_mul_f32 v[198:199], v[198:199], v[20:21] op_sel:[0,0] op_sel_hi:[1,0]
    v_pk_mul_f32 v[200:201], v[200:201], v[20:21] op_sel:[0,1] op_sel_hi:[1,1]
    v_pk_mul_f32 v[202:203], v[202:203], v[20:21] op_sel:[0,1] op_sel_hi:[1,1]
    v_pk_mul_f32 v[204:205], v[204:205], v[20:21] op_sel:[0,1] op_sel_hi:[1,1]
    v_pk_mul_f32 v[206:207], v[206:207], v[20:21] op_sel:[0,1] op_sel_hi:[1,1]
    v_pk_mul_f32 v[208:209], v[208:209], v[20:21] op_sel:[0,0] op_sel_hi:[1,0]
    v_pk_mul_f32 v[210:211], v[210:211], v[20:21] op_sel:[0,0] op_sel_hi:[1,0]
    v_pk_mul_f32 v[212:213], v[212:213], v[20:21] op_sel:[0,0] op_sel_hi:[1,0]
    v_pk_mul_f32 v[214:215], v[214:215], v[20:21] op_sel:[0,0] op_sel_hi:[1,0]
    v_pk_mul_f32 v[216:217], v[216:217], v[20:21] op_sel:[0,1] op_sel_hi:[1,1]
    v_pk_mul_f32 v[218:219], v[218:219], v[20:21] op_sel:[0,1] op_sel_hi:[1,1]
    v_pk_mul_f32 v[220:221], v[220:221], v[20:21] op_sel:[0,1] op_sel_hi:[1,1]
    v_pk_mul_f32 v[222:223], v[222:223], v[20:21] op_sel:[0,1] op_sel_hi:[1,1]
    v_pk_mul_f32 v[224:225], v[224:225], v[20:21] op_sel:[0,0] op_sel_hi:[1,0]
    v_pk_mul_f32 v[226:227], v[226:227], v[20:21] op_sel:[0,0] op_sel_hi:[1,0]
    v_pk_mul_f32 v[228:229], v[228:229], v[20:21] op_sel:[0,0] op_sel_hi:[1,0]
    v_pk_mul_f32 v[230:231], v[230:231], v[20:21] op_sel:[0,0] op_sel_hi:[1,0]
    v_pk_mul_f32 v[232:233], v[232:233], v[20:21] op_sel:[0,1] op_sel_hi:[1,1]
    v_pk_mul_f32 v[234:235], v[234:235], v[20:21] op_sel:[0,1] op_sel_hi:[1,1]
    v_pk_mul_f32 v[236:237], v[236:237], v[20:21] op_sel:[0,1] op_sel_hi:[1,1]
    v_pk_mul_f32 v[238:239], v[238:239], v[20:21] op_sel:[0,1] op_sel_hi:[1,1]
    v_pk_mul_f32 v[240:241], v[240:241], v[20:21] op_sel:[0,0] op_sel_hi:[1,0]
    v_pk_mul_f32 v[242:243], v[242:243], v[20:21] op_sel:[0,0] op_sel_hi:[1,0]
    v_pk_mul_f32 v[244:245], v[244:245], v[20:21] op_sel:[0,0] op_sel_hi:[1,0]
    v_pk_mul_f32 v[246:247], v[246:247], v[20:21] op_sel:[0,0] op_sel_hi:[1,0]
    v_pk_mul_f32 v[248:249], v[248:249], v[20:21] op_sel:[0,1] op_sel_hi:[1,1]
    v_pk_mul_f32 v[250:251], v[250:251], v[20:21] op_sel:[0,1] op_sel_hi:[1,1]
    v_pk_mul_f32 v[252:253], v[252:253], v[20:21] op_sel:[0,1] op_sel_hi:[1,1]
    v_pk_mul_f32 v[254:255], v[254:255], v[20:21] op_sel:[0,1] op_sel_hi:[1,1]
    s_nop 1
    s_setpc_b64 s[98:99]
L_k2_h1_evt:
    s_bitcmp1_b64 s[82:83], s37
    s_cbranch_scc1 L_k2_h1_other
L_k2_h1_mask:
    s_lshl_b32 s52, s37, 5
    s_sub_u32 s52, s75, s52
    s_cmp_lt_i32 s52, 1
    s_cbranch_scc0 L_k2_h1_ret
    s_cmp_eq_u32 s52, 0
    s_cbranch_scc0 L_k2_h1_mk_full
    v_pk_add_f32 v[96:97], v[96:97], v[64:65]
    v_pk_add_f32 v[98:99], v[98:99], v[66:67]
    v_pk_add_f32 v[100:101], v[100:101], v[68:69]
    v_pk_add_f32 v[102:103], v[102:103], v[70:71]
    v_pk_add_f32 v[104:105], v[104:105], v[72:73]
    v_pk_add_f32 v[106:107], v[106:107], v[74:75]
    v_pk_add_f32 v[108:109], v[108:109], v[76:77]
    v_pk_add_f32 v[110:111], v[110:111], v[78:79]
    s_setpc_b64 s[98:99]
L_k2_h1_mk_full:
    v_mov_b64 v[96:97], v[58:59]
    v_mov_b64 v[98:99], v[58:59]
    v_mov_b64 v[100:101], v[58:59]
    v_mov_b64 v[102:103], v[58:59]
    v_mov_b64 v[104:105], v[58:59]
    v_mov_b64 v[106:107], v[58:59]
    v_mov_b64 v[108:109], v[58:59]
    v_mov_b64 v[110:111], v[58:59]
    s_setpc_b64 s[98:99]
L_k2_h1_ret:
    s_setpc_b64 s[98:99]
L_k2_h1_other:
    s_add_u32 s52, s37, 1
    s_cmp_eq_u32 s52, s71
    s_cselect_b32 s75, s76, s75
    s_cselect_b32 s50, 2, s50
    s_cselect_b32 s47, 0xff800000, s47
    s_add_u32 s53, s37, 5
    s_cmp_eq_u32 s73, s72
    s_cselect_b32 s73, 0, s73
    s_cmp_eq_u32 s53, s70
    s_cbranch_scc0 L_k2_h1_mask
    s_mul_i32 s53, s79, 229376
    s_add_u32 s8, s30, s53
    s_addc_u32 s9, s31, 0
    s_mov_b32 s10, 229376
    s_mov_b32 s73, 0
    s_mov_b32 s74, 14336
    s_mov_b32 s43, 14336
    s_mov_b32 s42, 28672
    s_mov_b32 s72, -1
    v_accvgpr_read_b32 v3, a252
    v_add_u32 v48, 14336, v3
    v_accvgpr_read_b32 v4, a253
    v_add_u32 v49, 14336, v4
    v_accvgpr_read_b32 v5, a254
    v_add_u32 v50, 14336, v5
    v_accvgpr_read_b32 v6, a255
    v_add_u32 v51, 14336, v6
    buffer_load_dword v15, v14, s[60:63], s84 offen sc1
    s_branch L_k2_h1_mask
L_k2_h1_resc:
    s_mov_b32 s47, 0x41c00000
    s_bitcmp1_b32 s50, 1
    s_cbranch_scc1 L_k2_h1_switch
    v_max3_f32 v16, v96, v97, v98
    v_max3_f32 v16, v16, v99, v100
    v_max3_f32 v16, v16, v101, v102
    v_max_f32 v16, v16, v103
    v_max3_f32 v17, v104, v105, v106
    v_max3_f32 v17, v17, v107, v108
    v_max3_f32 v17, v17, v109, v110
    v_max_f32 v17, v17, v111
    v_mov_b32 v18, v16
    s_nop 1
    v_permlane16_swap_b32 v16, v18
    s_nop 1
    v_max_f32 v16, v16, v18
    v_mov_b32 v18, v16
    s_nop 1
    v_permlane32_swap_b32 v16, v18
    s_nop 1
    v_max_f32 v16, v16, v18
    v_mov_b32 v18, v17
    s_nop 1
    v_permlane16_swap_b32 v17, v18
    s_nop 1
    v_max_f32 v17, v17, v18
    v_mov_b32 v18, v17
    s_nop 1
    v_permlane32_swap_b32 v17, v18
    s_nop 1
    v_max_f32 v17, v17, v18
    v_max_f32 v16, 0, v16
    v_sub_f32 v20, 0, v16
    v_exp_f32 v20, v20
    v_add_f32 v32, v32, v16
    v_max_f32 v17, 0, v17
    v_sub_f32 v21, 0, v17
    v_exp_f32 v21, v21
    v_add_f32 v33, v33, v17
    v_pk_add_f32 v[96:97], v[96:97], v[16:17] op_sel:[0,0] op_sel_hi:[1,0] neg_lo:[0,1] neg_hi:[0,1]
    v_pk_add_f32 v[98:99], v[98:99], v[16:17] op_sel:[0,0] op_sel_hi:[1,0] neg_lo:[0,1] neg_hi:[0,1]
    v_pk_add_f32 v[100:101], v[100:101], v[16:17] op_sel:[0,0] op_sel_hi:[1,0] neg_lo:[0,1] neg_hi:[0,1]
    v_pk_add_f32 v[102:103], v[102:103], v[16:17] op_sel:[0,0] op_sel_hi:[1,0] neg_lo:[0,1] neg_hi:[0,1]
    v_pk_add_f32 v[104:105], v[104:105], v[16:17] op_sel:[0,1] op_sel_hi:[1,1] neg_lo:[0,1] neg_hi:[0,1]
    v_pk_add_f32 v[106:107], v[106:107], v[16:17] op_sel:[0,1] op_sel_hi:[1,1] neg_lo:[0,1] neg_hi:[0,1]
    v_pk_add_f32 v[108:109], v[108:109], v[16:17] op_sel:[0,1] op_sel_hi:[1,1] neg_lo:[0,1] neg_hi:[0,1]
    v_pk_add_f32 v[110:111], v[110:111], v[16:17] op_sel:[0,1] op_sel_hi:[1,1] neg_lo:[0,1] neg_hi:[0,1]
    v_sub_f32 v24, 0, v32
    v_sub_f32 v25, 0, v32
    v_sub_f32 v26, 0, v32
    v_sub_f32 v27, 0, v32
    v_sub_f32 v28, 0, v33
    v_sub_f32 v29, 0, v33
    v_sub_f32 v30, 0, v33
    v_sub_f32 v31, 0, v33
    v_pk_mul_f32 v[34:35], v[34:35], v[20:21]
    v_pk_mul_f32 v[128:129], v[128:129], v[20:21] op_sel:[0,0] op_sel_hi:[1,0]
    v_pk_mul_f32 v[130:131], v[130:131], v[20:21] op_sel:[0,0] op_sel_hi:[1,0]
    v_pk_mul_f32 v[132:133], v[132:133], v[20:21] op_sel:[0,0] op_sel_hi:[1,0]
    v_pk_mul_f32 v[134:135], v[134:135], v[20:21] op_sel:[0,0] op_sel_hi:[1,0]
    v_pk_mul_f32 v[136:137], v[136:137], v[20:21] op_sel:[0,1] op_sel_hi:[1,1]
    v_pk_mul_f32 v[138:139], v[138:139], v[20:21] op_sel:[0,1] op_sel_hi:[1,1]
    v_pk_mul_f32 v[140:141], v[140:141], v[20:21] op_sel:[0,1] op_sel_hi:[1,1]
    v_pk_mul_f32 v[142:143], v[142:143], v[20:21] op_sel:[0,1] op_sel_hi:[1,1]
    v_pk_mul_f32 v[144:145], v[144:145], v[20:21] op_sel:[0,0] op_sel_hi:[1,0]
    v_pk_mul_f32 v[146:147], v[146:147], v[20:21] op_sel:[0,0] op_sel_hi:[1,0]
    v_pk_mul_f32 v[148:149], v[148:149], v[20:21] op_sel:[0,0] op_sel_hi:[1,0]
    v_pk_mul_f32 v[150:151], v[150:151], v[20:21] op_sel:[0,0] op_sel_hi:[1,0]
    v_pk_mul_f32 v[152:153], v[152:153], v[20:21] op_sel:[0,1] op_sel_hi:[1,1]
    v_pk_mul_f32 v[154:155], v[154:155], v[20:21] op_sel:[0,1] op_sel_hi:[1,1]
    v_pk_mul_f32 v[156:157], v[156:157], v[20:21] op_sel:[0,1] op_sel_hi:[1,1]
    v_pk_mul_f32 v[158:159], v[158:159], v[20:21] op_sel:[0,1] op_sel_hi:[1,1]
    v_pk_mul_f32 v[160:161], v[160:161], v[20:21] op_sel:[0,0] op_sel_hi:[1,0]
    v_pk_mul_f32 v[162:163], v[162:163], v[20:21] op_sel:[0,0] op_sel_hi:[1,0]
    v_pk_mul_f32 v[164:165], v[164:165], v[20:21] op_sel:[0,0] op_sel_hi:[1,0]
    v_pk_mul_f32 v[166:167], v[166:167], v[20:21] op_sel:[0,0] op_sel_hi:[1,0]
    v_pk_mul_f32 v[168:169], v[168:169], v[20:21] op_sel:[0,1] op_sel_hi:[1,1]
    v_pk_mul_f32 v[170:171], v[170:171], v[20:21] op_sel:[0,1] op_sel_hi:[1,1]
    v_pk_mul_f32 v[172:173], v[172:173], v[20:21] op_sel:[0,1] op_sel_hi:[1,1]
    v_pk_mul_f32 v[174:175], v[174:175], v[20:21] op_sel:[0,1] op_sel_hi:[1,1]
    v_pk_mul_f32 v[176:177], v[176:177], v[20:21] op_sel:[0,0] op_sel_hi:[1,0]
    v_pk_mul_f32 v[178:179], v[178:179], v[20:21] op_sel:[0,0] op_sel_hi:[1,0]
    v_pk_mul_f32 v[180:181], v[180:181], v[20:21] op_sel:[0,0] op_sel_hi:[1,0]
    v_pk_mul_f32 v[182:183], v[182:183], v[20:21] op_sel:[0,0] op_sel_hi:[1,0]
    v_pk_mul_f32 v[184:185], v[184:185], v[20:21] op_sel:[0,1] op_sel_hi:[1,1]
    v_pk_mul_f32 v[186:187], v[186:187], v[20:21] op_sel:[0,1] op_sel_hi:[1,1]
    v_pk_mul_f32 v[188:189], v[188:189], v[20:21] op_sel:[0,1] op_sel_hi:[1,1]
    v_pk_mul_f32 v[190:191], v[190:191], v[20:21] op_sel:[0,1] op_sel_hi:[1,1]
    v_pk_mul_f32 v[192:193], v[192:193], v[20:21] op_sel:[0,0] op_sel_hi:[1,0]
    v_pk_mul_f32 v[194:195], v[194:195], v[20:21] op_sel:[0,0] op_sel_hi:[1,0]
    v_pk_mul_f32 v[196:197], v[196:197], v[20:21] op_sel:[0,0] op_sel_hi:[1,0]
    v_pk_mul_f32 v[198:199], v[198:199], v[20:21] op_sel:[0,0] op_sel_hi:[1,0]
    v_pk_mul_f32 v[200:201], v[200:201], v[20:21] op_sel:[0,1] op_sel_hi:[1,1]
    v_pk_mul_f32 v[202:203], v[202:203], v[20:21] op_sel:[0,1] op_sel_hi:[1,1]
    v_pk_mul_f32 v[204:205], v[204:205], v[20:21] op_sel:[0,1] op_sel_hi:[1,1]
    v_pk_mul_f32 v[206:207], v[206:207], v[20:21] op_sel:[0,1] op_sel_hi:[1,1]
    v_pk_mul_f32 v[208:209], v[208:209], v[20:21] op_sel:[0,0] op_sel_hi:[1,0]
    v_pk_mul_f32 v[210:211], v[210:211], v[20:21] op_sel:[0,0] op_sel_hi:[1,0]
    v_pk_mul_f32 v[212:213], v[212:213], v[20:21] op_sel:[0,0] op_sel_hi:[1,0]
    v_pk_mul_f32 v[214:215], v[214:215], v[20:21] op_sel:[0,0] op_sel_hi:[1,0]
    v_pk_mul_f32 v[216:217], v[216:217], v[20:21] op_sel:[0,1] op_sel_hi:[1,1]
    v_pk_mul_f32 v[218:219], v[218:219], v[20:21] op_sel:[0,1] op_sel_hi:[1,1]
    v_pk_mul_f32 v[220:221], v[220:221], v[20:21] op_sel:[0,1] op_sel_hi:[1,1]
    v_pk_mul_f32 v[222:223], v[222:223], v[20:21] op_sel:[0,1] op_sel_hi:[1,1]
    v_pk_mul_f32 v[224:225], v[224:225], v[20:21] op_sel:[0,0] op_sel_hi:[1,0]
    v_pk_mul_f32 v[226:227], v[226:227], v[20:21] op_sel:[0,0] op_sel_hi:[1,0]
    v_pk_mul_f32 v[228:229], v[228:229], v[20:21] op_sel:[0,0] op_sel_hi:[1,0]
    v_pk_mul_f32 v[230:231], v[230:231], v[20:21] op_sel:[0,0] op_sel_hi:[1,0]
    v_pk_mul_f32 v[232:233], v[232:233], v[20:21] op_sel:[0,1] op_sel_hi:[1,1]
    v_pk_mul_f32 v[234:235], v[234:235], v[20:21] op_sel:[0,1] op_sel_hi:[1,1]
    v_pk_mul_f32 v[236:237], v[236:237], v[20:21] op_sel:[0,1] op_sel_hi:[1,1]
    v_pk_mul_f32 v[238:239], v[238:239], v[20:21] op_sel:[0,1] op_sel_hi:[1,1]
    v_pk_mul_f32 v[240:241], v[240:241], v[20:21] op_sel:[0,0] op_sel_hi:[1,0]
    v_pk_mul_f32 v[242:243], v[242:243], v[20:21] op_sel:[0,0] op_sel_hi:[1,0]
    v_pk_mul_f32 v[244:245], v[244:245], v[20:21] op_sel:[0,0] op_sel_hi:[1,0]
    v_pk_mul_f32 v[246:247], v[246:247], v[20:21] op_sel:[0,0] op_sel_hi:[1,0]
    v_pk_mul_f32 v[248:249], v[248:249], v[20:21] op_sel:[0,1] op_sel_hi:[1,1]
    v_pk_mul_f32 v[250:251], v[250:251], v[20:21] op_sel:[0,1] op_sel_hi:[1,1]
    v_pk_mul_f32 v[252:253], v[252:253], v[20:21] op_sel:[0,1] op_sel_hi:[1,1]
    v_pk_mul_f32 v[254:255], v[254:255], v[20:21] op_sel:[0,1] op_sel_hi:[1,1]
    s_nop 1
    s_setpc_b64 s[98:99]
L_k2_h1_switch:
    s_mov_b32 s50, 0
    v_mov_b32 v19, v34
    s_nop 1
    v_permlane16_swap_b32 v34, v19
    s_nop 1
    v_add_f32 v34, v34, v19
    v_mov_b32 v19, v34
    s_nop 1
    v_permlane32_swap_b32 v34, v19
    s_nop 1
    v_add_f32 v34, v34, v19
    v_mov_b32 v19, v35
    s_nop 1
    v_permlane16_swap_b32 v35, v19
    s_nop 1
    v_add_f32 v35, v35, v19
    v_mov_b32 v19, v35
    s_nop 1
    v_permlane32_swap_b32 v35, v19
    s_nop 1
    v_add_f32 v35, v35, v19
    s_mov_b32 s52, 16384
    buffer_store_dwordx4 v[32:35], v2, s[88:91], s52 offen sc1
    v_cvt_pk_bf16_f32 v128, v128, v129
    v_cvt_pk_bf16_f32 v129, v130, v131
    v_cvt_pk_bf16_f32 v130, v132, v133
    v_cvt_pk_bf16_f32 v131, v134, v135
    s_mov_b32 s53, 0
    buffer_store_dwordx4 v[128:131], v2, s[88:91], s53 offen offset:0 sc1
    v_mov_b64 v[132:133], 0
    v_mov_b64 v[134:135], 0
    v_cvt_pk_bf16_f32 v136, v136, v137
    v_cvt_pk_bf16_f32 v137, v138, v139
    v_cvt_pk_bf16_f32 v138, v140, v141
    v_cvt_pk_bf16_f32 v139, v142, v143
    buffer_store_dwordx4 v[136:139], v2, s[88:91], s53 offen offset:1024 sc1
    v_mov_b64 v[140:141], 0
    v_mov_b64 v[142:143], 0
    v_mov_b64 v[128:129], 0
    v_mov_b64 v[130:131], 0
    v_cvt_pk_bf16_f32 v144, v144, v145
    v_cvt_pk_bf16_f32 v145, v146, v147
    v_cvt_pk_bf16_f32 v146, v148, v149
    v_cvt_pk_bf16_f32 v147, v150, v151
    buffer_store_dwordx4 v[144:147], v2, s[88:91], s53 offen offset:2048 sc1
    v_mov_b64 v[148:149], 0
    v_mov_b64 v[150:151], 0
    v_mov_b64 v[136:137], 0
    v_mov_b64 v[138:139], 0
    v_cvt_pk_bf16_f32 v152, v152, v153
    v_cvt_pk_bf16_f32 v153, v154, v155
    v_cvt_pk_bf16_f32 v154, v156, v157
    v_cvt_pk_bf16_f32 v155, v158, v159
    buffer_store_dwordx4 v[152:155], v2, s[88:91], s53 offen offset:3072 sc1
    v_mov_b64 v[156:157], 0
    v_mov_b64 v[158:159], 0
    v_mov_b64 v[144:145], 0
    v_mov_b64 v[146:147], 0
    v_cvt_pk_bf16_f32 v160, v160, v161
    v_cvt_pk_bf16_f32 v161, v162, v163
    v_cvt_pk_bf16_f32 v162, v164, v165
    v_cvt_pk_bf16_f32 v163, v166, v167
    s_mov_b32 s53, 4096
    buffer_store_dwordx4 v[160:163], v2, s[88:91], s53 offen offset:0 sc1
    v_mov_b64 v[164:165], 0
    v_mov_b64 v[166:167], 0
    v_mov_b64 v[152:153], 0
    v_mov_b64 v[154:155], 0
    v_cvt_pk_bf16_f32 v168, v168, v169
    v_cvt_pk_bf16_f32 v169, v170, v171
    v_cvt_pk_bf16_f32 v170, v172, v173
    v_cvt_pk_bf16_f32 v171, v174, v175
    buffer_store_dwordx4 v[168:171], v2, s[88:91], s53 offen offset:1024 sc1
    v_mov_b64 v[172:173], 0
    v_mov_b64 v[174:175], 0
    v_mov_b64 v[160:161], 0
    v_mov_b64 v[162:163], 0
    v_cvt_pk_bf16_f32 v176, v176, v177
    v_cvt_pk_bf16_f32 v177, v178, v179
    v_cvt_pk_bf16_f32 v178, v180, v181
    v_cvt_pk_bf16_f32 v179, v182, v183
    buffer_store_dwordx4 v[176:179], v2, s[88:91], s53 offen offset:2048 sc1
    v_mov_b64 v[180:181], 0
    v_mov_b64 v[182:183], 0
    v_mov_b64 v[168:169], 0
    v_mov_b64 v[170:171], 0
    v_cvt_pk_bf16_f32 v184, v184, v185
    v_cvt_pk_bf16_f32 v185, v186, v187
    v_cvt_pk_bf16_f32 v186, v188, v189
    v_cvt_pk_bf16_f32 v187, v190, v191
    buffer_store_dwordx4 v[184:187], v2, s[88:91], s53 offen offset:3072 sc1
    v_mov_b64 v[188:189], 0
    v_mov_b64 v[190:191], 0
    v_mov_b64 v[176:177], 0
    v_mov_b64 v[178:179], 0
    v_cvt_pk_bf16_f32 v192, v192, v193
    v_cvt_pk_bf16_f32 v193, v194, v195
    v_cvt_pk_bf16_f32 v194, v196, v197
    v_cvt_pk_bf16_f32 v195, v198, v199
    s_mov_b32 s53, 8192
    buffer_store_dwordx4 v[192:195], v2, s[88:91], s53 offen offset:0 sc1
    v_mov_b64 v[196:197], 0
    v_mov_b64 v[198:199], 0
    v_mov_b64 v[184:185], 0
    v_mov_b64 v[186:187], 0
    v_cvt_pk_bf16_f32 v200, v200, v201
    v_cvt_pk_bf16_f32 v201, v202, v203
    v_cvt_pk_bf16_f32 v202, v204, v205
    v_cvt_pk_bf16_f32 v203, v206, v207
    buffer_store_dwordx4 v[200:203], v2, s[88:91], s53 offen offset:1024 sc1
    v_mov_b64 v[204:205], 0
    v_mov_b64 v[206:207], 0
    v_mov_b64 v[192:193], 0
    v_mov_b64 v[194:195], 0
    v_cvt_pk_bf16_f32 v208, v208, v209
    v_cvt_pk_bf16_f32 v209, v210, v211
    v_cvt_pk_bf16_f32 v210, v212, v213
    v_cvt_pk_bf16_f32 v211, v214, v215
    buffer_store_dwordx4 v[208:211], v2, s[88:91], s53 offen offset:2048 sc1
    v_mov_b64 v[212:213], 0
    v_mov_b64 v[214:215], 0
    v_mov_b64 v[200:201], 0
    v_mov_b64 v[202:203], 0
    v_cvt_pk_bf16_f32 v216, v216, v217
    v_cvt_pk_bf16_f32 v217, v218, v219
    v_cvt_pk_bf16_f32 v218, v220, v221
    v_cvt_pk_bf16_f32 v219, v222, v223
    buffer_store_dwordx4 v[216:219], v2, s[88:91], s53 offen offset:3072 sc1
    v_mov_b64 v[220:221], 0
    v_mov_b64 v[222:223], 0
    v_mov_b64 v[208:209], 0
    v_mov_b64 v[210:211], 0
    v_cvt_pk_bf16_f32 v224, v224, v225
    v_cvt_pk_bf16_f32 v225, v226, v227
    v_cvt_pk_bf16_f32 v226, v228, v229
    v_cvt_pk_bf16_f32 v227, v230, v231
    s_mov_b32 s53, 12288
    buffer_store_dwordx4 v[224:227], v2, s[88:91], s53 offen offset:0 sc1
    v_mov_b64 v[228:229], 0
    v_mov_b64 v[230:231], 0
    v_mov_b64 v[216:217], 0
    v_mov_b64 v[218:219], 0
    v_cvt_pk_bf16_f32 v232, v232, v233
    v_cvt_pk_bf16_f32 v233, v234, v235
    v_cvt_pk_bf16_f32 v234, v236, v237
    v_cvt_pk_bf16_f32 v235, v238, v239
    buffer_store_dwordx4 v[232:235], v2, s[88:91], s53 offen offset:1024 sc1
    v_mov_b64 v[236:237], 0
    v_mov_b64 v[238:239], 0
    v_mov_b64 v[224:225], 0
    v_mov_b64 v[226:227], 0
    v_cvt_pk_bf16_f32 v240, v240, v241
    v_cvt_pk_bf16_f32 v241, v242, v243
    v_cvt_pk_bf16_f32 v242, v244, v245
    v_cvt_pk_bf16_f32 v243, v246, v247
    buffer_store_dwordx4 v[240:243], v2, s[88:91], s53 offen offset:2048 sc1
    v_mov_b64 v[244:245], 0
    v_mov_b64 v[246:247], 0
    v_mov_b64 v[232:233], 0
    v_mov_b64 v[234:235], 0
    v_cvt_pk_bf16_f32 v248, v248, v249
    v_cvt_pk_bf16_f32 v249, v250, v251
    v_cvt_pk_bf16_f32 v250, v252, v253
    v_cvt_pk_bf16_f32 v251, v254, v255
    buffer_store_dwordx4 v[248:251], v2, s[88:91], s53 offen offset:3072 sc1
    v_mov_b64 v[252:253], 0
    v_mov_b64 v[254:255], 0
    v_mov_b64 v[240:241], 0
    v_mov_b64 v[242:243], 0
    v_max3_f32 v16, v96, v97, v98
    v_max3_f32 v16, v16, v99, v100
    v_max3_f32 v16, v16, v101, v102
    v_max_f32 v16, v16, v103
    v_max3_f32 v17, v104, v105, v106
    v_max3_f32 v17, v17, v107, v108
    v_max3_f32 v17, v17, v109, v110
    v_max_f32 v17, v17, v111
    v_mov_b32 v18, v16
    s_nop 1
    v_permlane16_swap_b32 v16, v18
    s_nop 1
    v_max_f32 v16, v16, v18
    v_mov_b32 v18, v16
    s_nop 1
    v_permlane32_swap_b32 v16, v18
    s_nop 1
    v_max_f32 v16, v16, v18
    v_mov_b32 v18, v17
    s_nop 1
    v_permlane16_swap_b32 v17, v18
    s_nop 1
    v_max_f32 v17, v17, v18
    v_mov_b32 v18, v17
    s_nop 1
    v_permlane32_swap_b32 v17, v18
    s_nop 1
    v_max_f32 v17, v17, v18
    v_max_f32 v32, 0xe0ad78ec, v16
    v_max_f32 v33, 0xe0ad78ec, v17
    v_mov_b64 v[34:35], 0
    v_pk_add_f32 v[96:97], v[96:97], v[32:33] op_sel:[0,0] op_sel_hi:[1,0] neg_lo:[0,1] neg_hi:[0,1]
    v_pk_add_f32 v[98:99], v[98:99], v[32:33] op_sel:[0,0] op_sel_hi:[1,0] neg_lo:[0,1] neg_hi:[0,1]
    v_pk_add_f32 v[100:101], v[100:101], v[32:33] op_sel:[0,0] op_sel_hi:[1,0] neg_lo:[0,1] neg_hi:[0,1]
    v_pk_add_f32 v[102:103], v[102:103], v[32:33] op_sel:[0,0] op_sel_hi:[1,0] neg_lo:[0,1] neg_hi:[0,1]
    v_pk_add_f32 v[104:105], v[104:105], v[32:33] op_sel:[0,1] op_sel_hi:[1,1] neg_lo:[0,1] neg_hi:[0,1]
    v_pk_add_f32 v[106:107], v[106:107], v[32:33] op_sel:[0,1] op_sel_hi:[1,1] neg_lo:[0,1] neg_hi:[0,1]
    v_pk_add_f32 v[108:109], v[108:109], v[32:33] op_sel:[0,1] op_sel_hi:[1,1] neg_lo:[0,1] neg_hi:[0,1]
    v_pk_add_f32 v[110:111], v[110:111], v[32:33] op_sel:[0,1] op_sel_hi:[1,1] neg_lo:[0,1] neg_hi:[0,1]
    v_sub_f32 v24, 0, v32
    v_sub_f32 v25, 0, v32
    v_sub_f32 v26, 0, v32
    v_sub_f32 v27, 0, v32
    v_sub_f32 v28, 0, v33
    v_sub_f32 v29, 0, v33
    v_sub_f32 v30, 0, v33
    v_sub_f32 v31, 0, v33
    v_mov_b64 v[248:249], 0
    v_mov_b64 v[250:251], 0
    s_mov_b32 s90, 0
    s_nop 1
    s_setpc_b64 s[98:99]
L_km_codeend:
    s_endpgm
.section .rodata,"a"
.p2align 6
.amdhsa_kernel k1_kernel
  .amdhsa_next_free_vgpr 512
  .amdhsa_next_free_sgpr 102
  .amdhsa_accum_offset 256
  .amdhsa_group_segment_fixed_size 0
  .amdhsa_kernarg_size 96
  .amdhsa_user_sgpr_count 2
  .amdhsa_user_sgpr_kernarg_segment_ptr 1
  .amdhsa_system_sgpr_workgroup_id_x 1
.end_amdhsa_kernel
```
